```python
import torch

def _softmax(x, axis=-1):
    return torch.softmax(x, dim=axis)

def _gelu(x):
    return torch.nn.functional.gelu(x, approximate='tanh')

def _silu(x):
    return torch.nn.functional.silu(x)

def _sigmoid(x):
    return torch.sigmoid(x)

def _layernorm(x, axis=-1, eps=1e-05):
    m = x.mean(dim=axis, keepdim=True)
    v = x.var(dim=axis, keepdim=True, unbiased=False)
    return (x - m) / torch.sqrt(v + eps)

def _scatter_add(tgt, idx, src, axis=0):
    return tgt.clone().index_add_(axis, idx, src)

def _segment_sum(src, seg, n):
    out = torch.zeros((n,) + src.shape[1:], dtype=src.dtype)
    return out.index_add_(0, seg, src)

def _pad(x, pw):
    flat = tuple((v for pair in reversed(pw) for v in pair))
    return torch.nn.functional.pad(x, flat)
kernel_name = 'concat_heads__linear_attn_block__memory_aug_recurrent_mem_tr__prompt'

def setup_inputs():

    _w = lambda a: (lambda t: t.to(torch.bfloat16) if t.is_floating_point() else t)(torch.as_tensor(a))

    def _A_setup():
        B, S, D = (1, 2048, 448)
        return {'x': _w((lambda *s: torch.randn(*s, dtype=torch.bfloat16) * 0.05)(B, S, D)), 'wqkv': _w((lambda *s: torch.randn(*s, dtype=torch.bfloat16) * 1.6)(D, 3 * D)), 'wo': _w((lambda *s: torch.randn(*s, dtype=torch.bfloat16) * 0.1)(D, D))}
    _A_in = _A_setup()

    def _B_setup():
        B, S, Dm = (1, 2048, 448)
        H, Dh = (16, 256)
        M, seg = (8, 32)
        seg = min(seg, S)
        S = S // seg * seg
        return {'x': _w((lambda *s: torch.randn(*s, dtype=torch.bfloat16) * 0.05)(B, S, Dm)), 'mem0': _w((lambda *s: torch.randn(*s, dtype=torch.bfloat16) * 0.8)(B, M, Dm)), 'Wq': _w((lambda *s: torch.randn(*s, dtype=torch.bfloat16) * 1.6)(Dm, H, Dh) * Dm ** (-0.5)), 'Wk': _w((lambda *s: torch.randn(*s, dtype=torch.bfloat16) * 1.6)(Dm, H, Dh) * Dm ** (-0.5)), 'Wv': _w((lambda *s: torch.randn(*s, dtype=torch.bfloat16) * 0.8)(Dm, H, Dh) * Dm ** (-0.5)), 'Wo': _w((lambda *s: torch.randn(*s, dtype=torch.bfloat16) * 0.8)(H, Dh, Dm) * (H * Dh) ** (-0.5)), 'seg_len': seg}
    _B_in = _B_setup()
    return {'A_x': _A_in['x'], 'A_wqkv': _A_in['wqkv'], 'A_wo': _A_in['wo'], 'B_x': _B_in['x'], 'B_mem0': _B_in['mem0'], 'B_Wq': _B_in['Wq'], 'B_Wk': _B_in['Wk'], 'B_Wv': _B_in['Wv'], 'B_Wo': _B_in['Wo'], 'B_seg_len': _B_in['seg_len']}

def reference(A_x, A_wqkv, A_wo, B_x, B_mem0, B_Wq, B_Wk, B_Wv, B_Wo, B_seg_len):

    def _A_ref(x, wqkv, wo):
        B, S, D = x.shape
        H = 16
        Dh = D // H
        qkv = (lambda x, *d: x.permute(*d))((x @ wqkv).reshape(B, S, 3, H, Dh), 2, 0, 3, 1, 4)
        q, k, v = (qkv[0], qkv[1], qkv[2])
        phi = lambda t: torch.where(t > 0, t + 1, torch.exp(t)) + 1e-06
        pq, pk = (phi(q), phi(k))
        kv = torch.einsum('bhsd,bhse->bhde', pk, v)
        z = torch.einsum('bhsd->bhd', pk)
        num = torch.einsum('bhqd,bhde->bhqe', pq, kv)
        den = torch.einsum('bhqd,bhd->bhq', pq, z)[..., None] + 1e-06
        o = num / den
        return (lambda x, *d: x.permute(*d))(o, 0, 2, 1, 3).reshape(B, S, D) @ wo

    def _B_ref(x, mem0, Wq, Wk, Wv, Wo, seg_len):
        B, S, Dm = x.shape
        H, Dh = (Wq.shape[1], Wq.shape[2])
        M = mem0.shape[1]
        scale = Dh ** (-0.5)
        n_seg = S // seg_len
        L = M + seg_len
        idx = torch.arange(L)
        mask = (idx[:, None] < M) | (idx[:, None] >= idx[None, :])
        mem = mem0
        outs = []
        for s in range(n_seg):
            xs = x[:, s * seg_len:(s + 1) * seg_len, :].clone()
            h = torch.concatenate([mem, xs], axis=1)
            q = torch.einsum('btd,dhe->bhte', h, Wq)
            k = torch.einsum('btd,dhe->bhte', h, Wk)
            v = torch.einsum('btd,dhe->bhte', h, Wv)
            scores = torch.einsum('bhqe,bhke->bhqk', q, k) * scale
            scores = torch.where(mask[None, None], scores, -1000000000.0)
            p = _softmax(scores, axis=-1)
            o = torch.einsum('bhqk,bhke->bhqe', p, v)
            o = torch.einsum('bhte,hed->btd', o, Wo)
            mem = o[:, :M, :].clone()
            outs.append(o[:, M:, :])
        return torch.concatenate(outs, axis=1)
    a = _A_ref(A_x, A_wqkv, A_wo)
    b = _B_ref(B_x, B_mem0, B_Wq, B_Wk, B_Wv, B_Wo, B_seg_len)
    return torch.concatenate([a, b], axis=-1)
```

```asm
; @launch grid=(256,1,1) block=(256,1,1) lds=148480
.amdgcn_target "amdgcn-amd-amdhsa--gfx950"
.text
.globl concat_heads__linear_attn_block__memory_aug_recurrent_mem_tr__prompt_kernel
.p2align 8
.type concat_heads__linear_attn_block__memory_aug_recurrent_mem_tr__prompt_kernel,@function
concat_heads__linear_attn_block__memory_aug_recurrent_mem_tr__prompt_kernel:
    s_cmp_lt_u32 s2, 256
    s_cbranch_scc1 Lgo_100002
    s_endpgm
Lgo_100002:
    s_getpc_b64 s[30:31]
Lcode_pc:
    s_bfe_u32 s45, s2, 0x50003
    s_lshl_b32 s45, s45, 15
    v_lshl_add_u32 v1, v0, 7, s45
    v_cmp_gt_u32 vcc, Lcode_end-Lcode_pc, v1
    s_and_saveexec_b64 s[46:47], vcc
    s_cbranch_execz Lcode_skip
    global_load_dword v238, v1, s[30:31]
Lcode_skip:
    s_mov_b64 exec, s[46:47]
    s_load_dwordx2 s[4:5], s[0:1], 96
    s_mov_b32 s6, 0x10000000
    s_mov_b32 s7, 0x00020000
    s_load_dwordx2 s[8:9], s[0:1], 24
    s_mov_b32 s10, 0x1c0000
    s_mov_b32 s11, 0x00020000
    s_load_dwordx2 s[12:13], s[0:1], 88
    s_mov_b32 s14, 0x100
    s_mov_b32 s15, 0x00020000
    s_load_dwordx2 s[48:49], s[0:1], 80
    s_mov_b32 s50, 0x380000
    s_mov_b32 s51, 0x00020000
    s_load_dwordx2 s[52:53], s[0:1], 0
    s_mov_b32 s54, 0x1c0000
    s_mov_b32 s55, 0x00020000
    s_and_b32 s37, s2, 7
    s_lshl_b32 s33, s37, 2
    s_lshr_b32 s37, s2, 6
    s_add_u32 s33, s33, s37
    s_xor_b32 s33, s33, 0
    s_load_dwordx2 s[72:73], s[0:1], 32
    s_mov_b32 s74, 0x1c00
    s_mov_b32 s75, 0x00020000
    s_cmp_ge_u32 s33, 16
    s_cbranch_scc1 LmatB_100003
    s_load_dwordx2 s[64:65], s[0:1], 40
    s_mov_b32 s66, 0x380000
    s_mov_b32 s67, 0x00020000
    s_load_dwordx2 s[68:69], s[0:1], 48
    s_mov_b32 s70, 0x380000
    s_mov_b32 s71, 0x00020000
    s_branch LmatJ_100004
LmatB_100003:
    s_load_dwordx2 s[64:65], s[0:1], 56
    s_mov_b32 s66, 0x380000
    s_mov_b32 s67, 0x00020000
    s_load_dwordx2 s[68:69], s[0:1], 64
    s_mov_b32 s70, 0x380000
    s_mov_b32 s71, 0x00020000
LmatJ_100004:
    v_lshrrev_b32 v1, 6, v0
    s_nop 0
    v_readfirstlane_b32 s16, v1
    s_getreg_b32 s44, hwreg(HW_REG_XCC_ID)
    s_sub_u32 s44, s44, 3
    s_and_b32 s44, s44, 7
    s_waitcnt lgkmcnt(0)
    s_and_b32 s34, s33, 15
    s_bfe_u32 s35, s2, 0x10005
    s_bfe_u32 s36, s2, 0x20003
    v_and_b32 v1, 63, v0
    v_lshrrev_b32 v2, 4, v1
    v_and_b32 v3, 15, v1
    v_lshlrev_b32 v8, 4, v1
    v_lshrrev_b32 v4, 3, v1
    v_and_b32 v5, 7, v1
    v_xor_b32 v5, v5, v4
    v_lshlrev_b32 v6, 13, v4
    v_lshl_add_u32 v6, v5, 4, v6
    s_mul_i32 s37, s35, 7
    s_add_u32 s37, s37, s16
    s_lshl_b32 s40, s37, 10
    s_lshl_b32 s37, s37, 18
    s_lshl_b32 s38, s34, 9
    s_add_u32 s84, s37, s38
    s_add_u32 s85, s84, 1048576
    s_cmp_eq_u32 s16, 3
    s_cselect_b32 s85, 0x40000000, s85
    s_cmp_ge_u32 s33, 16
    s_cbranch_scc1 Lpb0_100005
    s_mul_i32 s37, s36, 112
    s_lshl_b32 s39, s16, 5
    s_add_u32 s37, s37, s39
    s_lshl_b32 s37, s37, 13
    s_add_u32 s86, s37, s38
    s_mov_b32 s87, 65536
    s_mov_b32 s88, 128
    s_cmp_eq_u32 s16, 3
    s_cselect_b32 s89, 0x40000000, 0
    v_mov_b32 v7, v6
    v_mov_b32 v9, v6
    s_branch Lpb1_100006
Lpb0_100005:
    s_mul_i32 s37, s34, 229376
    s_mul_i32 s39, s36, 224
    s_add_u32 s37, s37, s39
    s_mul_i32 s39, s16, 14336
    s_add_u32 s86, s37, s39
    s_mov_b32 s87, 3584
    s_mov_b32 s88, 57344
    s_mov_b32 s89, 0
    v_lshlrev_b32 v4, 1, v2
    v_xor_b32 v4, v4, v3
    v_mul_u32_u24 v5, 896, v2
    v_lshl_add_u32 v7, v4, 4, v5
    v_xor_b32 v4, 8, v4
    v_lshl_add_u32 v9, v4, 4, v5
Lpb1_100006:
    s_lshl_b32 s56, s16, 12
    s_lshl_b32 s57, s16, 13
    s_mul_i32 s59, s34, 2
    s_add_u32 s59, s59, 1
    s_add_u32 m0, s56, 0
    s_and_b32 s60, s59, 3
    s_add_u32 s59, s59, 1
    s_mul_i32 s37, s60, s88
    s_add_u32 s37, s37, s86
    s_lshl_b32 s60, s60, 7
    s_add_u32 s61, s60, s85
    s_add_u32 s60, s60, s84
    buffer_load_dwordx4 v7, s[68:71], s37 offen lds
    s_add_u32 m0, s56, 1024
    s_add_u32 s37, s37, s87
    buffer_load_dwordx4 v7, s[68:71], s37 offen lds
    s_add_u32 m0, s56, 2048
    s_add_u32 s37, s37, s87
    s_add_u32 s37, s37, s89
    buffer_load_dwordx4 v9, s[68:71], s37 offen lds
    s_add_u32 m0, s56, 3072
    s_add_u32 s37, s37, s87
    buffer_load_dwordx4 v9, s[68:71], s37 offen lds
    s_add_u32 m0, s57, 16384
    s_add_u32 s37, s60, 0
    buffer_load_dwordx4 v6, s[64:67], s37 offen lds
    s_add_u32 m0, s57, 17408
    s_add_u32 s37, s60, 65536
    buffer_load_dwordx4 v6, s[64:67], s37 offen lds
    s_add_u32 m0, s57, 18432
    s_add_u32 s37, s60, 131072
    buffer_load_dwordx4 v6, s[64:67], s37 offen lds
    s_add_u32 m0, s57, 19456
    s_add_u32 s37, s60, 196608
    buffer_load_dwordx4 v6, s[64:67], s37 offen lds
    s_add_u32 m0, s57, 20480
    s_add_u32 s37, s61, 0
    buffer_load_dwordx4 v6, s[64:67], s37 offen lds
    s_add_u32 m0, s57, 21504
    s_add_u32 s37, s61, 65536
    buffer_load_dwordx4 v6, s[64:67], s37 offen lds
    s_add_u32 m0, s57, 22528
    s_add_u32 s37, s61, 131072
    buffer_load_dwordx4 v6, s[64:67], s37 offen lds
    s_add_u32 m0, s57, 23552
    s_add_u32 s37, s61, 196608
    buffer_load_dwordx4 v6, s[64:67], s37 offen lds
    s_add_u32 m0, s56, 49152
    s_and_b32 s60, s59, 3
    s_add_u32 s59, s59, 1
    s_mul_i32 s37, s60, s88
    s_add_u32 s37, s37, s86
    s_lshl_b32 s60, s60, 7
    s_add_u32 s61, s60, s85
    s_add_u32 s60, s60, s84
    buffer_load_dwordx4 v7, s[68:71], s37 offen lds
    s_add_u32 m0, s56, 50176
    s_add_u32 s37, s37, s87
    buffer_load_dwordx4 v7, s[68:71], s37 offen lds
    s_add_u32 m0, s56, 51200
    s_add_u32 s37, s37, s87
    s_add_u32 s37, s37, s89
    buffer_load_dwordx4 v9, s[68:71], s37 offen lds
    s_add_u32 m0, s56, 52224
    s_add_u32 s37, s37, s87
    buffer_load_dwordx4 v9, s[68:71], s37 offen lds
    s_add_u32 m0, s57, 65536
    s_add_u32 s37, s60, 0
    buffer_load_dwordx4 v6, s[64:67], s37 offen lds
    s_add_u32 m0, s57, 66560
    s_add_u32 s37, s60, 65536
    buffer_load_dwordx4 v6, s[64:67], s37 offen lds
    s_add_u32 m0, s57, 67584
    s_add_u32 s37, s60, 131072
    buffer_load_dwordx4 v6, s[64:67], s37 offen lds
    s_add_u32 m0, s57, 68608
    s_add_u32 s37, s60, 196608
    buffer_load_dwordx4 v6, s[64:67], s37 offen lds
    s_add_u32 m0, s57, 69632
    s_add_u32 s37, s61, 0
    buffer_load_dwordx4 v6, s[64:67], s37 offen lds
    s_add_u32 m0, s57, 70656
    s_add_u32 s37, s61, 65536
    buffer_load_dwordx4 v6, s[64:67], s37 offen lds
    s_add_u32 m0, s57, 71680
    s_add_u32 s37, s61, 131072
    buffer_load_dwordx4 v6, s[64:67], s37 offen lds
    s_add_u32 m0, s57, 72704
    s_add_u32 s37, s61, 196608
    buffer_load_dwordx4 v6, s[64:67], s37 offen lds
    s_lshl_b32 s42, s2, 2
    s_add_u32 s42, s42, s16
    v_lshrrev_b32 v4, 1, v3
    v_mul_u32_u24 v5, 896, v4
    v_lshl_add_u32 v5, v2, 5, v5
    v_and_b32 v4, 1, v3
    v_lshl_add_u32 v5, v4, 2, v5
    s_lshl_b32 s37, s2, 7
    s_lshl_b32 s41, s2, 10
    s_add_u32 s41, s41, 0x2a00000
    s_cmp_lt_u32 s2, 7
    s_cselect_b32 s41, s41, 0x40000000
    s_cmp_eq_u32 s16, 3
    s_cselect_b32 s41, s41, 0x40000000
    buffer_load_dword v216, v5, s[72:75], s37 offen offset:0
    buffer_load_dword v217, v5, s[72:75], s37 offen offset:8
    buffer_load_dword v218, v5, s[72:75], s37 offen offset:16
    buffer_load_dword v219, v5, s[72:75], s37 offen offset:24
    v_lshrrev_b32 v237, 3, v1
    v_lshlrev_b32 v237, 8, v237
    v_and_b32 v4, 7, v1
    v_lshl_add_u32 v237, v4, 2, v237
    s_mov_b32 s37, 0x3d40000
    s_mov_b32 s38, 0x3d41000
    buffer_load_dword v232, v237, s[4:7], s37 offen offset:0 sc1
    buffer_load_dword v233, v237, s[4:7], s37 offen offset:2048 sc1
    buffer_load_dword v234, v237, s[4:7], s38 offen offset:0 sc1
    buffer_load_dword v235, v237, s[4:7], s38 offen offset:2048 sc1
    s_lshl_b32 s63, s33, 8
    s_bfe_u32 s37, s2, 0x30003
    s_lshl_b32 s37, s37, 2
    s_add_u32 s63, s63, s37
    s_add_u32 s63, s63, 0x3d40000
    buffer_load_dword v236, off, s[4:7], s63 sc1
    v_lshrrev_b32 v4, 2, v3
    v_lshlrev_b32 v10, 10, v4
    v_and_b32 v4, 3, v3
    v_lshl_add_u32 v10, v4, 7, v10
    v_xor_b32 v4, v4, v2
    v_lshl_add_u32 v10, v4, 4, v10
    s_lshl_b32 s37, s16, 13
    s_add_u32 s37, s37, 16384
    v_add_u32 v10, s37, v10
    v_mov_b32 v208, -1
    v_mov_b32 v212, 0
    v_mov_b32 v209, -1
    v_mov_b32 v213, 0
    v_mov_b32 v210, -1
    v_mov_b32 v214, 0
    v_mov_b32 v211, -1
    v_mov_b32 v215, 0
    s_mul_i32 s37, s34, 28
    s_mul_i32 s38, s36, 7
    s_add_u32 s37, s37, s38
    s_mul_i32 s37, s37, 14336
    s_add_u32 s40, s40, s37
    s_cmp_ge_u32 s33, 16
    s_cselect_b32 s37, 0x700000, 0x0
    s_add_u32 s40, s40, s37
    s_add_u32 s39, s40, 4096
    s_cmp_eq_u32 s16, 3
    s_cselect_b32 s39, 0x40000000, s39
    s_cmp_ge_u32 s33, 16
    s_cbranch_scc1 Lpb2_100007
    v_and_b32 v4, 7, v3
    v_xor_b32 v4, v4, v2
    v_lshlrev_b32 v5, 7, v3
    v_lshl_add_u32 v200, v4, 4, v5
    v_xor_b32 v201, 64, v200
    s_mov_b32 s62, 0x3db8aa3b
    s_waitcnt vmcnt(21)
    s_barrier
    v_add_u32 v12, 0, v10
    v_add_u32 v224, 0, v200
    v_add_u32 v225, 0, v201
    ds_read_b128 v[128:131], v12 offset:0
    ds_read_b128 v[132:135], v12 offset:64
    ds_read_b128 v[136:139], v12 offset:576
    ds_read_b128 v[140:143], v12 offset:512
    ds_read_b128 v[144:147], v12 offset:4096
    ds_read_b128 v[148:151], v12 offset:4160
    ds_read_b128 v[152:155], v12 offset:4672
    ds_read_b128 v[156:159], v12 offset:4608
    ds_read_b128 v[160:163], v224 offset:0
    ds_read_b128 v[164:167], v225 offset:0
    ds_read_b128 v[168:171], v224 offset:2048
    ds_read_b128 v[172:175], v225 offset:2048
    s_waitcnt lgkmcnt(3)
    v_mfma_f32_16x16x32_bf16 v[16:19], v[128:131], v[160:163], 0
    s_add_u32 m0, s56, 98304
    s_and_b32 s60, s59, 3
    s_add_u32 s59, s59, 1
    s_mul_i32 s37, s60, s88
    s_add_u32 s37, s37, s86
    s_lshl_b32 s60, s60, 7
    s_add_u32 s61, s60, s85
    s_add_u32 s60, s60, s84
    buffer_load_dwordx4 v7, s[68:71], s37 offen lds
    v_mfma_f32_16x16x32_bf16 v[20:23], v[136:139], v[160:163], 0
    v_mfma_f32_16x16x32_bf16 v[24:27], v[144:147], v[160:163], 0
    v_mfma_f32_16x16x32_bf16 v[28:31], v[152:155], v[160:163], 0
    ds_read_b128 v[160:163], v224 offset:4096
    s_waitcnt lgkmcnt(3)
    v_mfma_f32_16x16x32_bf16 v[16:19], v[132:135], v[164:167], v[16:19]
    s_add_u32 m0, s56, 99328
    s_add_u32 s37, s37, s87
    buffer_load_dwordx4 v7, s[68:71], s37 offen lds
    v_mfma_f32_16x16x32_bf16 v[20:23], v[140:143], v[164:167], v[20:23]
    v_mfma_f32_16x16x32_bf16 v[24:27], v[148:151], v[164:167], v[24:27]
    v_mfma_f32_16x16x32_bf16 v[28:31], v[156:159], v[164:167], v[28:31]
    ds_read_b128 v[164:167], v225 offset:4096
    s_waitcnt lgkmcnt(3)
    v_mfma_f32_16x16x32_bf16 v[32:35], v[128:131], v[168:171], 0
    s_add_u32 m0, s56, 100352
    s_add_u32 s37, s37, s87
    s_add_u32 s37, s37, s89
    buffer_load_dwordx4 v9, s[68:71], s37 offen lds
    v_mfma_f32_16x16x32_bf16 v[36:39], v[136:139], v[168:171], 0
    v_mfma_f32_16x16x32_bf16 v[40:43], v[144:147], v[168:171], 0
    v_mfma_f32_16x16x32_bf16 v[44:47], v[152:155], v[168:171], 0
    ds_read_b128 v[168:171], v224 offset:6144
    s_waitcnt lgkmcnt(3)
    v_mfma_f32_16x16x32_bf16 v[32:35], v[132:135], v[172:175], v[32:35]
    s_add_u32 m0, s56, 101376
    s_add_u32 s37, s37, s87
    buffer_load_dwordx4 v9, s[68:71], s37 offen lds
    v_mfma_f32_16x16x32_bf16 v[36:39], v[140:143], v[172:175], v[36:39]
    v_mfma_f32_16x16x32_bf16 v[40:43], v[148:151], v[172:175], v[40:43]
    v_mfma_f32_16x16x32_bf16 v[44:47], v[156:159], v[172:175], v[44:47]
    ds_read_b128 v[172:175], v225 offset:6144
    s_waitcnt lgkmcnt(3)
    v_mfma_f32_16x16x32_bf16 v[48:51], v[128:131], v[160:163], 0
    s_add_u32 m0, s57, 114688
    s_add_u32 s37, s60, 0
    buffer_load_dwordx4 v6, s[64:67], s37 offen lds
    v_mfma_f32_16x16x32_bf16 v[52:55], v[136:139], v[160:163], 0
    v_mfma_f32_16x16x32_bf16 v[56:59], v[144:147], v[160:163], 0
    v_mfma_f32_16x16x32_bf16 v[60:63], v[152:155], v[160:163], 0
    ds_read_b128 v[160:163], v224 offset:8192
    s_waitcnt lgkmcnt(3)
    v_mfma_f32_16x16x32_bf16 v[48:51], v[132:135], v[164:167], v[48:51]
    s_add_u32 m0, s57, 115712
    s_add_u32 s37, s60, 65536
    buffer_load_dwordx4 v6, s[64:67], s37 offen lds
    v_mfma_f32_16x16x32_bf16 v[52:55], v[140:143], v[164:167], v[52:55]
    v_mfma_f32_16x16x32_bf16 v[56:59], v[148:151], v[164:167], v[56:59]
    v_mfma_f32_16x16x32_bf16 v[60:63], v[156:159], v[164:167], v[60:63]
    ds_read_b128 v[164:167], v225 offset:8192
    s_waitcnt lgkmcnt(3)
    v_mfma_f32_16x16x32_bf16 v[64:67], v[128:131], v[168:171], 0
    s_add_u32 m0, s57, 116736
    s_add_u32 s37, s60, 131072
    buffer_load_dwordx4 v6, s[64:67], s37 offen lds
    v_mfma_f32_16x16x32_bf16 v[68:71], v[136:139], v[168:171], 0
    v_mfma_f32_16x16x32_bf16 v[72:75], v[144:147], v[168:171], 0
    v_mfma_f32_16x16x32_bf16 v[76:79], v[152:155], v[168:171], 0
    ds_read_b128 v[168:171], v224 offset:10240
    s_waitcnt lgkmcnt(3)
    v_mfma_f32_16x16x32_bf16 v[64:67], v[132:135], v[172:175], v[64:67]
    s_add_u32 m0, s57, 117760
    s_add_u32 s37, s60, 196608
    buffer_load_dwordx4 v6, s[64:67], s37 offen lds
    v_mfma_f32_16x16x32_bf16 v[68:71], v[140:143], v[172:175], v[68:71]
    v_mfma_f32_16x16x32_bf16 v[72:75], v[148:151], v[172:175], v[72:75]
    v_mfma_f32_16x16x32_bf16 v[76:79], v[156:159], v[172:175], v[76:79]
    ds_read_b128 v[172:175], v225 offset:10240
    s_waitcnt lgkmcnt(3)
    v_mfma_f32_16x16x32_bf16 v[80:83], v[128:131], v[160:163], 0
    s_add_u32 m0, s57, 118784
    s_add_u32 s37, s61, 0
    buffer_load_dwordx4 v6, s[64:67], s37 offen lds
    v_mfma_f32_16x16x32_bf16 v[84:87], v[136:139], v[160:163], 0
    v_mfma_f32_16x16x32_bf16 v[88:91], v[144:147], v[160:163], 0
    v_mfma_f32_16x16x32_bf16 v[92:95], v[152:155], v[160:163], 0
    ds_read_b128 v[160:163], v224 offset:12288
    s_waitcnt lgkmcnt(3)
    v_mfma_f32_16x16x32_bf16 v[80:83], v[132:135], v[164:167], v[80:83]
    s_add_u32 m0, s57, 119808
    s_add_u32 s37, s61, 65536
    buffer_load_dwordx4 v6, s[64:67], s37 offen lds
    v_mfma_f32_16x16x32_bf16 v[84:87], v[140:143], v[164:167], v[84:87]
    v_mfma_f32_16x16x32_bf16 v[88:91], v[148:151], v[164:167], v[88:91]
    v_mfma_f32_16x16x32_bf16 v[92:95], v[156:159], v[164:167], v[92:95]
    ds_read_b128 v[164:167], v225 offset:12288
    s_waitcnt lgkmcnt(3)
    v_mfma_f32_16x16x32_bf16 v[96:99], v[128:131], v[168:171], 0
    s_add_u32 m0, s57, 120832
    s_add_u32 s37, s61, 131072
    buffer_load_dwordx4 v6, s[64:67], s37 offen lds
    v_mfma_f32_16x16x32_bf16 v[100:103], v[136:139], v[168:171], 0
    v_mfma_f32_16x16x32_bf16 v[104:107], v[144:147], v[168:171], 0
    v_mfma_f32_16x16x32_bf16 v[108:111], v[152:155], v[168:171], 0
    s_waitcnt lgkmcnt(2)
    v_mfma_f32_16x16x32_bf16 v[96:99], v[132:135], v[172:175], v[96:99]
    s_add_u32 m0, s57, 121856
    s_add_u32 s37, s61, 196608
    buffer_load_dwordx4 v6, s[64:67], s37 offen lds
    v_mfma_f32_16x16x32_bf16 v[100:103], v[140:143], v[172:175], v[100:103]
    v_mfma_f32_16x16x32_bf16 v[104:107], v[148:151], v[172:175], v[104:107]
    v_mfma_f32_16x16x32_bf16 v[108:111], v[156:159], v[172:175], v[108:111]
    s_waitcnt lgkmcnt(1)
    v_mfma_f32_16x16x32_bf16 v[112:115], v[128:131], v[160:163], 0
    v_mfma_f32_16x16x32_bf16 v[116:119], v[136:139], v[160:163], 0
    v_mfma_f32_16x16x32_bf16 v[120:123], v[144:147], v[160:163], 0
    v_mfma_f32_16x16x32_bf16 v[124:127], v[152:155], v[160:163], 0
    s_waitcnt lgkmcnt(0)
    v_mfma_f32_16x16x32_bf16 v[112:115], v[132:135], v[164:167], v[112:115]
    v_mfma_f32_16x16x32_bf16 v[116:119], v[140:143], v[164:167], v[116:119]
    v_mfma_f32_16x16x32_bf16 v[120:123], v[148:151], v[164:167], v[120:123]
    v_mfma_f32_16x16x32_bf16 v[124:127], v[156:159], v[164:167], v[124:127]
    s_waitcnt vmcnt(12)
    s_barrier
    v_add_u32 v12, 49152, v10
    v_add_u32 v224, 49152, v200
    v_add_u32 v225, 49152, v201
    ds_read_b128 v[128:131], v12 offset:0
    ds_read_b128 v[132:135], v12 offset:64
    ds_read_b128 v[136:139], v12 offset:576
    ds_read_b128 v[140:143], v12 offset:512
    ds_read_b128 v[144:147], v12 offset:4096
    ds_read_b128 v[148:151], v12 offset:4160
    ds_read_b128 v[152:155], v12 offset:4672
    ds_read_b128 v[156:159], v12 offset:4608
    ds_read_b128 v[160:163], v224 offset:0
    ds_read_b128 v[164:167], v225 offset:0
    ds_read_b128 v[168:171], v224 offset:2048
    ds_read_b128 v[172:175], v225 offset:2048
    s_waitcnt lgkmcnt(3)
    v_mfma_f32_16x16x32_bf16 v[16:19], v[128:131], v[160:163], v[16:19]
    s_add_u32 m0, s56, 0
    s_and_b32 s60, s59, 3
    s_add_u32 s59, s59, 1
    s_mul_i32 s37, s60, s88
    s_add_u32 s37, s37, s86
    s_lshl_b32 s60, s60, 7
    s_add_u32 s61, s60, s85
    s_add_u32 s60, s60, s84
    buffer_load_dwordx4 v7, s[68:71], s37 offen lds
    v_mfma_f32_16x16x32_bf16 v[20:23], v[136:139], v[160:163], v[20:23]
    v_mfma_f32_16x16x32_bf16 v[24:27], v[144:147], v[160:163], v[24:27]
    v_mfma_f32_16x16x32_bf16 v[28:31], v[152:155], v[160:163], v[28:31]
    ds_read_b128 v[160:163], v224 offset:4096
    s_waitcnt lgkmcnt(3)
    v_mfma_f32_16x16x32_bf16 v[16:19], v[132:135], v[164:167], v[16:19]
    s_add_u32 m0, s56, 1024
    s_add_u32 s37, s37, s87
    buffer_load_dwordx4 v7, s[68:71], s37 offen lds
    v_mfma_f32_16x16x32_bf16 v[20:23], v[140:143], v[164:167], v[20:23]
    v_mfma_f32_16x16x32_bf16 v[24:27], v[148:151], v[164:167], v[24:27]
    v_mfma_f32_16x16x32_bf16 v[28:31], v[156:159], v[164:167], v[28:31]
    ds_read_b128 v[164:167], v225 offset:4096
    s_waitcnt lgkmcnt(3)
    v_mfma_f32_16x16x32_bf16 v[32:35], v[128:131], v[168:171], v[32:35]
    s_add_u32 m0, s56, 2048
    s_add_u32 s37, s37, s87
    s_add_u32 s37, s37, s89
    buffer_load_dwordx4 v9, s[68:71], s37 offen lds
    v_mfma_f32_16x16x32_bf16 v[36:39], v[136:139], v[168:171], v[36:39]
    v_mfma_f32_16x16x32_bf16 v[40:43], v[144:147], v[168:171], v[40:43]
    v_mfma_f32_16x16x32_bf16 v[44:47], v[152:155], v[168:171], v[44:47]
    ds_read_b128 v[168:171], v224 offset:6144
    s_waitcnt lgkmcnt(3)
    v_mfma_f32_16x16x32_bf16 v[32:35], v[132:135], v[172:175], v[32:35]
    s_add_u32 m0, s56, 3072
    s_add_u32 s37, s37, s87
    buffer_load_dwordx4 v9, s[68:71], s37 offen lds
    v_mfma_f32_16x16x32_bf16 v[36:39], v[140:143], v[172:175], v[36:39]
    v_mfma_f32_16x16x32_bf16 v[40:43], v[148:151], v[172:175], v[40:43]
    v_mfma_f32_16x16x32_bf16 v[44:47], v[156:159], v[172:175], v[44:47]
    ds_read_b128 v[172:175], v225 offset:6144
    s_waitcnt lgkmcnt(3)
    v_mfma_f32_16x16x32_bf16 v[48:51], v[128:131], v[160:163], v[48:51]
    s_add_u32 m0, s57, 16384
    s_add_u32 s37, s60, 0
    buffer_load_dwordx4 v6, s[64:67], s37 offen lds
    v_mfma_f32_16x16x32_bf16 v[52:55], v[136:139], v[160:163], v[52:55]
    v_mfma_f32_16x16x32_bf16 v[56:59], v[144:147], v[160:163], v[56:59]
    v_mfma_f32_16x16x32_bf16 v[60:63], v[152:155], v[160:163], v[60:63]
    ds_read_b128 v[160:163], v224 offset:8192
    s_waitcnt lgkmcnt(3)
    v_mfma_f32_16x16x32_bf16 v[48:51], v[132:135], v[164:167], v[48:51]
    s_add_u32 m0, s57, 17408
    s_add_u32 s37, s60, 65536
    buffer_load_dwordx4 v6, s[64:67], s37 offen lds
    v_mfma_f32_16x16x32_bf16 v[52:55], v[140:143], v[164:167], v[52:55]
    v_mfma_f32_16x16x32_bf16 v[56:59], v[148:151], v[164:167], v[56:59]
    v_mfma_f32_16x16x32_bf16 v[60:63], v[156:159], v[164:167], v[60:63]
    ds_read_b128 v[164:167], v225 offset:8192
    s_waitcnt lgkmcnt(3)
    v_mfma_f32_16x16x32_bf16 v[64:67], v[128:131], v[168:171], v[64:67]
    s_add_u32 m0, s57, 18432
    s_add_u32 s37, s60, 131072
    buffer_load_dwordx4 v6, s[64:67], s37 offen lds
    v_mfma_f32_16x16x32_bf16 v[68:71], v[136:139], v[168:171], v[68:71]
    v_mfma_f32_16x16x32_bf16 v[72:75], v[144:147], v[168:171], v[72:75]
    v_mfma_f32_16x16x32_bf16 v[76:79], v[152:155], v[168:171], v[76:79]
    ds_read_b128 v[168:171], v224 offset:10240
    s_waitcnt lgkmcnt(3)
    v_mfma_f32_16x16x32_bf16 v[64:67], v[132:135], v[172:175], v[64:67]
    s_add_u32 m0, s57, 19456
    s_add_u32 s37, s60, 196608
    buffer_load_dwordx4 v6, s[64:67], s37 offen lds
    v_mfma_f32_16x16x32_bf16 v[68:71], v[140:143], v[172:175], v[68:71]
    v_mfma_f32_16x16x32_bf16 v[72:75], v[148:151], v[172:175], v[72:75]
    v_mfma_f32_16x16x32_bf16 v[76:79], v[156:159], v[172:175], v[76:79]
    ds_read_b128 v[172:175], v225 offset:10240
    s_waitcnt lgkmcnt(3)
    v_mfma_f32_16x16x32_bf16 v[80:83], v[128:131], v[160:163], v[80:83]
    s_add_u32 m0, s57, 20480
    s_add_u32 s37, s61, 0
    buffer_load_dwordx4 v6, s[64:67], s37 offen lds
    v_mfma_f32_16x16x32_bf16 v[84:87], v[136:139], v[160:163], v[84:87]
    v_mfma_f32_16x16x32_bf16 v[88:91], v[144:147], v[160:163], v[88:91]
    v_mfma_f32_16x16x32_bf16 v[92:95], v[152:155], v[160:163], v[92:95]
    ds_read_b128 v[160:163], v224 offset:12288
    s_waitcnt lgkmcnt(3)
    v_mfma_f32_16x16x32_bf16 v[80:83], v[132:135], v[164:167], v[80:83]
    s_add_u32 m0, s57, 21504
    s_add_u32 s37, s61, 65536
    buffer_load_dwordx4 v6, s[64:67], s37 offen lds
    v_mfma_f32_16x16x32_bf16 v[84:87], v[140:143], v[164:167], v[84:87]
    v_mfma_f32_16x16x32_bf16 v[88:91], v[148:151], v[164:167], v[88:91]
    v_mfma_f32_16x16x32_bf16 v[92:95], v[156:159], v[164:167], v[92:95]
    ds_read_b128 v[164:167], v225 offset:12288
    s_waitcnt lgkmcnt(3)
    v_mfma_f32_16x16x32_bf16 v[96:99], v[128:131], v[168:171], v[96:99]
    s_add_u32 m0, s57, 22528
    s_add_u32 s37, s61, 131072
    buffer_load_dwordx4 v6, s[64:67], s37 offen lds
    v_mfma_f32_16x16x32_bf16 v[100:103], v[136:139], v[168:171], v[100:103]
    v_mfma_f32_16x16x32_bf16 v[104:107], v[144:147], v[168:171], v[104:107]
    v_mfma_f32_16x16x32_bf16 v[108:111], v[152:155], v[168:171], v[108:111]
    s_waitcnt lgkmcnt(2)
    v_mfma_f32_16x16x32_bf16 v[96:99], v[132:135], v[172:175], v[96:99]
    s_add_u32 m0, s57, 23552
    s_add_u32 s37, s61, 196608
    buffer_load_dwordx4 v6, s[64:67], s37 offen lds
    v_mfma_f32_16x16x32_bf16 v[100:103], v[140:143], v[172:175], v[100:103]
    v_mfma_f32_16x16x32_bf16 v[104:107], v[148:151], v[172:175], v[104:107]
    v_mfma_f32_16x16x32_bf16 v[108:111], v[156:159], v[172:175], v[108:111]
    s_waitcnt lgkmcnt(1)
    v_mfma_f32_16x16x32_bf16 v[112:115], v[128:131], v[160:163], v[112:115]
    v_mfma_f32_16x16x32_bf16 v[116:119], v[136:139], v[160:163], v[116:119]
    v_mfma_f32_16x16x32_bf16 v[120:123], v[144:147], v[160:163], v[120:123]
    v_mfma_f32_16x16x32_bf16 v[124:127], v[152:155], v[160:163], v[124:127]
    s_waitcnt lgkmcnt(0)
    v_mfma_f32_16x16x32_bf16 v[112:115], v[132:135], v[164:167], v[112:115]
    v_mfma_f32_16x16x32_bf16 v[116:119], v[140:143], v[164:167], v[116:119]
    v_mfma_f32_16x16x32_bf16 v[120:123], v[148:151], v[164:167], v[120:123]
    v_mfma_f32_16x16x32_bf16 v[124:127], v[156:159], v[164:167], v[124:127]
    s_waitcnt vmcnt(12)
    s_barrier
    v_add_u32 v12, 98304, v10
    v_add_u32 v224, 98304, v200
    v_add_u32 v225, 98304, v201
    ds_read_b128 v[128:131], v12 offset:0
    ds_read_b128 v[132:135], v12 offset:64
    ds_read_b128 v[136:139], v12 offset:576
    ds_read_b128 v[140:143], v12 offset:512
    ds_read_b128 v[144:147], v12 offset:4096
    ds_read_b128 v[148:151], v12 offset:4160
    ds_read_b128 v[152:155], v12 offset:4672
    ds_read_b128 v[156:159], v12 offset:4608
    ds_read_b128 v[160:163], v224 offset:0
    ds_read_b128 v[164:167], v225 offset:0
    ds_read_b128 v[168:171], v224 offset:2048
    s_lshl_b32 s45, s44, 2
    s_cmp_eq_u32 s16, 0
    s_cselect_b32 s45, s45, 0x40000000
    v_mov_b32 v220, 1
    s_mov_b64 exec, 1
    buffer_atomic_add v220, off, s[12:15], s45 sc0
    s_mov_b64 exec, -1
    s_nop 3
    ds_read_b128 v[172:175], v225 offset:2048
    s_waitcnt lgkmcnt(3)
    v_mfma_f32_16x16x32_bf16 v[16:19], v[128:131], v[160:163], v[16:19]
    s_lshl_b32 s38, s42, 10
    s_add_u32 s38, s38, 0x2a00000
    s_sub_u32 s43, s42, 0
    s_cmp_lt_u32 s43, 7
    s_cselect_b32 s38, 0x40000000, s38
    buffer_store_dwordx4 v[208:211], v8, s[4:7], s38 offen sc1
    v_mfma_f32_16x16x32_bf16 v[20:23], v[136:139], v[160:163], v[20:23]
    v_mfma_f32_16x16x32_bf16 v[24:27], v[144:147], v[160:163], v[24:27]
    v_mfma_f32_16x16x32_bf16 v[28:31], v[152:155], v[160:163], v[28:31]
    ds_read_b128 v[160:163], v224 offset:4096
    s_waitcnt lgkmcnt(3)
    v_mfma_f32_16x16x32_bf16 v[16:19], v[132:135], v[164:167], v[16:19]
    s_lshl_b32 s38, s42, 10
    s_add_u32 s38, s38, 0x2b00000
    s_sub_u32 s43, s42, 512
    s_cmp_lt_u32 s43, 7
    s_cselect_b32 s38, 0x40000000, s38
    buffer_store_dwordx4 v[208:211], v8, s[4:7], s38 offen sc1
    v_mfma_f32_16x16x32_bf16 v[20:23], v[140:143], v[164:167], v[20:23]
    v_mfma_f32_16x16x32_bf16 v[24:27], v[148:151], v[164:167], v[24:27]
    v_mfma_f32_16x16x32_bf16 v[28:31], v[156:159], v[164:167], v[28:31]
    ds_read_b128 v[164:167], v225 offset:4096
    s_waitcnt lgkmcnt(3)
    v_mfma_f32_16x16x32_bf16 v[32:35], v[128:131], v[168:171], v[32:35]
    s_lshl_b32 s37, s42, 10
    s_add_u32 s37, s37, 0x3d00000
    s_cmp_lt_u32 s42, 192
    s_cselect_b32 s37, s37, 0x40000000
    buffer_store_dwordx4 v[212:215], v8, s[4:7], s37 offen sc1
    v_mfma_f32_16x16x32_bf16 v[36:39], v[136:139], v[168:171], v[36:39]
    v_mfma_f32_16x16x32_bf16 v[40:43], v[144:147], v[168:171], v[40:43]
    v_mfma_f32_16x16x32_bf16 v[44:47], v[152:155], v[168:171], v[44:47]
    ds_read_b128 v[168:171], v224 offset:6144
    s_waitcnt lgkmcnt(3)
    v_mfma_f32_16x16x32_bf16 v[32:35], v[132:135], v[172:175], v[32:35]
    s_sub_u32 s43, s42, 256
    s_lshl_b32 s37, s43, 10
    s_mov_b32 s38, 0x3634000
    s_cmp_lt_u32 s43, 224
    s_cselect_b32 s38, 0x33c8000, s38
    v_mfma_f32_16x16x32_bf16 v[36:39], v[140:143], v[172:175], v[36:39]
    v_mfma_f32_16x16x32_bf16 v[40:43], v[148:151], v[172:175], v[40:43]
    v_mfma_f32_16x16x32_bf16 v[44:47], v[156:159], v[172:175], v[44:47]
    ds_read_b128 v[172:175], v225 offset:6144
    s_waitcnt lgkmcnt(3)
    v_mfma_f32_16x16x32_bf16 v[48:51], v[128:131], v[160:163], v[48:51]
    s_add_u32 s37, s37, s38
    s_cmp_lt_u32 s43, 304
    s_cselect_b32 s37, s37, 0x40000000
    buffer_store_dwordx4 v[208:211], v8, s[4:7], s37 offen sc1
    v_mfma_f32_16x16x32_bf16 v[52:55], v[136:139], v[160:163], v[52:55]
    v_mfma_f32_16x16x32_bf16 v[56:59], v[144:147], v[160:163], v[56:59]
    v_mfma_f32_16x16x32_bf16 v[60:63], v[152:155], v[160:163], v[60:63]
    ds_read_b128 v[160:163], v224 offset:8192
    s_waitcnt lgkmcnt(3)
    v_mfma_f32_16x16x32_bf16 v[48:51], v[132:135], v[164:167], v[48:51]
    v_min_u32 v216, -2, v216
    v_min_u32 v217, -2, v217
    v_min_u32 v218, -2, v218
    v_min_u32 v219, -2, v219
    buffer_store_dwordx4 v[216:219], v8, s[4:7], s41 offen sc1
    v_mfma_f32_16x16x32_bf16 v[52:55], v[140:143], v[164:167], v[52:55]
    v_mfma_f32_16x16x32_bf16 v[56:59], v[148:151], v[164:167], v[56:59]
    v_mfma_f32_16x16x32_bf16 v[60:63], v[156:159], v[164:167], v[60:63]
    ds_read_b128 v[164:167], v225 offset:8192
    s_waitcnt lgkmcnt(3)
    v_mfma_f32_16x16x32_bf16 v[64:67], v[128:131], v[168:171], v[64:67]
    s_add_u32 s41, s41, 0x180000
    buffer_store_dwordx4 v[216:219], v8, s[4:7], s41 offen sc1
    v_mfma_f32_16x16x32_bf16 v[68:71], v[136:139], v[168:171], v[68:71]
    v_mfma_f32_16x16x32_bf16 v[72:75], v[144:147], v[168:171], v[72:75]
    v_mfma_f32_16x16x32_bf16 v[76:79], v[152:155], v[168:171], v[76:79]
    ds_read_b128 v[168:171], v224 offset:10240
    s_waitcnt lgkmcnt(3)
    v_mfma_f32_16x16x32_bf16 v[64:67], v[132:135], v[172:175], v[64:67]
    v_mfma_f32_16x16x32_bf16 v[68:71], v[140:143], v[172:175], v[68:71]
    v_mfma_f32_16x16x32_bf16 v[72:75], v[148:151], v[172:175], v[72:75]
    v_mfma_f32_16x16x32_bf16 v[76:79], v[156:159], v[172:175], v[76:79]
    ds_read_b128 v[172:175], v225 offset:10240
    s_waitcnt lgkmcnt(3)
    v_mfma_f32_16x16x32_bf16 v[80:83], v[128:131], v[160:163], v[80:83]
    v_mfma_f32_16x16x32_bf16 v[84:87], v[136:139], v[160:163], v[84:87]
    v_mfma_f32_16x16x32_bf16 v[88:91], v[144:147], v[160:163], v[88:91]
    v_mfma_f32_16x16x32_bf16 v[92:95], v[152:155], v[160:163], v[92:95]
    ds_read_b128 v[160:163], v224 offset:12288
    s_waitcnt lgkmcnt(3)
    v_mfma_f32_16x16x32_bf16 v[80:83], v[132:135], v[164:167], v[80:83]
    v_mfma_f32_16x16x32_bf16 v[84:87], v[140:143], v[164:167], v[84:87]
    v_mfma_f32_16x16x32_bf16 v[88:91], v[148:151], v[164:167], v[88:91]
    v_mfma_f32_16x16x32_bf16 v[92:95], v[156:159], v[164:167], v[92:95]
    ds_read_b128 v[164:167], v225 offset:12288
    s_waitcnt lgkmcnt(3)
    v_mfma_f32_16x16x32_bf16 v[96:99], v[128:131], v[168:171], v[96:99]
    v_mfma_f32_16x16x32_bf16 v[100:103], v[136:139], v[168:171], v[100:103]
    v_mfma_f32_16x16x32_bf16 v[104:107], v[144:147], v[168:171], v[104:107]
    v_mfma_f32_16x16x32_bf16 v[108:111], v[152:155], v[168:171], v[108:111]
    s_waitcnt lgkmcnt(2)
    v_mfma_f32_16x16x32_bf16 v[96:99], v[132:135], v[172:175], v[96:99]
    v_mfma_f32_16x16x32_bf16 v[100:103], v[140:143], v[172:175], v[100:103]
    v_mfma_f32_16x16x32_bf16 v[104:107], v[148:151], v[172:175], v[104:107]
    v_mfma_f32_16x16x32_bf16 v[108:111], v[156:159], v[172:175], v[108:111]
    s_waitcnt lgkmcnt(1)
    v_mfma_f32_16x16x32_bf16 v[112:115], v[128:131], v[160:163], v[112:115]
    v_mfma_f32_16x16x32_bf16 v[116:119], v[136:139], v[160:163], v[116:119]
    v_mfma_f32_16x16x32_bf16 v[120:123], v[144:147], v[160:163], v[120:123]
    v_mfma_f32_16x16x32_bf16 v[124:127], v[152:155], v[160:163], v[124:127]
    s_waitcnt lgkmcnt(0)
    v_mfma_f32_16x16x32_bf16 v[112:115], v[132:135], v[164:167], v[112:115]
    v_mfma_f32_16x16x32_bf16 v[116:119], v[140:143], v[164:167], v[116:119]
    v_mfma_f32_16x16x32_bf16 v[120:123], v[148:151], v[164:167], v[120:123]
    v_mfma_f32_16x16x32_bf16 v[124:127], v[156:159], v[164:167], v[124:127]
    s_waitcnt vmcnt(7)
    s_barrier
    v_add_u32 v12, 0, v10
    v_add_u32 v224, 0, v200
    v_add_u32 v225, 0, v201
    ds_read_b128 v[128:131], v12 offset:0
    ds_read_b128 v[132:135], v12 offset:64
    ds_read_b128 v[136:139], v12 offset:576
    ds_read_b128 v[140:143], v12 offset:512
    ds_read_b128 v[144:147], v12 offset:4096
    ds_read_b128 v[148:151], v12 offset:4160
    ds_read_b128 v[152:155], v12 offset:4672
    ds_read_b128 v[156:159], v12 offset:4608
    ds_read_b128 v[160:163], v224 offset:0
    ds_read_b128 v[164:167], v225 offset:0
    ds_read_b128 v[168:171], v224 offset:2048
    ds_read_b128 v[172:175], v225 offset:2048
    s_waitcnt lgkmcnt(3)
    v_mfma_f32_16x16x32_bf16 v[16:19], v[128:131], v[160:163], v[16:19]
    v_mfma_f32_16x16x32_bf16 v[20:23], v[136:139], v[160:163], v[20:23]
    v_mfma_f32_16x16x32_bf16 v[24:27], v[144:147], v[160:163], v[24:27]
    v_mfma_f32_16x16x32_bf16 v[28:31], v[152:155], v[160:163], v[28:31]
    ds_read_b128 v[160:163], v224 offset:4096
    s_waitcnt lgkmcnt(3)
    v_mfma_f32_16x16x32_bf16 v[16:19], v[132:135], v[164:167], v[16:19]
    v_mfma_f32_16x16x32_bf16 v[20:23], v[140:143], v[164:167], v[20:23]
    v_mfma_f32_16x16x32_bf16 v[24:27], v[148:151], v[164:167], v[24:27]
    v_mfma_f32_16x16x32_bf16 v[28:31], v[156:159], v[164:167], v[28:31]
    ds_read_b128 v[164:167], v225 offset:4096
    s_waitcnt lgkmcnt(3)
    v_mfma_f32_16x16x32_bf16 v[32:35], v[128:131], v[168:171], v[32:35]
    v_mfma_f32_16x16x32_bf16 v[36:39], v[136:139], v[168:171], v[36:39]
    v_mfma_f32_16x16x32_bf16 v[40:43], v[144:147], v[168:171], v[40:43]
    v_mfma_f32_16x16x32_bf16 v[44:47], v[152:155], v[168:171], v[44:47]
    ds_read_b128 v[168:171], v224 offset:6144
    s_waitcnt lgkmcnt(3)
    v_mfma_f32_16x16x32_bf16 v[32:35], v[132:135], v[172:175], v[32:35]
    v_mul_f32 v16, s62, v16
    v_mul_f32 v17, s62, v17
    v_mul_f32 v18, s62, v18
    v_mul_f32 v19, s62, v19
    v_mfma_f32_16x16x32_bf16 v[36:39], v[140:143], v[172:175], v[36:39]
    v_mul_f32 v20, s62, v20
    v_mul_f32 v21, s62, v21
    v_mul_f32 v22, s62, v22
    v_mul_f32 v23, s62, v23
    v_mfma_f32_16x16x32_bf16 v[40:43], v[148:151], v[172:175], v[40:43]
    v_cvt_pk_bf16_f32 v16, v16, v17
    v_cvt_pk_bf16_f32 v17, v18, v19
    v_cvt_pk_bf16_f32 v18, v20, v21
    v_cvt_pk_bf16_f32 v19, v22, v23
    v_mfma_f32_16x16x32_bf16 v[44:47], v[156:159], v[172:175], v[44:47]
    buffer_store_dwordx4 v[16:19], v8, s[4:7], s40 offen sc1
    s_add_u32 s40, s40, 14336
    v_mul_f32 v24, s62, v24
    v_mul_f32 v25, s62, v25
    ds_read_b128 v[172:175], v225 offset:6144
    s_waitcnt lgkmcnt(3)
    v_mfma_f32_16x16x32_bf16 v[48:51], v[128:131], v[160:163], v[48:51]
    v_mul_f32 v26, s62, v26
    v_mul_f32 v27, s62, v27
    v_mul_f32 v28, s62, v28
    v_mul_f32 v29, s62, v29
    v_mfma_f32_16x16x32_bf16 v[52:55], v[136:139], v[160:163], v[52:55]
    v_mul_f32 v30, s62, v30
    v_mul_f32 v31, s62, v31
    v_cvt_pk_bf16_f32 v24, v24, v25
    v_cvt_pk_bf16_f32 v25, v26, v27
    v_mfma_f32_16x16x32_bf16 v[56:59], v[144:147], v[160:163], v[56:59]
    v_cvt_pk_bf16_f32 v26, v28, v29
    v_cvt_pk_bf16_f32 v27, v30, v31
    buffer_store_dwordx4 v[24:27], v8, s[4:7], s39 offen sc1
    s_add_u32 s39, s39, 14336
    v_mfma_f32_16x16x32_bf16 v[60:63], v[152:155], v[160:163], v[60:63]
    ds_read_b128 v[160:163], v224 offset:8192
    s_waitcnt lgkmcnt(3)
    v_mfma_f32_16x16x32_bf16 v[48:51], v[132:135], v[164:167], v[48:51]
    v_mul_f32 v32, s62, v32
    v_mul_f32 v33, s62, v33
    v_mul_f32 v34, s62, v34
    v_mul_f32 v35, s62, v35
    v_mfma_f32_16x16x32_bf16 v[52:55], v[140:143], v[164:167], v[52:55]
    v_mul_f32 v36, s62, v36
    v_mul_f32 v37, s62, v37
    v_mul_f32 v38, s62, v38
    v_mul_f32 v39, s62, v39
    v_mfma_f32_16x16x32_bf16 v[56:59], v[148:151], v[164:167], v[56:59]
    v_cvt_pk_bf16_f32 v32, v32, v33
    v_cvt_pk_bf16_f32 v33, v34, v35
    v_cvt_pk_bf16_f32 v34, v36, v37
    v_cvt_pk_bf16_f32 v35, v38, v39
    v_mfma_f32_16x16x32_bf16 v[60:63], v[156:159], v[164:167], v[60:63]
    buffer_store_dwordx4 v[32:35], v8, s[4:7], s40 offen sc1
    s_add_u32 s40, s40, 14336
    v_mul_f32 v40, s62, v40
    v_mul_f32 v41, s62, v41
    ds_read_b128 v[164:167], v225 offset:8192
    s_waitcnt lgkmcnt(3)
    v_mfma_f32_16x16x32_bf16 v[64:67], v[128:131], v[168:171], v[64:67]
    v_mul_f32 v42, s62, v42
    v_mul_f32 v43, s62, v43
    v_mul_f32 v44, s62, v44
    v_mul_f32 v45, s62, v45
    v_mfma_f32_16x16x32_bf16 v[68:71], v[136:139], v[168:171], v[68:71]
    v_mul_f32 v46, s62, v46
    v_mul_f32 v47, s62, v47
    v_cvt_pk_bf16_f32 v40, v40, v41
    v_cvt_pk_bf16_f32 v41, v42, v43
    v_mfma_f32_16x16x32_bf16 v[72:75], v[144:147], v[168:171], v[72:75]
    v_cvt_pk_bf16_f32 v42, v44, v45
    v_cvt_pk_bf16_f32 v43, v46, v47
    buffer_store_dwordx4 v[40:43], v8, s[4:7], s39 offen sc1
    s_add_u32 s39, s39, 14336
    v_mfma_f32_16x16x32_bf16 v[76:79], v[152:155], v[168:171], v[76:79]
    ds_read_b128 v[168:171], v224 offset:10240
    s_waitcnt lgkmcnt(3)
    v_mfma_f32_16x16x32_bf16 v[64:67], v[132:135], v[172:175], v[64:67]
    v_mul_f32 v48, s62, v48
    v_mul_f32 v49, s62, v49
    v_mul_f32 v50, s62, v50
    v_mul_f32 v51, s62, v51
    v_mfma_f32_16x16x32_bf16 v[68:71], v[140:143], v[172:175], v[68:71]
    v_mul_f32 v52, s62, v52
    v_mul_f32 v53, s62, v53
    v_mul_f32 v54, s62, v54
    v_mul_f32 v55, s62, v55
    v_mfma_f32_16x16x32_bf16 v[72:75], v[148:151], v[172:175], v[72:75]
    v_cvt_pk_bf16_f32 v48, v48, v49
    v_cvt_pk_bf16_f32 v49, v50, v51
    v_cvt_pk_bf16_f32 v50, v52, v53
    v_cvt_pk_bf16_f32 v51, v54, v55
    v_mfma_f32_16x16x32_bf16 v[76:79], v[156:159], v[172:175], v[76:79]
    buffer_store_dwordx4 v[48:51], v8, s[4:7], s40 offen sc1
    s_add_u32 s40, s40, 14336
    v_mul_f32 v56, s62, v56
    v_mul_f32 v57, s62, v57
    ds_read_b128 v[172:175], v225 offset:10240
    s_waitcnt lgkmcnt(3)
    v_mfma_f32_16x16x32_bf16 v[80:83], v[128:131], v[160:163], v[80:83]
    v_mul_f32 v58, s62, v58
    v_mul_f32 v59, s62, v59
    v_mul_f32 v60, s62, v60
    v_mul_f32 v61, s62, v61
    v_mfma_f32_16x16x32_bf16 v[84:87], v[136:139], v[160:163], v[84:87]
    v_mul_f32 v62, s62, v62
    v_mul_f32 v63, s62, v63
    v_cvt_pk_bf16_f32 v56, v56, v57
    v_cvt_pk_bf16_f32 v57, v58, v59
    v_mfma_f32_16x16x32_bf16 v[88:91], v[144:147], v[160:163], v[88:91]
    v_cvt_pk_bf16_f32 v58, v60, v61
    v_cvt_pk_bf16_f32 v59, v62, v63
    buffer_store_dwordx4 v[56:59], v8, s[4:7], s39 offen sc1
    s_add_u32 s39, s39, 14336
    v_mfma_f32_16x16x32_bf16 v[92:95], v[152:155], v[160:163], v[92:95]
    ds_read_b128 v[160:163], v224 offset:12288
    s_waitcnt lgkmcnt(3)
    v_mfma_f32_16x16x32_bf16 v[80:83], v[132:135], v[164:167], v[80:83]
    v_mul_f32 v64, s62, v64
    v_mul_f32 v65, s62, v65
    v_mul_f32 v66, s62, v66
    v_mul_f32 v67, s62, v67
    v_mfma_f32_16x16x32_bf16 v[84:87], v[140:143], v[164:167], v[84:87]
    v_mul_f32 v68, s62, v68
    v_mul_f32 v69, s62, v69
    v_mul_f32 v70, s62, v70
    v_mul_f32 v71, s62, v71
    v_mfma_f32_16x16x32_bf16 v[88:91], v[148:151], v[164:167], v[88:91]
    v_cvt_pk_bf16_f32 v64, v64, v65
    v_cvt_pk_bf16_f32 v65, v66, v67
    v_cvt_pk_bf16_f32 v66, v68, v69
    v_cvt_pk_bf16_f32 v67, v70, v71
    v_mfma_f32_16x16x32_bf16 v[92:95], v[156:159], v[164:167], v[92:95]
    buffer_store_dwordx4 v[64:67], v8, s[4:7], s40 offen sc1
    s_add_u32 s40, s40, 14336
    v_mul_f32 v72, s62, v72
    v_mul_f32 v73, s62, v73
    ds_read_b128 v[164:167], v225 offset:12288
    s_waitcnt lgkmcnt(3)
    v_mfma_f32_16x16x32_bf16 v[96:99], v[128:131], v[168:171], v[96:99]
    v_mul_f32 v74, s62, v74
    v_mul_f32 v75, s62, v75
    v_mul_f32 v76, s62, v76
    v_mul_f32 v77, s62, v77
    v_mfma_f32_16x16x32_bf16 v[100:103], v[136:139], v[168:171], v[100:103]
    v_mul_f32 v78, s62, v78
    v_mul_f32 v79, s62, v79
    v_cvt_pk_bf16_f32 v72, v72, v73
    v_cvt_pk_bf16_f32 v73, v74, v75
    v_mfma_f32_16x16x32_bf16 v[104:107], v[144:147], v[168:171], v[104:107]
    v_cvt_pk_bf16_f32 v74, v76, v77
    v_cvt_pk_bf16_f32 v75, v78, v79
    buffer_store_dwordx4 v[72:75], v8, s[4:7], s39 offen sc1
    s_add_u32 s39, s39, 14336
    v_mfma_f32_16x16x32_bf16 v[108:111], v[152:155], v[168:171], v[108:111]
    s_waitcnt lgkmcnt(2)
    v_mfma_f32_16x16x32_bf16 v[96:99], v[132:135], v[172:175], v[96:99]
    v_mul_f32 v80, s62, v80
    v_mul_f32 v81, s62, v81
    v_mul_f32 v82, s62, v82
    v_mul_f32 v83, s62, v83
    v_mfma_f32_16x16x32_bf16 v[100:103], v[140:143], v[172:175], v[100:103]
    v_mul_f32 v84, s62, v84
    v_mul_f32 v85, s62, v85
    v_mul_f32 v86, s62, v86
    v_mul_f32 v87, s62, v87
    v_mfma_f32_16x16x32_bf16 v[104:107], v[148:151], v[172:175], v[104:107]
    v_cvt_pk_bf16_f32 v80, v80, v81
    v_cvt_pk_bf16_f32 v81, v82, v83
    v_cvt_pk_bf16_f32 v82, v84, v85
    v_cvt_pk_bf16_f32 v83, v86, v87
    v_mfma_f32_16x16x32_bf16 v[108:111], v[156:159], v[172:175], v[108:111]
    buffer_store_dwordx4 v[80:83], v8, s[4:7], s40 offen sc1
    s_add_u32 s40, s40, 14336
    v_mul_f32 v88, s62, v88
    v_mul_f32 v89, s62, v89
    s_waitcnt lgkmcnt(1)
    v_mfma_f32_16x16x32_bf16 v[112:115], v[128:131], v[160:163], v[112:115]
    v_mul_f32 v90, s62, v90
    v_mul_f32 v91, s62, v91
    v_mul_f32 v92, s62, v92
    v_mul_f32 v93, s62, v93
    v_mfma_f32_16x16x32_bf16 v[116:119], v[136:139], v[160:163], v[116:119]
    v_mul_f32 v94, s62, v94
    v_mul_f32 v95, s62, v95
    v_cvt_pk_bf16_f32 v88, v88, v89
    v_cvt_pk_bf16_f32 v89, v90, v91
    v_mfma_f32_16x16x32_bf16 v[120:123], v[144:147], v[160:163], v[120:123]
    v_cvt_pk_bf16_f32 v90, v92, v93
    v_cvt_pk_bf16_f32 v91, v94, v95
    buffer_store_dwordx4 v[88:91], v8, s[4:7], s39 offen sc1
    s_add_u32 s39, s39, 14336
    v_mfma_f32_16x16x32_bf16 v[124:127], v[152:155], v[160:163], v[124:127]
    s_waitcnt lgkmcnt(0)
    v_mfma_f32_16x16x32_bf16 v[112:115], v[132:135], v[164:167], v[112:115]
    v_mul_f32 v96, s62, v96
    v_mul_f32 v97, s62, v97
    v_mul_f32 v98, s62, v98
    v_mul_f32 v99, s62, v99
    v_mfma_f32_16x16x32_bf16 v[116:119], v[140:143], v[164:167], v[116:119]
    v_mul_f32 v100, s62, v100
    v_mul_f32 v101, s62, v101
    v_mul_f32 v102, s62, v102
    v_mul_f32 v103, s62, v103
    v_mfma_f32_16x16x32_bf16 v[120:123], v[148:151], v[164:167], v[120:123]
    v_cvt_pk_bf16_f32 v96, v96, v97
    v_cvt_pk_bf16_f32 v97, v98, v99
    v_cvt_pk_bf16_f32 v98, v100, v101
    v_cvt_pk_bf16_f32 v99, v102, v103
    v_mfma_f32_16x16x32_bf16 v[124:127], v[156:159], v[164:167], v[124:127]
    buffer_store_dwordx4 v[96:99], v8, s[4:7], s40 offen sc1
    s_add_u32 s40, s40, 14336
    v_mul_f32 v104, s62, v104
    v_mul_f32 v105, s62, v105
    v_mul_f32 v106, s62, v106
    v_mul_f32 v107, s62, v107
    v_mul_f32 v108, s62, v108
    v_mul_f32 v109, s62, v109
    v_mul_f32 v110, s62, v110
    v_mul_f32 v111, s62, v111
    v_cvt_pk_bf16_f32 v104, v104, v105
    v_cvt_pk_bf16_f32 v105, v106, v107
    v_cvt_pk_bf16_f32 v106, v108, v109
    v_cvt_pk_bf16_f32 v107, v110, v111
    buffer_store_dwordx4 v[104:107], v8, s[4:7], s39 offen sc1
    s_add_u32 s39, s39, 14336
    s_nop 7
    v_mul_f32 v112, s62, v112
    v_mul_f32 v113, s62, v113
    v_mul_f32 v114, s62, v114
    v_mul_f32 v115, s62, v115
    v_mul_f32 v116, s62, v116
    v_mul_f32 v117, s62, v117
    v_mul_f32 v118, s62, v118
    v_mul_f32 v119, s62, v119
    v_cvt_pk_bf16_f32 v112, v112, v113
    v_cvt_pk_bf16_f32 v113, v114, v115
    v_cvt_pk_bf16_f32 v114, v116, v117
    v_cvt_pk_bf16_f32 v115, v118, v119
    buffer_store_dwordx4 v[112:115], v8, s[4:7], s40 offen sc1
    s_add_u32 s40, s40, 14336
    v_mul_f32 v120, s62, v120
    v_mul_f32 v121, s62, v121
    v_mul_f32 v122, s62, v122
    v_mul_f32 v123, s62, v123
    v_mul_f32 v124, s62, v124
    v_mul_f32 v125, s62, v125
    v_mul_f32 v126, s62, v126
    v_mul_f32 v127, s62, v127
    v_cvt_pk_bf16_f32 v120, v120, v121
    v_cvt_pk_bf16_f32 v121, v122, v123
    v_cvt_pk_bf16_f32 v122, v124, v125
    v_cvt_pk_bf16_f32 v123, v126, v127
    buffer_store_dwordx4 v[120:123], v8, s[4:7], s39 offen sc1
    s_add_u32 s39, s39, 14336
    s_branch Lpb3_100008
Lpb2_100007:
    v_lshrrev_b32 v4, 2, v3
    v_lshl_add_u32 v5, v2, 3, v4
    v_lshlrev_b32 v5, 8, v5
    v_and_b32 v13, 1, v3
    v_lshl_add_u32 v5, v13, 3, v5
    v_lshlrev_b32 v4, 1, v4
    v_and_b32 v15, 1, v2
    v_lshl_add_u32 v4, v15, 3, v4
    v_bfe_u32 v15, v3, 1, 1
    v_or_b32 v4, v4, v15
    v_xor_b32 v15, 0, v4
    v_lshl_add_u32 v200, v15, 4, v5
    v_xor_b32 v15, 2, v4
    v_lshl_add_u32 v201, v15, 4, v5
    v_xor_b32 v15, 4, v4
    v_lshl_add_u32 v202, v15, 4, v5
    v_xor_b32 v15, 6, v4
    v_lshl_add_u32 v203, v15, 4, v5
    v_xor_b32 v15, 8, v4
    v_lshl_add_u32 v204, v15, 4, v5
    v_xor_b32 v15, 10, v4
    v_lshl_add_u32 v205, v15, 4, v5
    v_xor_b32 v15, 12, v4
    v_lshl_add_u32 v206, v15, 4, v5
    s_waitcnt vmcnt(21)
    s_barrier
    v_add_u32 v12, 0, v10
    v_add_u32 v224, 0, v200
    v_add_u32 v225, 0, v201
    v_add_u32 v226, 0, v202
    v_add_u32 v227, 0, v203
    v_add_u32 v228, 0, v204
    v_add_u32 v229, 0, v205
    v_add_u32 v230, 0, v206
    ds_read_b128 v[128:131], v12 offset:0
    ds_read_b128 v[132:135], v12 offset:64
    ds_read_b128 v[136:139], v12 offset:576
    ds_read_b128 v[140:143], v12 offset:512
    ds_read_b128 v[144:147], v12 offset:4096
    ds_read_b128 v[148:151], v12 offset:4160
    ds_read_b128 v[152:155], v12 offset:4672
    ds_read_b128 v[156:159], v12 offset:4608
    ds_read_b64_tr_b16 v[160:161], v224 offset:0
    ds_read_b64_tr_b16 v[162:163], v224 offset:1024
    ds_read_b64_tr_b16 v[164:165], v224 offset:8192
    ds_read_b64_tr_b16 v[166:167], v224 offset:9216
    ds_read_b64_tr_b16 v[168:169], v225 offset:0
    ds_read_b64_tr_b16 v[170:171], v225 offset:1024
    ds_read_b64_tr_b16 v[172:173], v225 offset:8192
    ds_read_b64_tr_b16 v[174:175], v225 offset:9216
    s_waitcnt lgkmcnt(6)
    v_mfma_f32_16x16x32_bf16 v[16:19], v[128:131], v[160:163], 0
    s_add_u32 m0, s56, 98304
    s_and_b32 s60, s59, 3
    s_add_u32 s59, s59, 1
    s_mul_i32 s37, s60, s88
    s_add_u32 s37, s37, s86
    s_lshl_b32 s60, s60, 7
    s_add_u32 s61, s60, s85
    s_add_u32 s60, s60, s84
    buffer_load_dwordx4 v7, s[68:71], s37 offen lds
    v_mfma_f32_16x16x32_bf16 v[20:23], v[136:139], v[160:163], 0
    v_mfma_f32_16x16x32_bf16 v[24:27], v[144:147], v[160:163], 0
    v_mfma_f32_16x16x32_bf16 v[28:31], v[152:155], v[160:163], 0
    ds_read_b64_tr_b16 v[160:161], v226 offset:0
    ds_read_b64_tr_b16 v[162:163], v226 offset:1024
    s_waitcnt lgkmcnt(6)
    v_mfma_f32_16x16x32_bf16 v[16:19], v[132:135], v[164:167], v[16:19]
    s_add_u32 m0, s56, 99328
    s_add_u32 s37, s37, s87
    buffer_load_dwordx4 v7, s[68:71], s37 offen lds
    v_mfma_f32_16x16x32_bf16 v[20:23], v[140:143], v[164:167], v[20:23]
    v_mfma_f32_16x16x32_bf16 v[24:27], v[148:151], v[164:167], v[24:27]
    v_mfma_f32_16x16x32_bf16 v[28:31], v[156:159], v[164:167], v[28:31]
    ds_read_b64_tr_b16 v[164:165], v226 offset:8192
    ds_read_b64_tr_b16 v[166:167], v226 offset:9216
    s_waitcnt lgkmcnt(6)
    v_mfma_f32_16x16x32_bf16 v[32:35], v[128:131], v[168:171], 0
    s_add_u32 m0, s56, 100352
    s_add_u32 s37, s37, s87
    s_add_u32 s37, s37, s89
    buffer_load_dwordx4 v9, s[68:71], s37 offen lds
    v_mfma_f32_16x16x32_bf16 v[36:39], v[136:139], v[168:171], 0
    v_mfma_f32_16x16x32_bf16 v[40:43], v[144:147], v[168:171], 0
    v_mfma_f32_16x16x32_bf16 v[44:47], v[152:155], v[168:171], 0
    ds_read_b64_tr_b16 v[168:169], v227 offset:0
    ds_read_b64_tr_b16 v[170:171], v227 offset:1024
    s_waitcnt lgkmcnt(6)
    v_mfma_f32_16x16x32_bf16 v[32:35], v[132:135], v[172:175], v[32:35]
    s_add_u32 m0, s56, 101376
    s_add_u32 s37, s37, s87
    buffer_load_dwordx4 v9, s[68:71], s37 offen lds
    v_mfma_f32_16x16x32_bf16 v[36:39], v[140:143], v[172:175], v[36:39]
    v_mfma_f32_16x16x32_bf16 v[40:43], v[148:151], v[172:175], v[40:43]
    v_mfma_f32_16x16x32_bf16 v[44:47], v[156:159], v[172:175], v[44:47]
    ds_read_b64_tr_b16 v[172:173], v227 offset:8192
    ds_read_b64_tr_b16 v[174:175], v227 offset:9216
    s_waitcnt lgkmcnt(6)
    v_mfma_f32_16x16x32_bf16 v[48:51], v[128:131], v[160:163], 0
    s_add_u32 m0, s57, 114688
    s_add_u32 s37, s60, 0
    buffer_load_dwordx4 v6, s[64:67], s37 offen lds
    v_mfma_f32_16x16x32_bf16 v[52:55], v[136:139], v[160:163], 0
    v_mfma_f32_16x16x32_bf16 v[56:59], v[144:147], v[160:163], 0
    v_mfma_f32_16x16x32_bf16 v[60:63], v[152:155], v[160:163], 0
    ds_read_b64_tr_b16 v[160:161], v228 offset:0
    ds_read_b64_tr_b16 v[162:163], v228 offset:1024
    s_waitcnt lgkmcnt(6)
    v_mfma_f32_16x16x32_bf16 v[48:51], v[132:135], v[164:167], v[48:51]
    s_add_u32 m0, s57, 115712
    s_add_u32 s37, s60, 65536
    buffer_load_dwordx4 v6, s[64:67], s37 offen lds
    v_mfma_f32_16x16x32_bf16 v[52:55], v[140:143], v[164:167], v[52:55]
    v_mfma_f32_16x16x32_bf16 v[56:59], v[148:151], v[164:167], v[56:59]
    v_mfma_f32_16x16x32_bf16 v[60:63], v[156:159], v[164:167], v[60:63]
    ds_read_b64_tr_b16 v[164:165], v228 offset:8192
    ds_read_b64_tr_b16 v[166:167], v228 offset:9216
    s_waitcnt lgkmcnt(6)
    v_mfma_f32_16x16x32_bf16 v[64:67], v[128:131], v[168:171], 0
    s_add_u32 m0, s57, 116736
    s_add_u32 s37, s60, 131072
    buffer_load_dwordx4 v6, s[64:67], s37 offen lds
    v_mfma_f32_16x16x32_bf16 v[68:71], v[136:139], v[168:171], 0
    v_mfma_f32_16x16x32_bf16 v[72:75], v[144:147], v[168:171], 0
    v_mfma_f32_16x16x32_bf16 v[76:79], v[152:155], v[168:171], 0
    ds_read_b64_tr_b16 v[168:169], v229 offset:0
    ds_read_b64_tr_b16 v[170:171], v229 offset:1024
    s_waitcnt lgkmcnt(6)
    v_mfma_f32_16x16x32_bf16 v[64:67], v[132:135], v[172:175], v[64:67]
    s_add_u32 m0, s57, 117760
    s_add_u32 s37, s60, 196608
    buffer_load_dwordx4 v6, s[64:67], s37 offen lds
    v_mfma_f32_16x16x32_bf16 v[68:71], v[140:143], v[172:175], v[68:71]
    v_mfma_f32_16x16x32_bf16 v[72:75], v[148:151], v[172:175], v[72:75]
    v_mfma_f32_16x16x32_bf16 v[76:79], v[156:159], v[172:175], v[76:79]
    ds_read_b64_tr_b16 v[172:173], v229 offset:8192
    ds_read_b64_tr_b16 v[174:175], v229 offset:9216
    s_waitcnt lgkmcnt(6)
    v_mfma_f32_16x16x32_bf16 v[80:83], v[128:131], v[160:163], 0
    s_add_u32 m0, s57, 118784
    s_add_u32 s37, s61, 0
    buffer_load_dwordx4 v6, s[64:67], s37 offen lds
    v_mfma_f32_16x16x32_bf16 v[84:87], v[136:139], v[160:163], 0
    v_mfma_f32_16x16x32_bf16 v[88:91], v[144:147], v[160:163], 0
    v_mfma_f32_16x16x32_bf16 v[92:95], v[152:155], v[160:163], 0
    ds_read_b64_tr_b16 v[160:161], v230 offset:0
    ds_read_b64_tr_b16 v[162:163], v230 offset:1024
    s_waitcnt lgkmcnt(6)
    v_mfma_f32_16x16x32_bf16 v[80:83], v[132:135], v[164:167], v[80:83]
    s_add_u32 m0, s57, 119808
    s_add_u32 s37, s61, 65536
    buffer_load_dwordx4 v6, s[64:67], s37 offen lds
    v_mfma_f32_16x16x32_bf16 v[84:87], v[140:143], v[164:167], v[84:87]
    v_mfma_f32_16x16x32_bf16 v[88:91], v[148:151], v[164:167], v[88:91]
    v_mfma_f32_16x16x32_bf16 v[92:95], v[156:159], v[164:167], v[92:95]
    ds_read_b64_tr_b16 v[164:165], v230 offset:8192
    ds_read_b64_tr_b16 v[166:167], v230 offset:9216
    s_waitcnt lgkmcnt(6)
    v_mfma_f32_16x16x32_bf16 v[96:99], v[128:131], v[168:171], 0
    s_add_u32 m0, s57, 120832
    s_add_u32 s37, s61, 131072
    buffer_load_dwordx4 v6, s[64:67], s37 offen lds
    v_mfma_f32_16x16x32_bf16 v[100:103], v[136:139], v[168:171], 0
    v_mfma_f32_16x16x32_bf16 v[104:107], v[144:147], v[168:171], 0
    v_mfma_f32_16x16x32_bf16 v[108:111], v[152:155], v[168:171], 0
    s_waitcnt lgkmcnt(4)
    v_mfma_f32_16x16x32_bf16 v[96:99], v[132:135], v[172:175], v[96:99]
    s_add_u32 m0, s57, 121856
    s_add_u32 s37, s61, 196608
    buffer_load_dwordx4 v6, s[64:67], s37 offen lds
    v_mfma_f32_16x16x32_bf16 v[100:103], v[140:143], v[172:175], v[100:103]
    v_mfma_f32_16x16x32_bf16 v[104:107], v[148:151], v[172:175], v[104:107]
    v_mfma_f32_16x16x32_bf16 v[108:111], v[156:159], v[172:175], v[108:111]
    s_waitcnt lgkmcnt(2)
    v_mfma_f32_16x16x32_bf16 v[112:115], v[128:131], v[160:163], 0
    v_mfma_f32_16x16x32_bf16 v[116:119], v[136:139], v[160:163], 0
    v_mfma_f32_16x16x32_bf16 v[120:123], v[144:147], v[160:163], 0
    v_mfma_f32_16x16x32_bf16 v[124:127], v[152:155], v[160:163], 0
    s_waitcnt lgkmcnt(0)
    v_mfma_f32_16x16x32_bf16 v[112:115], v[132:135], v[164:167], v[112:115]
    v_mfma_f32_16x16x32_bf16 v[116:119], v[140:143], v[164:167], v[116:119]
    v_mfma_f32_16x16x32_bf16 v[120:123], v[148:151], v[164:167], v[120:123]
    v_mfma_f32_16x16x32_bf16 v[124:127], v[156:159], v[164:167], v[124:127]
    s_waitcnt vmcnt(12)
    s_barrier
    v_add_u32 v12, 49152, v10
    v_add_u32 v224, 49152, v200
    v_add_u32 v225, 49152, v201
    v_add_u32 v226, 49152, v202
    v_add_u32 v227, 49152, v203
    v_add_u32 v228, 49152, v204
    v_add_u32 v229, 49152, v205
    v_add_u32 v230, 49152, v206
    ds_read_b128 v[128:131], v12 offset:0
    ds_read_b128 v[132:135], v12 offset:64
    ds_read_b128 v[136:139], v12 offset:576
    ds_read_b128 v[140:143], v12 offset:512
    ds_read_b128 v[144:147], v12 offset:4096
    ds_read_b128 v[148:151], v12 offset:4160
    ds_read_b128 v[152:155], v12 offset:4672
    ds_read_b128 v[156:159], v12 offset:4608
    ds_read_b64_tr_b16 v[160:161], v224 offset:0
    ds_read_b64_tr_b16 v[162:163], v224 offset:1024
    ds_read_b64_tr_b16 v[164:165], v224 offset:8192
    ds_read_b64_tr_b16 v[166:167], v224 offset:9216
    ds_read_b64_tr_b16 v[168:169], v225 offset:0
    ds_read_b64_tr_b16 v[170:171], v225 offset:1024
    ds_read_b64_tr_b16 v[172:173], v225 offset:8192
    ds_read_b64_tr_b16 v[174:175], v225 offset:9216
    s_waitcnt lgkmcnt(6)
    v_mfma_f32_16x16x32_bf16 v[16:19], v[128:131], v[160:163], v[16:19]
    s_add_u32 m0, s56, 0
    s_and_b32 s60, s59, 3
    s_add_u32 s59, s59, 1
    s_mul_i32 s37, s60, s88
    s_add_u32 s37, s37, s86
    s_lshl_b32 s60, s60, 7
    s_add_u32 s61, s60, s85
    s_add_u32 s60, s60, s84
    buffer_load_dwordx4 v7, s[68:71], s37 offen lds
    v_mfma_f32_16x16x32_bf16 v[20:23], v[136:139], v[160:163], v[20:23]
    v_mfma_f32_16x16x32_bf16 v[24:27], v[144:147], v[160:163], v[24:27]
    v_mfma_f32_16x16x32_bf16 v[28:31], v[152:155], v[160:163], v[28:31]
    ds_read_b64_tr_b16 v[160:161], v226 offset:0
    ds_read_b64_tr_b16 v[162:163], v226 offset:1024
    s_waitcnt lgkmcnt(6)
    v_mfma_f32_16x16x32_bf16 v[16:19], v[132:135], v[164:167], v[16:19]
    s_add_u32 m0, s56, 1024
    s_add_u32 s37, s37, s87
    buffer_load_dwordx4 v7, s[68:71], s37 offen lds
    v_mfma_f32_16x16x32_bf16 v[20:23], v[140:143], v[164:167], v[20:23]
    v_mfma_f32_16x16x32_bf16 v[24:27], v[148:151], v[164:167], v[24:27]
    v_mfma_f32_16x16x32_bf16 v[28:31], v[156:159], v[164:167], v[28:31]
    ds_read_b64_tr_b16 v[164:165], v226 offset:8192
    ds_read_b64_tr_b16 v[166:167], v226 offset:9216
    s_waitcnt lgkmcnt(6)
    v_mfma_f32_16x16x32_bf16 v[32:35], v[128:131], v[168:171], v[32:35]
    s_add_u32 m0, s56, 2048
    s_add_u32 s37, s37, s87
    s_add_u32 s37, s37, s89
    buffer_load_dwordx4 v9, s[68:71], s37 offen lds
    v_mfma_f32_16x16x32_bf16 v[36:39], v[136:139], v[168:171], v[36:39]
    v_mfma_f32_16x16x32_bf16 v[40:43], v[144:147], v[168:171], v[40:43]
    v_mfma_f32_16x16x32_bf16 v[44:47], v[152:155], v[168:171], v[44:47]
    ds_read_b64_tr_b16 v[168:169], v227 offset:0
    ds_read_b64_tr_b16 v[170:171], v227 offset:1024
    s_waitcnt lgkmcnt(6)
    v_mfma_f32_16x16x32_bf16 v[32:35], v[132:135], v[172:175], v[32:35]
    s_add_u32 m0, s56, 3072
    s_add_u32 s37, s37, s87
    buffer_load_dwordx4 v9, s[68:71], s37 offen lds
    v_mfma_f32_16x16x32_bf16 v[36:39], v[140:143], v[172:175], v[36:39]
    v_mfma_f32_16x16x32_bf16 v[40:43], v[148:151], v[172:175], v[40:43]
    v_mfma_f32_16x16x32_bf16 v[44:47], v[156:159], v[172:175], v[44:47]
    ds_read_b64_tr_b16 v[172:173], v227 offset:8192
    ds_read_b64_tr_b16 v[174:175], v227 offset:9216
    s_waitcnt lgkmcnt(6)
    v_mfma_f32_16x16x32_bf16 v[48:51], v[128:131], v[160:163], v[48:51]
    s_add_u32 m0, s57, 16384
    s_add_u32 s37, s60, 0
    buffer_load_dwordx4 v6, s[64:67], s37 offen lds
    v_mfma_f32_16x16x32_bf16 v[52:55], v[136:139], v[160:163], v[52:55]
    v_mfma_f32_16x16x32_bf16 v[56:59], v[144:147], v[160:163], v[56:59]
    v_mfma_f32_16x16x32_bf16 v[60:63], v[152:155], v[160:163], v[60:63]
    ds_read_b64_tr_b16 v[160:161], v228 offset:0
    ds_read_b64_tr_b16 v[162:163], v228 offset:1024
    s_waitcnt lgkmcnt(6)
    v_mfma_f32_16x16x32_bf16 v[48:51], v[132:135], v[164:167], v[48:51]
    s_add_u32 m0, s57, 17408
    s_add_u32 s37, s60, 65536
    buffer_load_dwordx4 v6, s[64:67], s37 offen lds
    v_mfma_f32_16x16x32_bf16 v[52:55], v[140:143], v[164:167], v[52:55]
    v_mfma_f32_16x16x32_bf16 v[56:59], v[148:151], v[164:167], v[56:59]
    v_mfma_f32_16x16x32_bf16 v[60:63], v[156:159], v[164:167], v[60:63]
    ds_read_b64_tr_b16 v[164:165], v228 offset:8192
    ds_read_b64_tr_b16 v[166:167], v228 offset:9216
    s_waitcnt lgkmcnt(6)
    v_mfma_f32_16x16x32_bf16 v[64:67], v[128:131], v[168:171], v[64:67]
    s_add_u32 m0, s57, 18432
    s_add_u32 s37, s60, 131072
    buffer_load_dwordx4 v6, s[64:67], s37 offen lds
    v_mfma_f32_16x16x32_bf16 v[68:71], v[136:139], v[168:171], v[68:71]
    v_mfma_f32_16x16x32_bf16 v[72:75], v[144:147], v[168:171], v[72:75]
    v_mfma_f32_16x16x32_bf16 v[76:79], v[152:155], v[168:171], v[76:79]
    ds_read_b64_tr_b16 v[168:169], v229 offset:0
    ds_read_b64_tr_b16 v[170:171], v229 offset:1024
    s_waitcnt lgkmcnt(6)
    v_mfma_f32_16x16x32_bf16 v[64:67], v[132:135], v[172:175], v[64:67]
    s_add_u32 m0, s57, 19456
    s_add_u32 s37, s60, 196608
    buffer_load_dwordx4 v6, s[64:67], s37 offen lds
    v_mfma_f32_16x16x32_bf16 v[68:71], v[140:143], v[172:175], v[68:71]
    v_mfma_f32_16x16x32_bf16 v[72:75], v[148:151], v[172:175], v[72:75]
    v_mfma_f32_16x16x32_bf16 v[76:79], v[156:159], v[172:175], v[76:79]
    ds_read_b64_tr_b16 v[172:173], v229 offset:8192
    ds_read_b64_tr_b16 v[174:175], v229 offset:9216
    s_waitcnt lgkmcnt(6)
    v_mfma_f32_16x16x32_bf16 v[80:83], v[128:131], v[160:163], v[80:83]
    s_add_u32 m0, s57, 20480
    s_add_u32 s37, s61, 0
    buffer_load_dwordx4 v6, s[64:67], s37 offen lds
    v_mfma_f32_16x16x32_bf16 v[84:87], v[136:139], v[160:163], v[84:87]
    v_mfma_f32_16x16x32_bf16 v[88:91], v[144:147], v[160:163], v[88:91]
    v_mfma_f32_16x16x32_bf16 v[92:95], v[152:155], v[160:163], v[92:95]
    ds_read_b64_tr_b16 v[160:161], v230 offset:0
    ds_read_b64_tr_b16 v[162:163], v230 offset:1024
    s_waitcnt lgkmcnt(6)
    v_mfma_f32_16x16x32_bf16 v[80:83], v[132:135], v[164:167], v[80:83]
    s_add_u32 m0, s57, 21504
    s_add_u32 s37, s61, 65536
    buffer_load_dwordx4 v6, s[64:67], s37 offen lds
    v_mfma_f32_16x16x32_bf16 v[84:87], v[140:143], v[164:167], v[84:87]
    v_mfma_f32_16x16x32_bf16 v[88:91], v[148:151], v[164:167], v[88:91]
    v_mfma_f32_16x16x32_bf16 v[92:95], v[156:159], v[164:167], v[92:95]
    ds_read_b64_tr_b16 v[164:165], v230 offset:8192
    ds_read_b64_tr_b16 v[166:167], v230 offset:9216
    s_waitcnt lgkmcnt(6)
    v_mfma_f32_16x16x32_bf16 v[96:99], v[128:131], v[168:171], v[96:99]
    s_add_u32 m0, s57, 22528
    s_add_u32 s37, s61, 131072
    buffer_load_dwordx4 v6, s[64:67], s37 offen lds
    v_mfma_f32_16x16x32_bf16 v[100:103], v[136:139], v[168:171], v[100:103]
    v_mfma_f32_16x16x32_bf16 v[104:107], v[144:147], v[168:171], v[104:107]
    v_mfma_f32_16x16x32_bf16 v[108:111], v[152:155], v[168:171], v[108:111]
    s_waitcnt lgkmcnt(4)
    v_mfma_f32_16x16x32_bf16 v[96:99], v[132:135], v[172:175], v[96:99]
    s_add_u32 m0, s57, 23552
    s_add_u32 s37, s61, 196608
    buffer_load_dwordx4 v6, s[64:67], s37 offen lds
    v_mfma_f32_16x16x32_bf16 v[100:103], v[140:143], v[172:175], v[100:103]
    v_mfma_f32_16x16x32_bf16 v[104:107], v[148:151], v[172:175], v[104:107]
    v_mfma_f32_16x16x32_bf16 v[108:111], v[156:159], v[172:175], v[108:111]
    s_waitcnt lgkmcnt(2)
    v_mfma_f32_16x16x32_bf16 v[112:115], v[128:131], v[160:163], v[112:115]
    v_mfma_f32_16x16x32_bf16 v[116:119], v[136:139], v[160:163], v[116:119]
    v_mfma_f32_16x16x32_bf16 v[120:123], v[144:147], v[160:163], v[120:123]
    v_mfma_f32_16x16x32_bf16 v[124:127], v[152:155], v[160:163], v[124:127]
    s_waitcnt lgkmcnt(0)
    v_mfma_f32_16x16x32_bf16 v[112:115], v[132:135], v[164:167], v[112:115]
    v_mfma_f32_16x16x32_bf16 v[116:119], v[140:143], v[164:167], v[116:119]
    v_mfma_f32_16x16x32_bf16 v[120:123], v[148:151], v[164:167], v[120:123]
    v_mfma_f32_16x16x32_bf16 v[124:127], v[156:159], v[164:167], v[124:127]
    s_waitcnt vmcnt(12)
    s_barrier
    v_add_u32 v12, 98304, v10
    v_add_u32 v224, 98304, v200
    v_add_u32 v225, 98304, v201
    v_add_u32 v226, 98304, v202
    v_add_u32 v227, 98304, v203
    v_add_u32 v228, 98304, v204
    v_add_u32 v229, 98304, v205
    v_add_u32 v230, 98304, v206
    ds_read_b128 v[128:131], v12 offset:0
    ds_read_b128 v[132:135], v12 offset:64
    ds_read_b128 v[136:139], v12 offset:576
    ds_read_b128 v[140:143], v12 offset:512
    ds_read_b128 v[144:147], v12 offset:4096
    ds_read_b128 v[148:151], v12 offset:4160
    ds_read_b128 v[152:155], v12 offset:4672
    ds_read_b128 v[156:159], v12 offset:4608
    ds_read_b64_tr_b16 v[160:161], v224 offset:0
    ds_read_b64_tr_b16 v[162:163], v224 offset:1024
    ds_read_b64_tr_b16 v[164:165], v224 offset:8192
    ds_read_b64_tr_b16 v[166:167], v224 offset:9216
    ds_read_b64_tr_b16 v[168:169], v225 offset:0
    ds_read_b64_tr_b16 v[170:171], v225 offset:1024
    s_lshl_b32 s45, s44, 2
    s_cmp_eq_u32 s16, 0
    s_cselect_b32 s45, s45, 0x40000000
    v_mov_b32 v220, 1
    s_mov_b64 exec, 1
    buffer_atomic_add v220, off, s[12:15], s45 sc0
    s_mov_b64 exec, -1
    s_nop 3
    ds_read_b64_tr_b16 v[172:173], v225 offset:8192
    ds_read_b64_tr_b16 v[174:175], v225 offset:9216
    s_waitcnt lgkmcnt(6)
    v_mfma_f32_16x16x32_bf16 v[16:19], v[128:131], v[160:163], v[16:19]
    s_lshl_b32 s38, s42, 10
    s_add_u32 s38, s38, 0x2a00000
    s_sub_u32 s43, s42, 0
    s_cmp_lt_u32 s43, 7
    s_cselect_b32 s38, 0x40000000, s38
    buffer_store_dwordx4 v[208:211], v8, s[4:7], s38 offen sc1
    v_mfma_f32_16x16x32_bf16 v[20:23], v[136:139], v[160:163], v[20:23]
    v_mfma_f32_16x16x32_bf16 v[24:27], v[144:147], v[160:163], v[24:27]
    v_mfma_f32_16x16x32_bf16 v[28:31], v[152:155], v[160:163], v[28:31]
    ds_read_b64_tr_b16 v[160:161], v226 offset:0
    ds_read_b64_tr_b16 v[162:163], v226 offset:1024
    s_waitcnt lgkmcnt(6)
    v_mfma_f32_16x16x32_bf16 v[16:19], v[132:135], v[164:167], v[16:19]
    s_lshl_b32 s38, s42, 10
    s_add_u32 s38, s38, 0x2b00000
    s_sub_u32 s43, s42, 512
    s_cmp_lt_u32 s43, 7
    s_cselect_b32 s38, 0x40000000, s38
    buffer_store_dwordx4 v[208:211], v8, s[4:7], s38 offen sc1
    v_mfma_f32_16x16x32_bf16 v[20:23], v[140:143], v[164:167], v[20:23]
    v_mfma_f32_16x16x32_bf16 v[24:27], v[148:151], v[164:167], v[24:27]
    v_mfma_f32_16x16x32_bf16 v[28:31], v[156:159], v[164:167], v[28:31]
    ds_read_b64_tr_b16 v[164:165], v226 offset:8192
    ds_read_b64_tr_b16 v[166:167], v226 offset:9216
    s_waitcnt lgkmcnt(6)
    v_mfma_f32_16x16x32_bf16 v[32:35], v[128:131], v[168:171], v[32:35]
    s_lshl_b32 s37, s42, 10
    s_add_u32 s37, s37, 0x3d00000
    s_cmp_lt_u32 s42, 192
    s_cselect_b32 s37, s37, 0x40000000
    buffer_store_dwordx4 v[212:215], v8, s[4:7], s37 offen sc1
    v_mfma_f32_16x16x32_bf16 v[36:39], v[136:139], v[168:171], v[36:39]
    v_mfma_f32_16x16x32_bf16 v[40:43], v[144:147], v[168:171], v[40:43]
    v_mfma_f32_16x16x32_bf16 v[44:47], v[152:155], v[168:171], v[44:47]
    ds_read_b64_tr_b16 v[168:169], v227 offset:0
    ds_read_b64_tr_b16 v[170:171], v227 offset:1024
    s_waitcnt lgkmcnt(6)
    v_mfma_f32_16x16x32_bf16 v[32:35], v[132:135], v[172:175], v[32:35]
    s_sub_u32 s43, s42, 256
    s_lshl_b32 s37, s43, 10
    s_mov_b32 s38, 0x3634000
    s_cmp_lt_u32 s43, 224
    s_cselect_b32 s38, 0x33c8000, s38
    v_mfma_f32_16x16x32_bf16 v[36:39], v[140:143], v[172:175], v[36:39]
    v_mfma_f32_16x16x32_bf16 v[40:43], v[148:151], v[172:175], v[40:43]
    v_mfma_f32_16x16x32_bf16 v[44:47], v[156:159], v[172:175], v[44:47]
    ds_read_b64_tr_b16 v[172:173], v227 offset:8192
    ds_read_b64_tr_b16 v[174:175], v227 offset:9216
    s_waitcnt lgkmcnt(6)
    v_mfma_f32_16x16x32_bf16 v[48:51], v[128:131], v[160:163], v[48:51]
    s_add_u32 s37, s37, s38
    s_cmp_lt_u32 s43, 304
    s_cselect_b32 s37, s37, 0x40000000
    buffer_store_dwordx4 v[208:211], v8, s[4:7], s37 offen sc1
    v_mfma_f32_16x16x32_bf16 v[52:55], v[136:139], v[160:163], v[52:55]
    v_mfma_f32_16x16x32_bf16 v[56:59], v[144:147], v[160:163], v[56:59]
    v_mfma_f32_16x16x32_bf16 v[60:63], v[152:155], v[160:163], v[60:63]
    ds_read_b64_tr_b16 v[160:161], v228 offset:0
    ds_read_b64_tr_b16 v[162:163], v228 offset:1024
    s_waitcnt lgkmcnt(6)
    v_mfma_f32_16x16x32_bf16 v[48:51], v[132:135], v[164:167], v[48:51]
    v_min_u32 v216, -2, v216
    v_min_u32 v217, -2, v217
    v_min_u32 v218, -2, v218
    v_min_u32 v219, -2, v219
    buffer_store_dwordx4 v[216:219], v8, s[4:7], s41 offen sc1
    v_mfma_f32_16x16x32_bf16 v[52:55], v[140:143], v[164:167], v[52:55]
    v_mfma_f32_16x16x32_bf16 v[56:59], v[148:151], v[164:167], v[56:59]
    v_mfma_f32_16x16x32_bf16 v[60:63], v[156:159], v[164:167], v[60:63]
    ds_read_b64_tr_b16 v[164:165], v228 offset:8192
    ds_read_b64_tr_b16 v[166:167], v228 offset:9216
    s_waitcnt lgkmcnt(6)
    v_mfma_f32_16x16x32_bf16 v[64:67], v[128:131], v[168:171], v[64:67]
    s_add_u32 s41, s41, 0x180000
    buffer_store_dwordx4 v[216:219], v8, s[4:7], s41 offen sc1
    v_mfma_f32_16x16x32_bf16 v[68:71], v[136:139], v[168:171], v[68:71]
    v_mfma_f32_16x16x32_bf16 v[72:75], v[144:147], v[168:171], v[72:75]
    v_mfma_f32_16x16x32_bf16 v[76:79], v[152:155], v[168:171], v[76:79]
    ds_read_b64_tr_b16 v[168:169], v229 offset:0
    ds_read_b64_tr_b16 v[170:171], v229 offset:1024
    s_waitcnt lgkmcnt(6)
    v_mfma_f32_16x16x32_bf16 v[64:67], v[132:135], v[172:175], v[64:67]
    v_mfma_f32_16x16x32_bf16 v[68:71], v[140:143], v[172:175], v[68:71]
    v_mfma_f32_16x16x32_bf16 v[72:75], v[148:151], v[172:175], v[72:75]
    v_mfma_f32_16x16x32_bf16 v[76:79], v[156:159], v[172:175], v[76:79]
    ds_read_b64_tr_b16 v[172:173], v229 offset:8192
    ds_read_b64_tr_b16 v[174:175], v229 offset:9216
    s_waitcnt lgkmcnt(6)
    v_mfma_f32_16x16x32_bf16 v[80:83], v[128:131], v[160:163], v[80:83]
    v_mfma_f32_16x16x32_bf16 v[84:87], v[136:139], v[160:163], v[84:87]
    v_mfma_f32_16x16x32_bf16 v[88:91], v[144:147], v[160:163], v[88:91]
    v_mfma_f32_16x16x32_bf16 v[92:95], v[152:155], v[160:163], v[92:95]
    ds_read_b64_tr_b16 v[160:161], v230 offset:0
    ds_read_b64_tr_b16 v[162:163], v230 offset:1024
    s_waitcnt lgkmcnt(6)
    v_mfma_f32_16x16x32_bf16 v[80:83], v[132:135], v[164:167], v[80:83]
    v_mfma_f32_16x16x32_bf16 v[84:87], v[140:143], v[164:167], v[84:87]
    v_mfma_f32_16x16x32_bf16 v[88:91], v[148:151], v[164:167], v[88:91]
    v_mfma_f32_16x16x32_bf16 v[92:95], v[156:159], v[164:167], v[92:95]
    ds_read_b64_tr_b16 v[164:165], v230 offset:8192
    ds_read_b64_tr_b16 v[166:167], v230 offset:9216
    s_waitcnt lgkmcnt(6)
    v_mfma_f32_16x16x32_bf16 v[96:99], v[128:131], v[168:171], v[96:99]
    v_mfma_f32_16x16x32_bf16 v[100:103], v[136:139], v[168:171], v[100:103]
    v_mfma_f32_16x16x32_bf16 v[104:107], v[144:147], v[168:171], v[104:107]
    v_mfma_f32_16x16x32_bf16 v[108:111], v[152:155], v[168:171], v[108:111]
    s_waitcnt lgkmcnt(4)
    v_mfma_f32_16x16x32_bf16 v[96:99], v[132:135], v[172:175], v[96:99]
    v_mfma_f32_16x16x32_bf16 v[100:103], v[140:143], v[172:175], v[100:103]
    v_mfma_f32_16x16x32_bf16 v[104:107], v[148:151], v[172:175], v[104:107]
    v_mfma_f32_16x16x32_bf16 v[108:111], v[156:159], v[172:175], v[108:111]
    s_waitcnt lgkmcnt(2)
    v_mfma_f32_16x16x32_bf16 v[112:115], v[128:131], v[160:163], v[112:115]
    v_mfma_f32_16x16x32_bf16 v[116:119], v[136:139], v[160:163], v[116:119]
    v_mfma_f32_16x16x32_bf16 v[120:123], v[144:147], v[160:163], v[120:123]
    v_mfma_f32_16x16x32_bf16 v[124:127], v[152:155], v[160:163], v[124:127]
    s_waitcnt lgkmcnt(0)
    v_mfma_f32_16x16x32_bf16 v[112:115], v[132:135], v[164:167], v[112:115]
    v_mfma_f32_16x16x32_bf16 v[116:119], v[140:143], v[164:167], v[116:119]
    v_mfma_f32_16x16x32_bf16 v[120:123], v[148:151], v[164:167], v[120:123]
    v_mfma_f32_16x16x32_bf16 v[124:127], v[156:159], v[164:167], v[124:127]
    s_waitcnt vmcnt(7)
    s_barrier
    v_add_u32 v12, 0, v10
    v_add_u32 v224, 0, v200
    v_add_u32 v225, 0, v201
    v_add_u32 v226, 0, v202
    v_add_u32 v227, 0, v203
    v_add_u32 v228, 0, v204
    v_add_u32 v229, 0, v205
    v_add_u32 v230, 0, v206
    ds_read_b128 v[128:131], v12 offset:0
    ds_read_b128 v[132:135], v12 offset:64
    ds_read_b128 v[136:139], v12 offset:576
    ds_read_b128 v[140:143], v12 offset:512
    ds_read_b128 v[144:147], v12 offset:4096
    ds_read_b128 v[148:151], v12 offset:4160
    ds_read_b128 v[152:155], v12 offset:4672
    ds_read_b128 v[156:159], v12 offset:4608
    ds_read_b64_tr_b16 v[160:161], v224 offset:0
    ds_read_b64_tr_b16 v[162:163], v224 offset:1024
    ds_read_b64_tr_b16 v[164:165], v224 offset:8192
    ds_read_b64_tr_b16 v[166:167], v224 offset:9216
    ds_read_b64_tr_b16 v[168:169], v225 offset:0
    ds_read_b64_tr_b16 v[170:171], v225 offset:1024
    ds_read_b64_tr_b16 v[172:173], v225 offset:8192
    ds_read_b64_tr_b16 v[174:175], v225 offset:9216
    s_waitcnt lgkmcnt(6)
    v_mfma_f32_16x16x32_bf16 v[16:19], v[128:131], v[160:163], v[16:19]
    v_mfma_f32_16x16x32_bf16 v[20:23], v[136:139], v[160:163], v[20:23]
    v_mfma_f32_16x16x32_bf16 v[24:27], v[144:147], v[160:163], v[24:27]
    v_mfma_f32_16x16x32_bf16 v[28:31], v[152:155], v[160:163], v[28:31]
    ds_read_b64_tr_b16 v[160:161], v226 offset:0
    ds_read_b64_tr_b16 v[162:163], v226 offset:1024
    s_waitcnt lgkmcnt(6)
    v_mfma_f32_16x16x32_bf16 v[16:19], v[132:135], v[164:167], v[16:19]
    v_mfma_f32_16x16x32_bf16 v[20:23], v[140:143], v[164:167], v[20:23]
    v_mfma_f32_16x16x32_bf16 v[24:27], v[148:151], v[164:167], v[24:27]
    v_mfma_f32_16x16x32_bf16 v[28:31], v[156:159], v[164:167], v[28:31]
    ds_read_b64_tr_b16 v[164:165], v226 offset:8192
    ds_read_b64_tr_b16 v[166:167], v226 offset:9216
    s_waitcnt lgkmcnt(6)
    v_mfma_f32_16x16x32_bf16 v[32:35], v[128:131], v[168:171], v[32:35]
    v_mfma_f32_16x16x32_bf16 v[36:39], v[136:139], v[168:171], v[36:39]
    v_mfma_f32_16x16x32_bf16 v[40:43], v[144:147], v[168:171], v[40:43]
    v_mfma_f32_16x16x32_bf16 v[44:47], v[152:155], v[168:171], v[44:47]
    ds_read_b64_tr_b16 v[168:169], v227 offset:0
    ds_read_b64_tr_b16 v[170:171], v227 offset:1024
    s_waitcnt lgkmcnt(6)
    v_mfma_f32_16x16x32_bf16 v[32:35], v[132:135], v[172:175], v[32:35]
    v_cvt_pk_bf16_f32 v16, v16, v17
    v_cvt_pk_bf16_f32 v17, v18, v19
    v_mfma_f32_16x16x32_bf16 v[36:39], v[140:143], v[172:175], v[36:39]
    v_cvt_pk_bf16_f32 v18, v20, v21
    v_cvt_pk_bf16_f32 v19, v22, v23
    v_mfma_f32_16x16x32_bf16 v[40:43], v[148:151], v[172:175], v[40:43]
    buffer_store_dwordx4 v[16:19], v8, s[4:7], s40 offen sc1
    s_add_u32 s40, s40, 14336
    v_mfma_f32_16x16x32_bf16 v[44:47], v[156:159], v[172:175], v[44:47]
    v_cvt_pk_bf16_f32 v24, v24, v25
    v_cvt_pk_bf16_f32 v25, v26, v27
    ds_read_b64_tr_b16 v[172:173], v227 offset:8192
    ds_read_b64_tr_b16 v[174:175], v227 offset:9216
    s_waitcnt lgkmcnt(6)
    v_mfma_f32_16x16x32_bf16 v[48:51], v[128:131], v[160:163], v[48:51]
    v_cvt_pk_bf16_f32 v26, v28, v29
    v_cvt_pk_bf16_f32 v27, v30, v31
    v_mfma_f32_16x16x32_bf16 v[52:55], v[136:139], v[160:163], v[52:55]
    buffer_store_dwordx4 v[24:27], v8, s[4:7], s39 offen sc1
    s_add_u32 s39, s39, 14336
    v_mfma_f32_16x16x32_bf16 v[56:59], v[144:147], v[160:163], v[56:59]
    v_mfma_f32_16x16x32_bf16 v[60:63], v[152:155], v[160:163], v[60:63]
    ds_read_b64_tr_b16 v[160:161], v228 offset:0
    ds_read_b64_tr_b16 v[162:163], v228 offset:1024
    s_waitcnt lgkmcnt(6)
    v_mfma_f32_16x16x32_bf16 v[48:51], v[132:135], v[164:167], v[48:51]
    v_cvt_pk_bf16_f32 v32, v32, v33
    v_cvt_pk_bf16_f32 v33, v34, v35
    v_mfma_f32_16x16x32_bf16 v[52:55], v[140:143], v[164:167], v[52:55]
    v_cvt_pk_bf16_f32 v34, v36, v37
    v_cvt_pk_bf16_f32 v35, v38, v39
    v_mfma_f32_16x16x32_bf16 v[56:59], v[148:151], v[164:167], v[56:59]
    buffer_store_dwordx4 v[32:35], v8, s[4:7], s40 offen sc1
    s_add_u32 s40, s40, 14336
    v_mfma_f32_16x16x32_bf16 v[60:63], v[156:159], v[164:167], v[60:63]
    v_cvt_pk_bf16_f32 v40, v40, v41
    v_cvt_pk_bf16_f32 v41, v42, v43
    ds_read_b64_tr_b16 v[164:165], v228 offset:8192
    ds_read_b64_tr_b16 v[166:167], v228 offset:9216
    s_waitcnt lgkmcnt(6)
    v_mfma_f32_16x16x32_bf16 v[64:67], v[128:131], v[168:171], v[64:67]
    v_cvt_pk_bf16_f32 v42, v44, v45
    v_cvt_pk_bf16_f32 v43, v46, v47
    v_mfma_f32_16x16x32_bf16 v[68:71], v[136:139], v[168:171], v[68:71]
    buffer_store_dwordx4 v[40:43], v8, s[4:7], s39 offen sc1
    s_add_u32 s39, s39, 14336
    v_mfma_f32_16x16x32_bf16 v[72:75], v[144:147], v[168:171], v[72:75]
    v_mfma_f32_16x16x32_bf16 v[76:79], v[152:155], v[168:171], v[76:79]
    ds_read_b64_tr_b16 v[168:169], v229 offset:0
    ds_read_b64_tr_b16 v[170:171], v229 offset:1024
    s_waitcnt lgkmcnt(6)
    v_mfma_f32_16x16x32_bf16 v[64:67], v[132:135], v[172:175], v[64:67]
    v_cvt_pk_bf16_f32 v48, v48, v49
    v_cvt_pk_bf16_f32 v49, v50, v51
    v_mfma_f32_16x16x32_bf16 v[68:71], v[140:143], v[172:175], v[68:71]
    v_cvt_pk_bf16_f32 v50, v52, v53
    v_cvt_pk_bf16_f32 v51, v54, v55
    v_mfma_f32_16x16x32_bf16 v[72:75], v[148:151], v[172:175], v[72:75]
    buffer_store_dwordx4 v[48:51], v8, s[4:7], s40 offen sc1
    s_add_u32 s40, s40, 14336
    v_mfma_f32_16x16x32_bf16 v[76:79], v[156:159], v[172:175], v[76:79]
    v_cvt_pk_bf16_f32 v56, v56, v57
    v_cvt_pk_bf16_f32 v57, v58, v59
    ds_read_b64_tr_b16 v[172:173], v229 offset:8192
    ds_read_b64_tr_b16 v[174:175], v229 offset:9216
    s_waitcnt lgkmcnt(6)
    v_mfma_f32_16x16x32_bf16 v[80:83], v[128:131], v[160:163], v[80:83]
    v_cvt_pk_bf16_f32 v58, v60, v61
    v_cvt_pk_bf16_f32 v59, v62, v63
    v_mfma_f32_16x16x32_bf16 v[84:87], v[136:139], v[160:163], v[84:87]
    buffer_store_dwordx4 v[56:59], v8, s[4:7], s39 offen sc1
    s_add_u32 s39, s39, 14336
    v_mfma_f32_16x16x32_bf16 v[88:91], v[144:147], v[160:163], v[88:91]
    v_mfma_f32_16x16x32_bf16 v[92:95], v[152:155], v[160:163], v[92:95]
    ds_read_b64_tr_b16 v[160:161], v230 offset:0
    ds_read_b64_tr_b16 v[162:163], v230 offset:1024
    s_waitcnt lgkmcnt(6)
    v_mfma_f32_16x16x32_bf16 v[80:83], v[132:135], v[164:167], v[80:83]
    v_cvt_pk_bf16_f32 v64, v64, v65
    v_cvt_pk_bf16_f32 v65, v66, v67
    v_mfma_f32_16x16x32_bf16 v[84:87], v[140:143], v[164:167], v[84:87]
    v_cvt_pk_bf16_f32 v66, v68, v69
    v_cvt_pk_bf16_f32 v67, v70, v71
    v_mfma_f32_16x16x32_bf16 v[88:91], v[148:151], v[164:167], v[88:91]
    buffer_store_dwordx4 v[64:67], v8, s[4:7], s40 offen sc1
    s_add_u32 s40, s40, 14336
    v_mfma_f32_16x16x32_bf16 v[92:95], v[156:159], v[164:167], v[92:95]
    v_cvt_pk_bf16_f32 v72, v72, v73
    v_cvt_pk_bf16_f32 v73, v74, v75
    ds_read_b64_tr_b16 v[164:165], v230 offset:8192
    ds_read_b64_tr_b16 v[166:167], v230 offset:9216
    s_waitcnt lgkmcnt(6)
    v_mfma_f32_16x16x32_bf16 v[96:99], v[128:131], v[168:171], v[96:99]
    v_cvt_pk_bf16_f32 v74, v76, v77
    v_cvt_pk_bf16_f32 v75, v78, v79
    v_mfma_f32_16x16x32_bf16 v[100:103], v[136:139], v[168:171], v[100:103]
    buffer_store_dwordx4 v[72:75], v8, s[4:7], s39 offen sc1
    s_add_u32 s39, s39, 14336
    v_mfma_f32_16x16x32_bf16 v[104:107], v[144:147], v[168:171], v[104:107]
    v_mfma_f32_16x16x32_bf16 v[108:111], v[152:155], v[168:171], v[108:111]
    s_waitcnt lgkmcnt(4)
    v_mfma_f32_16x16x32_bf16 v[96:99], v[132:135], v[172:175], v[96:99]
    v_cvt_pk_bf16_f32 v80, v80, v81
    v_cvt_pk_bf16_f32 v81, v82, v83
    v_mfma_f32_16x16x32_bf16 v[100:103], v[140:143], v[172:175], v[100:103]
    v_cvt_pk_bf16_f32 v82, v84, v85
    v_cvt_pk_bf16_f32 v83, v86, v87
    v_mfma_f32_16x16x32_bf16 v[104:107], v[148:151], v[172:175], v[104:107]
    buffer_store_dwordx4 v[80:83], v8, s[4:7], s40 offen sc1
    s_add_u32 s40, s40, 14336
    v_mfma_f32_16x16x32_bf16 v[108:111], v[156:159], v[172:175], v[108:111]
    v_cvt_pk_bf16_f32 v88, v88, v89
    v_cvt_pk_bf16_f32 v89, v90, v91
    s_waitcnt lgkmcnt(2)
    v_mfma_f32_16x16x32_bf16 v[112:115], v[128:131], v[160:163], v[112:115]
    v_cvt_pk_bf16_f32 v90, v92, v93
    v_cvt_pk_bf16_f32 v91, v94, v95
    v_mfma_f32_16x16x32_bf16 v[116:119], v[136:139], v[160:163], v[116:119]
    buffer_store_dwordx4 v[88:91], v8, s[4:7], s39 offen sc1
    s_add_u32 s39, s39, 14336
    v_mfma_f32_16x16x32_bf16 v[120:123], v[144:147], v[160:163], v[120:123]
    v_mfma_f32_16x16x32_bf16 v[124:127], v[152:155], v[160:163], v[124:127]
    s_waitcnt lgkmcnt(0)
    v_mfma_f32_16x16x32_bf16 v[112:115], v[132:135], v[164:167], v[112:115]
    v_cvt_pk_bf16_f32 v96, v96, v97
    v_cvt_pk_bf16_f32 v97, v98, v99
    v_mfma_f32_16x16x32_bf16 v[116:119], v[140:143], v[164:167], v[116:119]
    v_cvt_pk_bf16_f32 v98, v100, v101
    v_cvt_pk_bf16_f32 v99, v102, v103
    v_mfma_f32_16x16x32_bf16 v[120:123], v[148:151], v[164:167], v[120:123]
    buffer_store_dwordx4 v[96:99], v8, s[4:7], s40 offen sc1
    s_add_u32 s40, s40, 14336
    v_mfma_f32_16x16x32_bf16 v[124:127], v[156:159], v[164:167], v[124:127]
    v_cvt_pk_bf16_f32 v104, v104, v105
    v_cvt_pk_bf16_f32 v105, v106, v107
    v_cvt_pk_bf16_f32 v106, v108, v109
    v_cvt_pk_bf16_f32 v107, v110, v111
    buffer_store_dwordx4 v[104:107], v8, s[4:7], s39 offen sc1
    s_add_u32 s39, s39, 14336
    s_nop 7
    v_cvt_pk_bf16_f32 v112, v112, v113
    v_cvt_pk_bf16_f32 v113, v114, v115
    v_cvt_pk_bf16_f32 v114, v116, v117
    v_cvt_pk_bf16_f32 v115, v118, v119
    buffer_store_dwordx4 v[112:115], v8, s[4:7], s40 offen sc1
    s_add_u32 s40, s40, 14336
    v_cvt_pk_bf16_f32 v120, v120, v121
    v_cvt_pk_bf16_f32 v121, v122, v123
    v_cvt_pk_bf16_f32 v122, v124, v125
    v_cvt_pk_bf16_f32 v123, v126, v127
    buffer_store_dwordx4 v[120:123], v8, s[4:7], s39 offen sc1
    s_add_u32 s39, s39, 14336
Lpb3_100008:
    s_waitcnt vmcnt(0)
    s_barrier
    s_lshl_b32 s37, s33, 2
    s_cmp_eq_u32 s16, 0
    s_cselect_b32 s37, s37, 0x40000000
    s_cselect_b32 s63, s63, 0x40000000
    v_add_u32 v236, 1, v236
    v_mov_b32 v4, 1
    s_mov_b64 exec, 1
    buffer_store_dword v236, off, s[4:7], s63 sc1
    buffer_atomic_add v4, off, s[12:15], s37 offset:64 sc1
    s_mov_b64 exec, -1
    s_cmp_lg_u32 s16, 0
    s_cbranch_scc1 Lnotw0_100009
    s_mov_b64 exec, 1
    v_readfirstlane_b32 s61, v220
    s_lshl_b32 s26, s44, 5
    s_add_u32 s26, s26, s61
    s_cmp_lt_u32 s61, 32
    s_cbranch_scc1 Lrd_100010
    v_mov_b32 v1, 1
    buffer_atomic_add v1, off, s[12:15], 0 offset:36 sc0
    s_waitcnt vmcnt(0)
    v_readfirstlane_b32 s61, v1
    s_mov_b32 s62, 300000
    s_mov_b32 s26, 1000
    s_mov_b64 exec, -1
    v_and_b32 v2, 31, v0
    v_lshlrev_b32 v2, 2, v2
Lovw_100011:
    buffer_load_dword v1, v2, s[12:15], 0 offen offset:64 sc1
    s_waitcnt vmcnt(0)
    v_cmp_gt_u32 vcc, 8, v1
    s_cbranch_vccz Lovg_100012
    s_sleep 4
    s_sub_u32 s62, s62, 1
    s_cbranch_scc1 Lrd_100010
    s_branch Lovw_100011
Lovg_100012:
    buffer_load_dwordx4 v[4:7], off, s[12:15], 0 sc1
    buffer_load_dwordx4 v[8:11], off, s[12:15], 0 offset:16 sc1
    s_waitcnt vmcnt(0)
    v_readfirstlane_b32 s63, v4
    s_min_u32 s63, s63, 32
    s_sub_u32 s62, 32, s63
    s_cmp_ge_u32 s61, s62
    s_cbranch_scc1 Lovn_100013
    s_add_u32 s26, s63, s61
    s_add_u32 s26, s26, 0
    s_branch Lrd_100010
Lovn_100013:
    s_sub_u32 s61, s61, s62
    v_readfirstlane_b32 s63, v5
    s_min_u32 s63, s63, 32
    s_sub_u32 s62, 32, s63
    s_cmp_ge_u32 s61, s62
    s_cbranch_scc1 Lovn_100014
    s_add_u32 s26, s63, s61
    s_add_u32 s26, s26, 32
    s_branch Lrd_100010
Lovn_100014:
    s_sub_u32 s61, s61, s62
    v_readfirstlane_b32 s63, v6
    s_min_u32 s63, s63, 32
    s_sub_u32 s62, 32, s63
    s_cmp_ge_u32 s61, s62
    s_cbranch_scc1 Lovn_100015
    s_add_u32 s26, s63, s61
    s_add_u32 s26, s26, 64
    s_branch Lrd_100010
Lovn_100015:
    s_sub_u32 s61, s61, s62
    v_readfirstlane_b32 s63, v7
    s_min_u32 s63, s63, 32
    s_sub_u32 s62, 32, s63
    s_cmp_ge_u32 s61, s62
    s_cbranch_scc1 Lovn_100016
    s_add_u32 s26, s63, s61
    s_add_u32 s26, s26, 96
    s_branch Lrd_100010
Lovn_100016:
    s_sub_u32 s61, s61, s62
    v_readfirstlane_b32 s63, v8
    s_min_u32 s63, s63, 32
    s_sub_u32 s62, 32, s63
    s_cmp_ge_u32 s61, s62
    s_cbranch_scc1 Lovn_100017
    s_add_u32 s26, s63, s61
    s_add_u32 s26, s26, 128
    s_branch Lrd_100010
Lovn_100017:
    s_sub_u32 s61, s61, s62
    v_readfirstlane_b32 s63, v9
    s_min_u32 s63, s63, 32
    s_sub_u32 s62, 32, s63
    s_cmp_ge_u32 s61, s62
    s_cbranch_scc1 Lovn_100018
    s_add_u32 s26, s63, s61
    s_add_u32 s26, s26, 160
    s_branch Lrd_100010
Lovn_100018:
    s_sub_u32 s61, s61, s62
    v_readfirstlane_b32 s63, v10
    s_min_u32 s63, s63, 32
    s_sub_u32 s62, 32, s63
    s_cmp_ge_u32 s61, s62
    s_cbranch_scc1 Lovn_100019
    s_add_u32 s26, s63, s61
    s_add_u32 s26, s26, 192
    s_branch Lrd_100010
Lovn_100019:
    s_sub_u32 s61, s61, s62
    v_readfirstlane_b32 s63, v11
    s_min_u32 s63, s63, 32
    s_sub_u32 s62, 32, s63
    s_cmp_ge_u32 s61, s62
    s_cbranch_scc1 Lovn_100020
    s_add_u32 s26, s63, s61
    s_add_u32 s26, s26, 224
    s_branch Lrd_100010
Lovn_100020:
    s_sub_u32 s61, s61, s62
Lrd_100010:
    v_mov_b32 v1, s26
    v_mov_b32 v2, 0x24000
    ds_write_b32 v2, v1
    s_waitcnt lgkmcnt(0)
    s_mov_b64 exec, -1
Lnotw0_100009:
    s_barrier
    v_mov_b32 v2, 0x24000
    ds_read_b32 v1, v2
    s_waitcnt lgkmcnt(0)
    v_readfirstlane_b32 s17, v1
    s_mov_b32 s24, 300000
    s_cmp_lt_u32 s17, 16
    s_cbranch_scc1 LjmpA_100028
    s_cmp_lt_u32 s17, 30
    s_cbranch_scc1 LjmpB_100029
    s_cmp_lt_u32 s17, 32
    s_cbranch_scc1 LjmpPF_100030
    s_cmp_lt_u32 s17, 96
    s_cbranch_scc1 LjmpV_100031
    s_cmp_lt_u32 s17, 144
    s_cbranch_scc1 LjmpX_100032
    s_cmp_lt_u32 s17, 176
    s_cbranch_scc1 LjmpL_100033
    s_cmp_lt_u32 s17, 218
    s_cbranch_scc1 LjmpPV_100034
Lexit_100001:
    s_endpgm
LjmpA_100028:
    s_branch LroleA_100021
LjmpB_100029:
    s_branch LroleB_100022
LjmpPF_100030:
    s_branch LrolePF_100023
LjmpV_100031:
    s_sub_u32 s17, s17, 32
    s_branch LroleV_100024
LjmpX_100032:
    s_sub_u32 s17, s17, 96
    s_branch LroleX_100025
LjmpL_100033:
    s_sub_u32 s17, s17, 144
    s_branch LroleL_100026
LjmpPV_100034:
    s_sub_u32 s17, s17, 176
    s_branch LrolePV_100027
Lteam_code:
LroleA_100021:
    s_cmp_eq_u32 s16, 1
    s_cbranch_scc1 LAw1_100036
    s_cmp_eq_u32 s16, 2
    s_cbranch_scc1 LAw2_100037
    s_cmp_eq_u32 s16, 3
    s_cbranch_scc1 LAw3_100038
LAw0_100035:
    v_and_b32 v3, 63, v0
    v_lshrrev_b32 v1, 4, v3
    v_and_b32 v2, 15, v3
    v_and_b32 v118, 1, v2
    v_mul_u32_u24 v112, 0xAAAA, v118
    v_lshrrev_b32 v118, 3, v2
    v_mul_u32_u24 v118, 0xAAAA, v118
    v_lshl_add_u32 v112, v118, 16, v112
    v_add_u32 v112, 0x44444444, v112
    v_lshlrev_b32 v113, 8, v1
    v_lshl_add_u32 v113, v2, 4, v113
    v_lshlrev_b32 v114, 4, v2
    v_lshl_add_u32 v114, v1, 2, v114
    v_add_u32 v114, 0, v114
    v_and_b32 v118, 1, v1
    v_mul_u32_u24 v115, 3616, v118
    v_lshrrev_b32 v118, 3, v2
    v_lshl_add_u32 v115, v118, 7, v115
    v_bfe_u32 v118, v2, 1, 1
    v_lshl_add_u32 v115, v118, 6, v115
    v_lshrrev_b32 v118, 1, v1
    v_lshl_add_u32 v115, v118, 5, v115
    v_bfe_u32 v118, v2, 2, 1
    v_lshl_add_u32 v115, v118, 4, v115
    v_and_b32 v118, 1, v2
    v_lshl_add_u32 v115, v118, 3, v115
    v_lshlrev_b32 v117, 10, v1
    v_lshl_add_u32 v117, v2, 3, v117
    v_add_u32 v117, 16384, v117
    v_lshlrev_b32 v116, 4, v3
    s_lshr_b32 s60, s17, 3
    s_and_b32 s61, s17, 7
    s_lshl_b32 s61, s61, 3
    s_add_u32 s61, s61, s16
    s_mov_b64 exec, 0x11
    s_lshl_b64 exec, exec, s61
    v_mov_b32 v5, v232
    s_mov_b32 s62, 64
    s_cmp_eq_u32 s60, 1
    s_cselect_b64 vcc, -1, 0
    v_cndmask_b32 v5, v5, v233, vcc
    s_cmp_eq_u32 s60, 2
    s_cselect_b64 vcc, -1, 0
    v_cndmask_b32 v5, v5, v234, vcc
    s_cmp_eq_u32 s60, 3
    s_cselect_b64 vcc, -1, 0
    v_cndmask_b32 v5, v5, v235, vcc
    s_lshl_b32 s60, s60, 11
    s_add_u32 s60, s60, 0x3d40000
LAww_100039:
    buffer_load_dword v4, v237, s[4:7], s60 offen sc1
    s_waitcnt vmcnt(0)
    v_cmp_eq_u32 vcc, v4, v5
    s_cbranch_vccz LAwg_100040
    s_sleep 12
    s_sub_u32 s62, s62, 1
    s_cbranch_scc0 LAww_100039
    s_mov_b64 exec, -1
    v_and_b32 v5, 31, v0
    v_lshlrev_b32 v5, 2, v5
LAwf_100041:
    buffer_load_dword v4, v5, s[12:15], 0 offen offset:64 sc1
    s_waitcnt vmcnt(0)
    v_cmp_gt_u32 vcc, 8, v4
    s_cbranch_vccz LAwg_100040
    s_sleep 30
    s_sub_u32 s24, s24, 1
    s_cbranch_scc1 Lexit_100001
    s_branch LAwf_100041
LAwg_100040:
    s_mov_b64 exec, -1
    v_lshlrev_b32 v118, 4, v3
    s_mul_i32 s25, s17, 401408
    s_add_u32 s25, s25, 0
    s_add_u32 s26, s25, 0
    buffer_load_dwordx4 a[0:3], v118, s[4:7], s26 offen offset:0 sc1
    buffer_load_dwordx4 a[4:7], v118, s[4:7], s26 offen offset:1024 sc1
    s_add_u32 s26, s25, 2048
    buffer_load_dwordx4 a[8:11], v118, s[4:7], s26 offen offset:0 sc1
    buffer_load_dwordx4 a[12:15], v118, s[4:7], s26 offen offset:1024 sc1
    s_add_u32 s26, s25, 4096
    buffer_load_dwordx4 a[16:19], v118, s[4:7], s26 offen offset:0 sc1
    buffer_load_dwordx4 a[20:23], v118, s[4:7], s26 offen offset:1024 sc1
    s_add_u32 s26, s25, 6144
    buffer_load_dwordx4 a[24:27], v118, s[4:7], s26 offen offset:0 sc1
    buffer_load_dwordx4 a[28:31], v118, s[4:7], s26 offen offset:1024 sc1
    s_add_u32 s26, s25, 8192
    buffer_load_dwordx4 a[32:35], v118, s[4:7], s26 offen offset:0 sc1
    buffer_load_dwordx4 a[36:39], v118, s[4:7], s26 offen offset:1024 sc1
    s_add_u32 s26, s25, 10240
    buffer_load_dwordx4 a[40:43], v118, s[4:7], s26 offen offset:0 sc1
    buffer_load_dwordx4 a[44:47], v118, s[4:7], s26 offen offset:1024 sc1
    s_add_u32 s26, s25, 12288
    buffer_load_dwordx4 a[48:51], v118, s[4:7], s26 offen offset:0 sc1
    buffer_load_dwordx4 a[52:55], v118, s[4:7], s26 offen offset:1024 sc1
    s_add_u32 s26, s25, 14336
    buffer_load_dwordx4 a[56:59], v118, s[4:7], s26 offen offset:0 sc1
    buffer_load_dwordx4 a[60:63], v118, s[4:7], s26 offen offset:1024 sc1
    s_add_u32 s26, s25, 16384
    buffer_load_dwordx4 a[64:67], v118, s[4:7], s26 offen offset:0 sc1
    buffer_load_dwordx4 a[68:71], v118, s[4:7], s26 offen offset:1024 sc1
    s_add_u32 s26, s25, 18432
    buffer_load_dwordx4 a[72:75], v118, s[4:7], s26 offen offset:0 sc1
    buffer_load_dwordx4 a[76:79], v118, s[4:7], s26 offen offset:1024 sc1
    s_add_u32 s26, s25, 20480
    buffer_load_dwordx4 a[80:83], v118, s[4:7], s26 offen offset:0 sc1
    buffer_load_dwordx4 a[84:87], v118, s[4:7], s26 offen offset:1024 sc1
    s_add_u32 s26, s25, 22528
    buffer_load_dwordx4 a[88:91], v118, s[4:7], s26 offen offset:0 sc1
    buffer_load_dwordx4 a[92:95], v118, s[4:7], s26 offen offset:1024 sc1
    s_add_u32 s26, s25, 24576
    buffer_load_dwordx4 a[96:99], v118, s[4:7], s26 offen offset:0 sc1
    buffer_load_dwordx4 a[100:103], v118, s[4:7], s26 offen offset:1024 sc1
    s_add_u32 s26, s25, 26624
    buffer_load_dwordx4 a[104:107], v118, s[4:7], s26 offen offset:0 sc1
    buffer_load_dwordx4 a[108:111], v118, s[4:7], s26 offen offset:1024 sc1
    s_add_u32 s26, s25, 28672
    buffer_load_dwordx4 a[112:115], v118, s[4:7], s26 offen offset:0 sc1
    buffer_load_dwordx4 a[116:119], v118, s[4:7], s26 offen offset:1024 sc1
    s_add_u32 s26, s25, 30720
    buffer_load_dwordx4 a[120:123], v118, s[4:7], s26 offen offset:0 sc1
    buffer_load_dwordx4 a[124:127], v118, s[4:7], s26 offen offset:1024 sc1
    s_add_u32 s26, s25, 32768
    buffer_load_dwordx4 a[128:131], v118, s[4:7], s26 offen offset:0 sc1
    buffer_load_dwordx4 a[132:135], v118, s[4:7], s26 offen offset:1024 sc1
    s_add_u32 s26, s25, 34816
    buffer_load_dwordx4 a[136:139], v118, s[4:7], s26 offen offset:0 sc1
    buffer_load_dwordx4 a[140:143], v118, s[4:7], s26 offen offset:1024 sc1
    s_add_u32 s26, s25, 36864
    buffer_load_dwordx4 a[144:147], v118, s[4:7], s26 offen offset:0 sc1
    buffer_load_dwordx4 a[148:151], v118, s[4:7], s26 offen offset:1024 sc1
    s_add_u32 s26, s25, 38912
    buffer_load_dwordx4 a[152:155], v118, s[4:7], s26 offen offset:0 sc1
    buffer_load_dwordx4 a[156:159], v118, s[4:7], s26 offen offset:1024 sc1
    s_add_u32 s26, s25, 40960
    buffer_load_dwordx4 a[160:163], v118, s[4:7], s26 offen offset:0 sc1
    buffer_load_dwordx4 a[164:167], v118, s[4:7], s26 offen offset:1024 sc1
    s_waitcnt vmcnt(28)
    s_add_u32 s26, s25, 43008
    buffer_load_dwordx4 a[168:171], v118, s[4:7], s26 offen offset:0 sc1
    buffer_load_dwordx4 a[172:175], v118, s[4:7], s26 offen offset:1024 sc1
    s_add_u32 s26, s25, 45056
    buffer_load_dwordx4 a[176:179], v118, s[4:7], s26 offen offset:0 sc1
    buffer_load_dwordx4 a[180:183], v118, s[4:7], s26 offen offset:1024 sc1
    s_add_u32 s26, s25, 47104
    buffer_load_dwordx4 a[184:187], v118, s[4:7], s26 offen offset:0 sc1
    buffer_load_dwordx4 a[188:191], v118, s[4:7], s26 offen offset:1024 sc1
    s_add_u32 s26, s25, 49152
    buffer_load_dwordx4 a[192:195], v118, s[4:7], s26 offen offset:0 sc1
    buffer_load_dwordx4 a[196:199], v118, s[4:7], s26 offen offset:1024 sc1
    s_add_u32 s26, s25, 51200
    buffer_load_dwordx4 a[200:203], v118, s[4:7], s26 offen offset:0 sc1
    buffer_load_dwordx4 a[204:207], v118, s[4:7], s26 offen offset:1024 sc1
    s_add_u32 s26, s25, 53248
    buffer_load_dwordx4 a[208:211], v118, s[4:7], s26 offen offset:0 sc1
    buffer_load_dwordx4 a[212:215], v118, s[4:7], s26 offen offset:1024 sc1
    s_add_u32 s26, s25, 55296
    buffer_load_dwordx4 a[216:219], v118, s[4:7], s26 offen offset:0 sc1
    buffer_load_dwordx4 a[220:223], v118, s[4:7], s26 offen offset:1024 sc1
    s_waitcnt vmcnt(28)
    s_add_u32 s26, s25, 57344
    buffer_load_dwordx4 a[224:227], v118, s[4:7], s26 offen offset:0 sc1
    buffer_load_dwordx4 a[228:231], v118, s[4:7], s26 offen offset:1024 sc1
    s_add_u32 s26, s25, 59392
    buffer_load_dwordx4 a[232:235], v118, s[4:7], s26 offen offset:0 sc1
    buffer_load_dwordx4 a[236:239], v118, s[4:7], s26 offen offset:1024 sc1
    s_add_u32 s26, s25, 61440
    buffer_load_dwordx4 a[240:243], v118, s[4:7], s26 offen offset:0 sc1
    buffer_load_dwordx4 a[244:247], v118, s[4:7], s26 offen offset:1024 sc1
    s_add_u32 s26, s25, 63488
    buffer_load_dwordx4 a[248:251], v118, s[4:7], s26 offen offset:0 sc1
    buffer_load_dwordx4 a[252:255], v118, s[4:7], s26 offen offset:1024 sc1
    s_add_u32 s26, s25, 65536
    buffer_load_dwordx4 v[120:123], v118, s[4:7], s26 offen offset:0 sc1
    buffer_load_dwordx4 v[124:127], v118, s[4:7], s26 offen offset:1024 sc1
    s_add_u32 s26, s25, 67584
    buffer_load_dwordx4 v[128:131], v118, s[4:7], s26 offen offset:0 sc1
    buffer_load_dwordx4 v[132:135], v118, s[4:7], s26 offen offset:1024 sc1
    s_add_u32 s26, s25, 69632
    buffer_load_dwordx4 v[136:139], v118, s[4:7], s26 offen offset:0 sc1
    buffer_load_dwordx4 v[140:143], v118, s[4:7], s26 offen offset:1024 sc1
    s_waitcnt vmcnt(28)
    s_add_u32 s26, s25, 71680
    buffer_load_dwordx4 v[144:147], v118, s[4:7], s26 offen offset:0 sc1
    buffer_load_dwordx4 v[148:151], v118, s[4:7], s26 offen offset:1024 sc1
    s_add_u32 s26, s25, 73728
    buffer_load_dwordx4 v[152:155], v118, s[4:7], s26 offen offset:0 sc1
    buffer_load_dwordx4 v[156:159], v118, s[4:7], s26 offen offset:1024 sc1
    s_add_u32 s26, s25, 75776
    buffer_load_dwordx4 v[160:163], v118, s[4:7], s26 offen offset:0 sc1
    buffer_load_dwordx4 v[164:167], v118, s[4:7], s26 offen offset:1024 sc1
    s_add_u32 s26, s25, 77824
    buffer_load_dwordx4 v[168:171], v118, s[4:7], s26 offen offset:0 sc1
    buffer_load_dwordx4 v[172:175], v118, s[4:7], s26 offen offset:1024 sc1
    s_add_u32 s26, s25, 79872
    buffer_load_dwordx4 v[176:179], v118, s[4:7], s26 offen offset:0 sc1
    buffer_load_dwordx4 v[180:183], v118, s[4:7], s26 offen offset:1024 sc1
    s_add_u32 s26, s25, 81920
    buffer_load_dwordx4 v[184:187], v118, s[4:7], s26 offen offset:0 sc1
    buffer_load_dwordx4 v[188:191], v118, s[4:7], s26 offen offset:1024 sc1
    s_add_u32 s26, s25, 83968
    buffer_load_dwordx4 v[192:195], v118, s[4:7], s26 offen offset:0 sc1
    buffer_load_dwordx4 v[196:199], v118, s[4:7], s26 offen offset:1024 sc1
    s_waitcnt vmcnt(28)
    s_add_u32 s26, s25, 86016
    buffer_load_dwordx4 v[200:203], v118, s[4:7], s26 offen offset:0 sc1
    buffer_load_dwordx4 v[204:207], v118, s[4:7], s26 offen offset:1024 sc1
    s_add_u32 s26, s25, 88064
    buffer_load_dwordx4 v[208:211], v118, s[4:7], s26 offen offset:0 sc1
    buffer_load_dwordx4 v[212:215], v118, s[4:7], s26 offen offset:1024 sc1
    s_add_u32 s26, s25, 90112
    buffer_load_dwordx4 v[216:219], v118, s[4:7], s26 offen offset:0 sc1
    buffer_load_dwordx4 v[220:223], v118, s[4:7], s26 offen offset:1024 sc1
    s_add_u32 s26, s25, 92160
    buffer_load_dwordx4 v[224:227], v118, s[4:7], s26 offen offset:0 sc1
    buffer_load_dwordx4 v[228:231], v118, s[4:7], s26 offen offset:1024 sc1
    s_add_u32 s26, s25, 94208
    buffer_load_dwordx4 v[232:235], v118, s[4:7], s26 offen offset:0 sc1
    buffer_load_dwordx4 v[236:239], v118, s[4:7], s26 offen offset:1024 sc1
    s_add_u32 s26, s25, 96256
    buffer_load_dwordx4 v[240:243], v118, s[4:7], s26 offen offset:0 sc1
    buffer_load_dwordx4 v[244:247], v118, s[4:7], s26 offen offset:1024 sc1
    s_add_u32 s26, s25, 98304
    buffer_load_dwordx4 v[248:251], v118, s[4:7], s26 offen offset:0 sc1
    buffer_load_dwordx4 v[252:255], v118, s[4:7], s26 offen offset:1024 sc1
    s_waitcnt vmcnt(28)
    s_mov_b32 s18, 0
    s_mov_b32 s19, 0x2a00000
    s_mov_b32 s20, 0x2a01000
    s_mov_b32 s21, 0x2a80000
    s_mov_b32 s22, 0x3800000
    s_mov_b32 s24, 300000
    s_cmp_lg_u32 s16, 0
    s_cbranch_scc1 LAcg_100045
    v_and_b32 v5, 31, v0
    v_add_lshl_u32 v5, v5, 0, 2
LAcw_100044:
    buffer_load_dword v4, v5, s[12:15], 0 offen offset:64 sc1
    s_waitcnt vmcnt(0)
    v_cmp_gt_u32 vcc, 8, v4
    s_cbranch_vccz LAcg_100045
    s_sleep 12
    s_sub_u32 s24, s24, 1
    s_cbranch_scc1 Lexit_100001
    s_branch LAcw_100044
LAcg_100045:
    s_barrier
    v_mov_b32 v119, 0
    v_lshrrev_b32 v6, 3, v2
    v_lshlrev_b32 v7, 4, v6
    v_and_b32 v6, 3, v2
    v_lshl_add_u32 v7, v6, 2, v7
    v_bfe_u32 v6, v2, 2, 1
    v_lshl_add_u32 v7, v6, 1, v7
    v_add_u32 v7, 0, v7
    v_mul_u32_u24 v7, 896, v7
    v_mul_u32_u24 v6, 224, v1
    v_add_u32 v7, v7, v6
    buffer_load_dwordx4 v[56:59], v7, s[8:11], 0 offen offset:0
    buffer_load_dwordx4 v[60:63], v7, s[8:11], 0 offen offset:16
    buffer_load_dwordx4 v[64:67], v7, s[8:11], 0 offen offset:32
    buffer_load_dwordx4 v[68:71], v7, s[8:11], 0 offen offset:48
    buffer_load_dwordx4 v[72:75], v7, s[8:11], 0 offen offset:64
    buffer_load_dwordx4 v[76:79], v7, s[8:11], 0 offen offset:80
    buffer_load_dwordx4 v[80:83], v7, s[8:11], 0 offen offset:96
    buffer_load_dwordx4 v[84:87], v7, s[8:11], 0 offen offset:112
    buffer_load_dwordx4 v[88:91], v7, s[8:11], 0 offen offset:128
    buffer_load_dwordx4 v[92:95], v7, s[8:11], 0 offen offset:144
    buffer_load_dwordx4 v[96:99], v7, s[8:11], 0 offen offset:160
    buffer_load_dwordx4 v[100:103], v7, s[8:11], 0 offen offset:176
    buffer_load_dwordx4 v[104:107], v7, s[8:11], 0 offen offset:192
    buffer_load_dwordx4 v[108:111], v7, s[8:11], 0 offen offset:208
    s_waitcnt vmcnt(0)
    v_swap_b32 v57, v58
    v_swap_b32 v58, v60
    v_swap_b32 v59, v62
    v_swap_b32 v62, v61
    v_swap_b32 v65, v66
    v_swap_b32 v66, v68
    v_swap_b32 v67, v70
    v_swap_b32 v70, v69
    v_swap_b32 v73, v74
    v_swap_b32 v74, v76
    v_swap_b32 v75, v78
    v_swap_b32 v78, v77
    v_swap_b32 v81, v82
    v_swap_b32 v82, v84
    v_swap_b32 v83, v86
    v_swap_b32 v86, v85
    v_swap_b32 v89, v90
    v_swap_b32 v90, v92
    v_swap_b32 v91, v94
    v_swap_b32 v94, v93
    v_swap_b32 v97, v98
    v_swap_b32 v98, v100
    v_swap_b32 v99, v102
    v_swap_b32 v102, v101
    v_swap_b32 v105, v106
    v_swap_b32 v106, v108
    v_swap_b32 v107, v110
    v_swap_b32 v110, v109
    s_mov_b32 s46, 0
    v_mov_b32 v28, 0
    v_mov_b32 v29, 0
    v_mov_b32 v30, 0
    v_mov_b32 v31, 0
    v_mov_b32 v32, 0
    v_mov_b32 v33, 0
    v_mov_b32 v34, 0
    v_mov_b32 v35, 0
    v_mov_b32 v36, 0
    v_mov_b32 v37, 0
    v_mov_b32 v38, 0
    v_mov_b32 v39, 0
    v_mov_b32 v40, 0
    v_mov_b32 v41, 0
    v_mov_b32 v42, 0
    v_mov_b32 v43, 0
    v_mov_b32 v44, 0
    v_mov_b32 v45, 0
    v_mov_b32 v46, 0
    v_mov_b32 v47, 0
    v_mov_b32 v48, 0
    v_mov_b32 v49, 0
    v_mov_b32 v50, 0
    v_mov_b32 v51, 0
    v_mov_b32 v52, 0
    v_mov_b32 v53, 0
    v_mov_b32 v54, 0
    v_mov_b32 v55, 0
LA0step_100042:
    s_barrier
    buffer_load_dwordx4 v[0:3], v113, s[4:7], s19 offen offset:0 sc1
    s_nop 9
    buffer_load_dwordx4 v[4:7], v113, s[4:7], s19 offen offset:1024 sc1
    s_nop 9
    buffer_load_dwordx4 v[8:11], v113, s[4:7], s19 offen offset:2048 sc1
    s_nop 15
    s_nop 9
    s_mov_b32 m0, 8192
    s_nop 0
    buffer_load_dwordx4 v113, s[4:7], s19 offen offset:3072 sc1 lds
    s_mov_b32 m0, 8192
    s_nop 0
    buffer_load_dwordx4 v113, s[4:7], s19 offen offset:0 sc1 lds
LA0poll_100043:
    s_waitcnt vmcnt(4)
    v_smfmac_f32_16x16x64_bf16 v[28:31], v[0:3], a[0:7], v112
    v_max3_u32 v118, v0, v1, v2
    v_smfmac_f32_16x16x64_bf16 v[32:35], v[0:3], a[56:63], v112
    v_max_u32 v118, v118, v3
    v_smfmac_f32_16x16x64_bf16 v[36:39], v[0:3], a[112:119], v112
    v_cmp_eq_u32 vcc, -1, v118
    v_smfmac_f32_16x16x64_bf16 v[40:43], v[0:3], a[168:175], v112
    v_smfmac_f32_16x16x64_bf16 v[44:47], v[0:3], a[224:231], v112
    s_cbranch_vccnz Lfail_100046
    v_smfmac_f32_16x16x64_bf16 v[48:51], v[0:3], v[144:151], v112
    s_waitcnt vmcnt(3)
    v_max3_u32 v118, v4, v5, v6
    v_smfmac_f32_16x16x64_bf16 v[52:55], v[0:3], v[200:207], v112
    v_max_u32 v118, v118, v7
    v_smfmac_f32_16x16x64_bf16 v[28:31], v[4:7], a[8:15], v112
    v_smfmac_f32_16x16x64_bf16 v[32:35], v[4:7], a[64:71], v112
    v_smfmac_f32_16x16x64_bf16 v[36:39], v[4:7], a[120:127], v112
    v_smfmac_f32_16x16x64_bf16 v[40:43], v[4:7], a[176:183], v112
    s_waitcnt vmcnt(2)
    v_max3_u32 v118, v118, v8, v9
    v_smfmac_f32_16x16x64_bf16 v[44:47], v[4:7], a[232:239], v112
    v_max3_u32 v118, v118, v10, v11
    v_smfmac_f32_16x16x64_bf16 v[48:51], v[4:7], v[152:159], v112
    v_cmp_eq_u32 vcc, -1, v118
    v_smfmac_f32_16x16x64_bf16 v[52:55], v[4:7], v[208:215], v112
    v_smfmac_f32_16x16x64_bf16 v[28:31], v[8:11], a[16:23], v112
    s_cbranch_vccnz Lfail_100046
    v_smfmac_f32_16x16x64_bf16 v[32:35], v[8:11], a[72:79], v112
    v_smfmac_f32_16x16x64_bf16 v[36:39], v[8:11], a[128:135], v112
    s_waitcnt vmcnt(0)
    s_barrier
    ds_read_b128 v[12:15], v113 offset:11264
    v_mov_b32 v0, 0
    v_smfmac_f32_16x16x64_bf16 v[40:43], v[8:11], a[184:191], v112
    ds_read_b128 v[16:19], v113 offset:12288
    v_mov_b32 v1, 0
    v_smfmac_f32_16x16x64_bf16 v[44:47], v[8:11], a[240:247], v112
    ds_read_b128 v[20:23], v113 offset:13312
    v_mov_b32 v2, 0
    v_smfmac_f32_16x16x64_bf16 v[48:51], v[8:11], v[160:167], v112
    ds_read_b128 v[24:27], v113 offset:14336
    v_mov_b32 v3, 0
    v_smfmac_f32_16x16x64_bf16 v[52:55], v[8:11], v[216:223], v112
    s_waitcnt lgkmcnt(3)
    v_smfmac_f32_16x16x64_bf16 v[28:31], v[12:15], a[24:31], v112
    s_waitcnt lgkmcnt(2)
    v_smfmac_f32_16x16x64_bf16 v[28:31], v[16:19], a[32:39], v112
    s_waitcnt lgkmcnt(1)
    v_smfmac_f32_16x16x64_bf16 v[28:31], v[20:23], a[40:47], v112
    s_waitcnt lgkmcnt(0)
    v_smfmac_f32_16x16x64_bf16 v[28:31], v[24:27], a[48:55], v112
    v_smfmac_f32_16x16x64_bf16 v[32:35], v[12:15], a[80:87], v112
    v_smfmac_f32_16x16x64_bf16 v[32:35], v[16:19], a[88:95], v112
    v_add_f32 v28, v28, v29
    v_smfmac_f32_16x16x64_bf16 v[32:35], v[20:23], a[96:103], v112
    v_add_f32 v30, v30, v31
    v_smfmac_f32_16x16x64_bf16 v[32:35], v[24:27], a[104:111], v112
    v_cmp_u_f32 vcc, v28, v30
    v_cvt_pk_bf16_f32 v28, v28, v30
    v_smfmac_f32_16x16x64_bf16 v[36:39], v[12:15], a[136:143], v112
    ds_write_b32 v114, v28 offset:0
    v_smfmac_f32_16x16x64_bf16 v[36:39], v[16:19], a[144:151], v112
    s_cbranch_vccnz Lfail2_100047
Lcont2_100048:
    v_add_f32 v32, v32, v33
    v_smfmac_f32_16x16x64_bf16 v[36:39], v[20:23], a[152:159], v112
    v_add_f32 v34, v34, v35
    v_smfmac_f32_16x16x64_bf16 v[36:39], v[24:27], a[160:167], v112
    v_cvt_pk_bf16_f32 v32, v32, v34
    v_smfmac_f32_16x16x64_bf16 v[40:43], v[12:15], a[192:199], v112
    ds_write_b32 v114, v32 offset:256
    v_smfmac_f32_16x16x64_bf16 v[40:43], v[16:19], a[200:207], v112
    v_add_f32 v36, v36, v37
    v_smfmac_f32_16x16x64_bf16 v[40:43], v[20:23], a[208:215], v112
    v_add_f32 v38, v38, v39
    v_smfmac_f32_16x16x64_bf16 v[40:43], v[24:27], a[216:223], v112
    v_cvt_pk_bf16_f32 v36, v36, v38
    v_smfmac_f32_16x16x64_bf16 v[44:47], v[12:15], a[248:255], v112
    ds_write_b32 v114, v36 offset:512
    v_smfmac_f32_16x16x64_bf16 v[44:47], v[16:19], v[120:127], v112
    v_add_f32 v40, v40, v41
    v_smfmac_f32_16x16x64_bf16 v[44:47], v[20:23], v[128:135], v112
    v_add_f32 v42, v42, v43
    v_smfmac_f32_16x16x64_bf16 v[44:47], v[24:27], v[136:143], v112
    v_cvt_pk_bf16_f32 v40, v40, v42
    v_smfmac_f32_16x16x64_bf16 v[48:51], v[12:15], v[168:175], v112
    s_waitcnt lgkmcnt(0)
    s_barrier
    ds_write_b32 v114, v40 offset:768
    v_smfmac_f32_16x16x64_bf16 v[48:51], v[16:19], v[176:183], v112
    ds_read_b64_tr_b16 v[4:5], v115 offset:0
    ds_read_b64_tr_b16 v[6:7], v115 offset:1808
    v_add_f32 v44, v44, v45
    v_smfmac_f32_16x16x64_bf16 v[48:51], v[20:23], v[184:191], v112
    ds_read_b64_tr_b16 v[8:9], v115 offset:256
    v_add_f32 v46, v46, v47
    v_smfmac_f32_16x16x64_bf16 v[48:51], v[24:27], v[192:199], v112
    ds_read_b64_tr_b16 v[10:11], v115 offset:2064
    ds_read_b64_tr_b16 v[28:29], v115 offset:512
    v_cvt_pk_bf16_f32 v44, v44, v46
    v_smfmac_f32_16x16x64_bf16 v[52:55], v[12:15], v[224:231], v112
    ds_read_b64_tr_b16 v[30:31], v115 offset:2320
    ds_write_b32 v114, v44 offset:1024
    v_smfmac_f32_16x16x64_bf16 v[52:55], v[16:19], v[232:239], v112
    s_waitcnt lgkmcnt(7)
    s_barrier
    v_add_f32 v48, v48, v49
    v_smfmac_f32_16x16x64_bf16 v[52:55], v[20:23], v[240:247], v112
    ds_read_b64_tr_b16 v[32:33], v115 offset:768
    v_add_f32 v50, v50, v51
    v_smfmac_f32_16x16x64_bf16 v[52:55], v[24:27], v[248:255], v112
    ds_read_b64_tr_b16 v[34:35], v115 offset:2576
    v_cvt_pk_bf16_f32 v48, v48, v50
    s_waitcnt lgkmcnt(2)
    v_smfmac_f32_16x16x64_bf16 v[0:3], v[4:7], v[56:63], v112 abid:1
    ds_write_b32 v114, v48 offset:1280
    s_nop 2
    v_add_f32 v52, v52, v53
    v_add_f32 v54, v54, v55
    v_cvt_pk_bf16_f32 v52, v52, v54
    ds_write_b32 v114, v52 offset:1536
    v_smfmac_f32_16x16x64_bf16 v[0:3], v[8:11], v[64:71], v112 abid:1
    v_smfmac_f32_16x16x64_bf16 v[0:3], v[28:31], v[72:79], v112 abid:1
    s_waitcnt lgkmcnt(2)
    v_smfmac_f32_16x16x64_bf16 v[0:3], v[32:35], v[80:87], v112 abid:1
    s_waitcnt lgkmcnt(0)
    s_barrier
    ds_read_b64_tr_b16 v[36:37], v115 offset:1024
    ds_read_b64_tr_b16 v[38:39], v115 offset:2832
    ds_read_b64_tr_b16 v[40:41], v115 offset:1280
    ds_read_b64_tr_b16 v[42:43], v115 offset:3088
    ds_read_b64_tr_b16 v[44:45], v115 offset:1536
    ds_read_b64_tr_b16 v[46:47], v115 offset:3344
    s_waitcnt lgkmcnt(4)
    v_smfmac_f32_16x16x64_bf16 v[0:3], v[36:39], v[88:95], v112 abid:1
    s_waitcnt lgkmcnt(2)
    v_smfmac_f32_16x16x64_bf16 v[0:3], v[40:43], v[96:103], v112 abid:1
    s_waitcnt lgkmcnt(0)
    v_smfmac_f32_16x16x64_bf16 v[0:3], v[44:47], v[104:111], v112 abid:1
    s_nop 7
    ds_write2st64_b32 v117, v0, v1 offset0:0 offset1:1
    ds_write2st64_b32 v117, v2, v3 offset0:2 offset1:3
    s_waitcnt lgkmcnt(0)
    s_barrier
    s_add_u32 s26, s21, 30720
    v_cmp_ne_u32 vcc, 15, v119
    s_cbranch_vccz Lcvg_100050
Lcvp_100049:
    buffer_load_dword v119, off, s[4:7], s26 sc1
    s_waitcnt vmcnt(0)
    v_cmp_ne_u32 vcc, 15, v119
    s_cbranch_vccz Lcvg_100050
    s_sleep 1
    s_sub_u32 s24, s24, 1
    s_cbranch_scc1 Lexit_100001
    s_branch Lcvp_100049
Lcvg_100050:
    s_add_u32 s26, s26, 16384
    buffer_load_dword v119, off, s[4:7], s26 sc1
    s_add_u32 s25, s22, 28672
    buffer_load_dwordx4 v[56:59], v116, s[4:7], s25 offen offset:0 sc1
    s_nop 13
    buffer_load_dwordx4 v[60:63], v116, s[4:7], s25 offen offset:1024 sc1
    s_nop 13
    buffer_load_dwordx4 v[64:67], v116, s[4:7], s25 offen offset:2048 sc1
    s_nop 13
    buffer_load_dwordx4 v[68:71], v116, s[4:7], s25 offen offset:3072 sc1
    s_nop 13
    s_add_u32 s25, s22, 32768
    buffer_load_dwordx4 v[72:75], v116, s[4:7], s25 offen offset:0 sc1
    s_nop 13
    buffer_load_dwordx4 v[76:79], v116, s[4:7], s25 offen offset:1024 sc1
    v_mov_b32 v28, 0
    v_mov_b32 v29, 0
    v_mov_b32 v30, 0
    v_mov_b32 v31, 0
    v_mov_b32 v32, 0
    v_mov_b32 v33, 0
    v_mov_b32 v34, 0
    v_mov_b32 v35, 0
    v_mov_b32 v36, 0
    v_mov_b32 v37, 0
    v_mov_b32 v38, 0
    v_mov_b32 v39, 0
    v_mov_b32 v40, 0
    v_mov_b32 v41, 0
    buffer_load_dwordx4 v[80:83], v116, s[4:7], s25 offen offset:2048 sc1
    v_mov_b32 v42, 0
    v_mov_b32 v43, 0
    v_mov_b32 v44, 0
    v_mov_b32 v45, 0
    v_mov_b32 v46, 0
    v_mov_b32 v47, 0
    v_mov_b32 v48, 0
    v_mov_b32 v49, 0
    v_mov_b32 v50, 0
    v_mov_b32 v51, 0
    v_mov_b32 v52, 0
    v_mov_b32 v53, 0
    v_mov_b32 v54, 0
    v_mov_b32 v55, 0
    buffer_load_dwordx4 v[84:87], v116, s[4:7], s25 offen offset:3072 sc1
    s_nop 13
    s_add_u32 s25, s22, 36864
    buffer_load_dwordx4 v[88:91], v116, s[4:7], s25 offen offset:0 sc1
    s_nop 15
    s_nop 1
    buffer_load_dwordx4 v[92:95], v116, s[4:7], s25 offen offset:1024 sc1
    s_nop 15
    s_nop 1
    buffer_load_dwordx4 v[96:99], v116, s[4:7], s25 offen offset:2048 sc1
    s_nop 15
    s_nop 1
    buffer_load_dwordx4 v[100:103], v116, s[4:7], s25 offen offset:3072 sc1
    s_nop 15
    s_nop 1
    s_add_u32 s25, s22, 40960
    buffer_load_dwordx4 v[104:107], v116, s[4:7], s25 offen offset:0 sc1
    s_nop 15
    s_nop 1
    buffer_load_dwordx4 v[108:111], v116, s[4:7], s25 offen offset:1024 sc1
    s_add_u32 s19, s19, 8192
    s_add_u32 s20, s20, 8192
    s_add_u32 s21, s21, 16384
    s_add_u32 s22, s22, 28672
    s_add_u32 s23, s23, 458752
    s_add_u32 s18, s18, 1
    s_cmp_lt_u32 s18, 63
    s_cbranch_scc1 LA0step_100042
    s_endpgm
Lfail2_100047:
    v_max3_u32 v118, v12, v13, v14
    v_max_u32 v118, v118, v15
    v_max3_u32 v118, v118, v16, v17
    v_max3_u32 v118, v118, v18, v19
    v_max3_u32 v118, v118, v20, v21
    v_max3_u32 v118, v118, v22, v23
    v_max3_u32 v118, v118, v24, v25
    v_max3_u32 v118, v118, v26, v27
    v_cmp_eq_u32 vcc, -1, v118
    s_cbranch_vccz Lcont2_100048
    s_waitcnt lgkmcnt(0)
    s_barrier
Lfail_100046:
    buffer_load_dwordx4 v[0:3], v113, s[4:7], s19 offen offset:0 sc1
    s_nop 9
    buffer_load_dwordx4 v[4:7], v113, s[4:7], s19 offen offset:1024 sc1
    s_nop 9
    buffer_load_dwordx4 v[8:11], v113, s[4:7], s19 offen offset:2048 sc1
    s_nop 15
    s_nop 9
    s_mov_b32 m0, 8192
    s_nop 0
    buffer_load_dwordx4 v113, s[4:7], s19 offen offset:3072 sc1 lds
    s_mov_b32 m0, 8192
    s_nop 0
    buffer_load_dwordx4 v113, s[4:7], s19 offen offset:0 sc1 lds
    s_sub_u32 s24, s24, 1
    s_cbranch_scc1 Lexit_100001
    v_mov_b32 v28, 0
    v_mov_b32 v29, 0
    v_mov_b32 v30, 0
    v_mov_b32 v31, 0
    v_mov_b32 v32, 0
    v_mov_b32 v33, 0
    v_mov_b32 v34, 0
    v_mov_b32 v35, 0
    v_mov_b32 v36, 0
    v_mov_b32 v37, 0
    v_mov_b32 v38, 0
    v_mov_b32 v39, 0
    v_mov_b32 v40, 0
    v_mov_b32 v41, 0
    v_mov_b32 v42, 0
    v_mov_b32 v43, 0
    v_mov_b32 v44, 0
    v_mov_b32 v45, 0
    v_mov_b32 v46, 0
    v_mov_b32 v47, 0
    v_mov_b32 v48, 0
    v_mov_b32 v49, 0
    v_mov_b32 v50, 0
    v_mov_b32 v51, 0
    v_mov_b32 v52, 0
    v_mov_b32 v53, 0
    v_mov_b32 v54, 0
    v_mov_b32 v55, 0
    s_branch LA0poll_100043
LAw1_100036:
    v_and_b32 v3, 63, v0
    v_lshrrev_b32 v1, 4, v3
    v_and_b32 v2, 15, v3
    v_and_b32 v118, 1, v2
    v_mul_u32_u24 v112, 0xAAAA, v118
    v_lshrrev_b32 v118, 3, v2
    v_mul_u32_u24 v118, 0xAAAA, v118
    v_lshl_add_u32 v112, v118, 16, v112
    v_add_u32 v112, 0x44444444, v112
    v_lshlrev_b32 v113, 8, v1
    v_lshl_add_u32 v113, v2, 4, v113
    v_lshlrev_b32 v114, 4, v2
    v_lshl_add_u32 v114, v1, 2, v114
    v_add_u32 v114, 1808, v114
    v_and_b32 v118, 1, v1
    v_mul_u32_u24 v115, 3616, v118
    v_lshrrev_b32 v118, 3, v2
    v_lshl_add_u32 v115, v118, 7, v115
    v_bfe_u32 v118, v2, 1, 1
    v_lshl_add_u32 v115, v118, 6, v115
    v_lshrrev_b32 v118, 1, v1
    v_lshl_add_u32 v115, v118, 5, v115
    v_bfe_u32 v118, v2, 2, 1
    v_lshl_add_u32 v115, v118, 4, v115
    v_and_b32 v118, 1, v2
    v_lshl_add_u32 v115, v118, 3, v115
    v_lshlrev_b32 v117, 10, v1
    v_lshl_add_u32 v117, v2, 3, v117
    v_add_u32 v117, 16388, v117
    v_lshlrev_b32 v116, 4, v3
    s_lshr_b32 s60, s17, 3
    s_and_b32 s61, s17, 7
    s_lshl_b32 s61, s61, 3
    s_add_u32 s61, s61, s16
    s_mov_b64 exec, 0x11
    s_lshl_b64 exec, exec, s61
    v_mov_b32 v5, v232
    s_mov_b32 s62, 64
    s_cmp_eq_u32 s60, 1
    s_cselect_b64 vcc, -1, 0
    v_cndmask_b32 v5, v5, v233, vcc
    s_cmp_eq_u32 s60, 2
    s_cselect_b64 vcc, -1, 0
    v_cndmask_b32 v5, v5, v234, vcc
    s_cmp_eq_u32 s60, 3
    s_cselect_b64 vcc, -1, 0
    v_cndmask_b32 v5, v5, v235, vcc
    s_lshl_b32 s60, s60, 11
    s_add_u32 s60, s60, 0x3d40000
LAww_100051:
    buffer_load_dword v4, v237, s[4:7], s60 offen sc1
    s_waitcnt vmcnt(0)
    v_cmp_eq_u32 vcc, v4, v5
    s_cbranch_vccz LAwg_100052
    s_sleep 12
    s_sub_u32 s62, s62, 1
    s_cbranch_scc0 LAww_100051
    s_mov_b64 exec, -1
    v_and_b32 v5, 31, v0
    v_lshlrev_b32 v5, 2, v5
LAwf_100053:
    buffer_load_dword v4, v5, s[12:15], 0 offen offset:64 sc1
    s_waitcnt vmcnt(0)
    v_cmp_gt_u32 vcc, 8, v4
    s_cbranch_vccz LAwg_100052
    s_sleep 30
    s_sub_u32 s24, s24, 1
    s_cbranch_scc1 Lexit_100001
    s_branch LAwf_100053
LAwg_100052:
    s_mov_b64 exec, -1
    v_lshlrev_b32 v118, 4, v3
    s_mul_i32 s25, s17, 401408
    s_add_u32 s25, s25, 100352
    s_add_u32 s26, s25, 2048
    buffer_load_dwordx4 a[0:3], v118, s[4:7], s26 offen offset:0 sc1
    buffer_load_dwordx4 a[4:7], v118, s[4:7], s26 offen offset:1024 sc1
    s_add_u32 s26, s25, 4096
    buffer_load_dwordx4 a[8:11], v118, s[4:7], s26 offen offset:0 sc1
    buffer_load_dwordx4 a[12:15], v118, s[4:7], s26 offen offset:1024 sc1
    s_add_u32 s26, s25, 0
    buffer_load_dwordx4 a[16:19], v118, s[4:7], s26 offen offset:0 sc1
    buffer_load_dwordx4 a[20:23], v118, s[4:7], s26 offen offset:1024 sc1
    s_add_u32 s26, s25, 6144
    buffer_load_dwordx4 a[24:27], v118, s[4:7], s26 offen offset:0 sc1
    buffer_load_dwordx4 a[28:31], v118, s[4:7], s26 offen offset:1024 sc1
    s_add_u32 s26, s25, 8192
    buffer_load_dwordx4 a[32:35], v118, s[4:7], s26 offen offset:0 sc1
    buffer_load_dwordx4 a[36:39], v118, s[4:7], s26 offen offset:1024 sc1
    s_add_u32 s26, s25, 10240
    buffer_load_dwordx4 a[40:43], v118, s[4:7], s26 offen offset:0 sc1
    buffer_load_dwordx4 a[44:47], v118, s[4:7], s26 offen offset:1024 sc1
    s_add_u32 s26, s25, 12288
    buffer_load_dwordx4 a[48:51], v118, s[4:7], s26 offen offset:0 sc1
    buffer_load_dwordx4 a[52:55], v118, s[4:7], s26 offen offset:1024 sc1
    s_add_u32 s26, s25, 16384
    buffer_load_dwordx4 a[56:59], v118, s[4:7], s26 offen offset:0 sc1
    buffer_load_dwordx4 a[60:63], v118, s[4:7], s26 offen offset:1024 sc1
    s_add_u32 s26, s25, 18432
    buffer_load_dwordx4 a[64:67], v118, s[4:7], s26 offen offset:0 sc1
    buffer_load_dwordx4 a[68:71], v118, s[4:7], s26 offen offset:1024 sc1
    s_add_u32 s26, s25, 14336
    buffer_load_dwordx4 a[72:75], v118, s[4:7], s26 offen offset:0 sc1
    buffer_load_dwordx4 a[76:79], v118, s[4:7], s26 offen offset:1024 sc1
    s_add_u32 s26, s25, 20480
    buffer_load_dwordx4 a[80:83], v118, s[4:7], s26 offen offset:0 sc1
    buffer_load_dwordx4 a[84:87], v118, s[4:7], s26 offen offset:1024 sc1
    s_add_u32 s26, s25, 22528
    buffer_load_dwordx4 a[88:91], v118, s[4:7], s26 offen offset:0 sc1
    buffer_load_dwordx4 a[92:95], v118, s[4:7], s26 offen offset:1024 sc1
    s_add_u32 s26, s25, 24576
    buffer_load_dwordx4 a[96:99], v118, s[4:7], s26 offen offset:0 sc1
    buffer_load_dwordx4 a[100:103], v118, s[4:7], s26 offen offset:1024 sc1
    s_add_u32 s26, s25, 26624
    buffer_load_dwordx4 a[104:107], v118, s[4:7], s26 offen offset:0 sc1
    buffer_load_dwordx4 a[108:111], v118, s[4:7], s26 offen offset:1024 sc1
    s_add_u32 s26, s25, 30720
    buffer_load_dwordx4 a[112:115], v118, s[4:7], s26 offen offset:0 sc1
    buffer_load_dwordx4 a[116:119], v118, s[4:7], s26 offen offset:1024 sc1
    s_add_u32 s26, s25, 32768
    buffer_load_dwordx4 a[120:123], v118, s[4:7], s26 offen offset:0 sc1
    buffer_load_dwordx4 a[124:127], v118, s[4:7], s26 offen offset:1024 sc1
    s_add_u32 s26, s25, 28672
    buffer_load_dwordx4 a[128:131], v118, s[4:7], s26 offen offset:0 sc1
    buffer_load_dwordx4 a[132:135], v118, s[4:7], s26 offen offset:1024 sc1
    s_add_u32 s26, s25, 34816
    buffer_load_dwordx4 a[136:139], v118, s[4:7], s26 offen offset:0 sc1
    buffer_load_dwordx4 a[140:143], v118, s[4:7], s26 offen offset:1024 sc1
    s_add_u32 s26, s25, 36864
    buffer_load_dwordx4 a[144:147], v118, s[4:7], s26 offen offset:0 sc1
    buffer_load_dwordx4 a[148:151], v118, s[4:7], s26 offen offset:1024 sc1
    s_add_u32 s26, s25, 38912
    buffer_load_dwordx4 a[152:155], v118, s[4:7], s26 offen offset:0 sc1
    buffer_load_dwordx4 a[156:159], v118, s[4:7], s26 offen offset:1024 sc1
    s_add_u32 s26, s25, 40960
    buffer_load_dwordx4 a[160:163], v118, s[4:7], s26 offen offset:0 sc1
    buffer_load_dwordx4 a[164:167], v118, s[4:7], s26 offen offset:1024 sc1
    s_waitcnt vmcnt(28)
    s_add_u32 s26, s25, 45056
    buffer_load_dwordx4 a[168:171], v118, s[4:7], s26 offen offset:0 sc1
    buffer_load_dwordx4 a[172:175], v118, s[4:7], s26 offen offset:1024 sc1
    s_add_u32 s26, s25, 47104
    buffer_load_dwordx4 a[176:179], v118, s[4:7], s26 offen offset:0 sc1
    buffer_load_dwordx4 a[180:183], v118, s[4:7], s26 offen offset:1024 sc1
    s_add_u32 s26, s25, 43008
    buffer_load_dwordx4 a[184:187], v118, s[4:7], s26 offen offset:0 sc1
    buffer_load_dwordx4 a[188:191], v118, s[4:7], s26 offen offset:1024 sc1
    s_add_u32 s26, s25, 49152
    buffer_load_dwordx4 a[192:195], v118, s[4:7], s26 offen offset:0 sc1
    buffer_load_dwordx4 a[196:199], v118, s[4:7], s26 offen offset:1024 sc1
    s_add_u32 s26, s25, 51200
    buffer_load_dwordx4 a[200:203], v118, s[4:7], s26 offen offset:0 sc1
    buffer_load_dwordx4 a[204:207], v118, s[4:7], s26 offen offset:1024 sc1
    s_add_u32 s26, s25, 53248
    buffer_load_dwordx4 a[208:211], v118, s[4:7], s26 offen offset:0 sc1
    buffer_load_dwordx4 a[212:215], v118, s[4:7], s26 offen offset:1024 sc1
    s_add_u32 s26, s25, 55296
    buffer_load_dwordx4 a[216:219], v118, s[4:7], s26 offen offset:0 sc1
    buffer_load_dwordx4 a[220:223], v118, s[4:7], s26 offen offset:1024 sc1
    s_waitcnt vmcnt(28)
    s_add_u32 s26, s25, 59392
    buffer_load_dwordx4 a[224:227], v118, s[4:7], s26 offen offset:0 sc1
    buffer_load_dwordx4 a[228:231], v118, s[4:7], s26 offen offset:1024 sc1
    s_add_u32 s26, s25, 61440
    buffer_load_dwordx4 a[232:235], v118, s[4:7], s26 offen offset:0 sc1
    buffer_load_dwordx4 a[236:239], v118, s[4:7], s26 offen offset:1024 sc1
    s_add_u32 s26, s25, 57344
    buffer_load_dwordx4 a[240:243], v118, s[4:7], s26 offen offset:0 sc1
    buffer_load_dwordx4 a[244:247], v118, s[4:7], s26 offen offset:1024 sc1
    s_add_u32 s26, s25, 63488
    buffer_load_dwordx4 a[248:251], v118, s[4:7], s26 offen offset:0 sc1
    buffer_load_dwordx4 a[252:255], v118, s[4:7], s26 offen offset:1024 sc1
    s_add_u32 s26, s25, 65536
    buffer_load_dwordx4 v[120:123], v118, s[4:7], s26 offen offset:0 sc1
    buffer_load_dwordx4 v[124:127], v118, s[4:7], s26 offen offset:1024 sc1
    s_add_u32 s26, s25, 67584
    buffer_load_dwordx4 v[128:131], v118, s[4:7], s26 offen offset:0 sc1
    buffer_load_dwordx4 v[132:135], v118, s[4:7], s26 offen offset:1024 sc1
    s_add_u32 s26, s25, 69632
    buffer_load_dwordx4 v[136:139], v118, s[4:7], s26 offen offset:0 sc1
    buffer_load_dwordx4 v[140:143], v118, s[4:7], s26 offen offset:1024 sc1
    s_waitcnt vmcnt(28)
    s_add_u32 s26, s25, 73728
    buffer_load_dwordx4 v[144:147], v118, s[4:7], s26 offen offset:0 sc1
    buffer_load_dwordx4 v[148:151], v118, s[4:7], s26 offen offset:1024 sc1
    s_add_u32 s26, s25, 75776
    buffer_load_dwordx4 v[152:155], v118, s[4:7], s26 offen offset:0 sc1
    buffer_load_dwordx4 v[156:159], v118, s[4:7], s26 offen offset:1024 sc1
    s_add_u32 s26, s25, 71680
    buffer_load_dwordx4 v[160:163], v118, s[4:7], s26 offen offset:0 sc1
    buffer_load_dwordx4 v[164:167], v118, s[4:7], s26 offen offset:1024 sc1
    s_add_u32 s26, s25, 77824
    buffer_load_dwordx4 v[168:171], v118, s[4:7], s26 offen offset:0 sc1
    buffer_load_dwordx4 v[172:175], v118, s[4:7], s26 offen offset:1024 sc1
    s_add_u32 s26, s25, 79872
    buffer_load_dwordx4 v[176:179], v118, s[4:7], s26 offen offset:0 sc1
    buffer_load_dwordx4 v[180:183], v118, s[4:7], s26 offen offset:1024 sc1
    s_add_u32 s26, s25, 81920
    buffer_load_dwordx4 v[184:187], v118, s[4:7], s26 offen offset:0 sc1
    buffer_load_dwordx4 v[188:191], v118, s[4:7], s26 offen offset:1024 sc1
    s_add_u32 s26, s25, 83968
    buffer_load_dwordx4 v[192:195], v118, s[4:7], s26 offen offset:0 sc1
    buffer_load_dwordx4 v[196:199], v118, s[4:7], s26 offen offset:1024 sc1
    s_waitcnt vmcnt(28)
    s_add_u32 s26, s25, 88064
    buffer_load_dwordx4 v[200:203], v118, s[4:7], s26 offen offset:0 sc1
    buffer_load_dwordx4 v[204:207], v118, s[4:7], s26 offen offset:1024 sc1
    s_add_u32 s26, s25, 90112
    buffer_load_dwordx4 v[208:211], v118, s[4:7], s26 offen offset:0 sc1
    buffer_load_dwordx4 v[212:215], v118, s[4:7], s26 offen offset:1024 sc1
    s_add_u32 s26, s25, 86016
    buffer_load_dwordx4 v[216:219], v118, s[4:7], s26 offen offset:0 sc1
    buffer_load_dwordx4 v[220:223], v118, s[4:7], s26 offen offset:1024 sc1
    s_add_u32 s26, s25, 92160
    buffer_load_dwordx4 v[224:227], v118, s[4:7], s26 offen offset:0 sc1
    buffer_load_dwordx4 v[228:231], v118, s[4:7], s26 offen offset:1024 sc1
    s_add_u32 s26, s25, 94208
    buffer_load_dwordx4 v[232:235], v118, s[4:7], s26 offen offset:0 sc1
    buffer_load_dwordx4 v[236:239], v118, s[4:7], s26 offen offset:1024 sc1
    s_add_u32 s26, s25, 96256
    buffer_load_dwordx4 v[240:243], v118, s[4:7], s26 offen offset:0 sc1
    buffer_load_dwordx4 v[244:247], v118, s[4:7], s26 offen offset:1024 sc1
    s_add_u32 s26, s25, 98304
    buffer_load_dwordx4 v[248:251], v118, s[4:7], s26 offen offset:0 sc1
    buffer_load_dwordx4 v[252:255], v118, s[4:7], s26 offen offset:1024 sc1
    s_waitcnt vmcnt(28)
    s_mov_b32 s18, 0
    s_mov_b32 s19, 0x2a00000
    s_mov_b32 s20, 0x2a01000
    s_mov_b32 s21, 0x2a80000
    s_mov_b32 s22, 0x3803800
    s_mov_b32 s24, 300000
    s_cmp_lg_u32 s16, 0
    s_cbranch_scc1 LAcg_100057
    v_and_b32 v5, 31, v0
    v_add_lshl_u32 v5, v5, 0, 2
LAcw_100056:
    buffer_load_dword v4, v5, s[12:15], 0 offen offset:64 sc1
    s_waitcnt vmcnt(0)
    v_cmp_gt_u32 vcc, 8, v4
    s_cbranch_vccz LAcg_100057
    s_sleep 12
    s_sub_u32 s24, s24, 1
    s_cbranch_scc1 Lexit_100001
    s_branch LAcw_100056
LAcg_100057:
    s_barrier
    v_mov_b32 v119, 0
    v_lshrrev_b32 v6, 3, v2
    v_lshlrev_b32 v7, 4, v6
    v_and_b32 v6, 3, v2
    v_lshl_add_u32 v7, v6, 2, v7
    v_bfe_u32 v6, v2, 2, 1
    v_lshl_add_u32 v7, v6, 1, v7
    v_add_u32 v7, 1, v7
    v_mul_u32_u24 v7, 896, v7
    v_mul_u32_u24 v6, 224, v1
    v_add_u32 v7, v7, v6
    buffer_load_dwordx4 v[56:59], v7, s[8:11], 0 offen offset:0
    buffer_load_dwordx4 v[60:63], v7, s[8:11], 0 offen offset:16
    buffer_load_dwordx4 v[64:67], v7, s[8:11], 0 offen offset:32
    buffer_load_dwordx4 v[68:71], v7, s[8:11], 0 offen offset:48
    buffer_load_dwordx4 v[72:75], v7, s[8:11], 0 offen offset:64
    buffer_load_dwordx4 v[76:79], v7, s[8:11], 0 offen offset:80
    buffer_load_dwordx4 v[80:83], v7, s[8:11], 0 offen offset:96
    buffer_load_dwordx4 v[84:87], v7, s[8:11], 0 offen offset:112
    buffer_load_dwordx4 v[88:91], v7, s[8:11], 0 offen offset:128
    buffer_load_dwordx4 v[92:95], v7, s[8:11], 0 offen offset:144
    buffer_load_dwordx4 v[96:99], v7, s[8:11], 0 offen offset:160
    buffer_load_dwordx4 v[100:103], v7, s[8:11], 0 offen offset:176
    buffer_load_dwordx4 v[104:107], v7, s[8:11], 0 offen offset:192
    buffer_load_dwordx4 v[108:111], v7, s[8:11], 0 offen offset:208
    s_waitcnt vmcnt(0)
    v_swap_b32 v57, v58
    v_swap_b32 v58, v60
    v_swap_b32 v59, v62
    v_swap_b32 v62, v61
    v_swap_b32 v65, v66
    v_swap_b32 v66, v68
    v_swap_b32 v67, v70
    v_swap_b32 v70, v69
    v_swap_b32 v73, v74
    v_swap_b32 v74, v76
    v_swap_b32 v75, v78
    v_swap_b32 v78, v77
    v_swap_b32 v81, v82
    v_swap_b32 v82, v84
    v_swap_b32 v83, v86
    v_swap_b32 v86, v85
    v_swap_b32 v89, v90
    v_swap_b32 v90, v92
    v_swap_b32 v91, v94
    v_swap_b32 v94, v93
    v_swap_b32 v97, v98
    v_swap_b32 v98, v100
    v_swap_b32 v99, v102
    v_swap_b32 v102, v101
    v_swap_b32 v105, v106
    v_swap_b32 v106, v108
    v_swap_b32 v107, v110
    v_swap_b32 v110, v109
    s_mov_b32 s46, 0
    v_mov_b32 v28, 0
    v_mov_b32 v29, 0
    v_mov_b32 v30, 0
    v_mov_b32 v31, 0
    v_mov_b32 v32, 0
    v_mov_b32 v33, 0
    v_mov_b32 v34, 0
    v_mov_b32 v35, 0
    v_mov_b32 v36, 0
    v_mov_b32 v37, 0
    v_mov_b32 v38, 0
    v_mov_b32 v39, 0
    v_mov_b32 v40, 0
    v_mov_b32 v41, 0
    v_mov_b32 v42, 0
    v_mov_b32 v43, 0
    v_mov_b32 v44, 0
    v_mov_b32 v45, 0
    v_mov_b32 v46, 0
    v_mov_b32 v47, 0
    v_mov_b32 v48, 0
    v_mov_b32 v49, 0
    v_mov_b32 v50, 0
    v_mov_b32 v51, 0
    v_mov_b32 v52, 0
    v_mov_b32 v53, 0
    v_mov_b32 v54, 0
    v_mov_b32 v55, 0
LA1step_100054:
    s_barrier
    buffer_load_dwordx4 v[0:3], v113, s[4:7], s19 offen offset:1024 sc1
    s_nop 9
    buffer_load_dwordx4 v[4:7], v113, s[4:7], s19 offen offset:2048 sc1
    s_nop 9
    buffer_load_dwordx4 v[8:11], v113, s[4:7], s19 offen offset:0 sc1
    s_nop 15
    s_nop 9
    s_mov_b32 m0, 12288
    s_nop 0
    buffer_load_dwordx4 v113, s[4:7], s20 offen offset:0 sc1 lds
    s_mov_b32 m0, 8192
    s_nop 0
    buffer_load_dwordx4 v113, s[4:7], s19 offen offset:1024 sc1 lds
LA1poll_100055:
    s_waitcnt vmcnt(4)
    v_smfmac_f32_16x16x64_bf16 v[28:31], v[0:3], a[0:7], v112
    v_max3_u32 v118, v0, v1, v2
    v_smfmac_f32_16x16x64_bf16 v[32:35], v[0:3], a[56:63], v112
    v_max_u32 v118, v118, v3
    v_smfmac_f32_16x16x64_bf16 v[36:39], v[0:3], a[112:119], v112
    v_cmp_eq_u32 vcc, -1, v118
    v_smfmac_f32_16x16x64_bf16 v[40:43], v[0:3], a[168:175], v112
    v_smfmac_f32_16x16x64_bf16 v[44:47], v[0:3], a[224:231], v112
    s_cbranch_vccnz Lfail_100058
    v_smfmac_f32_16x16x64_bf16 v[48:51], v[0:3], v[144:151], v112
    s_waitcnt vmcnt(3)
    v_max3_u32 v118, v4, v5, v6
    v_smfmac_f32_16x16x64_bf16 v[52:55], v[0:3], v[200:207], v112
    v_max_u32 v118, v118, v7
    v_smfmac_f32_16x16x64_bf16 v[28:31], v[4:7], a[8:15], v112
    v_smfmac_f32_16x16x64_bf16 v[32:35], v[4:7], a[64:71], v112
    v_smfmac_f32_16x16x64_bf16 v[36:39], v[4:7], a[120:127], v112
    v_smfmac_f32_16x16x64_bf16 v[40:43], v[4:7], a[176:183], v112
    s_waitcnt vmcnt(2)
    v_max3_u32 v118, v118, v8, v9
    v_smfmac_f32_16x16x64_bf16 v[44:47], v[4:7], a[232:239], v112
    v_max3_u32 v118, v118, v10, v11
    v_smfmac_f32_16x16x64_bf16 v[48:51], v[4:7], v[152:159], v112
    v_cmp_eq_u32 vcc, -1, v118
    v_smfmac_f32_16x16x64_bf16 v[52:55], v[4:7], v[208:215], v112
    v_smfmac_f32_16x16x64_bf16 v[28:31], v[8:11], a[16:23], v112
    s_cbranch_vccnz Lfail_100058
    v_smfmac_f32_16x16x64_bf16 v[32:35], v[8:11], a[72:79], v112
    v_smfmac_f32_16x16x64_bf16 v[36:39], v[8:11], a[128:135], v112
    s_waitcnt vmcnt(0)
    s_barrier
    ds_read_b128 v[12:15], v113 offset:11264
    v_mov_b32 v0, 0
    v_smfmac_f32_16x16x64_bf16 v[40:43], v[8:11], a[184:191], v112
    ds_read_b128 v[16:19], v113 offset:12288
    v_mov_b32 v1, 0
    v_smfmac_f32_16x16x64_bf16 v[44:47], v[8:11], a[240:247], v112
    ds_read_b128 v[20:23], v113 offset:13312
    v_mov_b32 v2, 0
    v_smfmac_f32_16x16x64_bf16 v[48:51], v[8:11], v[160:167], v112
    ds_read_b128 v[24:27], v113 offset:14336
    v_mov_b32 v3, 0
    v_smfmac_f32_16x16x64_bf16 v[52:55], v[8:11], v[216:223], v112
    s_waitcnt lgkmcnt(3)
    v_smfmac_f32_16x16x64_bf16 v[28:31], v[12:15], a[24:31], v112
    s_waitcnt lgkmcnt(2)
    v_smfmac_f32_16x16x64_bf16 v[28:31], v[16:19], a[32:39], v112
    s_waitcnt lgkmcnt(1)
    v_smfmac_f32_16x16x64_bf16 v[28:31], v[20:23], a[40:47], v112
    s_waitcnt lgkmcnt(0)
    v_smfmac_f32_16x16x64_bf16 v[28:31], v[24:27], a[48:55], v112
    v_smfmac_f32_16x16x64_bf16 v[32:35], v[12:15], a[80:87], v112
    v_smfmac_f32_16x16x64_bf16 v[32:35], v[16:19], a[88:95], v112
    v_add_f32 v28, v28, v29
    v_smfmac_f32_16x16x64_bf16 v[32:35], v[20:23], a[96:103], v112
    v_add_f32 v30, v30, v31
    v_smfmac_f32_16x16x64_bf16 v[32:35], v[24:27], a[104:111], v112
    v_cmp_u_f32 vcc, v28, v30
    v_cvt_pk_bf16_f32 v28, v28, v30
    v_smfmac_f32_16x16x64_bf16 v[36:39], v[12:15], a[136:143], v112
    ds_write_b32 v114, v28 offset:0
    v_smfmac_f32_16x16x64_bf16 v[36:39], v[16:19], a[144:151], v112
    s_cbranch_vccnz Lfail2_100059
Lcont2_100060:
    v_add_f32 v32, v32, v33
    v_smfmac_f32_16x16x64_bf16 v[36:39], v[20:23], a[152:159], v112
    v_add_f32 v34, v34, v35
    v_smfmac_f32_16x16x64_bf16 v[36:39], v[24:27], a[160:167], v112
    v_cvt_pk_bf16_f32 v32, v32, v34
    v_smfmac_f32_16x16x64_bf16 v[40:43], v[12:15], a[192:199], v112
    ds_write_b32 v114, v32 offset:256
    v_smfmac_f32_16x16x64_bf16 v[40:43], v[16:19], a[200:207], v112
    v_add_f32 v36, v36, v37
    v_smfmac_f32_16x16x64_bf16 v[40:43], v[20:23], a[208:215], v112
    v_add_f32 v38, v38, v39
    v_smfmac_f32_16x16x64_bf16 v[40:43], v[24:27], a[216:223], v112
    v_cvt_pk_bf16_f32 v36, v36, v38
    v_smfmac_f32_16x16x64_bf16 v[44:47], v[12:15], a[248:255], v112
    ds_write_b32 v114, v36 offset:512
    v_smfmac_f32_16x16x64_bf16 v[44:47], v[16:19], v[120:127], v112
    v_add_f32 v40, v40, v41
    v_smfmac_f32_16x16x64_bf16 v[44:47], v[20:23], v[128:135], v112
    v_add_f32 v42, v42, v43
    v_smfmac_f32_16x16x64_bf16 v[44:47], v[24:27], v[136:143], v112
    v_cvt_pk_bf16_f32 v40, v40, v42
    v_smfmac_f32_16x16x64_bf16 v[48:51], v[12:15], v[168:175], v112
    s_waitcnt lgkmcnt(0)
    s_barrier
    ds_write_b32 v114, v40 offset:768
    v_smfmac_f32_16x16x64_bf16 v[48:51], v[16:19], v[176:183], v112
    ds_read_b64_tr_b16 v[4:5], v115 offset:0
    ds_read_b64_tr_b16 v[6:7], v115 offset:1808
    v_add_f32 v44, v44, v45
    v_smfmac_f32_16x16x64_bf16 v[48:51], v[20:23], v[184:191], v112
    ds_read_b64_tr_b16 v[8:9], v115 offset:256
    v_add_f32 v46, v46, v47
    v_smfmac_f32_16x16x64_bf16 v[48:51], v[24:27], v[192:199], v112
    ds_read_b64_tr_b16 v[10:11], v115 offset:2064
    ds_read_b64_tr_b16 v[28:29], v115 offset:512
    v_cvt_pk_bf16_f32 v44, v44, v46
    v_smfmac_f32_16x16x64_bf16 v[52:55], v[12:15], v[224:231], v112
    ds_read_b64_tr_b16 v[30:31], v115 offset:2320
    ds_write_b32 v114, v44 offset:1024
    v_smfmac_f32_16x16x64_bf16 v[52:55], v[16:19], v[232:239], v112
    s_waitcnt lgkmcnt(7)
    s_barrier
    v_add_f32 v48, v48, v49
    v_smfmac_f32_16x16x64_bf16 v[52:55], v[20:23], v[240:247], v112
    ds_read_b64_tr_b16 v[32:33], v115 offset:768
    v_add_f32 v50, v50, v51
    v_smfmac_f32_16x16x64_bf16 v[52:55], v[24:27], v[248:255], v112
    ds_read_b64_tr_b16 v[34:35], v115 offset:2576
    v_cvt_pk_bf16_f32 v48, v48, v50
    s_waitcnt lgkmcnt(2)
    v_smfmac_f32_16x16x64_bf16 v[0:3], v[4:7], v[56:63], v112 abid:1
    ds_write_b32 v114, v48 offset:1280
    s_nop 2
    v_add_f32 v52, v52, v53
    v_add_f32 v54, v54, v55
    v_cvt_pk_bf16_f32 v52, v52, v54
    ds_write_b32 v114, v52 offset:1536
    v_smfmac_f32_16x16x64_bf16 v[0:3], v[8:11], v[64:71], v112 abid:1
    v_smfmac_f32_16x16x64_bf16 v[0:3], v[28:31], v[72:79], v112 abid:1
    s_waitcnt lgkmcnt(2)
    v_smfmac_f32_16x16x64_bf16 v[0:3], v[32:35], v[80:87], v112 abid:1
    s_waitcnt lgkmcnt(0)
    s_barrier
    ds_read_b64_tr_b16 v[36:37], v115 offset:1024
    ds_read_b64_tr_b16 v[38:39], v115 offset:2832
    ds_read_b64_tr_b16 v[40:41], v115 offset:1280
    ds_read_b64_tr_b16 v[42:43], v115 offset:3088
    ds_read_b64_tr_b16 v[44:45], v115 offset:1536
    ds_read_b64_tr_b16 v[46:47], v115 offset:3344
    s_waitcnt lgkmcnt(4)
    v_smfmac_f32_16x16x64_bf16 v[0:3], v[36:39], v[88:95], v112 abid:1
    s_waitcnt lgkmcnt(2)
    v_smfmac_f32_16x16x64_bf16 v[0:3], v[40:43], v[96:103], v112 abid:1
    s_waitcnt lgkmcnt(0)
    v_smfmac_f32_16x16x64_bf16 v[0:3], v[44:47], v[104:111], v112 abid:1
    s_nop 7
    ds_write2st64_b32 v117, v0, v1 offset0:0 offset1:1
    ds_write2st64_b32 v117, v2, v3 offset0:2 offset1:3
    s_waitcnt lgkmcnt(0)
    s_barrier
    s_add_u32 s26, s21, 30720
    v_cmp_ne_u32 vcc, 15, v119
    s_cbranch_vccz Lcvg_100062
Lcvp_100061:
    buffer_load_dword v119, off, s[4:7], s26 sc1
    s_waitcnt vmcnt(0)
    v_cmp_ne_u32 vcc, 15, v119
    s_cbranch_vccz Lcvg_100062
    s_sleep 1
    s_sub_u32 s24, s24, 1
    s_cbranch_scc1 Lexit_100001
    s_branch Lcvp_100061
Lcvg_100062:
    s_add_u32 s26, s26, 16384
    buffer_load_dword v119, off, s[4:7], s26 sc1
    s_add_u32 s25, s22, 28672
    buffer_load_dwordx4 v[56:59], v116, s[4:7], s25 offen offset:0 sc1
    s_nop 13
    buffer_load_dwordx4 v[60:63], v116, s[4:7], s25 offen offset:1024 sc1
    s_nop 13
    buffer_load_dwordx4 v[64:67], v116, s[4:7], s25 offen offset:2048 sc1
    s_nop 13
    buffer_load_dwordx4 v[68:71], v116, s[4:7], s25 offen offset:3072 sc1
    s_nop 13
    s_add_u32 s25, s22, 32768
    buffer_load_dwordx4 v[72:75], v116, s[4:7], s25 offen offset:0 sc1
    s_nop 13
    buffer_load_dwordx4 v[76:79], v116, s[4:7], s25 offen offset:1024 sc1
    v_mov_b32 v28, 0
    v_mov_b32 v29, 0
    v_mov_b32 v30, 0
    v_mov_b32 v31, 0
    v_mov_b32 v32, 0
    v_mov_b32 v33, 0
    v_mov_b32 v34, 0
    v_mov_b32 v35, 0
    v_mov_b32 v36, 0
    v_mov_b32 v37, 0
    v_mov_b32 v38, 0
    v_mov_b32 v39, 0
    v_mov_b32 v40, 0
    v_mov_b32 v41, 0
    buffer_load_dwordx4 v[80:83], v116, s[4:7], s25 offen offset:2048 sc1
    v_mov_b32 v42, 0
    v_mov_b32 v43, 0
    v_mov_b32 v44, 0
    v_mov_b32 v45, 0
    v_mov_b32 v46, 0
    v_mov_b32 v47, 0
    v_mov_b32 v48, 0
    v_mov_b32 v49, 0
    v_mov_b32 v50, 0
    v_mov_b32 v51, 0
    v_mov_b32 v52, 0
    v_mov_b32 v53, 0
    v_mov_b32 v54, 0
    v_mov_b32 v55, 0
    buffer_load_dwordx4 v[84:87], v116, s[4:7], s25 offen offset:3072 sc1
    s_nop 13
    s_add_u32 s25, s22, 36864
    buffer_load_dwordx4 v[88:91], v116, s[4:7], s25 offen offset:0 sc1
    s_nop 15
    s_nop 1
    buffer_load_dwordx4 v[92:95], v116, s[4:7], s25 offen offset:1024 sc1
    s_nop 15
    s_nop 1
    buffer_load_dwordx4 v[96:99], v116, s[4:7], s25 offen offset:2048 sc1
    s_nop 15
    s_nop 1
    buffer_load_dwordx4 v[100:103], v116, s[4:7], s25 offen offset:3072 sc1
    s_nop 15
    s_nop 1
    s_add_u32 s25, s22, 40960
    buffer_load_dwordx4 v[104:107], v116, s[4:7], s25 offen offset:0 sc1
    s_nop 15
    s_nop 1
    buffer_load_dwordx4 v[108:111], v116, s[4:7], s25 offen offset:1024 sc1
    s_add_u32 s19, s19, 8192
    s_add_u32 s20, s20, 8192
    s_add_u32 s21, s21, 16384
    s_add_u32 s22, s22, 28672
    s_add_u32 s23, s23, 458752
    s_add_u32 s18, s18, 1
    s_cmp_lt_u32 s18, 63
    s_cbranch_scc1 LA1step_100054
    s_endpgm
Lfail2_100059:
    v_max3_u32 v118, v12, v13, v14
    v_max_u32 v118, v118, v15
    v_max3_u32 v118, v118, v16, v17
    v_max3_u32 v118, v118, v18, v19
    v_max3_u32 v118, v118, v20, v21
    v_max3_u32 v118, v118, v22, v23
    v_max3_u32 v118, v118, v24, v25
    v_max3_u32 v118, v118, v26, v27
    v_cmp_eq_u32 vcc, -1, v118
    s_cbranch_vccz Lcont2_100060
    s_waitcnt lgkmcnt(0)
    s_barrier
Lfail_100058:
    buffer_load_dwordx4 v[0:3], v113, s[4:7], s19 offen offset:1024 sc1
    s_nop 9
    buffer_load_dwordx4 v[4:7], v113, s[4:7], s19 offen offset:2048 sc1
    s_nop 9
    buffer_load_dwordx4 v[8:11], v113, s[4:7], s19 offen offset:0 sc1
    s_nop 15
    s_nop 9
    s_mov_b32 m0, 12288
    s_nop 0
    buffer_load_dwordx4 v113, s[4:7], s20 offen offset:0 sc1 lds
    s_mov_b32 m0, 8192
    s_nop 0
    buffer_load_dwordx4 v113, s[4:7], s19 offen offset:1024 sc1 lds
    s_sub_u32 s24, s24, 1
    s_cbranch_scc1 Lexit_100001
    v_mov_b32 v28, 0
    v_mov_b32 v29, 0
    v_mov_b32 v30, 0
    v_mov_b32 v31, 0
    v_mov_b32 v32, 0
    v_mov_b32 v33, 0
    v_mov_b32 v34, 0
    v_mov_b32 v35, 0
    v_mov_b32 v36, 0
    v_mov_b32 v37, 0
    v_mov_b32 v38, 0
    v_mov_b32 v39, 0
    v_mov_b32 v40, 0
    v_mov_b32 v41, 0
    v_mov_b32 v42, 0
    v_mov_b32 v43, 0
    v_mov_b32 v44, 0
    v_mov_b32 v45, 0
    v_mov_b32 v46, 0
    v_mov_b32 v47, 0
    v_mov_b32 v48, 0
    v_mov_b32 v49, 0
    v_mov_b32 v50, 0
    v_mov_b32 v51, 0
    v_mov_b32 v52, 0
    v_mov_b32 v53, 0
    v_mov_b32 v54, 0
    v_mov_b32 v55, 0
    s_branch LA1poll_100055
LAw2_100037:
    v_and_b32 v3, 63, v0
    v_lshrrev_b32 v1, 4, v3
    v_and_b32 v2, 15, v3
    v_and_b32 v118, 1, v2
    v_mul_u32_u24 v112, 0xAAAA, v118
    v_lshrrev_b32 v118, 3, v2
    v_mul_u32_u24 v118, 0xAAAA, v118
    v_lshl_add_u32 v112, v118, 16, v112
    v_add_u32 v112, 0x44444444, v112
    v_lshlrev_b32 v113, 8, v1
    v_lshl_add_u32 v113, v2, 4, v113
    v_lshlrev_b32 v114, 4, v2
    v_lshl_add_u32 v114, v1, 2, v114
    v_add_u32 v114, 3616, v114
    v_and_b32 v118, 1, v1
    v_mul_u32_u24 v115, 3616, v118
    v_lshrrev_b32 v118, 3, v2
    v_lshl_add_u32 v115, v118, 7, v115
    v_bfe_u32 v118, v2, 1, 1
    v_lshl_add_u32 v115, v118, 6, v115
    v_lshrrev_b32 v118, 1, v1
    v_lshl_add_u32 v115, v118, 5, v115
    v_bfe_u32 v118, v2, 2, 1
    v_lshl_add_u32 v115, v118, 4, v115
    v_and_b32 v118, 1, v2
    v_lshl_add_u32 v115, v118, 3, v115
    v_lshlrev_b32 v117, 10, v1
    v_lshl_add_u32 v117, v2, 2, v117
    v_add_u32 v117, 16512, v117
    v_mul_u32_u24 v116, 1792, v1
    v_and_b32 v118, 7, v2
    v_lshl_add_u32 v116, v118, 5, v116
    v_add_u32 v116, 8192, v116
    v_min_u32 v119, 13, v3
    v_lshlrev_b32 v119, 2, v119
    s_lshr_b32 s25, s17, 2
    s_lshl_b32 s25, s25, 8
    s_add_u32 s25, s25, 12288
    v_add_u32 v119, s25, v119
    s_lshr_b32 s60, s17, 3
    s_and_b32 s61, s17, 7
    s_lshl_b32 s61, s61, 3
    s_add_u32 s61, s61, s16
    s_mov_b64 exec, 0x11
    s_lshl_b64 exec, exec, s61
    v_mov_b32 v5, v232
    s_mov_b32 s62, 64
    s_cmp_eq_u32 s60, 1
    s_cselect_b64 vcc, -1, 0
    v_cndmask_b32 v5, v5, v233, vcc
    s_cmp_eq_u32 s60, 2
    s_cselect_b64 vcc, -1, 0
    v_cndmask_b32 v5, v5, v234, vcc
    s_cmp_eq_u32 s60, 3
    s_cselect_b64 vcc, -1, 0
    v_cndmask_b32 v5, v5, v235, vcc
    s_lshl_b32 s60, s60, 11
    s_add_u32 s60, s60, 0x3d40000
LAww_100063:
    buffer_load_dword v4, v237, s[4:7], s60 offen sc1
    s_waitcnt vmcnt(0)
    v_cmp_eq_u32 vcc, v4, v5
    s_cbranch_vccz LAwg_100064
    s_sleep 12
    s_sub_u32 s62, s62, 1
    s_cbranch_scc0 LAww_100063
    s_mov_b64 exec, -1
    v_and_b32 v5, 31, v0
    v_lshlrev_b32 v5, 2, v5
LAwf_100065:
    buffer_load_dword v4, v5, s[12:15], 0 offen offset:64 sc1
    s_waitcnt vmcnt(0)
    v_cmp_gt_u32 vcc, 8, v4
    s_cbranch_vccz LAwg_100064
    s_sleep 30
    s_sub_u32 s24, s24, 1
    s_cbranch_scc1 Lexit_100001
    s_branch LAwf_100065
LAwg_100064:
    s_mov_b64 exec, -1
    v_lshlrev_b32 v118, 4, v3
    s_mul_i32 s25, s17, 401408
    s_add_u32 s25, s25, 200704
    s_add_u32 s26, s25, 4096
    buffer_load_dwordx4 a[0:3], v118, s[4:7], s26 offen offset:0 sc1
    buffer_load_dwordx4 a[4:7], v118, s[4:7], s26 offen offset:1024 sc1
    s_add_u32 s26, s25, 0
    buffer_load_dwordx4 a[8:11], v118, s[4:7], s26 offen offset:0 sc1
    buffer_load_dwordx4 a[12:15], v118, s[4:7], s26 offen offset:1024 sc1
    s_add_u32 s26, s25, 2048
    buffer_load_dwordx4 a[16:19], v118, s[4:7], s26 offen offset:0 sc1
    buffer_load_dwordx4 a[20:23], v118, s[4:7], s26 offen offset:1024 sc1
    s_add_u32 s26, s25, 6144
    buffer_load_dwordx4 a[24:27], v118, s[4:7], s26 offen offset:0 sc1
    buffer_load_dwordx4 a[28:31], v118, s[4:7], s26 offen offset:1024 sc1
    s_add_u32 s26, s25, 8192
    buffer_load_dwordx4 a[32:35], v118, s[4:7], s26 offen offset:0 sc1
    buffer_load_dwordx4 a[36:39], v118, s[4:7], s26 offen offset:1024 sc1
    s_add_u32 s26, s25, 10240
    buffer_load_dwordx4 a[40:43], v118, s[4:7], s26 offen offset:0 sc1
    buffer_load_dwordx4 a[44:47], v118, s[4:7], s26 offen offset:1024 sc1
    s_add_u32 s26, s25, 12288
    buffer_load_dwordx4 a[48:51], v118, s[4:7], s26 offen offset:0 sc1
    buffer_load_dwordx4 a[52:55], v118, s[4:7], s26 offen offset:1024 sc1
    s_add_u32 s26, s25, 18432
    buffer_load_dwordx4 a[56:59], v118, s[4:7], s26 offen offset:0 sc1
    buffer_load_dwordx4 a[60:63], v118, s[4:7], s26 offen offset:1024 sc1
    s_add_u32 s26, s25, 14336
    buffer_load_dwordx4 a[64:67], v118, s[4:7], s26 offen offset:0 sc1
    buffer_load_dwordx4 a[68:71], v118, s[4:7], s26 offen offset:1024 sc1
    s_add_u32 s26, s25, 16384
    buffer_load_dwordx4 a[72:75], v118, s[4:7], s26 offen offset:0 sc1
    buffer_load_dwordx4 a[76:79], v118, s[4:7], s26 offen offset:1024 sc1
    s_add_u32 s26, s25, 20480
    buffer_load_dwordx4 a[80:83], v118, s[4:7], s26 offen offset:0 sc1
    buffer_load_dwordx4 a[84:87], v118, s[4:7], s26 offen offset:1024 sc1
    s_add_u32 s26, s25, 22528
    buffer_load_dwordx4 a[88:91], v118, s[4:7], s26 offen offset:0 sc1
    buffer_load_dwordx4 a[92:95], v118, s[4:7], s26 offen offset:1024 sc1
    s_add_u32 s26, s25, 24576
    buffer_load_dwordx4 a[96:99], v118, s[4:7], s26 offen offset:0 sc1
    buffer_load_dwordx4 a[100:103], v118, s[4:7], s26 offen offset:1024 sc1
    s_add_u32 s26, s25, 26624
    buffer_load_dwordx4 a[104:107], v118, s[4:7], s26 offen offset:0 sc1
    buffer_load_dwordx4 a[108:111], v118, s[4:7], s26 offen offset:1024 sc1
    s_add_u32 s26, s25, 32768
    buffer_load_dwordx4 a[112:115], v118, s[4:7], s26 offen offset:0 sc1
    buffer_load_dwordx4 a[116:119], v118, s[4:7], s26 offen offset:1024 sc1
    s_add_u32 s26, s25, 28672
    buffer_load_dwordx4 a[120:123], v118, s[4:7], s26 offen offset:0 sc1
    buffer_load_dwordx4 a[124:127], v118, s[4:7], s26 offen offset:1024 sc1
    s_add_u32 s26, s25, 30720
    buffer_load_dwordx4 a[128:131], v118, s[4:7], s26 offen offset:0 sc1
    buffer_load_dwordx4 a[132:135], v118, s[4:7], s26 offen offset:1024 sc1
    s_add_u32 s26, s25, 34816
    buffer_load_dwordx4 a[136:139], v118, s[4:7], s26 offen offset:0 sc1
    buffer_load_dwordx4 a[140:143], v118, s[4:7], s26 offen offset:1024 sc1
    s_add_u32 s26, s25, 36864
    buffer_load_dwordx4 a[144:147], v118, s[4:7], s26 offen offset:0 sc1
    buffer_load_dwordx4 a[148:151], v118, s[4:7], s26 offen offset:1024 sc1
    s_add_u32 s26, s25, 38912
    buffer_load_dwordx4 a[152:155], v118, s[4:7], s26 offen offset:0 sc1
    buffer_load_dwordx4 a[156:159], v118, s[4:7], s26 offen offset:1024 sc1
    s_add_u32 s26, s25, 40960
    buffer_load_dwordx4 a[160:163], v118, s[4:7], s26 offen offset:0 sc1
    buffer_load_dwordx4 a[164:167], v118, s[4:7], s26 offen offset:1024 sc1
    s_waitcnt vmcnt(28)
    s_add_u32 s26, s25, 47104
    buffer_load_dwordx4 a[168:171], v118, s[4:7], s26 offen offset:0 sc1
    buffer_load_dwordx4 a[172:175], v118, s[4:7], s26 offen offset:1024 sc1
    s_add_u32 s26, s25, 43008
    buffer_load_dwordx4 a[176:179], v118, s[4:7], s26 offen offset:0 sc1
    buffer_load_dwordx4 a[180:183], v118, s[4:7], s26 offen offset:1024 sc1
    s_add_u32 s26, s25, 45056
    buffer_load_dwordx4 a[184:187], v118, s[4:7], s26 offen offset:0 sc1
    buffer_load_dwordx4 a[188:191], v118, s[4:7], s26 offen offset:1024 sc1
    s_add_u32 s26, s25, 49152
    buffer_load_dwordx4 a[192:195], v118, s[4:7], s26 offen offset:0 sc1
    buffer_load_dwordx4 a[196:199], v118, s[4:7], s26 offen offset:1024 sc1
    s_add_u32 s26, s25, 51200
    buffer_load_dwordx4 a[200:203], v118, s[4:7], s26 offen offset:0 sc1
    buffer_load_dwordx4 a[204:207], v118, s[4:7], s26 offen offset:1024 sc1
    s_add_u32 s26, s25, 53248
    buffer_load_dwordx4 a[208:211], v118, s[4:7], s26 offen offset:0 sc1
    buffer_load_dwordx4 a[212:215], v118, s[4:7], s26 offen offset:1024 sc1
    s_add_u32 s26, s25, 55296
    buffer_load_dwordx4 a[216:219], v118, s[4:7], s26 offen offset:0 sc1
    buffer_load_dwordx4 a[220:223], v118, s[4:7], s26 offen offset:1024 sc1
    s_waitcnt vmcnt(28)
    s_add_u32 s26, s25, 61440
    buffer_load_dwordx4 a[224:227], v118, s[4:7], s26 offen offset:0 sc1
    buffer_load_dwordx4 a[228:231], v118, s[4:7], s26 offen offset:1024 sc1
    s_add_u32 s26, s25, 57344
    buffer_load_dwordx4 a[232:235], v118, s[4:7], s26 offen offset:0 sc1
    buffer_load_dwordx4 a[236:239], v118, s[4:7], s26 offen offset:1024 sc1
    s_add_u32 s26, s25, 59392
    buffer_load_dwordx4 a[240:243], v118, s[4:7], s26 offen offset:0 sc1
    buffer_load_dwordx4 a[244:247], v118, s[4:7], s26 offen offset:1024 sc1
    s_add_u32 s26, s25, 63488
    buffer_load_dwordx4 a[248:251], v118, s[4:7], s26 offen offset:0 sc1
    buffer_load_dwordx4 a[252:255], v118, s[4:7], s26 offen offset:1024 sc1
    s_add_u32 s26, s25, 65536
    buffer_load_dwordx4 v[120:123], v118, s[4:7], s26 offen offset:0 sc1
    buffer_load_dwordx4 v[124:127], v118, s[4:7], s26 offen offset:1024 sc1
    s_add_u32 s26, s25, 67584
    buffer_load_dwordx4 v[128:131], v118, s[4:7], s26 offen offset:0 sc1
    buffer_load_dwordx4 v[132:135], v118, s[4:7], s26 offen offset:1024 sc1
    s_add_u32 s26, s25, 69632
    buffer_load_dwordx4 v[136:139], v118, s[4:7], s26 offen offset:0 sc1
    buffer_load_dwordx4 v[140:143], v118, s[4:7], s26 offen offset:1024 sc1
    s_waitcnt vmcnt(28)
    s_add_u32 s26, s25, 75776
    buffer_load_dwordx4 v[144:147], v118, s[4:7], s26 offen offset:0 sc1
    buffer_load_dwordx4 v[148:151], v118, s[4:7], s26 offen offset:1024 sc1
    s_add_u32 s26, s25, 71680
    buffer_load_dwordx4 v[152:155], v118, s[4:7], s26 offen offset:0 sc1
    buffer_load_dwordx4 v[156:159], v118, s[4:7], s26 offen offset:1024 sc1
    s_add_u32 s26, s25, 73728
    buffer_load_dwordx4 v[160:163], v118, s[4:7], s26 offen offset:0 sc1
    buffer_load_dwordx4 v[164:167], v118, s[4:7], s26 offen offset:1024 sc1
    s_add_u32 s26, s25, 77824
    buffer_load_dwordx4 v[168:171], v118, s[4:7], s26 offen offset:0 sc1
    buffer_load_dwordx4 v[172:175], v118, s[4:7], s26 offen offset:1024 sc1
    s_add_u32 s26, s25, 79872
    buffer_load_dwordx4 v[176:179], v118, s[4:7], s26 offen offset:0 sc1
    buffer_load_dwordx4 v[180:183], v118, s[4:7], s26 offen offset:1024 sc1
    s_add_u32 s26, s25, 81920
    buffer_load_dwordx4 v[184:187], v118, s[4:7], s26 offen offset:0 sc1
    buffer_load_dwordx4 v[188:191], v118, s[4:7], s26 offen offset:1024 sc1
    s_add_u32 s26, s25, 83968
    buffer_load_dwordx4 v[192:195], v118, s[4:7], s26 offen offset:0 sc1
    buffer_load_dwordx4 v[196:199], v118, s[4:7], s26 offen offset:1024 sc1
    s_waitcnt vmcnt(28)
    s_add_u32 s26, s25, 90112
    buffer_load_dwordx4 v[200:203], v118, s[4:7], s26 offen offset:0 sc1
    buffer_load_dwordx4 v[204:207], v118, s[4:7], s26 offen offset:1024 sc1
    s_add_u32 s26, s25, 86016
    buffer_load_dwordx4 v[208:211], v118, s[4:7], s26 offen offset:0 sc1
    buffer_load_dwordx4 v[212:215], v118, s[4:7], s26 offen offset:1024 sc1
    s_add_u32 s26, s25, 88064
    buffer_load_dwordx4 v[216:219], v118, s[4:7], s26 offen offset:0 sc1
    buffer_load_dwordx4 v[220:223], v118, s[4:7], s26 offen offset:1024 sc1
    s_add_u32 s26, s25, 92160
    buffer_load_dwordx4 v[224:227], v118, s[4:7], s26 offen offset:0 sc1
    buffer_load_dwordx4 v[228:231], v118, s[4:7], s26 offen offset:1024 sc1
    s_add_u32 s26, s25, 94208
    buffer_load_dwordx4 v[232:235], v118, s[4:7], s26 offen offset:0 sc1
    buffer_load_dwordx4 v[236:239], v118, s[4:7], s26 offen offset:1024 sc1
    s_add_u32 s26, s25, 96256
    buffer_load_dwordx4 v[240:243], v118, s[4:7], s26 offen offset:0 sc1
    buffer_load_dwordx4 v[244:247], v118, s[4:7], s26 offen offset:1024 sc1
    s_add_u32 s26, s25, 98304
    buffer_load_dwordx4 v[248:251], v118, s[4:7], s26 offen offset:0 sc1
    buffer_load_dwordx4 v[252:255], v118, s[4:7], s26 offen offset:1024 sc1
    s_waitcnt vmcnt(28)
    s_mov_b32 s18, 0
    s_mov_b32 s19, 0x2a00000
    s_mov_b32 s20, 0x2a01000
    s_mov_b32 s21, 0x2a80000
    s_mov_b32 s22, 0x3800000
    s_mov_b32 s24, 300000
    s_cmp_lg_u32 s16, 0
    s_cbranch_scc1 LAcg_100069
    v_and_b32 v5, 31, v0
    v_add_lshl_u32 v5, v5, 0, 2
LAcw_100068:
    buffer_load_dword v4, v5, s[12:15], 0 offen offset:64 sc1
    s_waitcnt vmcnt(0)
    v_cmp_gt_u32 vcc, 8, v4
    s_cbranch_vccz LAcg_100069
    s_sleep 12
    s_sub_u32 s24, s24, 1
    s_cbranch_scc1 Lexit_100001
    s_branch LAcw_100068
LAcg_100069:
    s_barrier
    s_mov_b32 s46, 0
    v_mov_b32 v28, 0
    v_mov_b32 v29, 0
    v_mov_b32 v30, 0
    v_mov_b32 v31, 0
    v_mov_b32 v32, 0
    v_mov_b32 v33, 0
    v_mov_b32 v34, 0
    v_mov_b32 v35, 0
    v_mov_b32 v36, 0
    v_mov_b32 v37, 0
    v_mov_b32 v38, 0
    v_mov_b32 v39, 0
    v_mov_b32 v40, 0
    v_mov_b32 v41, 0
    v_mov_b32 v42, 0
    v_mov_b32 v43, 0
    v_mov_b32 v44, 0
    v_mov_b32 v45, 0
    v_mov_b32 v46, 0
    v_mov_b32 v47, 0
    v_mov_b32 v48, 0
    v_mov_b32 v49, 0
    v_mov_b32 v50, 0
    v_mov_b32 v51, 0
    v_mov_b32 v52, 0
    v_mov_b32 v53, 0
    v_mov_b32 v54, 0
    v_mov_b32 v55, 0
LA2step_100066:
    s_barrier
    buffer_load_dwordx4 v[0:3], v113, s[4:7], s19 offen offset:2048 sc1
    s_nop 9
    buffer_load_dwordx4 v[4:7], v113, s[4:7], s19 offen offset:0 sc1
    s_nop 9
    buffer_load_dwordx4 v[8:11], v113, s[4:7], s19 offen offset:1024 sc1
    s_nop 15
    s_nop 9
    s_mov_b32 m0, 12288
    s_nop 0
    buffer_load_dwordx4 v113, s[4:7], s20 offen offset:1024 sc1 lds
    s_mov_b32 m0, 8192
    s_nop 0
    buffer_load_dwordx4 v113, s[4:7], s19 offen offset:2048 sc1 lds
LA2poll_100067:
    s_waitcnt vmcnt(4)
    v_smfmac_f32_16x16x64_bf16 v[28:31], v[0:3], a[0:7], v112
    v_max3_u32 v118, v0, v1, v2
    v_smfmac_f32_16x16x64_bf16 v[32:35], v[0:3], a[56:63], v112
    v_max_u32 v118, v118, v3
    v_smfmac_f32_16x16x64_bf16 v[36:39], v[0:3], a[112:119], v112
    v_cmp_eq_u32 vcc, -1, v118
    v_smfmac_f32_16x16x64_bf16 v[40:43], v[0:3], a[168:175], v112
    v_smfmac_f32_16x16x64_bf16 v[44:47], v[0:3], a[224:231], v112
    s_cbranch_vccnz Lfail_100070
    v_smfmac_f32_16x16x64_bf16 v[48:51], v[0:3], v[144:151], v112
    s_waitcnt vmcnt(3)
    v_max3_u32 v118, v4, v5, v6
    v_smfmac_f32_16x16x64_bf16 v[52:55], v[0:3], v[200:207], v112
    v_max_u32 v118, v118, v7
    v_smfmac_f32_16x16x64_bf16 v[28:31], v[4:7], a[8:15], v112
    v_smfmac_f32_16x16x64_bf16 v[32:35], v[4:7], a[64:71], v112
    v_smfmac_f32_16x16x64_bf16 v[36:39], v[4:7], a[120:127], v112
    v_smfmac_f32_16x16x64_bf16 v[40:43], v[4:7], a[176:183], v112
    s_waitcnt vmcnt(2)
    v_max3_u32 v118, v118, v8, v9
    v_smfmac_f32_16x16x64_bf16 v[44:47], v[4:7], a[232:239], v112
    v_max3_u32 v118, v118, v10, v11
    v_smfmac_f32_16x16x64_bf16 v[48:51], v[4:7], v[152:159], v112
    v_cmp_eq_u32 vcc, -1, v118
    v_smfmac_f32_16x16x64_bf16 v[52:55], v[4:7], v[208:215], v112
    v_smfmac_f32_16x16x64_bf16 v[28:31], v[8:11], a[16:23], v112
    s_cbranch_vccnz Lfail_100070
    v_smfmac_f32_16x16x64_bf16 v[32:35], v[8:11], a[72:79], v112
    v_smfmac_f32_16x16x64_bf16 v[36:39], v[8:11], a[128:135], v112
    s_waitcnt vmcnt(0)
    s_barrier
    ds_read_b128 v[12:15], v113 offset:11264
    v_mov_b32 v0, 0
    v_smfmac_f32_16x16x64_bf16 v[40:43], v[8:11], a[184:191], v112
    ds_read_b128 v[16:19], v113 offset:12288
    v_mov_b32 v1, 0
    v_smfmac_f32_16x16x64_bf16 v[44:47], v[8:11], a[240:247], v112
    ds_read_b128 v[20:23], v113 offset:13312
    v_mov_b32 v2, 0
    v_smfmac_f32_16x16x64_bf16 v[48:51], v[8:11], v[160:167], v112
    ds_read_b128 v[24:27], v113 offset:14336
    v_mov_b32 v3, 0
    v_smfmac_f32_16x16x64_bf16 v[52:55], v[8:11], v[216:223], v112
    s_waitcnt lgkmcnt(3)
    v_smfmac_f32_16x16x64_bf16 v[28:31], v[12:15], a[24:31], v112
    s_waitcnt lgkmcnt(2)
    v_smfmac_f32_16x16x64_bf16 v[28:31], v[16:19], a[32:39], v112
    s_waitcnt lgkmcnt(1)
    v_smfmac_f32_16x16x64_bf16 v[28:31], v[20:23], a[40:47], v112
    s_waitcnt lgkmcnt(0)
    v_smfmac_f32_16x16x64_bf16 v[28:31], v[24:27], a[48:55], v112
    ds_read_b128 v[56:59], v116 offset:0
    v_smfmac_f32_16x16x64_bf16 v[32:35], v[12:15], a[80:87], v112
    ds_read_b128 v[60:63], v116 offset:16
    v_smfmac_f32_16x16x64_bf16 v[32:35], v[16:19], a[88:95], v112
    ds_read_b128 v[64:67], v116 offset:256
    v_add_f32 v28, v28, v29
    v_smfmac_f32_16x16x64_bf16 v[32:35], v[20:23], a[96:103], v112
    ds_read_b128 v[68:71], v116 offset:272
    v_add_f32 v30, v30, v31
    v_smfmac_f32_16x16x64_bf16 v[32:35], v[24:27], a[104:111], v112
    ds_read_b128 v[72:75], v116 offset:512
    v_cmp_u_f32 vcc, v28, v30
    v_cvt_pk_bf16_f32 v28, v28, v30
    v_smfmac_f32_16x16x64_bf16 v[36:39], v[12:15], a[136:143], v112
    ds_read_b128 v[76:79], v116 offset:528
    ds_write_b32 v114, v28 offset:0
    v_smfmac_f32_16x16x64_bf16 v[36:39], v[16:19], a[144:151], v112
    ds_read_b128 v[80:83], v116 offset:768
    s_cbranch_vccnz Lfail2_100071
Lcont2_100072:
    v_add_f32 v32, v32, v33
    v_smfmac_f32_16x16x64_bf16 v[36:39], v[20:23], a[152:159], v112
    ds_read_b128 v[84:87], v116 offset:784
    v_add_f32 v34, v34, v35
    v_smfmac_f32_16x16x64_bf16 v[36:39], v[24:27], a[160:167], v112
    ds_read_b128 v[88:91], v116 offset:1024
    v_cvt_pk_bf16_f32 v32, v32, v34
    v_smfmac_f32_16x16x64_bf16 v[40:43], v[12:15], a[192:199], v112
    ds_read_b128 v[92:95], v116 offset:1040
    ds_write_b32 v114, v32 offset:256
    v_smfmac_f32_16x16x64_bf16 v[40:43], v[16:19], a[200:207], v112
    ds_read_b128 v[96:99], v116 offset:1280
    v_add_f32 v36, v36, v37
    v_smfmac_f32_16x16x64_bf16 v[40:43], v[20:23], a[208:215], v112
    ds_read_b128 v[100:103], v116 offset:1296
    v_add_f32 v38, v38, v39
    v_smfmac_f32_16x16x64_bf16 v[40:43], v[24:27], a[216:223], v112
    ds_read_b128 v[104:107], v116 offset:1536
    v_cvt_pk_bf16_f32 v36, v36, v38
    v_smfmac_f32_16x16x64_bf16 v[44:47], v[12:15], a[248:255], v112
    ds_read_b128 v[108:111], v116 offset:1552
    ds_write_b32 v114, v36 offset:512
    v_smfmac_f32_16x16x64_bf16 v[44:47], v[16:19], v[120:127], v112
    v_add_f32 v40, v40, v41
    v_smfmac_f32_16x16x64_bf16 v[44:47], v[20:23], v[128:135], v112
    v_add_f32 v42, v42, v43
    v_smfmac_f32_16x16x64_bf16 v[44:47], v[24:27], v[136:143], v112
    v_cvt_pk_bf16_f32 v40, v40, v42
    v_smfmac_f32_16x16x64_bf16 v[48:51], v[12:15], v[168:175], v112
    s_waitcnt lgkmcnt(0)
    s_barrier
    ds_write_b32 v114, v40 offset:768
    v_smfmac_f32_16x16x64_bf16 v[48:51], v[16:19], v[176:183], v112
    ds_read_b64_tr_b16 v[4:5], v115 offset:0
    ds_read_b64_tr_b16 v[6:7], v115 offset:1808
    v_add_f32 v44, v44, v45
    v_smfmac_f32_16x16x64_bf16 v[48:51], v[20:23], v[184:191], v112
    ds_read_b64_tr_b16 v[8:9], v115 offset:256
    v_add_f32 v46, v46, v47
    v_smfmac_f32_16x16x64_bf16 v[48:51], v[24:27], v[192:199], v112
    ds_read_b64_tr_b16 v[10:11], v115 offset:2064
    ds_read_b64_tr_b16 v[28:29], v115 offset:512
    v_cvt_pk_bf16_f32 v44, v44, v46
    v_smfmac_f32_16x16x64_bf16 v[52:55], v[12:15], v[224:231], v112
    ds_read_b64_tr_b16 v[30:31], v115 offset:2320
    ds_write_b32 v114, v44 offset:1024
    v_smfmac_f32_16x16x64_bf16 v[52:55], v[16:19], v[232:239], v112
    s_waitcnt lgkmcnt(7)
    s_barrier
    v_add_f32 v48, v48, v49
    v_smfmac_f32_16x16x64_bf16 v[52:55], v[20:23], v[240:247], v112
    ds_read_b64_tr_b16 v[32:33], v115 offset:768
    v_add_f32 v50, v50, v51
    v_smfmac_f32_16x16x64_bf16 v[52:55], v[24:27], v[248:255], v112
    ds_read_b64_tr_b16 v[34:35], v115 offset:2576
    v_cvt_pk_bf16_f32 v48, v48, v50
    s_waitcnt lgkmcnt(2)
    v_smfmac_f32_16x16x64_bf16 v[0:3], v[4:7], v[56:63], v112 abid:1
    ds_write_b32 v114, v48 offset:1280
    s_nop 2
    v_add_f32 v52, v52, v53
    v_add_f32 v54, v54, v55
    v_cvt_pk_bf16_f32 v52, v52, v54
    ds_write_b32 v114, v52 offset:1536
    v_smfmac_f32_16x16x64_bf16 v[0:3], v[8:11], v[64:71], v112 abid:1
    v_smfmac_f32_16x16x64_bf16 v[0:3], v[28:31], v[72:79], v112 abid:1
    s_waitcnt lgkmcnt(2)
    v_smfmac_f32_16x16x64_bf16 v[0:3], v[32:35], v[80:87], v112 abid:1
    s_waitcnt lgkmcnt(0)
    s_barrier
    ds_read_b64_tr_b16 v[36:37], v115 offset:1024
    ds_read_b64_tr_b16 v[38:39], v115 offset:2832
    ds_read_b64_tr_b16 v[40:41], v115 offset:1280
    ds_read_b64_tr_b16 v[42:43], v115 offset:3088
    ds_read_b64_tr_b16 v[44:45], v115 offset:1536
    ds_read_b64_tr_b16 v[46:47], v115 offset:3344
    s_waitcnt lgkmcnt(4)
    v_smfmac_f32_16x16x64_bf16 v[0:3], v[36:39], v[88:95], v112 abid:1
    s_waitcnt lgkmcnt(2)
    v_smfmac_f32_16x16x64_bf16 v[0:3], v[40:43], v[96:103], v112 abid:1
    s_waitcnt lgkmcnt(0)
    v_smfmac_f32_16x16x64_bf16 v[0:3], v[44:47], v[104:111], v112 abid:1
    s_nop 7
    ds_write2st64_b32 v117, v0, v1 offset0:0 offset1:1
    ds_write2st64_b32 v117, v2, v3 offset0:2 offset1:3
    s_waitcnt lgkmcnt(0)
    s_barrier
    s_nop 15
    s_nop 15
    s_nop 15
    s_nop 15
    s_nop 5
    v_mov_b32 v28, 0
    v_mov_b32 v29, 0
    v_mov_b32 v30, 0
    v_mov_b32 v31, 0
    v_mov_b32 v32, 0
    v_mov_b32 v33, 0
    v_mov_b32 v34, 0
    v_mov_b32 v35, 0
    v_mov_b32 v36, 0
    v_mov_b32 v37, 0
    v_mov_b32 v38, 0
    v_mov_b32 v39, 0
    v_mov_b32 v40, 0
    v_mov_b32 v41, 0
    v_mov_b32 v42, 0
    v_mov_b32 v43, 0
    v_mov_b32 v44, 0
    v_mov_b32 v45, 0
    v_mov_b32 v46, 0
    v_mov_b32 v47, 0
    v_mov_b32 v48, 0
    v_mov_b32 v49, 0
    v_mov_b32 v50, 0
    v_mov_b32 v51, 0
    v_mov_b32 v52, 0
    v_mov_b32 v53, 0
    v_mov_b32 v54, 0
    v_mov_b32 v55, 0
    buffer_load_dword v8, v119, s[4:7], s21 offen offset:0 sc1
    s_nop 8
    buffer_load_dword v9, v119, s[4:7], s21 offen offset:0 sc1
    s_nop 8
    buffer_load_dword v10, v119, s[4:7], s21 offen offset:0 sc1
    s_nop 8
    buffer_load_dword v11, v119, s[4:7], s21 offen offset:0 sc1
    s_nop 8
    buffer_load_dword v12, v119, s[4:7], s21 offen offset:0 sc1
    s_nop 8
LAfp_100073:
    s_waitcnt vmcnt(4)
    v_cmp_eq_u32 vcc, -1, v8
    s_cbranch_vccz LAgo_100074
    buffer_load_dword v8, v119, s[4:7], s21 offen offset:0 sc1
    s_waitcnt vmcnt(4)
    v_cmp_eq_u32 vcc, -1, v9
    s_cbranch_vccz LAgo_100074
    buffer_load_dword v9, v119, s[4:7], s21 offen offset:0 sc1
    s_waitcnt vmcnt(4)
    v_cmp_eq_u32 vcc, -1, v10
    s_cbranch_vccz LAgo_100074
    buffer_load_dword v10, v119, s[4:7], s21 offen offset:0 sc1
    s_waitcnt vmcnt(4)
    v_cmp_eq_u32 vcc, -1, v11
    s_cbranch_vccz LAgo_100074
    buffer_load_dword v11, v119, s[4:7], s21 offen offset:0 sc1
    s_waitcnt vmcnt(4)
    v_cmp_eq_u32 vcc, -1, v12
    s_cbranch_vccz LAgo_100074
    buffer_load_dword v12, v119, s[4:7], s21 offen offset:0 sc1
    s_sub_u32 s24, s24, 1
    s_cbranch_scc1 Lexit_100001
    s_branch LAfp_100073
LAgo_100074:
    s_nop 15
    s_nop 15
    s_nop 15
    s_nop 15
    s_nop 15
    s_nop 3
    s_add_u32 s19, s19, 8192
    s_add_u32 s20, s20, 8192
    s_add_u32 s21, s21, 16384
    s_add_u32 s22, s22, 28672
    s_add_u32 s23, s23, 458752
    s_add_u32 s18, s18, 1
    s_cmp_lt_u32 s18, 63
    s_cbranch_scc1 LA2step_100066
    s_endpgm
Lfail2_100071:
    v_max3_u32 v118, v12, v13, v14
    v_max_u32 v118, v118, v15
    v_max3_u32 v118, v118, v16, v17
    v_max3_u32 v118, v118, v18, v19
    v_max3_u32 v118, v118, v20, v21
    v_max3_u32 v118, v118, v22, v23
    v_max3_u32 v118, v118, v24, v25
    v_max3_u32 v118, v118, v26, v27
    v_cmp_eq_u32 vcc, -1, v118
    s_cbranch_vccz Lcont2_100072
    s_waitcnt lgkmcnt(0)
    s_barrier
Lfail_100070:
    buffer_load_dwordx4 v[0:3], v113, s[4:7], s19 offen offset:2048 sc1
    s_nop 9
    buffer_load_dwordx4 v[4:7], v113, s[4:7], s19 offen offset:0 sc1
    s_nop 9
    buffer_load_dwordx4 v[8:11], v113, s[4:7], s19 offen offset:1024 sc1
    s_nop 15
    s_nop 9
    s_mov_b32 m0, 12288
    s_nop 0
    buffer_load_dwordx4 v113, s[4:7], s20 offen offset:1024 sc1 lds
    s_mov_b32 m0, 8192
    s_nop 0
    buffer_load_dwordx4 v113, s[4:7], s19 offen offset:2048 sc1 lds
    s_sub_u32 s24, s24, 1
    s_cbranch_scc1 Lexit_100001
    v_mov_b32 v28, 0
    v_mov_b32 v29, 0
    v_mov_b32 v30, 0
    v_mov_b32 v31, 0
    v_mov_b32 v32, 0
    v_mov_b32 v33, 0
    v_mov_b32 v34, 0
    v_mov_b32 v35, 0
    v_mov_b32 v36, 0
    v_mov_b32 v37, 0
    v_mov_b32 v38, 0
    v_mov_b32 v39, 0
    v_mov_b32 v40, 0
    v_mov_b32 v41, 0
    v_mov_b32 v42, 0
    v_mov_b32 v43, 0
    v_mov_b32 v44, 0
    v_mov_b32 v45, 0
    v_mov_b32 v46, 0
    v_mov_b32 v47, 0
    v_mov_b32 v48, 0
    v_mov_b32 v49, 0
    v_mov_b32 v50, 0
    v_mov_b32 v51, 0
    v_mov_b32 v52, 0
    v_mov_b32 v53, 0
    v_mov_b32 v54, 0
    v_mov_b32 v55, 0
    s_branch LA2poll_100067
LAw3_100038:
    v_and_b32 v3, 63, v0
    v_lshrrev_b32 v1, 4, v3
    v_and_b32 v2, 15, v3
    v_and_b32 v118, 1, v2
    v_mul_u32_u24 v112, 0xAAAA, v118
    v_lshrrev_b32 v118, 3, v2
    v_mul_u32_u24 v118, 0xAAAA, v118
    v_lshl_add_u32 v112, v118, 16, v112
    v_add_u32 v112, 0x44444444, v112
    v_lshlrev_b32 v113, 8, v1
    v_lshl_add_u32 v113, v2, 4, v113
    v_lshlrev_b32 v114, 4, v2
    v_lshl_add_u32 v114, v1, 2, v114
    v_add_u32 v114, 5424, v114
    v_and_b32 v118, 1, v1
    v_mul_u32_u24 v115, 3616, v118
    v_lshrrev_b32 v118, 3, v2
    v_lshl_add_u32 v115, v118, 7, v115
    v_bfe_u32 v118, v2, 1, 1
    v_lshl_add_u32 v115, v118, 6, v115
    v_lshrrev_b32 v118, 1, v1
    v_lshl_add_u32 v115, v118, 5, v115
    v_bfe_u32 v118, v2, 2, 1
    v_lshl_add_u32 v115, v118, 4, v115
    v_and_b32 v118, 1, v2
    v_lshl_add_u32 v115, v118, 3, v115
    v_lshrrev_b32 v119, 3, v3
    v_mul_u32_u24 v116, 256, v119
    v_and_b32 v118, 7, v3
    v_lshl_add_u32 v117, v118, 4, v116
    v_add_u32 v117, 16384, v117
    v_lshl_add_u32 v116, v118, 2, v116
    v_add_u32 v116, 16512, v116
    v_and_b32 v118, 3, v3
    v_lshlrev_b32 v96, 3, v118
    v_lshl_add_u32 v96, v119, 5, v96
    v_bfe_u32 v118, v3, 2, 1
    v_lshl_add_u32 v96, v118, 8, v96
    s_lshl_b32 s25, s17, 9
    v_add_u32 v96, s25, v96
    v_lshlrev_b32 v97, 5, v119
    v_bfe_u32 v118, v3, 2, 1
    v_lshl_add_u32 v97, v118, 8, v97
    v_bfe_u32 v118, v3, 1, 1
    v_lshl_add_u32 v97, v118, 3, v97
    s_lshr_b32 s25, s17, 2
    s_lshl_b32 s25, s25, 9
    s_and_b32 s26, s17, 1
    s_lshl_b32 s26, s26, 4
    s_add_u32 s25, s25, s26
    s_bfe_u32 s26, s17, 0x10001
    s_lshl_b32 s26, s26, 2
    s_add_u32 s25, s25, s26
    s_add_u32 s25, s25, 8192
    v_add_u32 v97, s25, v97
    v_and_b32 v118, 1, v3
    v_lshl_add_u32 v97, v118, 30, v97
    v_lshlrev_b32 v119, 7, v3
    s_lshl_b32 s25, s17, 2
    s_add_u32 s25, s25, 10240
    v_add_u32 v119, s25, v119
    v_cmp_lt_u32 vcc, 13, v3
    v_mov_b32 v118, 0x40000000
    s_nop 0
    v_cndmask_b32 v119, v119, v118, vcc
    s_lshr_b32 s60, s17, 3
    s_and_b32 s61, s17, 7
    s_lshl_b32 s61, s61, 3
    s_add_u32 s61, s61, s16
    s_mov_b64 exec, 0x11
    s_lshl_b64 exec, exec, s61
    v_mov_b32 v5, v232
    s_mov_b32 s62, 64
    s_cmp_eq_u32 s60, 1
    s_cselect_b64 vcc, -1, 0
    v_cndmask_b32 v5, v5, v233, vcc
    s_cmp_eq_u32 s60, 2
    s_cselect_b64 vcc, -1, 0
    v_cndmask_b32 v5, v5, v234, vcc
    s_cmp_eq_u32 s60, 3
    s_cselect_b64 vcc, -1, 0
    v_cndmask_b32 v5, v5, v235, vcc
    s_lshl_b32 s60, s60, 11
    s_add_u32 s60, s60, 0x3d40000
LAww_100075:
    buffer_load_dword v4, v237, s[4:7], s60 offen sc1
    s_waitcnt vmcnt(0)
    v_cmp_eq_u32 vcc, v4, v5
    s_cbranch_vccz LAwg_100076
    s_sleep 12
    s_sub_u32 s62, s62, 1
    s_cbranch_scc0 LAww_100075
    s_mov_b64 exec, -1
    v_and_b32 v5, 31, v0
    v_lshlrev_b32 v5, 2, v5
LAwf_100077:
    buffer_load_dword v4, v5, s[12:15], 0 offen offset:64 sc1
    s_waitcnt vmcnt(0)
    v_cmp_gt_u32 vcc, 8, v4
    s_cbranch_vccz LAwg_100076
    s_sleep 30
    s_sub_u32 s24, s24, 1
    s_cbranch_scc1 Lexit_100001
    s_branch LAwf_100077
LAwg_100076:
    s_mov_b64 exec, -1
    v_lshlrev_b32 v118, 4, v3
    s_mul_i32 s25, s17, 401408
    s_add_u32 s25, s25, 301056
    s_add_u32 s26, s25, 0
    buffer_load_dwordx4 a[0:3], v118, s[4:7], s26 offen offset:0 sc1
    buffer_load_dwordx4 a[4:7], v118, s[4:7], s26 offen offset:1024 sc1
    s_add_u32 s26, s25, 2048
    buffer_load_dwordx4 a[8:11], v118, s[4:7], s26 offen offset:0 sc1
    buffer_load_dwordx4 a[12:15], v118, s[4:7], s26 offen offset:1024 sc1
    s_add_u32 s26, s25, 4096
    buffer_load_dwordx4 a[16:19], v118, s[4:7], s26 offen offset:0 sc1
    buffer_load_dwordx4 a[20:23], v118, s[4:7], s26 offen offset:1024 sc1
    s_add_u32 s26, s25, 6144
    buffer_load_dwordx4 a[24:27], v118, s[4:7], s26 offen offset:0 sc1
    buffer_load_dwordx4 a[28:31], v118, s[4:7], s26 offen offset:1024 sc1
    s_add_u32 s26, s25, 8192
    buffer_load_dwordx4 a[32:35], v118, s[4:7], s26 offen offset:0 sc1
    buffer_load_dwordx4 a[36:39], v118, s[4:7], s26 offen offset:1024 sc1
    s_add_u32 s26, s25, 10240
    buffer_load_dwordx4 a[40:43], v118, s[4:7], s26 offen offset:0 sc1
    buffer_load_dwordx4 a[44:47], v118, s[4:7], s26 offen offset:1024 sc1
    s_add_u32 s26, s25, 12288
    buffer_load_dwordx4 a[48:51], v118, s[4:7], s26 offen offset:0 sc1
    buffer_load_dwordx4 a[52:55], v118, s[4:7], s26 offen offset:1024 sc1
    s_add_u32 s26, s25, 14336
    buffer_load_dwordx4 a[56:59], v118, s[4:7], s26 offen offset:0 sc1
    buffer_load_dwordx4 a[60:63], v118, s[4:7], s26 offen offset:1024 sc1
    s_add_u32 s26, s25, 16384
    buffer_load_dwordx4 a[64:67], v118, s[4:7], s26 offen offset:0 sc1
    buffer_load_dwordx4 a[68:71], v118, s[4:7], s26 offen offset:1024 sc1
    s_add_u32 s26, s25, 18432
    buffer_load_dwordx4 a[72:75], v118, s[4:7], s26 offen offset:0 sc1
    buffer_load_dwordx4 a[76:79], v118, s[4:7], s26 offen offset:1024 sc1
    s_add_u32 s26, s25, 20480
    buffer_load_dwordx4 a[80:83], v118, s[4:7], s26 offen offset:0 sc1
    buffer_load_dwordx4 a[84:87], v118, s[4:7], s26 offen offset:1024 sc1
    s_add_u32 s26, s25, 22528
    buffer_load_dwordx4 a[88:91], v118, s[4:7], s26 offen offset:0 sc1
    buffer_load_dwordx4 a[92:95], v118, s[4:7], s26 offen offset:1024 sc1
    s_add_u32 s26, s25, 24576
    buffer_load_dwordx4 a[96:99], v118, s[4:7], s26 offen offset:0 sc1
    buffer_load_dwordx4 a[100:103], v118, s[4:7], s26 offen offset:1024 sc1
    s_add_u32 s26, s25, 26624
    buffer_load_dwordx4 a[104:107], v118, s[4:7], s26 offen offset:0 sc1
    buffer_load_dwordx4 a[108:111], v118, s[4:7], s26 offen offset:1024 sc1
    s_add_u32 s26, s25, 28672
    buffer_load_dwordx4 a[112:115], v118, s[4:7], s26 offen offset:0 sc1
    buffer_load_dwordx4 a[116:119], v118, s[4:7], s26 offen offset:1024 sc1
    s_add_u32 s26, s25, 30720
    buffer_load_dwordx4 a[120:123], v118, s[4:7], s26 offen offset:0 sc1
    buffer_load_dwordx4 a[124:127], v118, s[4:7], s26 offen offset:1024 sc1
    s_add_u32 s26, s25, 32768
    buffer_load_dwordx4 a[128:131], v118, s[4:7], s26 offen offset:0 sc1
    buffer_load_dwordx4 a[132:135], v118, s[4:7], s26 offen offset:1024 sc1
    s_add_u32 s26, s25, 34816
    buffer_load_dwordx4 a[136:139], v118, s[4:7], s26 offen offset:0 sc1
    buffer_load_dwordx4 a[140:143], v118, s[4:7], s26 offen offset:1024 sc1
    s_add_u32 s26, s25, 36864
    buffer_load_dwordx4 a[144:147], v118, s[4:7], s26 offen offset:0 sc1
    buffer_load_dwordx4 a[148:151], v118, s[4:7], s26 offen offset:1024 sc1
    s_add_u32 s26, s25, 38912
    buffer_load_dwordx4 a[152:155], v118, s[4:7], s26 offen offset:0 sc1
    buffer_load_dwordx4 a[156:159], v118, s[4:7], s26 offen offset:1024 sc1
    s_add_u32 s26, s25, 40960
    buffer_load_dwordx4 a[160:163], v118, s[4:7], s26 offen offset:0 sc1
    buffer_load_dwordx4 a[164:167], v118, s[4:7], s26 offen offset:1024 sc1
    s_waitcnt vmcnt(28)
    s_add_u32 s26, s25, 43008
    buffer_load_dwordx4 a[168:171], v118, s[4:7], s26 offen offset:0 sc1
    buffer_load_dwordx4 a[172:175], v118, s[4:7], s26 offen offset:1024 sc1
    s_add_u32 s26, s25, 45056
    buffer_load_dwordx4 a[176:179], v118, s[4:7], s26 offen offset:0 sc1
    buffer_load_dwordx4 a[180:183], v118, s[4:7], s26 offen offset:1024 sc1
    s_add_u32 s26, s25, 47104
    buffer_load_dwordx4 a[184:187], v118, s[4:7], s26 offen offset:0 sc1
    buffer_load_dwordx4 a[188:191], v118, s[4:7], s26 offen offset:1024 sc1
    s_add_u32 s26, s25, 49152
    buffer_load_dwordx4 a[192:195], v118, s[4:7], s26 offen offset:0 sc1
    buffer_load_dwordx4 a[196:199], v118, s[4:7], s26 offen offset:1024 sc1
    s_add_u32 s26, s25, 51200
    buffer_load_dwordx4 a[200:203], v118, s[4:7], s26 offen offset:0 sc1
    buffer_load_dwordx4 a[204:207], v118, s[4:7], s26 offen offset:1024 sc1
    s_add_u32 s26, s25, 53248
    buffer_load_dwordx4 a[208:211], v118, s[4:7], s26 offen offset:0 sc1
    buffer_load_dwordx4 a[212:215], v118, s[4:7], s26 offen offset:1024 sc1
    s_add_u32 s26, s25, 55296
    buffer_load_dwordx4 a[216:219], v118, s[4:7], s26 offen offset:0 sc1
    buffer_load_dwordx4 a[220:223], v118, s[4:7], s26 offen offset:1024 sc1
    s_waitcnt vmcnt(28)
    s_add_u32 s26, s25, 57344
    buffer_load_dwordx4 a[224:227], v118, s[4:7], s26 offen offset:0 sc1
    buffer_load_dwordx4 a[228:231], v118, s[4:7], s26 offen offset:1024 sc1
    s_add_u32 s26, s25, 59392
    buffer_load_dwordx4 a[232:235], v118, s[4:7], s26 offen offset:0 sc1
    buffer_load_dwordx4 a[236:239], v118, s[4:7], s26 offen offset:1024 sc1
    s_add_u32 s26, s25, 61440
    buffer_load_dwordx4 a[240:243], v118, s[4:7], s26 offen offset:0 sc1
    buffer_load_dwordx4 a[244:247], v118, s[4:7], s26 offen offset:1024 sc1
    s_add_u32 s26, s25, 63488
    buffer_load_dwordx4 a[248:251], v118, s[4:7], s26 offen offset:0 sc1
    buffer_load_dwordx4 a[252:255], v118, s[4:7], s26 offen offset:1024 sc1
    s_add_u32 s26, s25, 65536
    buffer_load_dwordx4 v[120:123], v118, s[4:7], s26 offen offset:0 sc1
    buffer_load_dwordx4 v[124:127], v118, s[4:7], s26 offen offset:1024 sc1
    s_add_u32 s26, s25, 67584
    buffer_load_dwordx4 v[128:131], v118, s[4:7], s26 offen offset:0 sc1
    buffer_load_dwordx4 v[132:135], v118, s[4:7], s26 offen offset:1024 sc1
    s_add_u32 s26, s25, 69632
    buffer_load_dwordx4 v[136:139], v118, s[4:7], s26 offen offset:0 sc1
    buffer_load_dwordx4 v[140:143], v118, s[4:7], s26 offen offset:1024 sc1
    s_waitcnt vmcnt(28)
    s_add_u32 s26, s25, 71680
    buffer_load_dwordx4 v[144:147], v118, s[4:7], s26 offen offset:0 sc1
    buffer_load_dwordx4 v[148:151], v118, s[4:7], s26 offen offset:1024 sc1
    s_add_u32 s26, s25, 73728
    buffer_load_dwordx4 v[152:155], v118, s[4:7], s26 offen offset:0 sc1
    buffer_load_dwordx4 v[156:159], v118, s[4:7], s26 offen offset:1024 sc1
    s_add_u32 s26, s25, 75776
    buffer_load_dwordx4 v[160:163], v118, s[4:7], s26 offen offset:0 sc1
    buffer_load_dwordx4 v[164:167], v118, s[4:7], s26 offen offset:1024 sc1
    s_add_u32 s26, s25, 77824
    buffer_load_dwordx4 v[168:171], v118, s[4:7], s26 offen offset:0 sc1
    buffer_load_dwordx4 v[172:175], v118, s[4:7], s26 offen offset:1024 sc1
    s_add_u32 s26, s25, 79872
    buffer_load_dwordx4 v[176:179], v118, s[4:7], s26 offen offset:0 sc1
    buffer_load_dwordx4 v[180:183], v118, s[4:7], s26 offen offset:1024 sc1
    s_add_u32 s26, s25, 81920
    buffer_load_dwordx4 v[184:187], v118, s[4:7], s26 offen offset:0 sc1
    buffer_load_dwordx4 v[188:191], v118, s[4:7], s26 offen offset:1024 sc1
    s_add_u32 s26, s25, 83968
    buffer_load_dwordx4 v[192:195], v118, s[4:7], s26 offen offset:0 sc1
    buffer_load_dwordx4 v[196:199], v118, s[4:7], s26 offen offset:1024 sc1
    s_waitcnt vmcnt(28)
    s_add_u32 s26, s25, 86016
    buffer_load_dwordx4 v[200:203], v118, s[4:7], s26 offen offset:0 sc1
    buffer_load_dwordx4 v[204:207], v118, s[4:7], s26 offen offset:1024 sc1
    s_add_u32 s26, s25, 88064
    buffer_load_dwordx4 v[208:211], v118, s[4:7], s26 offen offset:0 sc1
    buffer_load_dwordx4 v[212:215], v118, s[4:7], s26 offen offset:1024 sc1
    s_add_u32 s26, s25, 90112
    buffer_load_dwordx4 v[216:219], v118, s[4:7], s26 offen offset:0 sc1
    buffer_load_dwordx4 v[220:223], v118, s[4:7], s26 offen offset:1024 sc1
    s_add_u32 s26, s25, 92160
    buffer_load_dwordx4 v[224:227], v118, s[4:7], s26 offen offset:0 sc1
    buffer_load_dwordx4 v[228:231], v118, s[4:7], s26 offen offset:1024 sc1
    s_add_u32 s26, s25, 94208
    buffer_load_dwordx4 v[232:235], v118, s[4:7], s26 offen offset:0 sc1
    buffer_load_dwordx4 v[236:239], v118, s[4:7], s26 offen offset:1024 sc1
    s_add_u32 s26, s25, 96256
    buffer_load_dwordx4 v[240:243], v118, s[4:7], s26 offen offset:0 sc1
    buffer_load_dwordx4 v[244:247], v118, s[4:7], s26 offen offset:1024 sc1
    s_add_u32 s26, s25, 98304
    buffer_load_dwordx4 v[248:251], v118, s[4:7], s26 offen offset:0 sc1
    buffer_load_dwordx4 v[252:255], v118, s[4:7], s26 offen offset:1024 sc1
    s_waitcnt vmcnt(28)
    s_mov_b32 s18, 0
    s_mov_b32 s19, 0x2a00000
    s_mov_b32 s20, 0x2a01000
    s_mov_b32 s21, 0x2a80000
    s_mov_b32 s22, 0x3803800
    s_mov_b32 s24, 300000
    s_cmp_lg_u32 s16, 0
    s_cbranch_scc1 LAcg_100081
    v_and_b32 v5, 31, v0
    v_add_lshl_u32 v5, v5, 0, 2
LAcw_100080:
    buffer_load_dword v4, v5, s[12:15], 0 offen offset:64 sc1
    s_waitcnt vmcnt(0)
    v_cmp_gt_u32 vcc, 8, v4
    s_cbranch_vccz LAcg_100081
    s_sleep 12
    s_sub_u32 s24, s24, 1
    s_cbranch_scc1 Lexit_100001
    s_branch LAcw_100080
LAcg_100081:
    s_barrier
    buffer_load_dword v4, off, s[12:15], 0 sc1
    s_waitcnt vmcnt(0)
    v_readfirstlane_b32 s47, v4
    s_cmp_ge_u32 s47, 32
    s_cselect_b32 s47, 0x40000000, 0
    v_lshlrev_b32 v99, 7, v3
    s_lshl_b32 s23, s17, 13
    s_add_u32 s23, s23, 0xe90000
    s_cmp_lt_u32 s17, 8
    s_cselect_b32 s59, 262144, 0x40000000
    s_cmp_lt_u32 s17, 7
    s_cselect_b32 s61, 0x180000, 0x40000000
    s_min_u32 s25, s17, 6
    s_lshl_b32 s25, s25, 10
    v_add_u32 v103, s25, v113
    s_mov_b32 s46, 0
    v_mov_b32 v28, 0
    v_mov_b32 v29, 0
    v_mov_b32 v30, 0
    v_mov_b32 v31, 0
    v_mov_b32 v32, 0
    v_mov_b32 v33, 0
    v_mov_b32 v34, 0
    v_mov_b32 v35, 0
    v_mov_b32 v36, 0
    v_mov_b32 v37, 0
    v_mov_b32 v38, 0
    v_mov_b32 v39, 0
    v_mov_b32 v40, 0
    v_mov_b32 v41, 0
    v_mov_b32 v42, 0
    v_mov_b32 v43, 0
    v_mov_b32 v44, 0
    v_mov_b32 v45, 0
    v_mov_b32 v46, 0
    v_mov_b32 v47, 0
    v_mov_b32 v48, 0
    v_mov_b32 v49, 0
    v_mov_b32 v50, 0
    v_mov_b32 v51, 0
    v_mov_b32 v52, 0
    v_mov_b32 v53, 0
    v_mov_b32 v54, 0
    v_mov_b32 v55, 0
    s_mov_b32 s60, 0x40000000
LA3step_100078:
    s_barrier
    buffer_load_dwordx4 v[0:3], v113, s[4:7], s19 offen offset:0 sc1
    s_nop 9
    buffer_load_dwordx4 v[4:7], v113, s[4:7], s19 offen offset:1024 sc1
    s_nop 9
    buffer_load_dwordx4 v[8:11], v113, s[4:7], s19 offen offset:2048 sc1
    s_nop 15
    s_nop 9
    s_mov_b32 m0, 12288
    s_nop 0
    buffer_load_dwordx4 v113, s[4:7], s20 offen offset:2048 sc1 lds
LA3poll_100079:
    s_waitcnt vmcnt(3)
    v_smfmac_f32_16x16x64_bf16 v[28:31], v[0:3], a[0:7], v112
    v_max3_u32 v118, v0, v1, v2
    v_smfmac_f32_16x16x64_bf16 v[32:35], v[0:3], a[56:63], v112
    v_max_u32 v118, v118, v3
    v_smfmac_f32_16x16x64_bf16 v[36:39], v[0:3], a[112:119], v112
    v_cmp_eq_u32 vcc, -1, v118
    v_smfmac_f32_16x16x64_bf16 v[40:43], v[0:3], a[168:175], v112
    v_smfmac_f32_16x16x64_bf16 v[44:47], v[0:3], a[224:231], v112
    s_cbranch_vccnz Lfail_100082
    v_smfmac_f32_16x16x64_bf16 v[48:51], v[0:3], v[144:151], v112
    s_waitcnt vmcnt(2)
    v_max3_u32 v118, v4, v5, v6
    v_smfmac_f32_16x16x64_bf16 v[52:55], v[0:3], v[200:207], v112
    v_max_u32 v118, v118, v7
    v_smfmac_f32_16x16x64_bf16 v[28:31], v[4:7], a[8:15], v112
    v_smfmac_f32_16x16x64_bf16 v[32:35], v[4:7], a[64:71], v112
    v_smfmac_f32_16x16x64_bf16 v[36:39], v[4:7], a[120:127], v112
    v_smfmac_f32_16x16x64_bf16 v[40:43], v[4:7], a[176:183], v112
    s_waitcnt vmcnt(1)
    v_max3_u32 v118, v118, v8, v9
    v_smfmac_f32_16x16x64_bf16 v[44:47], v[4:7], a[232:239], v112
    v_max3_u32 v118, v118, v10, v11
    v_smfmac_f32_16x16x64_bf16 v[48:51], v[4:7], v[152:159], v112
    v_cmp_eq_u32 vcc, -1, v118
    v_smfmac_f32_16x16x64_bf16 v[52:55], v[4:7], v[208:215], v112
    v_smfmac_f32_16x16x64_bf16 v[28:31], v[8:11], a[16:23], v112
    s_cbranch_vccnz Lfail_100082
    v_smfmac_f32_16x16x64_bf16 v[32:35], v[8:11], a[72:79], v112
    v_smfmac_f32_16x16x64_bf16 v[36:39], v[8:11], a[128:135], v112
    s_waitcnt vmcnt(0)
    s_barrier
    ds_read_b128 v[12:15], v113 offset:11264
    v_smfmac_f32_16x16x64_bf16 v[40:43], v[8:11], a[184:191], v112
    ds_read_b128 v[16:19], v113 offset:12288
    s_add_u32 s25, s60, 0
    buffer_load_dword v108, v99, s[4:7], s25 offen sc1
    v_smfmac_f32_16x16x64_bf16 v[44:47], v[8:11], a[240:247], v112
    ds_read_b128 v[20:23], v113 offset:13312
    v_smfmac_f32_16x16x64_bf16 v[48:51], v[8:11], v[160:167], v112
    ds_read_b128 v[24:27], v113 offset:14336
    s_add_u32 s25, s60, 131072
    buffer_load_dword v109, v99, s[4:7], s25 offen sc1
    v_smfmac_f32_16x16x64_bf16 v[52:55], v[8:11], v[216:223], v112
    s_waitcnt lgkmcnt(3)
    v_smfmac_f32_16x16x64_bf16 v[28:31], v[12:15], a[24:31], v112
    s_waitcnt lgkmcnt(2)
    s_add_u32 s25, s60, s59
    buffer_load_dword v110, v99, s[4:7], s25 offen sc1
    v_smfmac_f32_16x16x64_bf16 v[28:31], v[16:19], a[32:39], v112
    s_waitcnt lgkmcnt(1)
    v_smfmac_f32_16x16x64_bf16 v[28:31], v[20:23], a[40:47], v112
    s_waitcnt lgkmcnt(0)
    v_smfmac_f32_16x16x64_bf16 v[28:31], v[24:27], a[48:55], v112
    v_smfmac_f32_16x16x64_bf16 v[32:35], v[12:15], a[80:87], v112
    ds_read_b128 v[104:107], v103 offset:8192
    s_add_u32 s62, s19, s61
    v_smfmac_f32_16x16x64_bf16 v[32:35], v[16:19], a[88:95], v112
    v_add_f32 v28, v28, v29
    v_smfmac_f32_16x16x64_bf16 v[32:35], v[20:23], a[96:103], v112
    v_add_f32 v30, v30, v31
    v_smfmac_f32_16x16x64_bf16 v[32:35], v[24:27], a[104:111], v112
    v_cmp_u_f32 vcc, v28, v30
    v_cvt_pk_bf16_f32 v28, v28, v30
    v_smfmac_f32_16x16x64_bf16 v[36:39], v[12:15], a[136:143], v112
    ds_write_b32 v114, v28 offset:0
    v_smfmac_f32_16x16x64_bf16 v[36:39], v[16:19], a[144:151], v112
    s_cbranch_vccnz Lfail2_100083
Lcont2_100084:
    v_add_f32 v32, v32, v33
    v_smfmac_f32_16x16x64_bf16 v[36:39], v[20:23], a[152:159], v112
    v_add_f32 v34, v34, v35
    v_smfmac_f32_16x16x64_bf16 v[36:39], v[24:27], a[160:167], v112
    s_waitcnt lgkmcnt(1)
    buffer_store_dwordx4 v[104:107], v103, s[4:7], s62 offen sc1
    v_cvt_pk_bf16_f32 v32, v32, v34
    v_smfmac_f32_16x16x64_bf16 v[40:43], v[12:15], a[192:199], v112
    ds_write_b32 v114, v32 offset:256
    v_smfmac_f32_16x16x64_bf16 v[40:43], v[16:19], a[200:207], v112
    v_add_f32 v36, v36, v37
    v_smfmac_f32_16x16x64_bf16 v[40:43], v[20:23], a[208:215], v112
    v_add_f32 v38, v38, v39
    v_smfmac_f32_16x16x64_bf16 v[40:43], v[24:27], a[216:223], v112
    v_cvt_pk_bf16_f32 v36, v36, v38
    v_smfmac_f32_16x16x64_bf16 v[44:47], v[12:15], a[248:255], v112
    ds_write_b32 v114, v36 offset:512
    v_smfmac_f32_16x16x64_bf16 v[44:47], v[16:19], v[120:127], v112
    v_add_f32 v40, v40, v41
    v_smfmac_f32_16x16x64_bf16 v[44:47], v[20:23], v[128:135], v112
    v_add_f32 v42, v42, v43
    v_smfmac_f32_16x16x64_bf16 v[44:47], v[24:27], v[136:143], v112
    v_cvt_pk_bf16_f32 v40, v40, v42
    v_smfmac_f32_16x16x64_bf16 v[48:51], v[12:15], v[168:175], v112
    s_waitcnt lgkmcnt(0)
    s_barrier
    ds_write_b32 v114, v40 offset:768
    v_smfmac_f32_16x16x64_bf16 v[48:51], v[16:19], v[176:183], v112
    v_add_f32 v44, v44, v45
    v_smfmac_f32_16x16x64_bf16 v[48:51], v[20:23], v[184:191], v112
    v_add_f32 v46, v46, v47
    v_smfmac_f32_16x16x64_bf16 v[48:51], v[24:27], v[192:199], v112
    v_cvt_pk_bf16_f32 v44, v44, v46
    v_smfmac_f32_16x16x64_bf16 v[52:55], v[12:15], v[224:231], v112
    ds_write_b32 v114, v44 offset:1024
    v_smfmac_f32_16x16x64_bf16 v[52:55], v[16:19], v[232:239], v112
    s_waitcnt lgkmcnt(1)
    s_barrier
    v_add_f32 v48, v48, v49
    v_smfmac_f32_16x16x64_bf16 v[52:55], v[20:23], v[240:247], v112
    v_add_f32 v50, v50, v51
    v_smfmac_f32_16x16x64_bf16 v[52:55], v[24:27], v[248:255], v112
    v_cvt_pk_bf16_f32 v48, v48, v50
    s_nop 1
    ds_write_b32 v114, v48 offset:1280
    s_nop 3
    v_add_f32 v52, v52, v53
    v_add_f32 v54, v54, v55
    v_cvt_pk_bf16_f32 v52, v52, v54
    ds_write_b32 v114, v52 offset:1536
    s_waitcnt lgkmcnt(0)
    s_barrier
    s_add_u32 s63, s21, s47
    s_xor_b32 s64, s63, 0x40000000
    s_nop 15
    s_nop 15
    s_nop 7
    buffer_store_dword v112, v119, s[4:7], s64 offen
    s_barrier
    ds_read_b128 v[56:59], v117
    ds_read_b128 v[76:79], v117 offset:2048
    ds_read2st64_b32 v[80:81], v116 offset0:0 offset1:8
    s_waitcnt lgkmcnt(1)
    v_pk_add_f32 v[84:85], v[56:57], v[76:77]
    v_pk_add_f32 v[86:87], v[58:59], v[78:79]
    v_exp_f32 v56, v84
    v_exp_f32 v57, v85
    s_waitcnt lgkmcnt(0)
    v_add_f32 v88, v80, v81
    v_exp_f32 v58, v86
    v_exp_f32 v59, v87
    v_exp_f32 v60, v88
    v_pk_add_f32 v[64:65], v[56:57], v[58:59]
    v_add_f32 v65, v65, v64
    v_add_f32 v65, v65, v60
    v_mov_b32_dpp v61, v60 quad_perm:[1,0,3,2] row_mask:0xf bank_mask:0xf
    s_nop 0
    v_add_f32_dpp v65, v65, v65 quad_perm:[1,0,3,2] row_mask:0xf bank_mask:0xf
    s_nop 1
    v_add_f32_dpp v65, v65, v65 quad_perm:[2,3,0,1] row_mask:0xf bank_mask:0xf
    s_nop 1
    v_add_f32_dpp v65, v65, v65 row_half_mirror row_mask:0xf bank_mask:0xf
    v_rcp_f32 v72, v65
    v_subrev_u32 v64, 0x21800000, v65
    v_pk_mul_f32 v[56:57], v[56:57], v[72:73] op_sel_hi:[1,0] clamp
    v_pk_mul_f32 v[58:59], v[58:59], v[72:73] op_sel_hi:[1,0] clamp
    v_cmp_lt_u32 vcc, 0x3c000000, v64
    v_cvt_pk_bf16_f32 v68, v56, v57
    v_cvt_pk_bf16_f32 v69, v58, v59
    v_pk_mul_f32 v[60:61], v[60:61], v[72:73] op_sel_hi:[1,0] clamp
    v_cvt_pk_bf16_f32 v70, v60, v61
    s_cbranch_vccnz Lslow_100085
    buffer_store_dwordx2 v[68:69], v96, s[4:7], s64 offen
    buffer_store_dword v70, v97, s[4:7], s64 offen
Lnorm_100086:
    buffer_store_dwordx2 v[68:69], v96, s[4:7], s63 offen sc1
    buffer_store_dword v70, v97, s[4:7], s63 offen sc1
    buffer_store_dword v112, v119, s[4:7], s63 offen sc1
    v_mov_b32 v28, 0
    v_mov_b32 v29, 0
    v_mov_b32 v30, 0
    v_mov_b32 v31, 0
    v_mov_b32 v32, 0
    v_mov_b32 v33, 0
    v_mov_b32 v34, 0
    v_mov_b32 v35, 0
    v_mov_b32 v36, 0
    v_mov_b32 v37, 0
    v_mov_b32 v38, 0
    v_mov_b32 v39, 0
    v_mov_b32 v40, 0
    v_mov_b32 v41, 0
    v_mov_b32 v42, 0
    v_mov_b32 v43, 0
    v_mov_b32 v44, 0
    v_mov_b32 v45, 0
    v_mov_b32 v46, 0
    v_mov_b32 v47, 0
    v_mov_b32 v48, 0
    v_mov_b32 v49, 0
    v_mov_b32 v50, 0
    v_mov_b32 v51, 0
    v_mov_b32 v52, 0
    v_mov_b32 v53, 0
    v_mov_b32 v54, 0
    v_mov_b32 v55, 0
    s_add_u32 s25, s21, 47104
    buffer_load_dword v118, off, s[4:7], s25 sc1
    s_add_u32 s60, s23, 458752
    s_waitcnt vmcnt(0)
    v_readfirstlane_b32 s25, v118
    s_cmp_eq_u32 s25, 15
    s_cselect_b32 s60, s60, 0x40000000
    s_add_u32 s19, s19, 8192
    s_add_u32 s20, s20, 8192
    s_add_u32 s21, s21, 16384
    s_add_u32 s22, s22, 28672
    s_add_u32 s23, s23, 458752
    s_add_u32 s18, s18, 1
    s_cmp_lt_u32 s18, 63
    s_cbranch_scc1 LA3step_100078
    s_endpgm
Lfail2_100083:
    v_max3_u32 v118, v12, v13, v14
    v_max_u32 v118, v118, v15
    v_max3_u32 v118, v118, v16, v17
    v_max3_u32 v118, v118, v18, v19
    v_max3_u32 v118, v118, v20, v21
    v_max3_u32 v118, v118, v22, v23
    v_max3_u32 v118, v118, v24, v25
    v_max3_u32 v118, v118, v26, v27
    v_cmp_eq_u32 vcc, -1, v118
    s_cbranch_vccz Lcont2_100084
    s_waitcnt lgkmcnt(0)
    s_barrier
Lfail_100082:
    buffer_load_dwordx4 v[0:3], v113, s[4:7], s19 offen offset:0 sc1
    s_nop 9
    buffer_load_dwordx4 v[4:7], v113, s[4:7], s19 offen offset:1024 sc1
    s_nop 9
    buffer_load_dwordx4 v[8:11], v113, s[4:7], s19 offen offset:2048 sc1
    s_nop 15
    s_nop 9
    s_mov_b32 m0, 12288
    s_nop 0
    buffer_load_dwordx4 v113, s[4:7], s20 offen offset:2048 sc1 lds
    s_sub_u32 s24, s24, 1
    s_cbranch_scc1 Lexit_100001
    v_mov_b32 v28, 0
    v_mov_b32 v29, 0
    v_mov_b32 v30, 0
    v_mov_b32 v31, 0
    v_mov_b32 v32, 0
    v_mov_b32 v33, 0
    v_mov_b32 v34, 0
    v_mov_b32 v35, 0
    v_mov_b32 v36, 0
    v_mov_b32 v37, 0
    v_mov_b32 v38, 0
    v_mov_b32 v39, 0
    v_mov_b32 v40, 0
    v_mov_b32 v41, 0
    v_mov_b32 v42, 0
    v_mov_b32 v43, 0
    v_mov_b32 v44, 0
    v_mov_b32 v45, 0
    v_mov_b32 v46, 0
    v_mov_b32 v47, 0
    v_mov_b32 v48, 0
    v_mov_b32 v49, 0
    v_mov_b32 v50, 0
    v_mov_b32 v51, 0
    v_mov_b32 v52, 0
    v_mov_b32 v53, 0
    v_mov_b32 v54, 0
    v_mov_b32 v55, 0
    s_branch LA3poll_100079
Lslow_100085:
    v_max3_f32 v64, v84, v85, v86
    v_max3_f32 v64, v64, v87, v88
    s_nop 1
    v_max_f32_dpp v64, v64, v64 quad_perm:[1,0,3,2] row_mask:0xf bank_mask:0xf
    s_nop 1
    v_max_f32_dpp v64, v64, v64 quad_perm:[2,3,0,1] row_mask:0xf bank_mask:0xf
    s_nop 1
    v_max_f32_dpp v64, v64, v64 row_half_mirror row_mask:0xf bank_mask:0xf
    v_sub_f32 v56, v84, v64
    v_sub_f32 v57, v85, v64
    v_sub_f32 v58, v86, v64
    v_sub_f32 v59, v87, v64
    v_sub_f32 v60, v88, v64
    v_exp_f32 v56, v56
    v_exp_f32 v57, v57
    v_exp_f32 v58, v58
    v_exp_f32 v59, v59
    v_exp_f32 v60, v60
    s_nop 0
    v_pk_add_f32 v[64:65], v[56:57], v[58:59]
    v_add_f32 v65, v65, v64
    v_add_f32 v65, v65, v60
    v_mov_b32_dpp v61, v60 quad_perm:[1,0,3,2] row_mask:0xf bank_mask:0xf
    s_nop 0
    v_add_f32_dpp v65, v65, v65 quad_perm:[1,0,3,2] row_mask:0xf bank_mask:0xf
    s_nop 1
    v_add_f32_dpp v65, v65, v65 quad_perm:[2,3,0,1] row_mask:0xf bank_mask:0xf
    s_nop 1
    v_add_f32_dpp v65, v65, v65 row_half_mirror row_mask:0xf bank_mask:0xf
    v_rcp_f32 v72, v65
    s_nop 0
    v_pk_mul_f32 v[56:57], v[56:57], v[72:73] op_sel_hi:[1,0] clamp
    v_pk_mul_f32 v[58:59], v[58:59], v[72:73] op_sel_hi:[1,0] clamp
    v_cvt_pk_bf16_f32 v68, v56, v57
    v_cvt_pk_bf16_f32 v69, v58, v59
    v_pk_mul_f32 v[60:61], v[60:61], v[72:73] op_sel_hi:[1,0] clamp
    v_cvt_pk_bf16_f32 v70, v60, v61
    buffer_store_dwordx2 v[68:69], v96, s[4:7], s64 offen
    buffer_store_dword v70, v97, s[4:7], s64 offen
    s_branch Lnorm_100086
LroleB_100022:
    s_cmp_eq_u32 s16, 1
    s_cbranch_scc1 LBw1_100088
    s_cmp_eq_u32 s16, 2
    s_cbranch_scc1 LBw2_100089
    s_cmp_eq_u32 s16, 3
    s_cbranch_scc1 LBw3_100090
LBw0_100087:
    v_and_b32 v3, 63, v0
    v_lshrrev_b32 v1, 4, v3
    v_and_b32 v2, 15, v3
    v_and_b32 v58, 1, v2
    v_mul_u32_u24 v56, 0xAAAA, v58
    v_lshrrev_b32 v58, 3, v2
    v_mul_u32_u24 v58, 0xAAAA, v58
    v_lshl_add_u32 v56, v58, 16, v56
    v_add_u32 v56, 0x44444444, v56
    v_lshlrev_b32 v57, 4, v3
    v_add_u32 v60, 65536, v57
    s_sub_u32 s25, s17, 16
    v_lshlrev_b32 v61, 2, v2
    s_lshl_b32 s26, s25, 7
    s_add_u32 s26, s26, 2048
    v_add_u32 v61, s26, v61
    v_lshlrev_b32 v166, 8, v3
    s_lshl_b32 s26, s25, 2
    s_add_u32 s26, s26, 4096
    v_add_u32 v166, s26, v166
    v_cmp_lt_u32 vcc, 3, v3
    v_mov_b32 v58, 0x40000000
    s_nop 0
    v_cndmask_b32 v166, v166, v58, vcc
    v_lshlrev_b32 v164, 6, v1
    v_and_b32 v58, 1, v2
    v_lshl_add_u32 v164, v58, 5, v164
    v_bfe_u32 v58, v2, 1, 1
    v_lshl_add_u32 v164, v58, 4, v164
    v_lshrrev_b32 v58, 2, v2
    v_lshl_add_u32 v164, v58, 2, v164
    s_mul_i32 s23, s25, 16384
    s_lshl_b32 s28, s25, 8
    s_add_u32 s28, s28, 0x2a02000
    s_mul_i32 s25, s25, 14336
    s_add_u32 s25, s25, 0x700000
    s_add_u32 s23, s23, 0xe00000
    v_mov_b32 v5, v234
    v_mov_b32 v6, v237
    v_and_b32 v7, 31, v0
    v_lshlrev_b32 v7, 2, v7
    s_cmp_ge_u32 s17, 23
    s_cselect_b32 s60, 1, 0
    s_mov_b32 s61, 0xff
    s_mov_b32 s62, 64
    s_mov_b32 s63, 0x3d41000
Lbdw_100091:
    s_sub_u32 s62, s62, 1
    s_cbranch_scc1 Lbdc_100092
    buffer_load_dword v4, v6, s[4:7], s63 offen sc1
    s_waitcnt vmcnt(0)
    v_cmp_eq_u32 vcc, v4, v5
    s_nop 1
    s_lshr_b64 s[66:67], vcc, s60
    s_lshr_b64 s[68:69], s[66:67], 4
    s_or_b64 s[66:67], s[66:67], s[68:69]
    s_branch Lbdg_100093
Lbdc_100092:
    buffer_load_dword v4, v7, s[12:15], 0 offen offset:64 sc1
    s_waitcnt vmcnt(0)
    v_cmp_gt_u32 vcc, 8, v4
    s_mov_b64 s[66:67], 0
    s_cbranch_vccz Lbdg_100093
    s_sleep 30
    s_sub_u32 s24, s24, 1
    s_cbranch_scc1 Lexit_100001
    s_branch Lbdc_100092
Lbdg_100093:
    s_mov_b32 s70, s61
    s_bitcmp0_b32 s61, 0
    s_cbranch_scc1 Lbu_100095
    s_bitcmp1_b64 s[66:67], 0
    s_cbranch_scc1 Lbu_100095
    s_bitset0_b32 s61, 0
    s_add_u32 s26, s25, 0
    buffer_load_dwordx4 a[0:3], v57, s[4:7], s26 offen offset:0 sc1
    buffer_load_dwordx4 a[4:7], v57, s[4:7], s26 offen offset:1024 sc1
    s_add_u32 s26, s25, 2048
    buffer_load_dwordx4 a[8:11], v57, s[4:7], s26 offen offset:0 sc1
    buffer_load_dwordx4 a[12:15], v57, s[4:7], s26 offen offset:1024 sc1
    s_add_u32 s26, s25, 4096
    buffer_load_dwordx4 a[16:19], v57, s[4:7], s26 offen offset:0 sc1
    buffer_load_dwordx4 a[20:23], v57, s[4:7], s26 offen offset:1024 sc1
    s_add_u32 s26, s25, 6144
    buffer_load_dwordx4 a[24:27], v57, s[4:7], s26 offen offset:0 sc1
    buffer_load_dwordx4 a[28:31], v57, s[4:7], s26 offen offset:1024 sc1
    s_add_u32 s26, s25, 8192
    buffer_load_dwordx4 a[32:35], v57, s[4:7], s26 offen offset:0 sc1
    buffer_load_dwordx4 a[36:39], v57, s[4:7], s26 offen offset:1024 sc1
    s_add_u32 s26, s25, 10240
    buffer_load_dwordx4 a[40:43], v57, s[4:7], s26 offen offset:0 sc1
    buffer_load_dwordx4 a[44:47], v57, s[4:7], s26 offen offset:1024 sc1
    s_add_u32 s26, s25, 12288
    buffer_load_dwordx4 a[48:51], v57, s[4:7], s26 offen offset:0 sc1
    buffer_load_dwordx4 a[52:55], v57, s[4:7], s26 offen offset:1024 sc1
    s_waitcnt vmcnt(28)
Lbu_100095:
    s_bitcmp0_b32 s61, 1
    s_cbranch_scc1 Lbu_100096
    s_bitcmp1_b64 s[66:67], 8
    s_cbranch_scc1 Lbu_100096
    s_bitset0_b32 s61, 1
    s_add_u32 s26, s25, 401408
    buffer_load_dwordx4 a[56:59], v57, s[4:7], s26 offen offset:0 sc1
    buffer_load_dwordx4 a[60:63], v57, s[4:7], s26 offen offset:1024 sc1
    s_add_u32 s26, s25, 403456
    buffer_load_dwordx4 a[64:67], v57, s[4:7], s26 offen offset:0 sc1
    buffer_load_dwordx4 a[68:71], v57, s[4:7], s26 offen offset:1024 sc1
    s_add_u32 s26, s25, 405504
    buffer_load_dwordx4 a[72:75], v57, s[4:7], s26 offen offset:0 sc1
    buffer_load_dwordx4 a[76:79], v57, s[4:7], s26 offen offset:1024 sc1
    s_add_u32 s26, s25, 407552
    buffer_load_dwordx4 a[80:83], v57, s[4:7], s26 offen offset:0 sc1
    buffer_load_dwordx4 a[84:87], v57, s[4:7], s26 offen offset:1024 sc1
    s_add_u32 s26, s25, 409600
    buffer_load_dwordx4 a[88:91], v57, s[4:7], s26 offen offset:0 sc1
    buffer_load_dwordx4 a[92:95], v57, s[4:7], s26 offen offset:1024 sc1
    s_add_u32 s26, s25, 411648
    buffer_load_dwordx4 a[96:99], v57, s[4:7], s26 offen offset:0 sc1
    buffer_load_dwordx4 a[100:103], v57, s[4:7], s26 offen offset:1024 sc1
    s_add_u32 s26, s25, 413696
    buffer_load_dwordx4 a[104:107], v57, s[4:7], s26 offen offset:0 sc1
    buffer_load_dwordx4 a[108:111], v57, s[4:7], s26 offen offset:1024 sc1
    s_waitcnt vmcnt(28)
Lbu_100096:
    s_bitcmp0_b32 s61, 2
    s_cbranch_scc1 Lbu_100097
    s_bitcmp1_b64 s[66:67], 16
    s_cbranch_scc1 Lbu_100097
    s_bitset0_b32 s61, 2
    s_add_u32 s26, s25, 802816
    buffer_load_dwordx4 a[112:115], v57, s[4:7], s26 offen offset:0 sc1
    buffer_load_dwordx4 a[116:119], v57, s[4:7], s26 offen offset:1024 sc1
    s_add_u32 s26, s25, 804864
    buffer_load_dwordx4 a[120:123], v57, s[4:7], s26 offen offset:0 sc1
    buffer_load_dwordx4 a[124:127], v57, s[4:7], s26 offen offset:1024 sc1
    s_add_u32 s26, s25, 806912
    buffer_load_dwordx4 a[128:131], v57, s[4:7], s26 offen offset:0 sc1
    buffer_load_dwordx4 a[132:135], v57, s[4:7], s26 offen offset:1024 sc1
    s_add_u32 s26, s25, 808960
    buffer_load_dwordx4 a[136:139], v57, s[4:7], s26 offen offset:0 sc1
    buffer_load_dwordx4 a[140:143], v57, s[4:7], s26 offen offset:1024 sc1
    s_add_u32 s26, s25, 811008
    buffer_load_dwordx4 a[144:147], v57, s[4:7], s26 offen offset:0 sc1
    buffer_load_dwordx4 a[148:151], v57, s[4:7], s26 offen offset:1024 sc1
    s_add_u32 s26, s25, 813056
    buffer_load_dwordx4 a[152:155], v57, s[4:7], s26 offen offset:0 sc1
    buffer_load_dwordx4 a[156:159], v57, s[4:7], s26 offen offset:1024 sc1
    s_add_u32 s26, s25, 815104
    buffer_load_dwordx4 a[160:163], v57, s[4:7], s26 offen offset:0 sc1
    buffer_load_dwordx4 a[164:167], v57, s[4:7], s26 offen offset:1024 sc1
    s_waitcnt vmcnt(28)
Lbu_100097:
    s_bitcmp0_b32 s61, 3
    s_cbranch_scc1 Lbu_100098
    s_bitcmp1_b64 s[66:67], 24
    s_cbranch_scc1 Lbu_100098
    s_bitset0_b32 s61, 3
    s_add_u32 s26, s25, 1204224
    buffer_load_dwordx4 a[168:171], v57, s[4:7], s26 offen offset:0 sc1
    buffer_load_dwordx4 a[172:175], v57, s[4:7], s26 offen offset:1024 sc1
    s_add_u32 s26, s25, 1206272
    buffer_load_dwordx4 a[176:179], v57, s[4:7], s26 offen offset:0 sc1
    buffer_load_dwordx4 a[180:183], v57, s[4:7], s26 offen offset:1024 sc1
    s_add_u32 s26, s25, 1208320
    buffer_load_dwordx4 a[184:187], v57, s[4:7], s26 offen offset:0 sc1
    buffer_load_dwordx4 a[188:191], v57, s[4:7], s26 offen offset:1024 sc1
    s_add_u32 s26, s25, 1210368
    buffer_load_dwordx4 a[192:195], v57, s[4:7], s26 offen offset:0 sc1
    buffer_load_dwordx4 a[196:199], v57, s[4:7], s26 offen offset:1024 sc1
    s_add_u32 s26, s25, 1212416
    buffer_load_dwordx4 a[200:203], v57, s[4:7], s26 offen offset:0 sc1
    buffer_load_dwordx4 a[204:207], v57, s[4:7], s26 offen offset:1024 sc1
    s_add_u32 s26, s25, 1214464
    buffer_load_dwordx4 a[208:211], v57, s[4:7], s26 offen offset:0 sc1
    buffer_load_dwordx4 a[212:215], v57, s[4:7], s26 offen offset:1024 sc1
    s_add_u32 s26, s25, 1216512
    buffer_load_dwordx4 a[216:219], v57, s[4:7], s26 offen offset:0 sc1
    buffer_load_dwordx4 a[220:223], v57, s[4:7], s26 offen offset:1024 sc1
    s_waitcnt vmcnt(28)
Lbu_100098:
    s_bitcmp0_b32 s61, 4
    s_cbranch_scc1 Lbu_100099
    s_bitcmp1_b64 s[66:67], 32
    s_cbranch_scc1 Lbu_100099
    s_bitset0_b32 s61, 4
    s_add_u32 s26, s25, 1605632
    buffer_load_dwordx4 a[224:227], v57, s[4:7], s26 offen offset:0 sc1
    buffer_load_dwordx4 a[228:231], v57, s[4:7], s26 offen offset:1024 sc1
    s_add_u32 s26, s25, 1607680
    buffer_load_dwordx4 a[232:235], v57, s[4:7], s26 offen offset:0 sc1
    buffer_load_dwordx4 a[236:239], v57, s[4:7], s26 offen offset:1024 sc1
    s_add_u32 s26, s25, 1609728
    buffer_load_dwordx4 a[240:243], v57, s[4:7], s26 offen offset:0 sc1
    buffer_load_dwordx4 a[244:247], v57, s[4:7], s26 offen offset:1024 sc1
    s_add_u32 s26, s25, 1611776
    buffer_load_dwordx4 a[248:251], v57, s[4:7], s26 offen offset:0 sc1
    buffer_load_dwordx4 a[252:255], v57, s[4:7], s26 offen offset:1024 sc1
    s_add_u32 s26, s25, 1613824
    buffer_load_dwordx4 v[176:179], v57, s[4:7], s26 offen offset:0 sc1
    buffer_load_dwordx4 v[180:183], v57, s[4:7], s26 offen offset:1024 sc1
    s_add_u32 s26, s25, 1615872
    buffer_load_dwordx4 v[184:187], v57, s[4:7], s26 offen offset:0 sc1
    buffer_load_dwordx4 v[188:191], v57, s[4:7], s26 offen offset:1024 sc1
    s_add_u32 s26, s25, 1617920
    buffer_load_dwordx4 v[192:195], v57, s[4:7], s26 offen offset:0 sc1
    buffer_load_dwordx4 v[196:199], v57, s[4:7], s26 offen offset:1024 sc1
    s_waitcnt vmcnt(28)
Lbu_100099:
    s_bitcmp0_b32 s61, 5
    s_cbranch_scc1 Lbu_100100
    s_bitcmp1_b64 s[66:67], 40
    s_cbranch_scc1 Lbu_100100
    s_bitset0_b32 s61, 5
    s_add_u32 s26, s25, 2007040
    buffer_load_dwordx4 v[200:203], v57, s[4:7], s26 offen offset:0 sc1
    buffer_load_dwordx4 v[204:207], v57, s[4:7], s26 offen offset:1024 sc1
    s_add_u32 s26, s25, 2009088
    buffer_load_dwordx4 v[208:211], v57, s[4:7], s26 offen offset:0 sc1
    buffer_load_dwordx4 v[212:215], v57, s[4:7], s26 offen offset:1024 sc1
    s_add_u32 s26, s25, 2011136
    buffer_load_dwordx4 v[216:219], v57, s[4:7], s26 offen offset:0 sc1
    buffer_load_dwordx4 v[220:223], v57, s[4:7], s26 offen offset:1024 sc1
    s_add_u32 s26, s25, 2013184
    buffer_load_dwordx4 v[224:227], v57, s[4:7], s26 offen offset:0 sc1
    buffer_load_dwordx4 v[228:231], v57, s[4:7], s26 offen offset:1024 sc1
    s_add_u32 s26, s25, 2015232
    buffer_load_dwordx4 v[232:235], v57, s[4:7], s26 offen offset:0 sc1
    buffer_load_dwordx4 v[236:239], v57, s[4:7], s26 offen offset:1024 sc1
    s_add_u32 s26, s25, 2017280
    buffer_load_dwordx4 v[240:243], v57, s[4:7], s26 offen offset:0 sc1
    buffer_load_dwordx4 v[244:247], v57, s[4:7], s26 offen offset:1024 sc1
    s_add_u32 s26, s25, 2019328
    buffer_load_dwordx4 v[248:251], v57, s[4:7], s26 offen offset:0 sc1
    buffer_load_dwordx4 v[252:255], v57, s[4:7], s26 offen offset:1024 sc1
    s_waitcnt vmcnt(28)
Lbu_100100:
    s_bitcmp0_b32 s61, 6
    s_cbranch_scc1 Lbu_100101
    s_bitcmp1_b64 s[66:67], 48
    s_cbranch_scc1 Lbu_100101
    s_bitset0_b32 s61, 6
    s_add_u32 s26, s25, 2408448
    s_mov_b32 m0, 0
    s_nop 0
    buffer_load_dwordx4 v57, s[4:7], s26 offen offset:0 sc1 lds
    buffer_load_dwordx4 v57, s[4:7], s26 offen offset:1024 sc1 lds
    s_add_u32 s26, s25, 2410496
    s_mov_b32 m0, 2048
    s_nop 0
    buffer_load_dwordx4 v57, s[4:7], s26 offen offset:0 sc1 lds
    buffer_load_dwordx4 v57, s[4:7], s26 offen offset:1024 sc1 lds
    s_add_u32 s26, s25, 2412544
    s_mov_b32 m0, 4096
    s_nop 0
    buffer_load_dwordx4 v57, s[4:7], s26 offen offset:0 sc1 lds
    buffer_load_dwordx4 v57, s[4:7], s26 offen offset:1024 sc1 lds
    s_add_u32 s26, s25, 2414592
    s_mov_b32 m0, 6144
    s_nop 0
    buffer_load_dwordx4 v57, s[4:7], s26 offen offset:0 sc1 lds
    buffer_load_dwordx4 v57, s[4:7], s26 offen offset:1024 sc1 lds
    s_add_u32 s26, s25, 2416640
    s_mov_b32 m0, 8192
    s_nop 0
    buffer_load_dwordx4 v57, s[4:7], s26 offen offset:0 sc1 lds
    buffer_load_dwordx4 v57, s[4:7], s26 offen offset:1024 sc1 lds
    s_add_u32 s26, s25, 2418688
    s_mov_b32 m0, 10240
    s_nop 0
    buffer_load_dwordx4 v57, s[4:7], s26 offen offset:0 sc1 lds
    buffer_load_dwordx4 v57, s[4:7], s26 offen offset:1024 sc1 lds
    s_add_u32 s26, s25, 2420736
    s_mov_b32 m0, 12288
    s_nop 0
    buffer_load_dwordx4 v57, s[4:7], s26 offen offset:0 sc1 lds
    buffer_load_dwordx4 v57, s[4:7], s26 offen offset:1024 sc1 lds
    s_waitcnt vmcnt(28)
Lbu_100101:
    s_bitcmp0_b32 s61, 7
    s_cbranch_scc1 Lbu_100102
    s_bitcmp1_b64 s[66:67], 56
    s_cbranch_scc1 Lbu_100102
    s_bitset0_b32 s61, 7
    s_add_u32 s26, s25, 2809856
    s_mov_b32 m0, 14336
    s_nop 0
    buffer_load_dwordx4 v57, s[4:7], s26 offen offset:0 sc1 lds
    buffer_load_dwordx4 v57, s[4:7], s26 offen offset:1024 sc1 lds
    s_add_u32 s26, s25, 2811904
    s_mov_b32 m0, 16384
    s_nop 0
    buffer_load_dwordx4 v57, s[4:7], s26 offen offset:0 sc1 lds
    buffer_load_dwordx4 v57, s[4:7], s26 offen offset:1024 sc1 lds
    s_add_u32 s26, s25, 2813952
    s_mov_b32 m0, 18432
    s_nop 0
    buffer_load_dwordx4 v57, s[4:7], s26 offen offset:0 sc1 lds
    buffer_load_dwordx4 v57, s[4:7], s26 offen offset:1024 sc1 lds
    s_add_u32 s26, s25, 2816000
    s_mov_b32 m0, 20480
    s_nop 0
    buffer_load_dwordx4 v57, s[4:7], s26 offen offset:0 sc1 lds
    buffer_load_dwordx4 v57, s[4:7], s26 offen offset:1024 sc1 lds
    s_add_u32 s26, s25, 2818048
    s_mov_b32 m0, 22528
    s_nop 0
    buffer_load_dwordx4 v57, s[4:7], s26 offen offset:0 sc1 lds
    buffer_load_dwordx4 v57, s[4:7], s26 offen offset:1024 sc1 lds
    s_add_u32 s26, s25, 2820096
    s_mov_b32 m0, 24576
    s_nop 0
    buffer_load_dwordx4 v57, s[4:7], s26 offen offset:0 sc1 lds
    buffer_load_dwordx4 v57, s[4:7], s26 offen offset:1024 sc1 lds
    s_add_u32 s26, s25, 2822144
    s_mov_b32 m0, 26624
    s_nop 0
    buffer_load_dwordx4 v57, s[4:7], s26 offen offset:0 sc1 lds
    buffer_load_dwordx4 v57, s[4:7], s26 offen offset:1024 sc1 lds
    s_waitcnt vmcnt(28)
Lbu_100102:
    s_cmp_eq_u32 s61, 0
    s_cbranch_scc1 Lbdd_100094
    s_cmp_lg_u32 s61, s70
    s_cbranch_scc1 Lbdw_100091
    s_sleep 12
    s_branch Lbdw_100091
Lbdd_100094:
    s_waitcnt vmcnt(0)
    s_cmp_lg_u32 s16, 0
    s_cbranch_scc1 LBcg_100104
    v_and_b32 v5, 31, v0
    v_add_lshl_u32 v5, v5, 0, 2
LBcw_100103:
    buffer_load_dword v4, v5, s[12:15], 0 offen offset:64 sc1
    s_waitcnt vmcnt(0)
    v_cmp_gt_u32 vcc, 8, v4
    s_cbranch_vccz LBcg_100104
    s_sleep 12
    s_sub_u32 s24, s24, 1
    s_cbranch_scc1 Lexit_100001
    s_branch LBcw_100103
LBcg_100104:
    s_barrier
    buffer_load_dword v4, off, s[12:15], 0 sc1
    s_waitcnt vmcnt(0)
    v_readfirstlane_b32 s47, v4
    s_cmp_ge_u32 s47, 32
    s_cselect_b32 s47, 0x40000000, 0
    s_mov_b32 s18, 0
    s_mov_b32 s19, 0x2a00000
    s_mov_b32 s20, 0x2a01000
    s_mov_b32 s21, 0x2a80000
    s_mov_b32 s22, 0x2a81000
    s_mov_b32 s27, 0x2a82000
    s_mov_b32 s24, 300000
    s_mov_b32 s65, 0x2a83800
    s_mov_b32 s66, 0xaaaaaaaa
    s_mov_b32 s67, 0xaaaaaaaa
    s_waitcnt vmcnt(0) lgkmcnt(0)
    s_mov_b32 s40, 0
    v_mov_b32 v59, 0
    s_branch LB0poll_100106
LB0step_100105:
    s_nop 15
    s_nop 15
    s_nop 15
    s_nop 11
LB0poll_100106:
    s_mov_b32 m0, 57344
    s_nop 0
    buffer_load_dwordx4 v57, s[4:7], s19 offen offset:0 sc1 lds
    s_mov_b32 m0, 57344
    s_nop 0
    buffer_load_dwordx4 v57, s[4:7], s19 offen offset:1024 sc1 lds
    v_mov_b32 v40, 0
    v_mov_b32 v41, 0
    v_mov_b32 v42, 0
    v_mov_b32 v43, 0
    v_mov_b32 v44, 0
    v_mov_b32 v45, 0
    v_mov_b32 v46, 0
    v_mov_b32 v47, 0
    v_mov_b32 v152, 0
    v_mov_b32 v153, 0
    v_mov_b32 v154, 0
    v_mov_b32 v155, 0
    v_mov_b32 v168, 0
    v_mov_b32 v169, 0
    v_mov_b32 v170, 0
    v_mov_b32 v171, 0
    ds_read_b128 v[136:139], v57 offset:0
    ds_read_b128 v[140:143], v57 offset:1024
    ds_read_b128 v[144:147], v57 offset:2048
    ds_read_b128 v[148:151], v57 offset:3072
    v_cmp_ne_u32 vcc, 15, v59
    s_add_u32 s26, s65, 0
    s_cbranch_vccz Lbcg_100109
Lbcv_100108:
    buffer_load_dword v59, off, s[4:7], s26 sc1
    s_waitcnt vmcnt(0)
    v_cmp_ne_u32 vcc, 15, v59
    s_cbranch_vccz Lbcg_100109
    s_sleep 1
    s_sub_u32 s24, s24, 1
    s_cbranch_scc1 Lexit_100001
    s_branch Lbcv_100108
Lbcg_100109:
    s_waitcnt vmcnt(0)
    s_barrier
    ds_read_b128 v[0:3], v57 offset:57344
    ds_read_b128 v[4:7], v57 offset:58368
    ds_read_b128 v[8:11], v57 offset:59392
    ds_read_b128 v[12:15], v57 offset:60416
    ds_read_b128 v[16:19], v57 offset:61440
    ds_read_b128 v[20:23], v57 offset:62464
    ds_read_b128 v[24:27], v57 offset:63488
    s_waitcnt lgkmcnt(6)
    v_smfmac_f32_16x16x64_bf16 v[40:43], v[0:3], a[0:7], v56
    s_waitcnt lgkmcnt(5)
    v_smfmac_f32_16x16x64_bf16 v[40:43], v[4:7], a[8:15], v56
    s_waitcnt lgkmcnt(4)
    v_smfmac_f32_16x16x64_bf16 v[40:43], v[8:11], a[16:23], v56
    s_waitcnt lgkmcnt(3)
    v_smfmac_f32_16x16x64_bf16 v[40:43], v[12:15], a[24:31], v56
    s_waitcnt lgkmcnt(2)
    v_smfmac_f32_16x16x64_bf16 v[40:43], v[16:19], a[32:39], v56
    v_smfmac_f32_16x16x64_bf16 v[152:155], v[0:3], v[136:143], v56
    s_waitcnt lgkmcnt(1)
    v_smfmac_f32_16x16x64_bf16 v[40:43], v[20:23], a[40:47], v56
    ds_read_b128 v[136:139], v57 offset:4096
    ds_read_b128 v[140:143], v57 offset:5120
    s_waitcnt lgkmcnt(2)
    v_smfmac_f32_16x16x64_bf16 v[40:43], v[24:27], a[48:55], v56
    v_smfmac_f32_16x16x64_bf16 v[44:47], v[0:3], a[56:63], v56
    v_smfmac_f32_16x16x64_bf16 v[44:47], v[4:7], a[64:71], v56
    s_add_u32 s25, s23, 0
    buffer_load_dwordx4 v[72:75], v57, s[4:7], s25 offen offset:0 sc1
    v_add_f32 v40, v40, v41
    v_smfmac_f32_16x16x64_bf16 v[44:47], v[8:11], a[72:79], v56
    buffer_load_dwordx4 v[76:79], v57, s[4:7], s25 offen offset:1024 sc1
    v_add_f32 v42, v42, v43
    v_smfmac_f32_16x16x64_bf16 v[44:47], v[12:15], a[80:87], v56
    v_cmp_u_f32 vcc, v40, v42
    v_cvt_pk_bf16_f32 v48, v40, v42
    v_smfmac_f32_16x16x64_bf16 v[152:155], v[4:7], v[144:151], v56
    buffer_load_dwordx4 v[80:83], v57, s[4:7], s25 offen offset:2048 sc1
    v_mov_b32 v40, 0
    v_smfmac_f32_16x16x64_bf16 v[44:47], v[16:19], a[88:95], v56
    ds_read_b128 v[144:147], v57 offset:6144
    ds_read_b128 v[148:151], v57 offset:7168
    s_cbranch_vccnz LBretry_100110
LBcont_100111:
    v_mov_b32 v41, 0
    v_smfmac_f32_16x16x64_bf16 v[44:47], v[20:23], a[96:103], v56
    buffer_load_dwordx4 v[84:87], v57, s[4:7], s25 offen offset:3072 sc1
    v_mov_b32 v42, 0
    v_mov_b32 v43, 0
    v_smfmac_f32_16x16x64_bf16 v[44:47], v[24:27], a[104:111], v56
    s_add_u32 s25, s23, 4096
    buffer_load_dwordx4 v[88:91], v57, s[4:7], s25 offen offset:0 sc1
    v_smfmac_f32_16x16x64_bf16 v[40:43], v[0:3], a[112:119], v56
    buffer_load_dwordx4 v[92:95], v57, s[4:7], s25 offen offset:1024 sc1
    v_smfmac_f32_16x16x64_bf16 v[40:43], v[4:7], a[120:127], v56
    v_add_f32 v44, v44, v45
    v_smfmac_f32_16x16x64_bf16 v[40:43], v[8:11], a[128:135], v56
    s_waitcnt lgkmcnt(2)
    buffer_load_dwordx4 v[96:99], v57, s[4:7], s25 offen offset:2048 sc1
    v_add_f32 v46, v46, v47
    v_smfmac_f32_16x16x64_bf16 v[152:155], v[8:11], v[136:143], v56
    buffer_load_dwordx4 v[100:103], v57, s[4:7], s25 offen offset:3072 sc1
    v_cvt_pk_bf16_f32 v49, v44, v46
    v_smfmac_f32_16x16x64_bf16 v[40:43], v[12:15], a[136:143], v56
    ds_read_b128 v[136:139], v57 offset:8192
    ds_read_b128 v[140:143], v57 offset:9216
    v_mov_b32 v44, 0
    v_smfmac_f32_16x16x64_bf16 v[40:43], v[16:19], a[144:151], v56
    s_add_u32 s25, s23, 8192
    buffer_load_dwordx4 v[104:107], v57, s[4:7], s25 offen offset:0 sc1
    v_mov_b32 v45, 0
    v_smfmac_f32_16x16x64_bf16 v[40:43], v[20:23], a[152:159], v56
    buffer_load_dwordx4 v[108:111], v57, s[4:7], s25 offen offset:1024 sc1
    s_add_u32 s60, s28, s47
    v_mov_b32 v46, 0
    v_mov_b32 v47, 0
    v_smfmac_f32_16x16x64_bf16 v[40:43], v[24:27], a[160:167], v56
    s_add_u32 s61, s27, s47
    v_smfmac_f32_16x16x64_bf16 v[44:47], v[0:3], a[168:175], v56
    buffer_load_dwordx4 v[112:115], v57, s[4:7], s25 offen offset:2048 sc1
    v_smfmac_f32_16x16x64_bf16 v[44:47], v[4:7], a[176:183], v56
    s_waitcnt lgkmcnt(2)
    buffer_load_dwordx4 v[116:119], v57, s[4:7], s25 offen offset:3072 sc1
    v_add_f32 v40, v40, v41
    v_smfmac_f32_16x16x64_bf16 v[152:155], v[12:15], v[144:151], v56
    s_xor_b32 s62, s60, 0x40000000
    v_add_f32 v42, v42, v43
    v_smfmac_f32_16x16x64_bf16 v[44:47], v[8:11], a[184:191], v56
    ds_read_b128 v[144:147], v57 offset:10240
    ds_read_b128 v[148:151], v57 offset:11264
    v_cvt_pk_bf16_f32 v50, v40, v42
    v_smfmac_f32_16x16x64_bf16 v[44:47], v[12:15], a[192:199], v56
    s_add_u32 s25, s23, 12288
    buffer_load_dwordx4 v[120:123], v57, s[4:7], s25 offen offset:0 sc1
    v_mov_b32 v40, 0
    v_smfmac_f32_16x16x64_bf16 v[44:47], v[16:19], a[200:207], v56
    buffer_load_dwordx4 v[124:127], v57, s[4:7], s25 offen offset:1024 sc1
    s_xor_b32 s63, s61, 0x40000000
    v_mov_b32 v41, 0
    v_smfmac_f32_16x16x64_bf16 v[44:47], v[20:23], a[208:215], v56
    buffer_load_dwordx4 v[128:131], v57, s[4:7], s25 offen offset:2048 sc1
    v_mov_b32 v42, 0
    v_mov_b32 v43, 0
    v_smfmac_f32_16x16x64_bf16 v[44:47], v[24:27], a[216:223], v56
    buffer_load_dwordx4 v[132:135], v57, s[4:7], s25 offen offset:3072 sc1
    v_smfmac_f32_16x16x64_bf16 v[40:43], v[0:3], a[224:231], v56
    s_waitcnt lgkmcnt(2)
    v_smfmac_f32_16x16x64_bf16 v[152:155], v[16:19], v[136:143], v56
    s_add_u32 s26, s65, 16384
    buffer_load_dword v59, off, s[4:7], s26 sc1
    v_add_f32 v44, v44, v45
    v_smfmac_f32_16x16x64_bf16 v[40:43], v[4:7], a[232:239], v56
    ds_read_b128 v[136:139], v57 offset:12288
    ds_read_b128 v[140:143], v57 offset:13312
    v_add_f32 v46, v46, v47
    v_smfmac_f32_16x16x64_bf16 v[40:43], v[8:11], a[240:247], v56
    v_cvt_pk_bf16_f32 v51, v44, v46
    v_smfmac_f32_16x16x64_bf16 v[40:43], v[12:15], a[248:255], v56
    buffer_load_dword v28, v61, s[4:7], s27 offen offset:0 sc1
    v_mov_b32 v44, 0
    v_smfmac_f32_16x16x64_bf16 v[40:43], v[16:19], v[176:183], v56
    v_mov_b32 v45, 0
    v_smfmac_f32_16x16x64_bf16 v[40:43], v[20:23], v[184:191], v56
    v_mov_b32 v46, 0
    v_smfmac_f32_16x16x64_bf16 v[40:43], v[24:27], v[192:199], v56
    s_waitcnt lgkmcnt(2)
    buffer_load_dword v29, v61, s[4:7], s27 offen offset:0 sc1
    v_mov_b32 v47, 0
    v_smfmac_f32_16x16x64_bf16 v[152:155], v[20:23], v[144:151], v56
    v_smfmac_f32_16x16x64_bf16 v[44:47], v[0:3], v[200:207], v56
    v_add_f32 v40, v40, v41
    v_smfmac_f32_16x16x64_bf16 v[44:47], v[4:7], v[208:215], v56
    buffer_load_dword v30, v61, s[4:7], s27 offen offset:0 sc1
    v_add_f32 v42, v42, v43
    v_smfmac_f32_16x16x64_bf16 v[44:47], v[8:11], v[216:223], v56
    v_cvt_pk_bf16_f32 v52, v40, v42
    v_smfmac_f32_16x16x64_bf16 v[44:47], v[12:15], v[224:231], v56
    v_smfmac_f32_16x16x64_bf16 v[44:47], v[16:19], v[232:239], v56
    buffer_load_dword v31, v61, s[4:7], s27 offen offset:0 sc1
    v_smfmac_f32_16x16x64_bf16 v[44:47], v[20:23], v[240:247], v56
    s_waitcnt lgkmcnt(0)
    v_smfmac_f32_16x16x64_bf16 v[152:155], v[24:27], v[136:143], v56
    v_smfmac_f32_16x16x64_bf16 v[44:47], v[24:27], v[248:255], v56
    buffer_load_dword v32, v61, s[4:7], s27 offen offset:0 sc1
    s_nop 7
    v_add_f32 v44, v44, v45
    v_add_f32 v46, v46, v47
    v_cvt_pk_bf16_f32 v53, v44, v46
    v_add_f32 v152, v152, v153
    v_add_f32 v154, v154, v155
    v_cvt_pk_bf16_f32 v54, v152, v154
LBfp_100112:
    s_waitcnt vmcnt(4)
    v_cmp_eq_u32 vcc, -1, v28
    s_cbranch_vccz LBgo_100113
    buffer_load_dword v28, v61, s[4:7], s27 offen offset:0 sc1
    s_waitcnt vmcnt(4)
    v_cmp_eq_u32 vcc, -1, v29
    s_cbranch_vccz LBgo_100113
    buffer_load_dword v29, v61, s[4:7], s27 offen offset:0 sc1
    s_waitcnt vmcnt(4)
    v_cmp_eq_u32 vcc, -1, v30
    s_cbranch_vccz LBgo_100113
    buffer_load_dword v30, v61, s[4:7], s27 offen offset:0 sc1
    s_waitcnt vmcnt(4)
    v_cmp_eq_u32 vcc, -1, v31
    s_cbranch_vccz LBgo_100113
    buffer_load_dword v31, v61, s[4:7], s27 offen offset:0 sc1
    s_waitcnt vmcnt(4)
    v_cmp_eq_u32 vcc, -1, v32
    s_cbranch_vccz LBgo_100113
    buffer_load_dword v32, v61, s[4:7], s27 offen offset:0 sc1
    s_sub_u32 s24, s24, 1
    s_cbranch_scc1 Lexit_100001
    s_branch LBfp_100112
LBgo_100113:
    buffer_store_dword v56, v166, s[4:7], s63 offen
    s_nop 15
    s_nop 1
    buffer_load_dwordx4 v[0:3], v57, s[4:7], s21 offen offset:0 sc1
    buffer_load_dwordx4 v[4:7], v57, s[4:7], s21 offen offset:1024 sc1
    buffer_load_dwordx4 v[8:11], v57, s[4:7], s21 offen offset:2048 sc1
    buffer_load_dwordx4 v[12:15], v57, s[4:7], s21 offen offset:3072 sc1
    buffer_load_dwordx4 v[16:19], v57, s[4:7], s22 offen offset:0 sc1
    buffer_load_dwordx4 v[20:23], v57, s[4:7], s22 offen offset:1024 sc1
    buffer_load_dwordx4 v[24:27], v57, s[4:7], s22 offen offset:2048 sc1
    buffer_load_dwordx4 v[28:31], v57, s[4:7], s22 offen offset:3072 sc1
    buffer_load_dwordx4 v[32:35], v57, s[4:7], s27 offen offset:0 sc1
    buffer_load_dwordx4 v[36:39], v57, s[4:7], s27 offen offset:1024 sc1
    s_barrier
    ds_read_b128 v[64:67], v60
    ds_read_b128 v[68:71], v60 offset:1024
    ds_read_b32 v55, v60 offset:4096
Lpp_100114:
    s_waitcnt lgkmcnt(0)
    s_waitcnt vmcnt(9)
    v_smfmac_f32_16x16x64_bf16 v[168:171], v[0:3], v[72:79], v56
    s_waitcnt vmcnt(8)
    v_smfmac_f32_16x16x64_bf16 v[168:171], v[4:7], v[80:87], v56
    s_waitcnt vmcnt(7)
    v_smfmac_f32_16x16x64_bf16 v[168:171], v[8:11], v[88:95], v56
    s_waitcnt vmcnt(6)
    v_smfmac_f32_16x16x64_bf16 v[168:171], v[12:15], v[96:103], v56
    s_waitcnt vmcnt(5)
    v_smfmac_f32_16x16x64_bf16 v[168:171], v[16:19], v[104:111], v56
    s_waitcnt vmcnt(4)
    v_smfmac_f32_16x16x64_bf16 v[168:171], v[20:23], v[112:119], v56
    s_waitcnt vmcnt(3)
    v_smfmac_f32_16x16x64_bf16 v[168:171], v[24:27], v[120:127], v56
    s_waitcnt vmcnt(2)
    v_smfmac_f32_16x16x64_bf16 v[168:171], v[28:31], v[128:135], v56
    s_waitcnt vmcnt(1)
    v_smfmac_f32_16x16x64_bf16 v[168:171], v[32:35], v[48:55], v56
    s_waitcnt vmcnt(0)
    v_smfmac_f32_16x16x64_bf16 v[168:171], v[36:39], v[64:71], v56
    s_mov_b64 vcc, s[66:67]
    s_nop 6
    v_add_f32 v168, v168, v169
    v_add_f32 v170, v170, v171
    v_cmp_u_f32 s[68:69], v168, v170
    v_cndmask_b32_dpp v171, v168, v170, vcc quad_perm:[1,0,3,2] row_mask:0xf bank_mask:0xf
    s_not_b64 vcc, vcc
    v_cndmask_b32_dpp v169, v170, v168, vcc quad_perm:[1,0,3,2] row_mask:0xf bank_mask:0xf
    s_cmp_lg_u64 s[68:69], 0
    v_cvt_pk_bf16_f32 v165, v169, v171
    s_cbranch_scc1 Lbad_100115
Lgood_100116:
    buffer_store_dword v165, v164, s[4:7], s62 offen
    buffer_store_dword v165, v164, s[4:7], s60 offen sc1
    buffer_store_dword v56, v166, s[4:7], s61 offen sc1
    s_add_u32 s64, s28, 0x180000
    s_cmp_lg_u32 s18, 62
    s_cbranch_scc1 LBq_100117
    buffer_store_dword v165, v164, s[4:7], s64 offen sc1
LBq_100117:
    s_barrier
    s_add_u32 s19, s19, 8192
    s_add_u32 s20, s20, 8192
    s_add_u32 s28, s28, 8192
    s_add_u32 s21, s21, 16384
    s_add_u32 s27, s27, 16384
    s_add_u32 s22, s22, 16384
    s_add_u32 s23, s23, 458752
    s_add_u32 s65, s65, 16384
    s_add_u32 s18, s18, 1
    s_cmp_lt_u32 s18, 63
    s_cbranch_scc1 LB0step_100105
    s_endpgm
LBretry_100110:
    v_max3_u32 v58, v0, v1, v2
    v_max_u32 v58, v58, v3
    v_max3_u32 v58, v58, v4, v5
    v_max3_u32 v58, v58, v6, v7
    v_max3_u32 v58, v58, v8, v9
    v_max3_u32 v58, v58, v10, v11
    v_max3_u32 v58, v58, v12, v13
    v_max3_u32 v58, v58, v14, v15
    v_max3_u32 v58, v58, v16, v17
    v_max3_u32 v58, v58, v18, v19
    v_max3_u32 v58, v58, v20, v21
    v_max3_u32 v58, v58, v22, v23
    v_max3_u32 v58, v58, v24, v25
    v_max3_u32 v58, v58, v26, v27
    v_cmp_eq_u32 vcc, -1, v58
    s_cbranch_vccz LBcont_100111
    s_waitcnt lgkmcnt(0)
    s_barrier
    s_sub_u32 s24, s24, 1
    s_cbranch_scc1 Lexit_100001
    s_branch LB0poll_100106
Lbad_100115:
    v_max3_u32 v58, v0, v1, v2
    v_max_u32 v58, v58, v3
    v_max3_u32 v58, v58, v4, v5
    v_max3_u32 v58, v58, v6, v7
    v_max3_u32 v58, v58, v8, v9
    v_max3_u32 v58, v58, v10, v11
    v_max3_u32 v58, v58, v12, v13
    v_max3_u32 v58, v58, v14, v15
    v_max3_u32 v58, v58, v16, v17
    v_max3_u32 v58, v58, v18, v19
    v_max3_u32 v58, v58, v20, v21
    v_max3_u32 v58, v58, v22, v23
    v_max3_u32 v58, v58, v24, v25
    v_max3_u32 v58, v58, v26, v27
    v_max3_u32 v58, v58, v28, v29
    v_max3_u32 v58, v58, v30, v31
    v_max3_u32 v58, v58, v32, v33
    v_max3_u32 v58, v58, v34, v35
    v_max3_u32 v58, v58, v36, v37
    v_max3_u32 v58, v58, v38, v39
    v_min_u32 v165, -2, v165
    v_cmp_eq_u32 vcc, -1, v58
    s_cbranch_vccz Lgood_100116
    buffer_load_dwordx4 v[0:3], v57, s[4:7], s21 offen offset:0 sc1
    buffer_load_dwordx4 v[4:7], v57, s[4:7], s21 offen offset:1024 sc1
    buffer_load_dwordx4 v[8:11], v57, s[4:7], s21 offen offset:2048 sc1
    buffer_load_dwordx4 v[12:15], v57, s[4:7], s21 offen offset:3072 sc1
    buffer_load_dwordx4 v[16:19], v57, s[4:7], s22 offen offset:0 sc1
    buffer_load_dwordx4 v[20:23], v57, s[4:7], s22 offen offset:1024 sc1
    buffer_load_dwordx4 v[24:27], v57, s[4:7], s22 offen offset:2048 sc1
    buffer_load_dwordx4 v[28:31], v57, s[4:7], s22 offen offset:3072 sc1
    buffer_load_dwordx4 v[32:35], v57, s[4:7], s27 offen offset:0 sc1
    buffer_load_dwordx4 v[36:39], v57, s[4:7], s27 offen offset:1024 sc1
    v_mov_b32 v168, 0
    v_mov_b32 v169, 0
    v_mov_b32 v170, 0
    v_mov_b32 v171, 0
    s_sub_u32 s24, s24, 1
    s_cbranch_scc1 Lexit_100001
    s_branch Lpp_100114
LBw1_100088:
    v_and_b32 v3, 63, v0
    v_lshrrev_b32 v1, 4, v3
    v_and_b32 v2, 15, v3
    v_and_b32 v58, 1, v2
    v_mul_u32_u24 v56, 0xAAAA, v58
    v_lshrrev_b32 v58, 3, v2
    v_mul_u32_u24 v58, 0xAAAA, v58
    v_lshl_add_u32 v56, v58, 16, v56
    v_add_u32 v56, 0x44444444, v56
    v_lshlrev_b32 v57, 4, v3
    v_add_u32 v60, 67584, v57
    s_sub_u32 s25, s17, 16
    v_lshlrev_b32 v61, 2, v2
    s_lshl_b32 s26, s25, 7
    s_add_u32 s26, s26, 2048
    v_add_u32 v61, s26, v61
    v_lshlrev_b32 v166, 8, v3
    s_lshl_b32 s26, s25, 2
    s_add_u32 s26, s26, 4096
    v_add_u32 v166, s26, v166
    v_cmp_lt_u32 vcc, 3, v3
    v_mov_b32 v58, 0x40000000
    s_nop 0
    v_cndmask_b32 v166, v166, v58, vcc
    v_lshlrev_b32 v164, 6, v1
    v_and_b32 v58, 1, v2
    v_lshl_add_u32 v164, v58, 5, v164
    v_bfe_u32 v58, v2, 1, 1
    v_lshl_add_u32 v164, v58, 4, v164
    v_lshrrev_b32 v58, 2, v2
    v_lshl_add_u32 v164, v58, 2, v164
    s_mul_i32 s23, s25, 16384
    s_lshl_b32 s28, s25, 8
    s_add_u32 s28, s28, 0x2a02e00
    s_mul_i32 s25, s25, 14336
    s_add_u32 s25, s25, 0x731000
    s_add_u32 s23, s23, 0xe38000
    v_mov_b32 v5, v234
    v_mov_b32 v6, v237
    v_and_b32 v7, 31, v0
    v_lshlrev_b32 v7, 2, v7
    s_cmp_ge_u32 s17, 23
    s_cselect_b32 s60, 3, 2
    s_mov_b32 s61, 0xff
    s_mov_b32 s62, 64
    s_mov_b32 s63, 0x3d41000
Lbdw_100118:
    s_sub_u32 s62, s62, 1
    s_cbranch_scc1 Lbdc_100119
    buffer_load_dword v4, v6, s[4:7], s63 offen sc1
    s_waitcnt vmcnt(0)
    v_cmp_eq_u32 vcc, v4, v5
    s_nop 1
    s_lshr_b64 s[66:67], vcc, s60
    s_lshr_b64 s[68:69], s[66:67], 4
    s_or_b64 s[66:67], s[66:67], s[68:69]
    s_branch Lbdg_100120
Lbdc_100119:
    buffer_load_dword v4, v7, s[12:15], 0 offen offset:64 sc1
    s_waitcnt vmcnt(0)
    v_cmp_gt_u32 vcc, 8, v4
    s_mov_b64 s[66:67], 0
    s_cbranch_vccz Lbdg_100120
    s_sleep 30
    s_sub_u32 s24, s24, 1
    s_cbranch_scc1 Lexit_100001
    s_branch Lbdc_100119
Lbdg_100120:
    s_mov_b32 s70, s61
    s_bitcmp0_b32 s61, 0
    s_cbranch_scc1 Lbu_100122
    s_bitcmp1_b64 s[66:67], 0
    s_cbranch_scc1 Lbu_100122
    s_bitset0_b32 s61, 0
    s_add_u32 s26, s25, 0
    buffer_load_dwordx4 a[0:3], v57, s[4:7], s26 offen offset:0 sc1
    buffer_load_dwordx4 a[4:7], v57, s[4:7], s26 offen offset:1024 sc1
    s_add_u32 s26, s25, 2048
    buffer_load_dwordx4 a[8:11], v57, s[4:7], s26 offen offset:0 sc1
    buffer_load_dwordx4 a[12:15], v57, s[4:7], s26 offen offset:1024 sc1
    s_add_u32 s26, s25, 4096
    buffer_load_dwordx4 a[16:19], v57, s[4:7], s26 offen offset:0 sc1
    buffer_load_dwordx4 a[20:23], v57, s[4:7], s26 offen offset:1024 sc1
    s_add_u32 s26, s25, 6144
    buffer_load_dwordx4 a[24:27], v57, s[4:7], s26 offen offset:0 sc1
    buffer_load_dwordx4 a[28:31], v57, s[4:7], s26 offen offset:1024 sc1
    s_add_u32 s26, s25, 8192
    buffer_load_dwordx4 a[32:35], v57, s[4:7], s26 offen offset:0 sc1
    buffer_load_dwordx4 a[36:39], v57, s[4:7], s26 offen offset:1024 sc1
    s_add_u32 s26, s25, 10240
    buffer_load_dwordx4 a[40:43], v57, s[4:7], s26 offen offset:0 sc1
    buffer_load_dwordx4 a[44:47], v57, s[4:7], s26 offen offset:1024 sc1
    s_add_u32 s26, s25, 12288
    buffer_load_dwordx4 a[48:51], v57, s[4:7], s26 offen offset:0 sc1
    buffer_load_dwordx4 a[52:55], v57, s[4:7], s26 offen offset:1024 sc1
    s_waitcnt vmcnt(28)
Lbu_100122:
    s_bitcmp0_b32 s61, 1
    s_cbranch_scc1 Lbu_100123
    s_bitcmp1_b64 s[66:67], 8
    s_cbranch_scc1 Lbu_100123
    s_bitset0_b32 s61, 1
    s_add_u32 s26, s25, 401408
    buffer_load_dwordx4 a[56:59], v57, s[4:7], s26 offen offset:0 sc1
    buffer_load_dwordx4 a[60:63], v57, s[4:7], s26 offen offset:1024 sc1
    s_add_u32 s26, s25, 403456
    buffer_load_dwordx4 a[64:67], v57, s[4:7], s26 offen offset:0 sc1
    buffer_load_dwordx4 a[68:71], v57, s[4:7], s26 offen offset:1024 sc1
    s_add_u32 s26, s25, 405504
    buffer_load_dwordx4 a[72:75], v57, s[4:7], s26 offen offset:0 sc1
    buffer_load_dwordx4 a[76:79], v57, s[4:7], s26 offen offset:1024 sc1
    s_add_u32 s26, s25, 407552
    buffer_load_dwordx4 a[80:83], v57, s[4:7], s26 offen offset:0 sc1
    buffer_load_dwordx4 a[84:87], v57, s[4:7], s26 offen offset:1024 sc1
    s_add_u32 s26, s25, 409600
    buffer_load_dwordx4 a[88:91], v57, s[4:7], s26 offen offset:0 sc1
    buffer_load_dwordx4 a[92:95], v57, s[4:7], s26 offen offset:1024 sc1
    s_add_u32 s26, s25, 411648
    buffer_load_dwordx4 a[96:99], v57, s[4:7], s26 offen offset:0 sc1
    buffer_load_dwordx4 a[100:103], v57, s[4:7], s26 offen offset:1024 sc1
    s_add_u32 s26, s25, 413696
    buffer_load_dwordx4 a[104:107], v57, s[4:7], s26 offen offset:0 sc1
    buffer_load_dwordx4 a[108:111], v57, s[4:7], s26 offen offset:1024 sc1
    s_waitcnt vmcnt(28)
Lbu_100123:
    s_bitcmp0_b32 s61, 2
    s_cbranch_scc1 Lbu_100124
    s_bitcmp1_b64 s[66:67], 16
    s_cbranch_scc1 Lbu_100124
    s_bitset0_b32 s61, 2
    s_add_u32 s26, s25, 802816
    buffer_load_dwordx4 a[112:115], v57, s[4:7], s26 offen offset:0 sc1
    buffer_load_dwordx4 a[116:119], v57, s[4:7], s26 offen offset:1024 sc1
    s_add_u32 s26, s25, 804864
    buffer_load_dwordx4 a[120:123], v57, s[4:7], s26 offen offset:0 sc1
    buffer_load_dwordx4 a[124:127], v57, s[4:7], s26 offen offset:1024 sc1
    s_add_u32 s26, s25, 806912
    buffer_load_dwordx4 a[128:131], v57, s[4:7], s26 offen offset:0 sc1
    buffer_load_dwordx4 a[132:135], v57, s[4:7], s26 offen offset:1024 sc1
    s_add_u32 s26, s25, 808960
    buffer_load_dwordx4 a[136:139], v57, s[4:7], s26 offen offset:0 sc1
    buffer_load_dwordx4 a[140:143], v57, s[4:7], s26 offen offset:1024 sc1
    s_add_u32 s26, s25, 811008
    buffer_load_dwordx4 a[144:147], v57, s[4:7], s26 offen offset:0 sc1
    buffer_load_dwordx4 a[148:151], v57, s[4:7], s26 offen offset:1024 sc1
    s_add_u32 s26, s25, 813056
    buffer_load_dwordx4 a[152:155], v57, s[4:7], s26 offen offset:0 sc1
    buffer_load_dwordx4 a[156:159], v57, s[4:7], s26 offen offset:1024 sc1
    s_add_u32 s26, s25, 815104
    buffer_load_dwordx4 a[160:163], v57, s[4:7], s26 offen offset:0 sc1
    buffer_load_dwordx4 a[164:167], v57, s[4:7], s26 offen offset:1024 sc1
    s_waitcnt vmcnt(28)
Lbu_100124:
    s_bitcmp0_b32 s61, 3
    s_cbranch_scc1 Lbu_100125
    s_bitcmp1_b64 s[66:67], 24
    s_cbranch_scc1 Lbu_100125
    s_bitset0_b32 s61, 3
    s_add_u32 s26, s25, 1204224
    buffer_load_dwordx4 a[168:171], v57, s[4:7], s26 offen offset:0 sc1
    buffer_load_dwordx4 a[172:175], v57, s[4:7], s26 offen offset:1024 sc1
    s_add_u32 s26, s25, 1206272
    buffer_load_dwordx4 a[176:179], v57, s[4:7], s26 offen offset:0 sc1
    buffer_load_dwordx4 a[180:183], v57, s[4:7], s26 offen offset:1024 sc1
    s_add_u32 s26, s25, 1208320
    buffer_load_dwordx4 a[184:187], v57, s[4:7], s26 offen offset:0 sc1
    buffer_load_dwordx4 a[188:191], v57, s[4:7], s26 offen offset:1024 sc1
    s_add_u32 s26, s25, 1210368
    buffer_load_dwordx4 a[192:195], v57, s[4:7], s26 offen offset:0 sc1
    buffer_load_dwordx4 a[196:199], v57, s[4:7], s26 offen offset:1024 sc1
    s_add_u32 s26, s25, 1212416
    buffer_load_dwordx4 a[200:203], v57, s[4:7], s26 offen offset:0 sc1
    buffer_load_dwordx4 a[204:207], v57, s[4:7], s26 offen offset:1024 sc1
    s_add_u32 s26, s25, 1214464
    buffer_load_dwordx4 a[208:211], v57, s[4:7], s26 offen offset:0 sc1
    buffer_load_dwordx4 a[212:215], v57, s[4:7], s26 offen offset:1024 sc1
    s_add_u32 s26, s25, 1216512
    buffer_load_dwordx4 a[216:219], v57, s[4:7], s26 offen offset:0 sc1
    buffer_load_dwordx4 a[220:223], v57, s[4:7], s26 offen offset:1024 sc1
    s_waitcnt vmcnt(28)
Lbu_100125:
    s_bitcmp0_b32 s61, 4
    s_cbranch_scc1 Lbu_100126
    s_bitcmp1_b64 s[66:67], 32
    s_cbranch_scc1 Lbu_100126
    s_bitset0_b32 s61, 4
    s_add_u32 s26, s25, 1605632
    buffer_load_dwordx4 a[224:227], v57, s[4:7], s26 offen offset:0 sc1
    buffer_load_dwordx4 a[228:231], v57, s[4:7], s26 offen offset:1024 sc1
    s_add_u32 s26, s25, 1607680
    buffer_load_dwordx4 a[232:235], v57, s[4:7], s26 offen offset:0 sc1
    buffer_load_dwordx4 a[236:239], v57, s[4:7], s26 offen offset:1024 sc1
    s_add_u32 s26, s25, 1609728
    buffer_load_dwordx4 a[240:243], v57, s[4:7], s26 offen offset:0 sc1
    buffer_load_dwordx4 a[244:247], v57, s[4:7], s26 offen offset:1024 sc1
    s_add_u32 s26, s25, 1611776
    buffer_load_dwordx4 a[248:251], v57, s[4:7], s26 offen offset:0 sc1
    buffer_load_dwordx4 a[252:255], v57, s[4:7], s26 offen offset:1024 sc1
    s_add_u32 s26, s25, 1613824
    buffer_load_dwordx4 v[176:179], v57, s[4:7], s26 offen offset:0 sc1
    buffer_load_dwordx4 v[180:183], v57, s[4:7], s26 offen offset:1024 sc1
    s_add_u32 s26, s25, 1615872
    buffer_load_dwordx4 v[184:187], v57, s[4:7], s26 offen offset:0 sc1
    buffer_load_dwordx4 v[188:191], v57, s[4:7], s26 offen offset:1024 sc1
    s_add_u32 s26, s25, 1617920
    buffer_load_dwordx4 v[192:195], v57, s[4:7], s26 offen offset:0 sc1
    buffer_load_dwordx4 v[196:199], v57, s[4:7], s26 offen offset:1024 sc1
    s_waitcnt vmcnt(28)
Lbu_100126:
    s_bitcmp0_b32 s61, 5
    s_cbranch_scc1 Lbu_100127
    s_bitcmp1_b64 s[66:67], 40
    s_cbranch_scc1 Lbu_100127
    s_bitset0_b32 s61, 5
    s_add_u32 s26, s25, 2007040
    buffer_load_dwordx4 v[200:203], v57, s[4:7], s26 offen offset:0 sc1
    buffer_load_dwordx4 v[204:207], v57, s[4:7], s26 offen offset:1024 sc1
    s_add_u32 s26, s25, 2009088
    buffer_load_dwordx4 v[208:211], v57, s[4:7], s26 offen offset:0 sc1
    buffer_load_dwordx4 v[212:215], v57, s[4:7], s26 offen offset:1024 sc1
    s_add_u32 s26, s25, 2011136
    buffer_load_dwordx4 v[216:219], v57, s[4:7], s26 offen offset:0 sc1
    buffer_load_dwordx4 v[220:223], v57, s[4:7], s26 offen offset:1024 sc1
    s_add_u32 s26, s25, 2013184
    buffer_load_dwordx4 v[224:227], v57, s[4:7], s26 offen offset:0 sc1
    buffer_load_dwordx4 v[228:231], v57, s[4:7], s26 offen offset:1024 sc1
    s_add_u32 s26, s25, 2015232
    buffer_load_dwordx4 v[232:235], v57, s[4:7], s26 offen offset:0 sc1
    buffer_load_dwordx4 v[236:239], v57, s[4:7], s26 offen offset:1024 sc1
    s_add_u32 s26, s25, 2017280
    buffer_load_dwordx4 v[240:243], v57, s[4:7], s26 offen offset:0 sc1
    buffer_load_dwordx4 v[244:247], v57, s[4:7], s26 offen offset:1024 sc1
    s_add_u32 s26, s25, 2019328
    buffer_load_dwordx4 v[248:251], v57, s[4:7], s26 offen offset:0 sc1
    buffer_load_dwordx4 v[252:255], v57, s[4:7], s26 offen offset:1024 sc1
    s_waitcnt vmcnt(28)
Lbu_100127:
    s_bitcmp0_b32 s61, 6
    s_cbranch_scc1 Lbu_100128
    s_bitcmp1_b64 s[66:67], 48
    s_cbranch_scc1 Lbu_100128
    s_bitset0_b32 s61, 6
    s_add_u32 s26, s25, 2408448
    s_mov_b32 m0, 28672
    s_nop 0
    buffer_load_dwordx4 v57, s[4:7], s26 offen offset:0 sc1 lds
    buffer_load_dwordx4 v57, s[4:7], s26 offen offset:1024 sc1 lds
    s_add_u32 s26, s25, 2410496
    s_mov_b32 m0, 30720
    s_nop 0
    buffer_load_dwordx4 v57, s[4:7], s26 offen offset:0 sc1 lds
    buffer_load_dwordx4 v57, s[4:7], s26 offen offset:1024 sc1 lds
    s_add_u32 s26, s25, 2412544
    s_mov_b32 m0, 32768
    s_nop 0
    buffer_load_dwordx4 v57, s[4:7], s26 offen offset:0 sc1 lds
    buffer_load_dwordx4 v57, s[4:7], s26 offen offset:1024 sc1 lds
    s_add_u32 s26, s25, 2414592
    s_mov_b32 m0, 34816
    s_nop 0
    buffer_load_dwordx4 v57, s[4:7], s26 offen offset:0 sc1 lds
    buffer_load_dwordx4 v57, s[4:7], s26 offen offset:1024 sc1 lds
    s_add_u32 s26, s25, 2416640
    s_mov_b32 m0, 36864
    s_nop 0
    buffer_load_dwordx4 v57, s[4:7], s26 offen offset:0 sc1 lds
    buffer_load_dwordx4 v57, s[4:7], s26 offen offset:1024 sc1 lds
    s_add_u32 s26, s25, 2418688
    s_mov_b32 m0, 38912
    s_nop 0
    buffer_load_dwordx4 v57, s[4:7], s26 offen offset:0 sc1 lds
    buffer_load_dwordx4 v57, s[4:7], s26 offen offset:1024 sc1 lds
    s_add_u32 s26, s25, 2420736
    s_mov_b32 m0, 40960
    s_nop 0
    buffer_load_dwordx4 v57, s[4:7], s26 offen offset:0 sc1 lds
    buffer_load_dwordx4 v57, s[4:7], s26 offen offset:1024 sc1 lds
    s_waitcnt vmcnt(28)
Lbu_100128:
    s_bitcmp0_b32 s61, 7
    s_cbranch_scc1 Lbu_100129
    s_bitcmp1_b64 s[66:67], 56
    s_cbranch_scc1 Lbu_100129
    s_bitset0_b32 s61, 7
    s_add_u32 s26, s25, 2809856
    s_mov_b32 m0, 43008
    s_nop 0
    buffer_load_dwordx4 v57, s[4:7], s26 offen offset:0 sc1 lds
    buffer_load_dwordx4 v57, s[4:7], s26 offen offset:1024 sc1 lds
    s_add_u32 s26, s25, 2811904
    s_mov_b32 m0, 45056
    s_nop 0
    buffer_load_dwordx4 v57, s[4:7], s26 offen offset:0 sc1 lds
    buffer_load_dwordx4 v57, s[4:7], s26 offen offset:1024 sc1 lds
    s_add_u32 s26, s25, 2813952
    s_mov_b32 m0, 47104
    s_nop 0
    buffer_load_dwordx4 v57, s[4:7], s26 offen offset:0 sc1 lds
    buffer_load_dwordx4 v57, s[4:7], s26 offen offset:1024 sc1 lds
    s_add_u32 s26, s25, 2816000
    s_mov_b32 m0, 49152
    s_nop 0
    buffer_load_dwordx4 v57, s[4:7], s26 offen offset:0 sc1 lds
    buffer_load_dwordx4 v57, s[4:7], s26 offen offset:1024 sc1 lds
    s_add_u32 s26, s25, 2818048
    s_mov_b32 m0, 51200
    s_nop 0
    buffer_load_dwordx4 v57, s[4:7], s26 offen offset:0 sc1 lds
    buffer_load_dwordx4 v57, s[4:7], s26 offen offset:1024 sc1 lds
    s_add_u32 s26, s25, 2820096
    s_mov_b32 m0, 53248
    s_nop 0
    buffer_load_dwordx4 v57, s[4:7], s26 offen offset:0 sc1 lds
    buffer_load_dwordx4 v57, s[4:7], s26 offen offset:1024 sc1 lds
    s_add_u32 s26, s25, 2822144
    s_mov_b32 m0, 55296
    s_nop 0
    buffer_load_dwordx4 v57, s[4:7], s26 offen offset:0 sc1 lds
    buffer_load_dwordx4 v57, s[4:7], s26 offen offset:1024 sc1 lds
    s_waitcnt vmcnt(28)
Lbu_100129:
    s_cmp_eq_u32 s61, 0
    s_cbranch_scc1 Lbdd_100121
    s_cmp_lg_u32 s61, s70
    s_cbranch_scc1 Lbdw_100118
    s_sleep 12
    s_branch Lbdw_100118
Lbdd_100121:
    s_waitcnt vmcnt(0)
    s_cmp_lg_u32 s16, 0
    s_cbranch_scc1 LBcg_100131
    v_and_b32 v5, 31, v0
    v_add_lshl_u32 v5, v5, 0, 2
LBcw_100130:
    buffer_load_dword v4, v5, s[12:15], 0 offen offset:64 sc1
    s_waitcnt vmcnt(0)
    v_cmp_gt_u32 vcc, 8, v4
    s_cbranch_vccz LBcg_100131
    s_sleep 12
    s_sub_u32 s24, s24, 1
    s_cbranch_scc1 Lexit_100001
    s_branch LBcw_100130
LBcg_100131:
    s_barrier
    buffer_load_dword v4, off, s[12:15], 0 sc1
    s_waitcnt vmcnt(0)
    v_readfirstlane_b32 s47, v4
    s_cmp_ge_u32 s47, 32
    s_cselect_b32 s47, 0x40000000, 0
    s_mov_b32 s18, 0
    s_mov_b32 s19, 0x2a00000
    s_mov_b32 s20, 0x2a01000
    s_mov_b32 s21, 0x2a80000
    s_mov_b32 s22, 0x2a81000
    s_mov_b32 s27, 0x2a82000
    s_mov_b32 s24, 300000
    s_mov_b32 s65, 0x2a83800
    s_mov_b32 s66, 0xaaaaaaaa
    s_mov_b32 s67, 0xaaaaaaaa
    s_waitcnt vmcnt(0) lgkmcnt(0)
    s_mov_b32 s40, 0
    v_mov_b32 v59, 0
    s_branch LB1poll_100133
LB1step_100132:
    s_nop 15
    s_nop 15
    s_nop 15
    s_nop 11
LB1poll_100133:
    s_mov_b32 m0, 57344
    s_nop 0
    buffer_load_dwordx4 v57, s[4:7], s19 offen offset:2048 sc1 lds
    s_mov_b32 m0, 57344
    s_nop 0
    buffer_load_dwordx4 v57, s[4:7], s19 offen offset:3072 sc1 lds
    v_mov_b32 v40, 0
    v_mov_b32 v41, 0
    v_mov_b32 v42, 0
    v_mov_b32 v43, 0
    v_mov_b32 v44, 0
    v_mov_b32 v45, 0
    v_mov_b32 v46, 0
    v_mov_b32 v47, 0
    v_mov_b32 v152, 0
    v_mov_b32 v153, 0
    v_mov_b32 v154, 0
    v_mov_b32 v155, 0
    v_mov_b32 v156, 0
    v_mov_b32 v157, 0
    v_mov_b32 v158, 0
    v_mov_b32 v159, 0
    v_mov_b32 v160, 0
    v_mov_b32 v161, 0
    v_mov_b32 v162, 0
    v_mov_b32 v163, 0
    v_mov_b32 v168, 0
    v_mov_b32 v169, 0
    v_mov_b32 v170, 0
    v_mov_b32 v171, 0
    ds_read_b128 v[136:139], v57 offset:28672
    ds_read_b128 v[140:143], v57 offset:29696
    ds_read_b128 v[144:147], v57 offset:43008
    ds_read_b128 v[148:151], v57 offset:44032
    v_cmp_ne_u32 vcc, 15, v59
    s_add_u32 s26, s65, 0
    s_cbranch_vccz Lbcg_100136
Lbcv_100135:
    buffer_load_dword v59, off, s[4:7], s26 sc1
    s_waitcnt vmcnt(0)
    v_cmp_ne_u32 vcc, 15, v59
    s_cbranch_vccz Lbcg_100136
    s_sleep 1
    s_sub_u32 s24, s24, 1
    s_cbranch_scc1 Lexit_100001
    s_branch Lbcv_100135
Lbcg_100136:
    s_waitcnt vmcnt(0)
    s_barrier
    ds_read_b128 v[0:3], v57 offset:57344
    ds_read_b128 v[4:7], v57 offset:58368
    ds_read_b128 v[8:11], v57 offset:59392
    ds_read_b128 v[12:15], v57 offset:60416
    ds_read_b128 v[16:19], v57 offset:61440
    ds_read_b128 v[20:23], v57 offset:62464
    ds_read_b128 v[24:27], v57 offset:63488
    s_waitcnt lgkmcnt(6)
    v_smfmac_f32_16x16x64_bf16 v[40:43], v[0:3], a[0:7], v56
    s_waitcnt lgkmcnt(5)
    v_smfmac_f32_16x16x64_bf16 v[40:43], v[4:7], a[8:15], v56
    v_smfmac_f32_16x16x64_bf16 v[152:155], v[0:3], v[136:143], v56
    s_waitcnt lgkmcnt(4)
    v_smfmac_f32_16x16x64_bf16 v[40:43], v[8:11], a[16:23], v56
    ds_read_b128 v[136:139], v57 offset:14336
    ds_read_b128 v[140:143], v57 offset:15360
    s_waitcnt lgkmcnt(5)
    v_smfmac_f32_16x16x64_bf16 v[40:43], v[12:15], a[24:31], v56
    v_smfmac_f32_16x16x64_bf16 v[156:159], v[0:3], v[144:151], v56
    s_waitcnt lgkmcnt(4)
    v_smfmac_f32_16x16x64_bf16 v[40:43], v[16:19], a[32:39], v56
    ds_read_b128 v[144:147], v57 offset:30720
    ds_read_b128 v[148:151], v57 offset:31744
    s_waitcnt lgkmcnt(5)
    v_smfmac_f32_16x16x64_bf16 v[40:43], v[20:23], a[40:47], v56
    s_waitcnt lgkmcnt(2)
    v_smfmac_f32_16x16x64_bf16 v[160:163], v[0:3], v[136:143], v56
    s_waitcnt lgkmcnt(4)
    v_smfmac_f32_16x16x64_bf16 v[40:43], v[24:27], a[48:55], v56
    ds_read_b128 v[136:139], v57 offset:45056
    ds_read_b128 v[140:143], v57 offset:46080
    v_smfmac_f32_16x16x64_bf16 v[44:47], v[0:3], a[56:63], v56
    s_waitcnt lgkmcnt(2)
    v_smfmac_f32_16x16x64_bf16 v[152:155], v[4:7], v[144:151], v56
    s_add_u32 s25, s23, 0
    buffer_load_dwordx4 v[72:75], v57, s[4:7], s25 offen offset:0 sc1
    v_add_f32 v40, v40, v41
    v_smfmac_f32_16x16x64_bf16 v[44:47], v[4:7], a[64:71], v56
    ds_read_b128 v[144:147], v57 offset:16384
    ds_read_b128 v[148:151], v57 offset:17408
    v_add_f32 v42, v42, v43
    v_smfmac_f32_16x16x64_bf16 v[44:47], v[8:11], a[72:79], v56
    s_waitcnt lgkmcnt(2)
    buffer_load_dwordx4 v[76:79], v57, s[4:7], s25 offen offset:1024 sc1
    v_cmp_u_f32 vcc, v40, v42
    v_cvt_pk_bf16_f32 v48, v40, v42
    v_smfmac_f32_16x16x64_bf16 v[156:159], v[4:7], v[136:143], v56
    v_mov_b32 v40, 0
    v_smfmac_f32_16x16x64_bf16 v[44:47], v[12:15], a[80:87], v56
    ds_read_b128 v[136:139], v57 offset:32768
    ds_read_b128 v[140:143], v57 offset:33792
    s_cbranch_vccnz LBretry_100137
LBcont_100138:
    v_mov_b32 v41, 0
    v_smfmac_f32_16x16x64_bf16 v[44:47], v[16:19], a[88:95], v56
    s_waitcnt lgkmcnt(2)
    buffer_load_dwordx4 v[80:83], v57, s[4:7], s25 offen offset:2048 sc1
    v_mov_b32 v42, 0
    v_smfmac_f32_16x16x64_bf16 v[160:163], v[4:7], v[144:151], v56
    v_mov_b32 v43, 0
    v_smfmac_f32_16x16x64_bf16 v[44:47], v[20:23], a[96:103], v56
    ds_read_b128 v[144:147], v57 offset:47104
    ds_read_b128 v[148:151], v57 offset:48128
    v_smfmac_f32_16x16x64_bf16 v[44:47], v[24:27], a[104:111], v56
    s_waitcnt lgkmcnt(2)
    buffer_load_dwordx4 v[84:87], v57, s[4:7], s25 offen offset:3072 sc1
    v_smfmac_f32_16x16x64_bf16 v[152:155], v[8:11], v[136:143], v56
    s_add_u32 s60, s28, s47
    v_smfmac_f32_16x16x64_bf16 v[40:43], v[0:3], a[112:119], v56
    ds_read_b128 v[136:139], v57 offset:18432
    ds_read_b128 v[140:143], v57 offset:19456
    v_add_f32 v44, v44, v45
    v_smfmac_f32_16x16x64_bf16 v[40:43], v[4:7], a[120:127], v56
    s_waitcnt lgkmcnt(2)
    s_add_u32 s61, s27, s47
    v_add_f32 v46, v46, v47
    v_smfmac_f32_16x16x64_bf16 v[156:159], v[8:11], v[144:151], v56
    s_add_u32 s25, s23, 4096
    buffer_load_dwordx4 v[88:91], v57, s[4:7], s25 offen offset:0 sc1
    v_cvt_pk_bf16_f32 v49, v44, v46
    v_smfmac_f32_16x16x64_bf16 v[40:43], v[8:11], a[128:135], v56
    ds_read_b128 v[144:147], v57 offset:34816
    ds_read_b128 v[148:151], v57 offset:35840
    v_mov_b32 v44, 0
    v_smfmac_f32_16x16x64_bf16 v[40:43], v[12:15], a[136:143], v56
    s_waitcnt lgkmcnt(2)
    buffer_load_dwordx4 v[92:95], v57, s[4:7], s25 offen offset:1024 sc1
    v_mov_b32 v45, 0
    v_smfmac_f32_16x16x64_bf16 v[160:163], v[8:11], v[136:143], v56
    s_xor_b32 s62, s60, 0x40000000
    v_mov_b32 v46, 0
    v_smfmac_f32_16x16x64_bf16 v[40:43], v[16:19], a[144:151], v56
    ds_read_b128 v[136:139], v57 offset:49152
    ds_read_b128 v[140:143], v57 offset:50176
    v_mov_b32 v47, 0
    v_smfmac_f32_16x16x64_bf16 v[40:43], v[20:23], a[152:159], v56
    s_waitcnt lgkmcnt(2)
    buffer_load_dwordx4 v[96:99], v57, s[4:7], s25 offen offset:2048 sc1
    v_smfmac_f32_16x16x64_bf16 v[152:155], v[12:15], v[144:151], v56
    s_xor_b32 s63, s61, 0x40000000
    v_smfmac_f32_16x16x64_bf16 v[40:43], v[24:27], a[160:167], v56
    ds_read_b128 v[144:147], v57 offset:20480
    ds_read_b128 v[148:151], v57 offset:21504
    v_smfmac_f32_16x16x64_bf16 v[44:47], v[0:3], a[168:175], v56
    s_waitcnt lgkmcnt(2)
    buffer_load_dwordx4 v[100:103], v57, s[4:7], s25 offen offset:3072 sc1
    v_smfmac_f32_16x16x64_bf16 v[156:159], v[12:15], v[136:143], v56
    v_add_f32 v40, v40, v41
    v_smfmac_f32_16x16x64_bf16 v[44:47], v[4:7], a[176:183], v56
    ds_read_b128 v[136:139], v57 offset:36864
    ds_read_b128 v[140:143], v57 offset:37888
    v_add_f32 v42, v42, v43
    v_smfmac_f32_16x16x64_bf16 v[44:47], v[8:11], a[184:191], v56
    s_waitcnt lgkmcnt(2)
    v_cvt_pk_bf16_f32 v50, v40, v42
    v_smfmac_f32_16x16x64_bf16 v[160:163], v[12:15], v[144:151], v56
    s_add_u32 s25, s23, 8192
    buffer_load_dwordx4 v[104:107], v57, s[4:7], s25 offen offset:0 sc1
    v_mov_b32 v40, 0
    v_smfmac_f32_16x16x64_bf16 v[44:47], v[12:15], a[192:199], v56
    ds_read_b128 v[144:147], v57 offset:51200
    ds_read_b128 v[148:151], v57 offset:52224
    v_mov_b32 v41, 0
    v_smfmac_f32_16x16x64_bf16 v[44:47], v[16:19], a[200:207], v56
    s_waitcnt lgkmcnt(2)
    buffer_load_dwordx4 v[108:111], v57, s[4:7], s25 offen offset:1024 sc1
    v_mov_b32 v42, 0
    v_smfmac_f32_16x16x64_bf16 v[152:155], v[16:19], v[136:143], v56
    v_mov_b32 v43, 0
    v_smfmac_f32_16x16x64_bf16 v[44:47], v[20:23], a[208:215], v56
    ds_read_b128 v[136:139], v57 offset:22528
    ds_read_b128 v[140:143], v57 offset:23552
    v_smfmac_f32_16x16x64_bf16 v[44:47], v[24:27], a[216:223], v56
    s_waitcnt lgkmcnt(2)
    buffer_load_dwordx4 v[112:115], v57, s[4:7], s25 offen offset:2048 sc1
    v_smfmac_f32_16x16x64_bf16 v[156:159], v[16:19], v[144:151], v56
    v_smfmac_f32_16x16x64_bf16 v[40:43], v[0:3], a[224:231], v56
    ds_read_b128 v[144:147], v57 offset:38912
    ds_read_b128 v[148:151], v57 offset:39936
    v_add_f32 v44, v44, v45
    v_smfmac_f32_16x16x64_bf16 v[40:43], v[4:7], a[232:239], v56
    s_waitcnt lgkmcnt(2)
    buffer_load_dwordx4 v[116:119], v57, s[4:7], s25 offen offset:3072 sc1
    v_add_f32 v46, v46, v47
    v_smfmac_f32_16x16x64_bf16 v[160:163], v[16:19], v[136:143], v56
    v_cvt_pk_bf16_f32 v51, v44, v46
    v_smfmac_f32_16x16x64_bf16 v[40:43], v[8:11], a[240:247], v56
    ds_read_b128 v[136:139], v57 offset:53248
    ds_read_b128 v[140:143], v57 offset:54272
    v_mov_b32 v44, 0
    v_smfmac_f32_16x16x64_bf16 v[40:43], v[12:15], a[248:255], v56
    s_waitcnt lgkmcnt(2)
    v_mov_b32 v45, 0
    v_smfmac_f32_16x16x64_bf16 v[152:155], v[20:23], v[144:151], v56
    s_add_u32 s25, s23, 12288
    buffer_load_dwordx4 v[120:123], v57, s[4:7], s25 offen offset:0 sc1
    v_mov_b32 v46, 0
    v_smfmac_f32_16x16x64_bf16 v[40:43], v[16:19], v[176:183], v56
    ds_read_b128 v[144:147], v57 offset:24576
    ds_read_b128 v[148:151], v57 offset:25600
    v_mov_b32 v47, 0
    v_smfmac_f32_16x16x64_bf16 v[40:43], v[20:23], v[184:191], v56
    s_waitcnt lgkmcnt(2)
    buffer_load_dwordx4 v[124:127], v57, s[4:7], s25 offen offset:1024 sc1
    v_smfmac_f32_16x16x64_bf16 v[156:159], v[20:23], v[136:143], v56
    v_smfmac_f32_16x16x64_bf16 v[40:43], v[24:27], v[192:199], v56
    ds_read_b128 v[136:139], v57 offset:40960
    ds_read_b128 v[140:143], v57 offset:41984
    v_smfmac_f32_16x16x64_bf16 v[44:47], v[0:3], v[200:207], v56
    s_waitcnt lgkmcnt(2)
    buffer_load_dwordx4 v[128:131], v57, s[4:7], s25 offen offset:2048 sc1
    v_smfmac_f32_16x16x64_bf16 v[160:163], v[20:23], v[144:151], v56
    v_add_f32 v40, v40, v41
    v_smfmac_f32_16x16x64_bf16 v[44:47], v[4:7], v[208:215], v56
    ds_read_b128 v[144:147], v57 offset:55296
    ds_read_b128 v[148:151], v57 offset:56320
    v_add_f32 v42, v42, v43
    v_smfmac_f32_16x16x64_bf16 v[44:47], v[8:11], v[216:223], v56
    s_waitcnt lgkmcnt(2)
    buffer_load_dwordx4 v[132:135], v57, s[4:7], s25 offen offset:3072 sc1
    v_cvt_pk_bf16_f32 v52, v40, v42
    v_smfmac_f32_16x16x64_bf16 v[152:155], v[24:27], v[136:143], v56
    s_add_u32 s26, s65, 16384
    buffer_load_dword v59, off, s[4:7], s26 sc1
    v_smfmac_f32_16x16x64_bf16 v[44:47], v[12:15], v[224:231], v56
    ds_read_b128 v[136:139], v57 offset:26624
    ds_read_b128 v[140:143], v57 offset:27648
    v_smfmac_f32_16x16x64_bf16 v[44:47], v[16:19], v[232:239], v56
    s_waitcnt lgkmcnt(2)
    v_smfmac_f32_16x16x64_bf16 v[156:159], v[24:27], v[144:151], v56
    v_smfmac_f32_16x16x64_bf16 v[44:47], v[20:23], v[240:247], v56
    v_smfmac_f32_16x16x64_bf16 v[44:47], v[24:27], v[248:255], v56
    s_waitcnt lgkmcnt(0)
    v_smfmac_f32_16x16x64_bf16 v[160:163], v[24:27], v[136:143], v56
    s_nop 7
    v_add_f32 v44, v44, v45
    v_add_f32 v46, v46, v47
    v_cvt_pk_bf16_f32 v53, v44, v46
    v_add_f32 v152, v152, v153
    v_add_f32 v154, v154, v155
    v_cvt_pk_bf16_f32 v54, v152, v154
    v_add_f32 v156, v156, v157
    v_add_f32 v158, v158, v159
    v_cvt_pk_bf16_f32 v55, v156, v158
    v_add_f32 v160, v160, v161
    v_add_f32 v162, v162, v163
    v_cvt_pk_bf16_f32 v160, v160, v162
    ds_write_b32 v60, v160 offset:2048
    s_waitcnt lgkmcnt(0)
    s_barrier
    buffer_load_dwordx4 v[16:19], v57, s[4:7], s22 offen offset:0 sc1
    buffer_load_dwordx4 v[20:23], v57, s[4:7], s22 offen offset:1024 sc1
    buffer_load_dwordx4 v[24:27], v57, s[4:7], s22 offen offset:2048 sc1
    buffer_load_dwordx4 v[28:31], v57, s[4:7], s22 offen offset:3072 sc1
    buffer_load_dwordx4 v[0:3], v57, s[4:7], s21 offen offset:0 sc1
    buffer_load_dwordx4 v[4:7], v57, s[4:7], s21 offen offset:1024 sc1
    buffer_load_dwordx4 v[8:11], v57, s[4:7], s21 offen offset:2048 sc1
    buffer_load_dwordx4 v[12:15], v57, s[4:7], s21 offen offset:3072 sc1
    buffer_load_dwordx4 v[32:35], v57, s[4:7], s27 offen offset:0 sc1
    buffer_load_dwordx4 v[36:39], v57, s[4:7], s27 offen offset:1024 sc1
    ds_read_b128 v[64:67], v60
    ds_read_b128 v[68:71], v60 offset:1024
Lpp_100139:
    s_waitcnt lgkmcnt(0)
    s_waitcnt vmcnt(9)
    v_smfmac_f32_16x16x64_bf16 v[168:171], v[16:19], v[104:111], v56
    s_waitcnt vmcnt(8)
    v_smfmac_f32_16x16x64_bf16 v[168:171], v[20:23], v[112:119], v56
    s_waitcnt vmcnt(7)
    v_smfmac_f32_16x16x64_bf16 v[168:171], v[24:27], v[120:127], v56
    s_waitcnt vmcnt(6)
    v_smfmac_f32_16x16x64_bf16 v[168:171], v[28:31], v[128:135], v56
    s_waitcnt vmcnt(5)
    v_smfmac_f32_16x16x64_bf16 v[168:171], v[0:3], v[72:79], v56
    s_waitcnt vmcnt(4)
    v_smfmac_f32_16x16x64_bf16 v[168:171], v[4:7], v[80:87], v56
    s_waitcnt vmcnt(3)
    v_smfmac_f32_16x16x64_bf16 v[168:171], v[8:11], v[88:95], v56
    s_waitcnt vmcnt(2)
    v_smfmac_f32_16x16x64_bf16 v[168:171], v[12:15], v[96:103], v56
    s_waitcnt vmcnt(1)
    v_smfmac_f32_16x16x64_bf16 v[168:171], v[32:35], v[48:55], v56
    s_waitcnt vmcnt(0)
    v_smfmac_f32_16x16x64_bf16 v[168:171], v[36:39], v[64:71], v56
    s_mov_b64 vcc, s[66:67]
    s_nop 6
    v_add_f32 v168, v168, v169
    v_add_f32 v170, v170, v171
    v_cmp_u_f32 s[68:69], v168, v170
    v_cndmask_b32_dpp v171, v168, v170, vcc quad_perm:[1,0,3,2] row_mask:0xf bank_mask:0xf
    s_not_b64 vcc, vcc
    v_cndmask_b32_dpp v169, v170, v168, vcc quad_perm:[1,0,3,2] row_mask:0xf bank_mask:0xf
    s_cmp_lg_u64 s[68:69], 0
    v_cvt_pk_bf16_f32 v165, v169, v171
    s_cbranch_scc1 Lbad_100140
Lgood_100141:
    buffer_store_dword v165, v164, s[4:7], s62 offen
    buffer_store_dword v165, v164, s[4:7], s60 offen sc1
    s_add_u32 s64, s28, 0x180000
    s_cmp_lg_u32 s18, 62
    s_cbranch_scc1 LBq_100142
    buffer_store_dword v165, v164, s[4:7], s64 offen sc1
LBq_100142:
    s_barrier
    s_add_u32 s19, s19, 8192
    s_add_u32 s20, s20, 8192
    s_add_u32 s28, s28, 8192
    s_add_u32 s21, s21, 16384
    s_add_u32 s27, s27, 16384
    s_add_u32 s22, s22, 16384
    s_add_u32 s23, s23, 458752
    s_add_u32 s65, s65, 16384
    s_add_u32 s18, s18, 1
    s_cmp_lt_u32 s18, 63
    s_cbranch_scc1 LB1step_100132
    s_endpgm
LBretry_100137:
    v_max3_u32 v58, v0, v1, v2
    v_max_u32 v58, v58, v3
    v_max3_u32 v58, v58, v4, v5
    v_max3_u32 v58, v58, v6, v7
    v_max3_u32 v58, v58, v8, v9
    v_max3_u32 v58, v58, v10, v11
    v_max3_u32 v58, v58, v12, v13
    v_max3_u32 v58, v58, v14, v15
    v_max3_u32 v58, v58, v16, v17
    v_max3_u32 v58, v58, v18, v19
    v_max3_u32 v58, v58, v20, v21
    v_max3_u32 v58, v58, v22, v23
    v_max3_u32 v58, v58, v24, v25
    v_max3_u32 v58, v58, v26, v27
    v_cmp_eq_u32 vcc, -1, v58
    s_cbranch_vccz LBcont_100138
    s_waitcnt lgkmcnt(0)
    s_barrier
    s_sub_u32 s24, s24, 1
    s_cbranch_scc1 Lexit_100001
    s_branch LB1poll_100133
Lbad_100140:
    v_max3_u32 v58, v0, v1, v2
    v_max_u32 v58, v58, v3
    v_max3_u32 v58, v58, v4, v5
    v_max3_u32 v58, v58, v6, v7
    v_max3_u32 v58, v58, v8, v9
    v_max3_u32 v58, v58, v10, v11
    v_max3_u32 v58, v58, v12, v13
    v_max3_u32 v58, v58, v14, v15
    v_max3_u32 v58, v58, v16, v17
    v_max3_u32 v58, v58, v18, v19
    v_max3_u32 v58, v58, v20, v21
    v_max3_u32 v58, v58, v22, v23
    v_max3_u32 v58, v58, v24, v25
    v_max3_u32 v58, v58, v26, v27
    v_max3_u32 v58, v58, v28, v29
    v_max3_u32 v58, v58, v30, v31
    v_max3_u32 v58, v58, v32, v33
    v_max3_u32 v58, v58, v34, v35
    v_max3_u32 v58, v58, v36, v37
    v_max3_u32 v58, v58, v38, v39
    v_min_u32 v165, -2, v165
    v_cmp_eq_u32 vcc, -1, v58
    s_cbranch_vccz Lgood_100141
    buffer_load_dwordx4 v[16:19], v57, s[4:7], s22 offen offset:0 sc1
    buffer_load_dwordx4 v[20:23], v57, s[4:7], s22 offen offset:1024 sc1
    buffer_load_dwordx4 v[24:27], v57, s[4:7], s22 offen offset:2048 sc1
    buffer_load_dwordx4 v[28:31], v57, s[4:7], s22 offen offset:3072 sc1
    buffer_load_dwordx4 v[0:3], v57, s[4:7], s21 offen offset:0 sc1
    buffer_load_dwordx4 v[4:7], v57, s[4:7], s21 offen offset:1024 sc1
    buffer_load_dwordx4 v[8:11], v57, s[4:7], s21 offen offset:2048 sc1
    buffer_load_dwordx4 v[12:15], v57, s[4:7], s21 offen offset:3072 sc1
    buffer_load_dwordx4 v[32:35], v57, s[4:7], s27 offen offset:0 sc1
    buffer_load_dwordx4 v[36:39], v57, s[4:7], s27 offen offset:1024 sc1
    v_mov_b32 v168, 0
    v_mov_b32 v169, 0
    v_mov_b32 v170, 0
    v_mov_b32 v171, 0
    s_sub_u32 s24, s24, 1
    s_cbranch_scc1 Lexit_100001
    s_branch Lpp_100139
LBw2_100089:
    v_and_b32 v3, 63, v0
    v_lshrrev_b32 v1, 4, v3
    v_and_b32 v2, 15, v3
    v_and_b32 v58, 1, v2
    v_mul_u32_u24 v56, 0xAAAA, v58
    v_lshrrev_b32 v58, 3, v2
    v_mul_u32_u24 v58, 0xAAAA, v58
    v_lshl_add_u32 v56, v58, 16, v56
    v_add_u32 v56, 0x44444444, v56
    v_lshlrev_b32 v57, 4, v3
    v_add_u32 v60, 65536, v57
    s_sub_u32 s25, s17, 16
    s_mul_i32 s23, s25, 16384
    s_lshl_b32 s28, s25, 8
    s_add_u32 s28, s28, 0x2a02000
    s_mul_i32 s25, s25, 14336
    s_add_u32 s25, s25, 0xa10000
    s_add_u32 s23, s23, 0xe00000
    v_mov_b32 v5, v235
    v_mov_b32 v6, v237
    v_and_b32 v7, 31, v0
    v_lshlrev_b32 v7, 2, v7
    s_cmp_ge_u32 s17, 23
    s_cselect_b32 s60, 1, 0
    s_mov_b32 s61, 0xff
    s_mov_b32 s62, 64
    s_mov_b32 s63, 0x3d41800
Lbdw_100143:
    s_sub_u32 s62, s62, 1
    s_cbranch_scc1 Lbdc_100144
    buffer_load_dword v4, v6, s[4:7], s63 offen sc1
    s_waitcnt vmcnt(0)
    v_cmp_eq_u32 vcc, v4, v5
    s_nop 1
    s_lshr_b64 s[66:67], vcc, s60
    s_lshr_b64 s[68:69], s[66:67], 4
    s_or_b64 s[66:67], s[66:67], s[68:69]
    s_branch Lbdg_100145
Lbdc_100144:
    buffer_load_dword v4, v7, s[12:15], 0 offen offset:64 sc1
    s_waitcnt vmcnt(0)
    v_cmp_gt_u32 vcc, 8, v4
    s_mov_b64 s[66:67], 0
    s_cbranch_vccz Lbdg_100145
    s_sleep 30
    s_sub_u32 s24, s24, 1
    s_cbranch_scc1 Lexit_100001
    s_branch Lbdc_100144
Lbdg_100145:
    s_mov_b32 s70, s61
    s_bitcmp0_b32 s61, 0
    s_cbranch_scc1 Lbu_100147
    s_bitcmp1_b64 s[66:67], 0
    s_cbranch_scc1 Lbu_100147
    s_bitset0_b32 s61, 0
    s_add_u32 s26, s25, 0
    buffer_load_dwordx4 a[0:3], v57, s[4:7], s26 offen offset:0 sc1
    buffer_load_dwordx4 a[4:7], v57, s[4:7], s26 offen offset:1024 sc1
    s_add_u32 s26, s25, 2048
    buffer_load_dwordx4 a[8:11], v57, s[4:7], s26 offen offset:0 sc1
    buffer_load_dwordx4 a[12:15], v57, s[4:7], s26 offen offset:1024 sc1
    s_add_u32 s26, s25, 4096
    buffer_load_dwordx4 a[16:19], v57, s[4:7], s26 offen offset:0 sc1
    buffer_load_dwordx4 a[20:23], v57, s[4:7], s26 offen offset:1024 sc1
    s_add_u32 s26, s25, 6144
    buffer_load_dwordx4 a[24:27], v57, s[4:7], s26 offen offset:0 sc1
    buffer_load_dwordx4 a[28:31], v57, s[4:7], s26 offen offset:1024 sc1
    s_add_u32 s26, s25, 8192
    buffer_load_dwordx4 a[32:35], v57, s[4:7], s26 offen offset:0 sc1
    buffer_load_dwordx4 a[36:39], v57, s[4:7], s26 offen offset:1024 sc1
    s_add_u32 s26, s25, 10240
    buffer_load_dwordx4 a[40:43], v57, s[4:7], s26 offen offset:0 sc1
    buffer_load_dwordx4 a[44:47], v57, s[4:7], s26 offen offset:1024 sc1
    s_add_u32 s26, s25, 12288
    buffer_load_dwordx4 a[48:51], v57, s[4:7], s26 offen offset:0 sc1
    buffer_load_dwordx4 a[52:55], v57, s[4:7], s26 offen offset:1024 sc1
    s_waitcnt vmcnt(28)
Lbu_100147:
    s_bitcmp0_b32 s61, 1
    s_cbranch_scc1 Lbu_100148
    s_bitcmp1_b64 s[66:67], 8
    s_cbranch_scc1 Lbu_100148
    s_bitset0_b32 s61, 1
    s_add_u32 s26, s25, 401408
    buffer_load_dwordx4 a[56:59], v57, s[4:7], s26 offen offset:0 sc1
    buffer_load_dwordx4 a[60:63], v57, s[4:7], s26 offen offset:1024 sc1
    s_add_u32 s26, s25, 403456
    buffer_load_dwordx4 a[64:67], v57, s[4:7], s26 offen offset:0 sc1
    buffer_load_dwordx4 a[68:71], v57, s[4:7], s26 offen offset:1024 sc1
    s_add_u32 s26, s25, 405504
    buffer_load_dwordx4 a[72:75], v57, s[4:7], s26 offen offset:0 sc1
    buffer_load_dwordx4 a[76:79], v57, s[4:7], s26 offen offset:1024 sc1
    s_add_u32 s26, s25, 407552
    buffer_load_dwordx4 a[80:83], v57, s[4:7], s26 offen offset:0 sc1
    buffer_load_dwordx4 a[84:87], v57, s[4:7], s26 offen offset:1024 sc1
    s_add_u32 s26, s25, 409600
    buffer_load_dwordx4 a[88:91], v57, s[4:7], s26 offen offset:0 sc1
    buffer_load_dwordx4 a[92:95], v57, s[4:7], s26 offen offset:1024 sc1
    s_add_u32 s26, s25, 411648
    buffer_load_dwordx4 a[96:99], v57, s[4:7], s26 offen offset:0 sc1
    buffer_load_dwordx4 a[100:103], v57, s[4:7], s26 offen offset:1024 sc1
    s_add_u32 s26, s25, 413696
    buffer_load_dwordx4 a[104:107], v57, s[4:7], s26 offen offset:0 sc1
    buffer_load_dwordx4 a[108:111], v57, s[4:7], s26 offen offset:1024 sc1
    s_waitcnt vmcnt(28)
Lbu_100148:
    s_bitcmp0_b32 s61, 2
    s_cbranch_scc1 Lbu_100149
    s_bitcmp1_b64 s[66:67], 16
    s_cbranch_scc1 Lbu_100149
    s_bitset0_b32 s61, 2
    s_add_u32 s26, s25, 802816
    buffer_load_dwordx4 a[112:115], v57, s[4:7], s26 offen offset:0 sc1
    buffer_load_dwordx4 a[116:119], v57, s[4:7], s26 offen offset:1024 sc1
    s_add_u32 s26, s25, 804864
    buffer_load_dwordx4 a[120:123], v57, s[4:7], s26 offen offset:0 sc1
    buffer_load_dwordx4 a[124:127], v57, s[4:7], s26 offen offset:1024 sc1
    s_add_u32 s26, s25, 806912
    buffer_load_dwordx4 a[128:131], v57, s[4:7], s26 offen offset:0 sc1
    buffer_load_dwordx4 a[132:135], v57, s[4:7], s26 offen offset:1024 sc1
    s_add_u32 s26, s25, 808960
    buffer_load_dwordx4 a[136:139], v57, s[4:7], s26 offen offset:0 sc1
    buffer_load_dwordx4 a[140:143], v57, s[4:7], s26 offen offset:1024 sc1
    s_add_u32 s26, s25, 811008
    buffer_load_dwordx4 a[144:147], v57, s[4:7], s26 offen offset:0 sc1
    buffer_load_dwordx4 a[148:151], v57, s[4:7], s26 offen offset:1024 sc1
    s_add_u32 s26, s25, 813056
    buffer_load_dwordx4 a[152:155], v57, s[4:7], s26 offen offset:0 sc1
    buffer_load_dwordx4 a[156:159], v57, s[4:7], s26 offen offset:1024 sc1
    s_add_u32 s26, s25, 815104
    buffer_load_dwordx4 a[160:163], v57, s[4:7], s26 offen offset:0 sc1
    buffer_load_dwordx4 a[164:167], v57, s[4:7], s26 offen offset:1024 sc1
    s_waitcnt vmcnt(28)
Lbu_100149:
    s_bitcmp0_b32 s61, 3
    s_cbranch_scc1 Lbu_100150
    s_bitcmp1_b64 s[66:67], 24
    s_cbranch_scc1 Lbu_100150
    s_bitset0_b32 s61, 3
    s_add_u32 s26, s25, 1204224
    buffer_load_dwordx4 a[168:171], v57, s[4:7], s26 offen offset:0 sc1
    buffer_load_dwordx4 a[172:175], v57, s[4:7], s26 offen offset:1024 sc1
    s_add_u32 s26, s25, 1206272
    buffer_load_dwordx4 a[176:179], v57, s[4:7], s26 offen offset:0 sc1
    buffer_load_dwordx4 a[180:183], v57, s[4:7], s26 offen offset:1024 sc1
    s_add_u32 s26, s25, 1208320
    buffer_load_dwordx4 a[184:187], v57, s[4:7], s26 offen offset:0 sc1
    buffer_load_dwordx4 a[188:191], v57, s[4:7], s26 offen offset:1024 sc1
    s_add_u32 s26, s25, 1210368
    buffer_load_dwordx4 a[192:195], v57, s[4:7], s26 offen offset:0 sc1
    buffer_load_dwordx4 a[196:199], v57, s[4:7], s26 offen offset:1024 sc1
    s_add_u32 s26, s25, 1212416
    buffer_load_dwordx4 a[200:203], v57, s[4:7], s26 offen offset:0 sc1
    buffer_load_dwordx4 a[204:207], v57, s[4:7], s26 offen offset:1024 sc1
    s_add_u32 s26, s25, 1214464
    buffer_load_dwordx4 a[208:211], v57, s[4:7], s26 offen offset:0 sc1
    buffer_load_dwordx4 a[212:215], v57, s[4:7], s26 offen offset:1024 sc1
    s_add_u32 s26, s25, 1216512
    buffer_load_dwordx4 a[216:219], v57, s[4:7], s26 offen offset:0 sc1
    buffer_load_dwordx4 a[220:223], v57, s[4:7], s26 offen offset:1024 sc1
    s_waitcnt vmcnt(28)
Lbu_100150:
    s_bitcmp0_b32 s61, 4
    s_cbranch_scc1 Lbu_100151
    s_bitcmp1_b64 s[66:67], 32
    s_cbranch_scc1 Lbu_100151
    s_bitset0_b32 s61, 4
    s_add_u32 s26, s25, 1605632
    buffer_load_dwordx4 a[224:227], v57, s[4:7], s26 offen offset:0 sc1
    buffer_load_dwordx4 a[228:231], v57, s[4:7], s26 offen offset:1024 sc1
    s_add_u32 s26, s25, 1607680
    buffer_load_dwordx4 a[232:235], v57, s[4:7], s26 offen offset:0 sc1
    buffer_load_dwordx4 a[236:239], v57, s[4:7], s26 offen offset:1024 sc1
    s_add_u32 s26, s25, 1609728
    buffer_load_dwordx4 a[240:243], v57, s[4:7], s26 offen offset:0 sc1
    buffer_load_dwordx4 a[244:247], v57, s[4:7], s26 offen offset:1024 sc1
    s_add_u32 s26, s25, 1611776
    buffer_load_dwordx4 a[248:251], v57, s[4:7], s26 offen offset:0 sc1
    buffer_load_dwordx4 a[252:255], v57, s[4:7], s26 offen offset:1024 sc1
    s_add_u32 s26, s25, 1613824
    buffer_load_dwordx4 v[64:67], v57, s[4:7], s26 offen offset:0 sc1
    buffer_load_dwordx4 v[68:71], v57, s[4:7], s26 offen offset:1024 sc1
    s_add_u32 s26, s25, 1615872
    buffer_load_dwordx4 v[72:75], v57, s[4:7], s26 offen offset:0 sc1
    buffer_load_dwordx4 v[76:79], v57, s[4:7], s26 offen offset:1024 sc1
    s_add_u32 s26, s25, 1617920
    buffer_load_dwordx4 v[80:83], v57, s[4:7], s26 offen offset:0 sc1
    buffer_load_dwordx4 v[84:87], v57, s[4:7], s26 offen offset:1024 sc1
    s_waitcnt vmcnt(28)
Lbu_100151:
    s_bitcmp0_b32 s61, 5
    s_cbranch_scc1 Lbu_100152
    s_bitcmp1_b64 s[66:67], 40
    s_cbranch_scc1 Lbu_100152
    s_bitset0_b32 s61, 5
    s_add_u32 s26, s25, 2007040
    buffer_load_dwordx4 v[88:91], v57, s[4:7], s26 offen offset:0 sc1
    buffer_load_dwordx4 v[92:95], v57, s[4:7], s26 offen offset:1024 sc1
    s_add_u32 s26, s25, 2009088
    buffer_load_dwordx4 v[96:99], v57, s[4:7], s26 offen offset:0 sc1
    buffer_load_dwordx4 v[100:103], v57, s[4:7], s26 offen offset:1024 sc1
    s_add_u32 s26, s25, 2011136
    buffer_load_dwordx4 v[104:107], v57, s[4:7], s26 offen offset:0 sc1
    buffer_load_dwordx4 v[108:111], v57, s[4:7], s26 offen offset:1024 sc1
    s_add_u32 s26, s25, 2013184
    buffer_load_dwordx4 v[112:115], v57, s[4:7], s26 offen offset:0 sc1
    buffer_load_dwordx4 v[116:119], v57, s[4:7], s26 offen offset:1024 sc1
    s_add_u32 s26, s25, 2015232
    buffer_load_dwordx4 v[120:123], v57, s[4:7], s26 offen offset:0 sc1
    buffer_load_dwordx4 v[124:127], v57, s[4:7], s26 offen offset:1024 sc1
    s_add_u32 s26, s25, 2017280
    buffer_load_dwordx4 v[128:131], v57, s[4:7], s26 offen offset:0 sc1
    buffer_load_dwordx4 v[132:135], v57, s[4:7], s26 offen offset:1024 sc1
    s_add_u32 s26, s25, 2019328
    buffer_load_dwordx4 v[136:139], v57, s[4:7], s26 offen offset:0 sc1
    buffer_load_dwordx4 v[140:143], v57, s[4:7], s26 offen offset:1024 sc1
    s_waitcnt vmcnt(28)
Lbu_100152:
    s_bitcmp0_b32 s61, 6
    s_cbranch_scc1 Lbu_100153
    s_bitcmp1_b64 s[66:67], 48
    s_cbranch_scc1 Lbu_100153
    s_bitset0_b32 s61, 6
    s_add_u32 s26, s25, 2408448
    buffer_load_dwordx4 v[144:147], v57, s[4:7], s26 offen offset:0 sc1
    buffer_load_dwordx4 v[148:151], v57, s[4:7], s26 offen offset:1024 sc1
    s_add_u32 s26, s25, 2410496
    buffer_load_dwordx4 v[152:155], v57, s[4:7], s26 offen offset:0 sc1
    buffer_load_dwordx4 v[156:159], v57, s[4:7], s26 offen offset:1024 sc1
    s_add_u32 s26, s25, 2412544
    buffer_load_dwordx4 v[160:163], v57, s[4:7], s26 offen offset:0 sc1
    buffer_load_dwordx4 v[164:167], v57, s[4:7], s26 offen offset:1024 sc1
    s_add_u32 s26, s25, 2414592
    buffer_load_dwordx4 v[168:171], v57, s[4:7], s26 offen offset:0 sc1
    buffer_load_dwordx4 v[172:175], v57, s[4:7], s26 offen offset:1024 sc1
    s_add_u32 s26, s25, 2416640
    buffer_load_dwordx4 v[176:179], v57, s[4:7], s26 offen offset:0 sc1
    buffer_load_dwordx4 v[180:183], v57, s[4:7], s26 offen offset:1024 sc1
    s_add_u32 s26, s25, 2418688
    buffer_load_dwordx4 v[184:187], v57, s[4:7], s26 offen offset:0 sc1
    buffer_load_dwordx4 v[188:191], v57, s[4:7], s26 offen offset:1024 sc1
    s_add_u32 s26, s25, 2420736
    buffer_load_dwordx4 v[192:195], v57, s[4:7], s26 offen offset:0 sc1
    buffer_load_dwordx4 v[196:199], v57, s[4:7], s26 offen offset:1024 sc1
    s_waitcnt vmcnt(28)
Lbu_100153:
    s_bitcmp0_b32 s61, 7
    s_cbranch_scc1 Lbu_100154
    s_bitcmp1_b64 s[66:67], 56
    s_cbranch_scc1 Lbu_100154
    s_bitset0_b32 s61, 7
    s_add_u32 s26, s25, 2809856
    buffer_load_dwordx4 v[200:203], v57, s[4:7], s26 offen offset:0 sc1
    buffer_load_dwordx4 v[204:207], v57, s[4:7], s26 offen offset:1024 sc1
    s_add_u32 s26, s25, 2811904
    buffer_load_dwordx4 v[208:211], v57, s[4:7], s26 offen offset:0 sc1
    buffer_load_dwordx4 v[212:215], v57, s[4:7], s26 offen offset:1024 sc1
    s_add_u32 s26, s25, 2813952
    buffer_load_dwordx4 v[216:219], v57, s[4:7], s26 offen offset:0 sc1
    buffer_load_dwordx4 v[220:223], v57, s[4:7], s26 offen offset:1024 sc1
    s_add_u32 s26, s25, 2816000
    buffer_load_dwordx4 v[224:227], v57, s[4:7], s26 offen offset:0 sc1
    buffer_load_dwordx4 v[228:231], v57, s[4:7], s26 offen offset:1024 sc1
    s_add_u32 s26, s25, 2818048
    buffer_load_dwordx4 v[232:235], v57, s[4:7], s26 offen offset:0 sc1
    buffer_load_dwordx4 v[236:239], v57, s[4:7], s26 offen offset:1024 sc1
    s_add_u32 s26, s25, 2820096
    buffer_load_dwordx4 v[240:243], v57, s[4:7], s26 offen offset:0 sc1
    buffer_load_dwordx4 v[244:247], v57, s[4:7], s26 offen offset:1024 sc1
    s_add_u32 s26, s25, 2822144
    buffer_load_dwordx4 v[248:251], v57, s[4:7], s26 offen offset:0 sc1
    buffer_load_dwordx4 v[252:255], v57, s[4:7], s26 offen offset:1024 sc1
    s_waitcnt vmcnt(28)
Lbu_100154:
    s_cmp_eq_u32 s61, 0
    s_cbranch_scc1 Lbdd_100146
    s_cmp_lg_u32 s61, s70
    s_cbranch_scc1 Lbdw_100143
    s_sleep 12
    s_branch Lbdw_100143
Lbdd_100146:
    s_waitcnt vmcnt(0)
    s_cmp_lg_u32 s16, 0
    s_cbranch_scc1 LBcg_100156
    v_and_b32 v5, 31, v0
    v_add_lshl_u32 v5, v5, 0, 2
LBcw_100155:
    buffer_load_dword v4, v5, s[12:15], 0 offen offset:64 sc1
    s_waitcnt vmcnt(0)
    v_cmp_gt_u32 vcc, 8, v4
    s_cbranch_vccz LBcg_100156
    s_sleep 12
    s_sub_u32 s24, s24, 1
    s_cbranch_scc1 Lexit_100001
    s_branch LBcw_100155
LBcg_100156:
    s_barrier
    s_mov_b32 s18, 0
    s_mov_b32 s19, 0x2a00000
    s_mov_b32 s20, 0x2a01000
    s_mov_b32 s21, 0x2a80000
    s_mov_b32 s22, 0x2a81000
    s_mov_b32 s27, 0x2a82000
    s_mov_b32 s24, 300000
    s_mov_b32 s65, 0x2a83800
    s_mov_b32 s66, 0xaaaaaaaa
    s_mov_b32 s67, 0xaaaaaaaa
    s_waitcnt vmcnt(0) lgkmcnt(0)
    s_mov_b32 s40, 0
    v_lshlrev_b32 v61, 3, v57
    v_mov_b32 v59, 0
    s_sub_u32 s25, s17, 16
    s_cmp_lt_u32 s25, 7
    s_cselect_b32 s70, 0x180000, 0x40000000
    s_min_u32 s25, s25, 6
    s_lshl_b32 s25, s25, 10
    v_add_u32 v32, s25, v57
    v_lshrrev_b32 v33, 4, v57
    v_min_u32 v33, 13, v33
    v_lshlrev_b32 v33, 2, v33
    s_and_b32 s25, s17, 3
    s_lshl_b32 s25, s25, 8
    s_add_u32 s25, s25, 12288
    v_add_u32 v33, s25, v33
    s_branch LB2poll_100158
LB2step_100157:
    s_nop 15
    s_nop 15
    s_nop 15
    s_nop 11
LB2poll_100158:
    s_mov_b32 m0, 61440
    s_nop 0
    buffer_load_dwordx4 v57, s[4:7], s20 offen offset:0 sc1 lds
    s_mov_b32 m0, 61440
    s_nop 0
    buffer_load_dwordx4 v57, s[4:7], s20 offen offset:1024 sc1 lds
    v_mov_b32 v40, 0
    v_mov_b32 v41, 0
    v_mov_b32 v42, 0
    v_mov_b32 v43, 0
    v_mov_b32 v44, 0
    v_mov_b32 v45, 0
    v_mov_b32 v46, 0
    v_mov_b32 v47, 0
    s_waitcnt vmcnt(0)
    s_barrier
    ds_read_b128 v[0:3], v57 offset:57344
    ds_read_b128 v[4:7], v57 offset:58368
    ds_read_b128 v[8:11], v57 offset:59392
    ds_read_b128 v[12:15], v57 offset:60416
    ds_read_b128 v[16:19], v57 offset:61440
    ds_read_b128 v[20:23], v57 offset:62464
    ds_read_b128 v[24:27], v57 offset:63488
    s_waitcnt lgkmcnt(6)
    v_smfmac_f32_16x16x64_bf16 v[40:43], v[0:3], a[0:7], v56
    s_waitcnt lgkmcnt(5)
    v_smfmac_f32_16x16x64_bf16 v[40:43], v[4:7], a[8:15], v56
    s_waitcnt lgkmcnt(4)
    v_smfmac_f32_16x16x64_bf16 v[40:43], v[8:11], a[16:23], v56
    s_waitcnt lgkmcnt(3)
    v_smfmac_f32_16x16x64_bf16 v[40:43], v[12:15], a[24:31], v56
    s_waitcnt lgkmcnt(2)
    v_smfmac_f32_16x16x64_bf16 v[40:43], v[16:19], a[32:39], v56
    s_waitcnt lgkmcnt(1)
    v_smfmac_f32_16x16x64_bf16 v[40:43], v[20:23], a[40:47], v56
    s_waitcnt lgkmcnt(0)
    v_smfmac_f32_16x16x64_bf16 v[40:43], v[24:27], a[48:55], v56
    v_smfmac_f32_16x16x64_bf16 v[44:47], v[0:3], a[56:63], v56
    v_smfmac_f32_16x16x64_bf16 v[44:47], v[4:7], a[64:71], v56
    v_add_f32 v40, v40, v41
    v_smfmac_f32_16x16x64_bf16 v[44:47], v[8:11], a[72:79], v56
    v_add_f32 v42, v42, v43
    v_smfmac_f32_16x16x64_bf16 v[44:47], v[12:15], a[80:87], v56
    v_cmp_u_f32 vcc, v40, v42
    v_cvt_pk_bf16_f32 v48, v40, v42
    v_smfmac_f32_16x16x64_bf16 v[44:47], v[16:19], a[88:95], v56
    v_mov_b32 v40, 0
    v_smfmac_f32_16x16x64_bf16 v[44:47], v[20:23], a[96:103], v56
    s_cbranch_vccnz LBretry_100160
LBcont_100161:
    v_mov_b32 v41, 0
    v_mov_b32 v42, 0
    v_mov_b32 v43, 0
    v_smfmac_f32_16x16x64_bf16 v[44:47], v[24:27], a[104:111], v56
    v_smfmac_f32_16x16x64_bf16 v[40:43], v[0:3], a[112:119], v56
    v_smfmac_f32_16x16x64_bf16 v[40:43], v[4:7], a[120:127], v56
    v_add_f32 v44, v44, v45
    v_smfmac_f32_16x16x64_bf16 v[40:43], v[8:11], a[128:135], v56
    v_add_f32 v46, v46, v47
    v_smfmac_f32_16x16x64_bf16 v[40:43], v[12:15], a[136:143], v56
    v_cvt_pk_bf16_f32 v49, v44, v46
    v_smfmac_f32_16x16x64_bf16 v[40:43], v[16:19], a[144:151], v56
    v_mov_b32 v44, 0
    v_smfmac_f32_16x16x64_bf16 v[40:43], v[20:23], a[152:159], v56
    v_mov_b32 v45, 0
    v_mov_b32 v46, 0
    v_mov_b32 v47, 0
    v_smfmac_f32_16x16x64_bf16 v[40:43], v[24:27], a[160:167], v56
    v_smfmac_f32_16x16x64_bf16 v[44:47], v[0:3], a[168:175], v56
    v_smfmac_f32_16x16x64_bf16 v[44:47], v[4:7], a[176:183], v56
    v_add_f32 v40, v40, v41
    v_smfmac_f32_16x16x64_bf16 v[44:47], v[8:11], a[184:191], v56
    v_add_f32 v42, v42, v43
    v_smfmac_f32_16x16x64_bf16 v[44:47], v[12:15], a[192:199], v56
    v_cvt_pk_bf16_f32 v50, v40, v42
    v_smfmac_f32_16x16x64_bf16 v[44:47], v[16:19], a[200:207], v56
    v_mov_b32 v40, 0
    v_smfmac_f32_16x16x64_bf16 v[44:47], v[20:23], a[208:215], v56
    v_mov_b32 v41, 0
    v_mov_b32 v42, 0
    v_mov_b32 v43, 0
    v_smfmac_f32_16x16x64_bf16 v[44:47], v[24:27], a[216:223], v56
    v_smfmac_f32_16x16x64_bf16 v[40:43], v[0:3], a[224:231], v56
    v_smfmac_f32_16x16x64_bf16 v[40:43], v[4:7], a[232:239], v56
    v_add_f32 v44, v44, v45
    v_smfmac_f32_16x16x64_bf16 v[40:43], v[8:11], a[240:247], v56
    v_add_f32 v46, v46, v47
    v_smfmac_f32_16x16x64_bf16 v[40:43], v[12:15], a[248:255], v56
    v_cvt_pk_bf16_f32 v51, v44, v46
    v_smfmac_f32_16x16x64_bf16 v[40:43], v[16:19], v[64:71], v56
    v_mov_b32 v44, 0
    v_smfmac_f32_16x16x64_bf16 v[40:43], v[20:23], v[72:79], v56
    v_mov_b32 v45, 0
    v_mov_b32 v46, 0
    v_mov_b32 v47, 0
    v_smfmac_f32_16x16x64_bf16 v[40:43], v[24:27], v[80:87], v56
    v_smfmac_f32_16x16x64_bf16 v[44:47], v[0:3], v[88:95], v56
    v_smfmac_f32_16x16x64_bf16 v[44:47], v[4:7], v[96:103], v56
    v_add_f32 v40, v40, v41
    v_smfmac_f32_16x16x64_bf16 v[44:47], v[8:11], v[104:111], v56
    v_add_f32 v42, v42, v43
    v_smfmac_f32_16x16x64_bf16 v[44:47], v[12:15], v[112:119], v56
    v_cvt_pk_bf16_f32 v52, v40, v42
    v_smfmac_f32_16x16x64_bf16 v[44:47], v[16:19], v[120:127], v56
    v_mov_b32 v40, 0
    v_smfmac_f32_16x16x64_bf16 v[44:47], v[20:23], v[128:135], v56
    v_mov_b32 v41, 0
    v_mov_b32 v42, 0
    v_mov_b32 v43, 0
    v_smfmac_f32_16x16x64_bf16 v[44:47], v[24:27], v[136:143], v56
    v_smfmac_f32_16x16x64_bf16 v[40:43], v[0:3], v[144:151], v56
    v_smfmac_f32_16x16x64_bf16 v[40:43], v[4:7], v[152:159], v56
    v_add_f32 v44, v44, v45
    v_smfmac_f32_16x16x64_bf16 v[40:43], v[8:11], v[160:167], v56
    v_add_f32 v46, v46, v47
    v_smfmac_f32_16x16x64_bf16 v[40:43], v[12:15], v[168:175], v56
    v_cvt_pk_bf16_f32 v53, v44, v46
    v_smfmac_f32_16x16x64_bf16 v[40:43], v[16:19], v[176:183], v56
    v_mov_b32 v44, 0
    v_smfmac_f32_16x16x64_bf16 v[40:43], v[20:23], v[184:191], v56
    v_mov_b32 v45, 0
    v_mov_b32 v46, 0
    v_mov_b32 v47, 0
    v_smfmac_f32_16x16x64_bf16 v[40:43], v[24:27], v[192:199], v56
    v_smfmac_f32_16x16x64_bf16 v[44:47], v[0:3], v[200:207], v56
    v_smfmac_f32_16x16x64_bf16 v[44:47], v[4:7], v[208:215], v56
    v_add_f32 v40, v40, v41
    v_smfmac_f32_16x16x64_bf16 v[44:47], v[8:11], v[216:223], v56
    v_add_f32 v42, v42, v43
    v_smfmac_f32_16x16x64_bf16 v[44:47], v[12:15], v[224:231], v56
    v_cvt_pk_bf16_f32 v54, v40, v42
    v_smfmac_f32_16x16x64_bf16 v[44:47], v[16:19], v[232:239], v56
    v_smfmac_f32_16x16x64_bf16 v[44:47], v[20:23], v[240:247], v56
    v_smfmac_f32_16x16x64_bf16 v[44:47], v[24:27], v[248:255], v56
    s_nop 7
    v_add_f32 v44, v44, v45
    v_add_f32 v46, v46, v47
    v_cvt_pk_bf16_f32 v55, v44, v46
    ds_write_b128 v60, v[48:51]
    ds_write_b128 v60, v[52:55] offset:1024
    s_waitcnt lgkmcnt(0)
    s_barrier
    s_barrier
    s_add_u32 s19, s19, 8192
    s_add_u32 s20, s20, 8192
    s_add_u32 s28, s28, 8192
    s_add_u32 s21, s21, 16384
    s_add_u32 s27, s27, 16384
    s_add_u32 s22, s22, 16384
    s_add_u32 s23, s23, 458752
    s_add_u32 s65, s65, 16384
    s_add_u32 s18, s18, 1
    s_cmp_lt_u32 s18, 63
    s_cbranch_scc1 LB2step_100157
    s_endpgm
LBretry_100160:
    v_max3_u32 v58, v0, v1, v2
    v_max_u32 v58, v58, v3
    v_max3_u32 v58, v58, v4, v5
    v_max3_u32 v58, v58, v6, v7
    v_max3_u32 v58, v58, v8, v9
    v_max3_u32 v58, v58, v10, v11
    v_max3_u32 v58, v58, v12, v13
    v_max3_u32 v58, v58, v14, v15
    v_max3_u32 v58, v58, v16, v17
    v_max3_u32 v58, v58, v18, v19
    v_max3_u32 v58, v58, v20, v21
    v_max3_u32 v58, v58, v22, v23
    v_max3_u32 v58, v58, v24, v25
    v_max3_u32 v58, v58, v26, v27
    v_cmp_eq_u32 vcc, -1, v58
    s_cbranch_vccz LBcont_100161
    s_waitcnt lgkmcnt(0)
    s_barrier
    s_sub_u32 s24, s24, 1
    s_cbranch_scc1 Lexit_100001
    s_branch LB2poll_100158
LBw3_100090:
    v_and_b32 v3, 63, v0
    v_lshrrev_b32 v1, 4, v3
    v_and_b32 v2, 15, v3
    v_and_b32 v58, 1, v2
    v_mul_u32_u24 v56, 0xAAAA, v58
    v_lshrrev_b32 v58, 3, v2
    v_mul_u32_u24 v58, 0xAAAA, v58
    v_lshl_add_u32 v56, v58, 16, v56
    v_add_u32 v56, 0x44444444, v56
    v_lshlrev_b32 v57, 4, v3
    v_add_u32 v60, 67584, v57
    s_sub_u32 s25, s17, 16
    s_mul_i32 s23, s25, 16384
    s_lshl_b32 s28, s25, 8
    s_add_u32 s28, s28, 0x2a02e00
    s_mul_i32 s25, s25, 14336
    s_add_u32 s25, s25, 0xa41000
    s_add_u32 s23, s23, 0xe38000
    v_mov_b32 v5, v235
    v_mov_b32 v6, v237
    v_and_b32 v7, 31, v0
    v_lshlrev_b32 v7, 2, v7
    s_cmp_ge_u32 s17, 23
    s_cselect_b32 s60, 3, 2
    s_mov_b32 s61, 0xff
    s_mov_b32 s62, 64
    s_mov_b32 s63, 0x3d41800
Lbdw_100162:
    s_sub_u32 s62, s62, 1
    s_cbranch_scc1 Lbdc_100163
    buffer_load_dword v4, v6, s[4:7], s63 offen sc1
    s_waitcnt vmcnt(0)
    v_cmp_eq_u32 vcc, v4, v5
    s_nop 1
    s_lshr_b64 s[66:67], vcc, s60
    s_lshr_b64 s[68:69], s[66:67], 4
    s_or_b64 s[66:67], s[66:67], s[68:69]
    s_branch Lbdg_100164
Lbdc_100163:
    buffer_load_dword v4, v7, s[12:15], 0 offen offset:64 sc1
    s_waitcnt vmcnt(0)
    v_cmp_gt_u32 vcc, 8, v4
    s_mov_b64 s[66:67], 0
    s_cbranch_vccz Lbdg_100164
    s_sleep 30
    s_sub_u32 s24, s24, 1
    s_cbranch_scc1 Lexit_100001
    s_branch Lbdc_100163
Lbdg_100164:
    s_mov_b32 s70, s61
    s_bitcmp0_b32 s61, 0
    s_cbranch_scc1 Lbu_100166
    s_bitcmp1_b64 s[66:67], 0
    s_cbranch_scc1 Lbu_100166
    s_bitset0_b32 s61, 0
    s_add_u32 s26, s25, 0
    buffer_load_dwordx4 a[0:3], v57, s[4:7], s26 offen offset:0 sc1
    buffer_load_dwordx4 a[4:7], v57, s[4:7], s26 offen offset:1024 sc1
    s_add_u32 s26, s25, 2048
    buffer_load_dwordx4 a[8:11], v57, s[4:7], s26 offen offset:0 sc1
    buffer_load_dwordx4 a[12:15], v57, s[4:7], s26 offen offset:1024 sc1
    s_add_u32 s26, s25, 4096
    buffer_load_dwordx4 a[16:19], v57, s[4:7], s26 offen offset:0 sc1
    buffer_load_dwordx4 a[20:23], v57, s[4:7], s26 offen offset:1024 sc1
    s_add_u32 s26, s25, 6144
    buffer_load_dwordx4 a[24:27], v57, s[4:7], s26 offen offset:0 sc1
    buffer_load_dwordx4 a[28:31], v57, s[4:7], s26 offen offset:1024 sc1
    s_add_u32 s26, s25, 8192
    buffer_load_dwordx4 a[32:35], v57, s[4:7], s26 offen offset:0 sc1
    buffer_load_dwordx4 a[36:39], v57, s[4:7], s26 offen offset:1024 sc1
    s_add_u32 s26, s25, 10240
    buffer_load_dwordx4 a[40:43], v57, s[4:7], s26 offen offset:0 sc1
    buffer_load_dwordx4 a[44:47], v57, s[4:7], s26 offen offset:1024 sc1
    s_add_u32 s26, s25, 12288
    buffer_load_dwordx4 a[48:51], v57, s[4:7], s26 offen offset:0 sc1
    buffer_load_dwordx4 a[52:55], v57, s[4:7], s26 offen offset:1024 sc1
    s_waitcnt vmcnt(28)
Lbu_100166:
    s_bitcmp0_b32 s61, 1
    s_cbranch_scc1 Lbu_100167
    s_bitcmp1_b64 s[66:67], 8
    s_cbranch_scc1 Lbu_100167
    s_bitset0_b32 s61, 1
    s_add_u32 s26, s25, 401408
    buffer_load_dwordx4 a[56:59], v57, s[4:7], s26 offen offset:0 sc1
    buffer_load_dwordx4 a[60:63], v57, s[4:7], s26 offen offset:1024 sc1
    s_add_u32 s26, s25, 403456
    buffer_load_dwordx4 a[64:67], v57, s[4:7], s26 offen offset:0 sc1
    buffer_load_dwordx4 a[68:71], v57, s[4:7], s26 offen offset:1024 sc1
    s_add_u32 s26, s25, 405504
    buffer_load_dwordx4 a[72:75], v57, s[4:7], s26 offen offset:0 sc1
    buffer_load_dwordx4 a[76:79], v57, s[4:7], s26 offen offset:1024 sc1
    s_add_u32 s26, s25, 407552
    buffer_load_dwordx4 a[80:83], v57, s[4:7], s26 offen offset:0 sc1
    buffer_load_dwordx4 a[84:87], v57, s[4:7], s26 offen offset:1024 sc1
    s_add_u32 s26, s25, 409600
    buffer_load_dwordx4 a[88:91], v57, s[4:7], s26 offen offset:0 sc1
    buffer_load_dwordx4 a[92:95], v57, s[4:7], s26 offen offset:1024 sc1
    s_add_u32 s26, s25, 411648
    buffer_load_dwordx4 a[96:99], v57, s[4:7], s26 offen offset:0 sc1
    buffer_load_dwordx4 a[100:103], v57, s[4:7], s26 offen offset:1024 sc1
    s_add_u32 s26, s25, 413696
    buffer_load_dwordx4 a[104:107], v57, s[4:7], s26 offen offset:0 sc1
    buffer_load_dwordx4 a[108:111], v57, s[4:7], s26 offen offset:1024 sc1
    s_waitcnt vmcnt(28)
Lbu_100167:
    s_bitcmp0_b32 s61, 2
    s_cbranch_scc1 Lbu_100168
    s_bitcmp1_b64 s[66:67], 16
    s_cbranch_scc1 Lbu_100168
    s_bitset0_b32 s61, 2
    s_add_u32 s26, s25, 802816
    buffer_load_dwordx4 a[112:115], v57, s[4:7], s26 offen offset:0 sc1
    buffer_load_dwordx4 a[116:119], v57, s[4:7], s26 offen offset:1024 sc1
    s_add_u32 s26, s25, 804864
    buffer_load_dwordx4 a[120:123], v57, s[4:7], s26 offen offset:0 sc1
    buffer_load_dwordx4 a[124:127], v57, s[4:7], s26 offen offset:1024 sc1
    s_add_u32 s26, s25, 806912
    buffer_load_dwordx4 a[128:131], v57, s[4:7], s26 offen offset:0 sc1
    buffer_load_dwordx4 a[132:135], v57, s[4:7], s26 offen offset:1024 sc1
    s_add_u32 s26, s25, 808960
    buffer_load_dwordx4 a[136:139], v57, s[4:7], s26 offen offset:0 sc1
    buffer_load_dwordx4 a[140:143], v57, s[4:7], s26 offen offset:1024 sc1
    s_add_u32 s26, s25, 811008
    buffer_load_dwordx4 a[144:147], v57, s[4:7], s26 offen offset:0 sc1
    buffer_load_dwordx4 a[148:151], v57, s[4:7], s26 offen offset:1024 sc1
    s_add_u32 s26, s25, 813056
    buffer_load_dwordx4 a[152:155], v57, s[4:7], s26 offen offset:0 sc1
    buffer_load_dwordx4 a[156:159], v57, s[4:7], s26 offen offset:1024 sc1
    s_add_u32 s26, s25, 815104
    buffer_load_dwordx4 a[160:163], v57, s[4:7], s26 offen offset:0 sc1
    buffer_load_dwordx4 a[164:167], v57, s[4:7], s26 offen offset:1024 sc1
    s_waitcnt vmcnt(28)
Lbu_100168:
    s_bitcmp0_b32 s61, 3
    s_cbranch_scc1 Lbu_100169
    s_bitcmp1_b64 s[66:67], 24
    s_cbranch_scc1 Lbu_100169
    s_bitset0_b32 s61, 3
    s_add_u32 s26, s25, 1204224
    buffer_load_dwordx4 a[168:171], v57, s[4:7], s26 offen offset:0 sc1
    buffer_load_dwordx4 a[172:175], v57, s[4:7], s26 offen offset:1024 sc1
    s_add_u32 s26, s25, 1206272
    buffer_load_dwordx4 a[176:179], v57, s[4:7], s26 offen offset:0 sc1
    buffer_load_dwordx4 a[180:183], v57, s[4:7], s26 offen offset:1024 sc1
    s_add_u32 s26, s25, 1208320
    buffer_load_dwordx4 a[184:187], v57, s[4:7], s26 offen offset:0 sc1
    buffer_load_dwordx4 a[188:191], v57, s[4:7], s26 offen offset:1024 sc1
    s_add_u32 s26, s25, 1210368
    buffer_load_dwordx4 a[192:195], v57, s[4:7], s26 offen offset:0 sc1
    buffer_load_dwordx4 a[196:199], v57, s[4:7], s26 offen offset:1024 sc1
    s_add_u32 s26, s25, 1212416
    buffer_load_dwordx4 a[200:203], v57, s[4:7], s26 offen offset:0 sc1
    buffer_load_dwordx4 a[204:207], v57, s[4:7], s26 offen offset:1024 sc1
    s_add_u32 s26, s25, 1214464
    buffer_load_dwordx4 a[208:211], v57, s[4:7], s26 offen offset:0 sc1
    buffer_load_dwordx4 a[212:215], v57, s[4:7], s26 offen offset:1024 sc1
    s_add_u32 s26, s25, 1216512
    buffer_load_dwordx4 a[216:219], v57, s[4:7], s26 offen offset:0 sc1
    buffer_load_dwordx4 a[220:223], v57, s[4:7], s26 offen offset:1024 sc1
    s_waitcnt vmcnt(28)
Lbu_100169:
    s_bitcmp0_b32 s61, 4
    s_cbranch_scc1 Lbu_100170
    s_bitcmp1_b64 s[66:67], 32
    s_cbranch_scc1 Lbu_100170
    s_bitset0_b32 s61, 4
    s_add_u32 s26, s25, 1605632
    buffer_load_dwordx4 a[224:227], v57, s[4:7], s26 offen offset:0 sc1
    buffer_load_dwordx4 a[228:231], v57, s[4:7], s26 offen offset:1024 sc1
    s_add_u32 s26, s25, 1607680
    buffer_load_dwordx4 a[232:235], v57, s[4:7], s26 offen offset:0 sc1
    buffer_load_dwordx4 a[236:239], v57, s[4:7], s26 offen offset:1024 sc1
    s_add_u32 s26, s25, 1609728
    buffer_load_dwordx4 a[240:243], v57, s[4:7], s26 offen offset:0 sc1
    buffer_load_dwordx4 a[244:247], v57, s[4:7], s26 offen offset:1024 sc1
    s_add_u32 s26, s25, 1611776
    buffer_load_dwordx4 a[248:251], v57, s[4:7], s26 offen offset:0 sc1
    buffer_load_dwordx4 a[252:255], v57, s[4:7], s26 offen offset:1024 sc1
    s_add_u32 s26, s25, 1613824
    buffer_load_dwordx4 v[64:67], v57, s[4:7], s26 offen offset:0 sc1
    buffer_load_dwordx4 v[68:71], v57, s[4:7], s26 offen offset:1024 sc1
    s_add_u32 s26, s25, 1615872
    buffer_load_dwordx4 v[72:75], v57, s[4:7], s26 offen offset:0 sc1
    buffer_load_dwordx4 v[76:79], v57, s[4:7], s26 offen offset:1024 sc1
    s_add_u32 s26, s25, 1617920
    buffer_load_dwordx4 v[80:83], v57, s[4:7], s26 offen offset:0 sc1
    buffer_load_dwordx4 v[84:87], v57, s[4:7], s26 offen offset:1024 sc1
    s_waitcnt vmcnt(28)
Lbu_100170:
    s_bitcmp0_b32 s61, 5
    s_cbranch_scc1 Lbu_100171
    s_bitcmp1_b64 s[66:67], 40
    s_cbranch_scc1 Lbu_100171
    s_bitset0_b32 s61, 5
    s_add_u32 s26, s25, 2007040
    buffer_load_dwordx4 v[88:91], v57, s[4:7], s26 offen offset:0 sc1
    buffer_load_dwordx4 v[92:95], v57, s[4:7], s26 offen offset:1024 sc1
    s_add_u32 s26, s25, 2009088
    buffer_load_dwordx4 v[96:99], v57, s[4:7], s26 offen offset:0 sc1
    buffer_load_dwordx4 v[100:103], v57, s[4:7], s26 offen offset:1024 sc1
    s_add_u32 s26, s25, 2011136
    buffer_load_dwordx4 v[104:107], v57, s[4:7], s26 offen offset:0 sc1
    buffer_load_dwordx4 v[108:111], v57, s[4:7], s26 offen offset:1024 sc1
    s_add_u32 s26, s25, 2013184
    buffer_load_dwordx4 v[112:115], v57, s[4:7], s26 offen offset:0 sc1
    buffer_load_dwordx4 v[116:119], v57, s[4:7], s26 offen offset:1024 sc1
    s_add_u32 s26, s25, 2015232
    buffer_load_dwordx4 v[120:123], v57, s[4:7], s26 offen offset:0 sc1
    buffer_load_dwordx4 v[124:127], v57, s[4:7], s26 offen offset:1024 sc1
    s_add_u32 s26, s25, 2017280
    buffer_load_dwordx4 v[128:131], v57, s[4:7], s26 offen offset:0 sc1
    buffer_load_dwordx4 v[132:135], v57, s[4:7], s26 offen offset:1024 sc1
    s_add_u32 s26, s25, 2019328
    buffer_load_dwordx4 v[136:139], v57, s[4:7], s26 offen offset:0 sc1
    buffer_load_dwordx4 v[140:143], v57, s[4:7], s26 offen offset:1024 sc1
    s_waitcnt vmcnt(28)
Lbu_100171:
    s_bitcmp0_b32 s61, 6
    s_cbranch_scc1 Lbu_100172
    s_bitcmp1_b64 s[66:67], 48
    s_cbranch_scc1 Lbu_100172
    s_bitset0_b32 s61, 6
    s_add_u32 s26, s25, 2408448
    buffer_load_dwordx4 v[144:147], v57, s[4:7], s26 offen offset:0 sc1
    buffer_load_dwordx4 v[148:151], v57, s[4:7], s26 offen offset:1024 sc1
    s_add_u32 s26, s25, 2410496
    buffer_load_dwordx4 v[152:155], v57, s[4:7], s26 offen offset:0 sc1
    buffer_load_dwordx4 v[156:159], v57, s[4:7], s26 offen offset:1024 sc1
    s_add_u32 s26, s25, 2412544
    buffer_load_dwordx4 v[160:163], v57, s[4:7], s26 offen offset:0 sc1
    buffer_load_dwordx4 v[164:167], v57, s[4:7], s26 offen offset:1024 sc1
    s_add_u32 s26, s25, 2414592
    buffer_load_dwordx4 v[168:171], v57, s[4:7], s26 offen offset:0 sc1
    buffer_load_dwordx4 v[172:175], v57, s[4:7], s26 offen offset:1024 sc1
    s_add_u32 s26, s25, 2416640
    buffer_load_dwordx4 v[176:179], v57, s[4:7], s26 offen offset:0 sc1
    buffer_load_dwordx4 v[180:183], v57, s[4:7], s26 offen offset:1024 sc1
    s_add_u32 s26, s25, 2418688
    buffer_load_dwordx4 v[184:187], v57, s[4:7], s26 offen offset:0 sc1
    buffer_load_dwordx4 v[188:191], v57, s[4:7], s26 offen offset:1024 sc1
    s_add_u32 s26, s25, 2420736
    buffer_load_dwordx4 v[192:195], v57, s[4:7], s26 offen offset:0 sc1
    buffer_load_dwordx4 v[196:199], v57, s[4:7], s26 offen offset:1024 sc1
    s_waitcnt vmcnt(28)
Lbu_100172:
    s_bitcmp0_b32 s61, 7
    s_cbranch_scc1 Lbu_100173
    s_bitcmp1_b64 s[66:67], 56
    s_cbranch_scc1 Lbu_100173
    s_bitset0_b32 s61, 7
    s_add_u32 s26, s25, 2809856
    buffer_load_dwordx4 v[200:203], v57, s[4:7], s26 offen offset:0 sc1
    buffer_load_dwordx4 v[204:207], v57, s[4:7], s26 offen offset:1024 sc1
    s_add_u32 s26, s25, 2811904
    buffer_load_dwordx4 v[208:211], v57, s[4:7], s26 offen offset:0 sc1
    buffer_load_dwordx4 v[212:215], v57, s[4:7], s26 offen offset:1024 sc1
    s_add_u32 s26, s25, 2813952
    buffer_load_dwordx4 v[216:219], v57, s[4:7], s26 offen offset:0 sc1
    buffer_load_dwordx4 v[220:223], v57, s[4:7], s26 offen offset:1024 sc1
    s_add_u32 s26, s25, 2816000
    buffer_load_dwordx4 v[224:227], v57, s[4:7], s26 offen offset:0 sc1
    buffer_load_dwordx4 v[228:231], v57, s[4:7], s26 offen offset:1024 sc1
    s_add_u32 s26, s25, 2818048
    buffer_load_dwordx4 v[232:235], v57, s[4:7], s26 offen offset:0 sc1
    buffer_load_dwordx4 v[236:239], v57, s[4:7], s26 offen offset:1024 sc1
    s_add_u32 s26, s25, 2820096
    buffer_load_dwordx4 v[240:243], v57, s[4:7], s26 offen offset:0 sc1
    buffer_load_dwordx4 v[244:247], v57, s[4:7], s26 offen offset:1024 sc1
    s_add_u32 s26, s25, 2822144
    buffer_load_dwordx4 v[248:251], v57, s[4:7], s26 offen offset:0 sc1
    buffer_load_dwordx4 v[252:255], v57, s[4:7], s26 offen offset:1024 sc1
    s_waitcnt vmcnt(28)
Lbu_100173:
    s_cmp_eq_u32 s61, 0
    s_cbranch_scc1 Lbdd_100165
    s_cmp_lg_u32 s61, s70
    s_cbranch_scc1 Lbdw_100162
    s_sleep 12
    s_branch Lbdw_100162
Lbdd_100165:
    s_waitcnt vmcnt(0)
    s_cmp_lg_u32 s16, 0
    s_cbranch_scc1 LBcg_100175
    v_and_b32 v5, 31, v0
    v_add_lshl_u32 v5, v5, 0, 2
LBcw_100174:
    buffer_load_dword v4, v5, s[12:15], 0 offen offset:64 sc1
    s_waitcnt vmcnt(0)
    v_cmp_gt_u32 vcc, 8, v4
    s_cbranch_vccz LBcg_100175
    s_sleep 12
    s_sub_u32 s24, s24, 1
    s_cbranch_scc1 Lexit_100001
    s_branch LBcw_100174
LBcg_100175:
    s_barrier
    s_mov_b32 s18, 0
    s_mov_b32 s19, 0x2a00000
    s_mov_b32 s20, 0x2a01000
    s_mov_b32 s21, 0x2a80000
    s_mov_b32 s22, 0x2a81000
    s_mov_b32 s27, 0x2a82000
    s_mov_b32 s24, 300000
    s_mov_b32 s65, 0x2a83800
    s_mov_b32 s66, 0xaaaaaaaa
    s_mov_b32 s67, 0xaaaaaaaa
    s_waitcnt vmcnt(0) lgkmcnt(0)
    s_mov_b32 s40, 0
    v_lshlrev_b32 v61, 3, v57
    v_mov_b32 v59, 0
    s_sub_u32 s25, s17, 16
    s_cmp_lt_u32 s25, 7
    s_cselect_b32 s70, 0x180000, 0x40000000
    s_min_u32 s25, s25, 6
    s_lshl_b32 s25, s25, 10
    v_add_u32 v32, s25, v57
    v_lshrrev_b32 v33, 4, v57
    v_min_u32 v33, 13, v33
    v_lshlrev_b32 v33, 2, v33
    s_and_b32 s25, s17, 3
    s_lshl_b32 s25, s25, 8
    s_add_u32 s25, s25, 12288
    v_add_u32 v33, s25, v33
    s_branch LB3poll_100177
LB3step_100176:
    s_nop 15
    s_nop 15
    s_nop 15
    s_nop 11
LB3poll_100177:
    s_mov_b32 m0, 61440
    s_nop 0
    buffer_load_dwordx4 v57, s[4:7], s20 offen offset:2048 sc1 lds
    v_mov_b32 v40, 0
    v_mov_b32 v41, 0
    v_mov_b32 v42, 0
    v_mov_b32 v43, 0
    v_mov_b32 v44, 0
    v_mov_b32 v45, 0
    v_mov_b32 v46, 0
    v_mov_b32 v47, 0
    s_waitcnt vmcnt(0)
    s_barrier
    ds_read_b128 v[0:3], v57 offset:57344
    ds_read_b128 v[4:7], v57 offset:58368
    ds_read_b128 v[8:11], v57 offset:59392
    ds_read_b128 v[12:15], v57 offset:60416
    ds_read_b128 v[16:19], v57 offset:61440
    ds_read_b128 v[20:23], v57 offset:62464
    ds_read_b128 v[24:27], v57 offset:63488
    s_waitcnt lgkmcnt(6)
    v_smfmac_f32_16x16x64_bf16 v[40:43], v[0:3], a[0:7], v56
    s_waitcnt lgkmcnt(5)
    v_smfmac_f32_16x16x64_bf16 v[40:43], v[4:7], a[8:15], v56
    s_waitcnt lgkmcnt(4)
    v_smfmac_f32_16x16x64_bf16 v[40:43], v[8:11], a[16:23], v56
    s_waitcnt lgkmcnt(3)
    v_smfmac_f32_16x16x64_bf16 v[40:43], v[12:15], a[24:31], v56
    s_waitcnt lgkmcnt(2)
    v_smfmac_f32_16x16x64_bf16 v[40:43], v[16:19], a[32:39], v56
    s_waitcnt lgkmcnt(1)
    v_smfmac_f32_16x16x64_bf16 v[40:43], v[20:23], a[40:47], v56
    s_waitcnt lgkmcnt(0)
    v_smfmac_f32_16x16x64_bf16 v[40:43], v[24:27], a[48:55], v56
    v_smfmac_f32_16x16x64_bf16 v[44:47], v[0:3], a[56:63], v56
    v_smfmac_f32_16x16x64_bf16 v[44:47], v[4:7], a[64:71], v56
    v_add_f32 v40, v40, v41
    v_smfmac_f32_16x16x64_bf16 v[44:47], v[8:11], a[72:79], v56
    v_add_f32 v42, v42, v43
    v_smfmac_f32_16x16x64_bf16 v[44:47], v[12:15], a[80:87], v56
    v_cmp_u_f32 vcc, v40, v42
    v_cvt_pk_bf16_f32 v48, v40, v42
    v_smfmac_f32_16x16x64_bf16 v[44:47], v[16:19], a[88:95], v56
    v_mov_b32 v40, 0
    v_smfmac_f32_16x16x64_bf16 v[44:47], v[20:23], a[96:103], v56
    s_cbranch_vccnz LBretry_100179
LBcont_100180:
    v_mov_b32 v41, 0
    v_mov_b32 v42, 0
    v_mov_b32 v43, 0
    v_smfmac_f32_16x16x64_bf16 v[44:47], v[24:27], a[104:111], v56
    v_smfmac_f32_16x16x64_bf16 v[40:43], v[0:3], a[112:119], v56
    v_smfmac_f32_16x16x64_bf16 v[40:43], v[4:7], a[120:127], v56
    v_add_f32 v44, v44, v45
    v_smfmac_f32_16x16x64_bf16 v[40:43], v[8:11], a[128:135], v56
    v_add_f32 v46, v46, v47
    v_smfmac_f32_16x16x64_bf16 v[40:43], v[12:15], a[136:143], v56
    v_cvt_pk_bf16_f32 v49, v44, v46
    v_smfmac_f32_16x16x64_bf16 v[40:43], v[16:19], a[144:151], v56
    v_mov_b32 v44, 0
    v_smfmac_f32_16x16x64_bf16 v[40:43], v[20:23], a[152:159], v56
    v_mov_b32 v45, 0
    v_mov_b32 v46, 0
    v_mov_b32 v47, 0
    v_smfmac_f32_16x16x64_bf16 v[40:43], v[24:27], a[160:167], v56
    v_smfmac_f32_16x16x64_bf16 v[44:47], v[0:3], a[168:175], v56
    v_smfmac_f32_16x16x64_bf16 v[44:47], v[4:7], a[176:183], v56
    v_add_f32 v40, v40, v41
    v_smfmac_f32_16x16x64_bf16 v[44:47], v[8:11], a[184:191], v56
    v_add_f32 v42, v42, v43
    v_smfmac_f32_16x16x64_bf16 v[44:47], v[12:15], a[192:199], v56
    v_cvt_pk_bf16_f32 v50, v40, v42
    v_smfmac_f32_16x16x64_bf16 v[44:47], v[16:19], a[200:207], v56
    v_mov_b32 v40, 0
    v_smfmac_f32_16x16x64_bf16 v[44:47], v[20:23], a[208:215], v56
    v_mov_b32 v41, 0
    v_mov_b32 v42, 0
    v_mov_b32 v43, 0
    v_smfmac_f32_16x16x64_bf16 v[44:47], v[24:27], a[216:223], v56
    v_smfmac_f32_16x16x64_bf16 v[40:43], v[0:3], a[224:231], v56
    v_smfmac_f32_16x16x64_bf16 v[40:43], v[4:7], a[232:239], v56
    v_add_f32 v44, v44, v45
    v_smfmac_f32_16x16x64_bf16 v[40:43], v[8:11], a[240:247], v56
    v_add_f32 v46, v46, v47
    v_smfmac_f32_16x16x64_bf16 v[40:43], v[12:15], a[248:255], v56
    v_cvt_pk_bf16_f32 v51, v44, v46
    v_smfmac_f32_16x16x64_bf16 v[40:43], v[16:19], v[64:71], v56
    v_mov_b32 v44, 0
    v_smfmac_f32_16x16x64_bf16 v[40:43], v[20:23], v[72:79], v56
    v_mov_b32 v45, 0
    v_mov_b32 v46, 0
    v_mov_b32 v47, 0
    v_smfmac_f32_16x16x64_bf16 v[40:43], v[24:27], v[80:87], v56
    v_smfmac_f32_16x16x64_bf16 v[44:47], v[0:3], v[88:95], v56
    v_smfmac_f32_16x16x64_bf16 v[44:47], v[4:7], v[96:103], v56
    v_add_f32 v40, v40, v41
    v_smfmac_f32_16x16x64_bf16 v[44:47], v[8:11], v[104:111], v56
    v_add_f32 v42, v42, v43
    v_smfmac_f32_16x16x64_bf16 v[44:47], v[12:15], v[112:119], v56
    v_cvt_pk_bf16_f32 v52, v40, v42
    v_smfmac_f32_16x16x64_bf16 v[44:47], v[16:19], v[120:127], v56
    v_mov_b32 v40, 0
    v_smfmac_f32_16x16x64_bf16 v[44:47], v[20:23], v[128:135], v56
    v_mov_b32 v41, 0
    v_mov_b32 v42, 0
    v_mov_b32 v43, 0
    v_smfmac_f32_16x16x64_bf16 v[44:47], v[24:27], v[136:143], v56
    v_smfmac_f32_16x16x64_bf16 v[40:43], v[0:3], v[144:151], v56
    v_smfmac_f32_16x16x64_bf16 v[40:43], v[4:7], v[152:159], v56
    v_add_f32 v44, v44, v45
    v_smfmac_f32_16x16x64_bf16 v[40:43], v[8:11], v[160:167], v56
    v_add_f32 v46, v46, v47
    v_smfmac_f32_16x16x64_bf16 v[40:43], v[12:15], v[168:175], v56
    v_cvt_pk_bf16_f32 v53, v44, v46
    v_smfmac_f32_16x16x64_bf16 v[40:43], v[16:19], v[176:183], v56
    v_mov_b32 v44, 0
    v_smfmac_f32_16x16x64_bf16 v[40:43], v[20:23], v[184:191], v56
    v_mov_b32 v45, 0
    v_mov_b32 v46, 0
    v_mov_b32 v47, 0
    v_smfmac_f32_16x16x64_bf16 v[40:43], v[24:27], v[192:199], v56
    v_smfmac_f32_16x16x64_bf16 v[44:47], v[0:3], v[200:207], v56
    v_smfmac_f32_16x16x64_bf16 v[44:47], v[4:7], v[208:215], v56
    v_add_f32 v40, v40, v41
    v_smfmac_f32_16x16x64_bf16 v[44:47], v[8:11], v[216:223], v56
    v_add_f32 v42, v42, v43
    v_smfmac_f32_16x16x64_bf16 v[44:47], v[12:15], v[224:231], v56
    v_cvt_pk_bf16_f32 v54, v40, v42
    v_smfmac_f32_16x16x64_bf16 v[44:47], v[16:19], v[232:239], v56
    v_smfmac_f32_16x16x64_bf16 v[44:47], v[20:23], v[240:247], v56
    v_smfmac_f32_16x16x64_bf16 v[44:47], v[24:27], v[248:255], v56
    s_nop 7
    v_add_f32 v44, v44, v45
    v_add_f32 v46, v46, v47
    v_cvt_pk_bf16_f32 v55, v44, v46
    ds_write_b128 v60, v[48:51]
    ds_write_b128 v60, v[52:55] offset:1024
    s_waitcnt lgkmcnt(0)
    s_barrier
    s_nop 15
    s_nop 15
    s_nop 15
    s_nop 15
    s_nop 5
    buffer_load_dword v28, v33, s[4:7], s21 offen offset:0 sc1
    s_waitcnt vmcnt(0)
    v_cmp_eq_u32 vcc, -1, v28
    s_cbranch_vccz Lbgo_100181
    buffer_load_dword v28, v33, s[4:7], s21 offen offset:0 sc1
    s_nop 11
    buffer_load_dword v29, v33, s[4:7], s21 offen offset:0 sc1
    s_nop 11
    buffer_load_dword v30, v33, s[4:7], s21 offen offset:0 sc1
    s_nop 11
    buffer_load_dword v31, v33, s[4:7], s21 offen offset:0 sc1
    s_nop 11
LGfp_100182:
    s_waitcnt vmcnt(3)
    v_cmp_eq_u32 vcc, -1, v28
    s_cbranch_vccz LGgo_100183
    buffer_load_dword v28, v33, s[4:7], s21 offen offset:0 sc1
    s_waitcnt vmcnt(3)
    v_cmp_eq_u32 vcc, -1, v29
    s_cbranch_vccz LGgo_100183
    buffer_load_dword v29, v33, s[4:7], s21 offen offset:0 sc1
    s_waitcnt vmcnt(3)
    v_cmp_eq_u32 vcc, -1, v30
    s_cbranch_vccz LGgo_100183
    buffer_load_dword v30, v33, s[4:7], s21 offen offset:0 sc1
    s_waitcnt vmcnt(3)
    v_cmp_eq_u32 vcc, -1, v31
    s_cbranch_vccz LGgo_100183
    buffer_load_dword v31, v33, s[4:7], s21 offen offset:0 sc1
    s_sub_u32 s24, s24, 1
    s_cbranch_scc1 Lexit_100001
    s_branch LGfp_100182
LGgo_100183:
    s_nop 15
    s_nop 15
    s_nop 15
    s_nop 15
    s_nop 0
Lbgo_100181:
    s_barrier
    s_add_u32 s19, s19, 8192
    s_add_u32 s20, s20, 8192
    s_add_u32 s28, s28, 8192
    s_add_u32 s21, s21, 16384
    s_add_u32 s27, s27, 16384
    s_add_u32 s22, s22, 16384
    s_add_u32 s23, s23, 458752
    s_add_u32 s65, s65, 16384
    s_add_u32 s18, s18, 1
    s_cmp_lt_u32 s18, 63
    s_cbranch_scc1 LB3step_100176
    s_endpgm
LBretry_100179:
    v_max3_u32 v58, v0, v1, v2
    v_max_u32 v58, v58, v3
    v_max3_u32 v58, v58, v4, v5
    v_max3_u32 v58, v58, v6, v7
    v_max3_u32 v58, v58, v8, v9
    v_max3_u32 v58, v58, v10, v11
    v_max3_u32 v58, v58, v12, v13
    v_max3_u32 v58, v58, v14, v15
    v_max3_u32 v58, v58, v16, v17
    v_max3_u32 v58, v58, v18, v19
    v_max3_u32 v58, v58, v20, v21
    v_max3_u32 v58, v58, v22, v23
    v_max3_u32 v58, v58, v24, v25
    v_max3_u32 v58, v58, v26, v27
    v_cmp_eq_u32 vcc, -1, v58
    s_cbranch_vccz LBcont_100180
    s_waitcnt lgkmcnt(0)
    s_barrier
    s_sub_u32 s24, s24, 1
    s_cbranch_scc1 Lexit_100001
    s_branch LB3poll_100177
LrolePF_100023:
    s_cmp_lg_u32 s16, 0
    s_cbranch_scc1 LPtf_100187
    s_mov_b32 s62, 64
    s_mov_b32 s60, 0x3d41000
LPtw_100185:
    buffer_load_dword v4, v237, s[4:7], s60 offen sc1
    buffer_load_dword v5, v237, s[4:7], s60 offen offset:2048 sc1
    s_waitcnt vmcnt(0)
    v_cmp_eq_u32 s[66:67], v4, v234
    v_cmp_eq_u32 vcc, v5, v235
    s_nop 1
    s_or_b64 vcc, vcc, s[66:67]
    s_cbranch_scc0 LPtg_100186
    s_sleep 12
    s_sub_u32 s62, s62, 1
    s_cbranch_scc0 LPtw_100185
    s_mov_b64 exec, -1
LPtf_100187:
    s_cmp_lg_u32 s16, 0
    s_cbranch_scc1 LPcg_100190
    v_and_b32 v5, 15, v0
    v_add_lshl_u32 v5, v5, 16, 2
LPcw_100189:
    buffer_load_dword v4, v5, s[12:15], 0 offen offset:64 sc1
    s_waitcnt vmcnt(0)
    v_cmp_gt_u32 vcc, 8, v4
    s_cbranch_vccz LPcg_100190
    s_sleep 12
    s_sub_u32 s24, s24, 1
    s_cbranch_scc1 Lexit2_100184
    s_branch LPcw_100189
LPcg_100190:
    s_barrier
    s_branch Ltj_100188
LPtg_100186:
    s_mov_b64 exec, -1
    s_barrier
Ltj_100188:
    v_and_b32 v3, 63, v0
    v_lshlrev_b32 v1, 7, v3
    v_mov_b32 v2, 0
    v_mov_b32 v12, 0
    s_sub_u32 s26, s17, 30
    s_lshl_b32 s26, s26, 2
    s_add_u32 s26, s26, s16
    s_lshl_b32 s26, s26, 13
    s_mov_b32 s18, 0
    s_mov_b32 s24, 300000
    s_cmp_lg_u32 s16, 0
    s_cbranch_scc1 LPcg_100192
    v_and_b32 v5, 31, v0
    v_add_lshl_u32 v5, v5, 0, 2
LPcw_100191:
    buffer_load_dword v4, v5, s[12:15], 0 offen offset:64 sc1
    s_waitcnt vmcnt(0)
    v_cmp_gt_u32 vcc, 8, v4
    s_cbranch_vccz LPcg_100192
    s_sleep 30
    s_sub_u32 s24, s24, 1
    s_cbranch_scc1 Lexit2_100184
    s_branch LPcw_100191
LPcg_100192:
    s_barrier
    s_mov_b32 s21, 0x2a83800
    s_add_u32 s22, s26, 0x3800000
    s_mov_b32 s27, 28672
    s_cmp_lt_u32 s26, 32768
    s_cbranch_scc1 Lpf2_100194
    s_mov_b32 s22, 0x2a02000
    s_mov_b32 s27, 8192
    s_cmp_eq_u32 s26, 32768
    s_cbranch_scc1 Lpf2_100194
    s_and_b32 s22, s26, 8192
    s_add_u32 s22, s22, 0x2a80000
    s_mov_b32 s27, 16384
Lpf2_100194:
    s_lshl_b32 s23, s26, 0
    s_add_u32 s23, s23, 0xe00000
    s_cmp_eq_u32 s26, 57344
    s_cselect_b32 s22, 0x40000000, s22
    s_mov_b32 s19, 0x29fa000
Lpfw_100198:
    buffer_load_dword v12, off, s[4:7], s21 sc1
    s_waitcnt vmcnt(0)
    v_cmp_eq_u32 vcc, -1, v12
    s_cbranch_vccz Lpfg_100199
    s_sleep 8
    s_sub_u32 s24, s24, 1
    s_cbranch_scc1 Lexit2_100184
    s_branch Lpfw_100198
Lpfg_100199:
    s_getpc_b64 s[30:31]
Lpf_pc:
    s_sub_u32 s30, s30, Lpf_pc-Lteam_code
    s_subb_u32 s31, s31, 0
    v_add_u32 v13, s26, v1
    v_min_u32 v13, Lpf_pc-Lteam_code, v13
    global_load_dword v14, v13, s[30:31]
    v_mov_b32 v4, -1
Lpfstep_100195:
    s_cmp_lt_u32 s18, 4
    s_cbranch_scc1 Lpfgo_100197
    v_cmp_eq_u32 vcc, -1, v4
    s_cbranch_vccz Lpfgo_100197
Lpfpoll_100196:
    buffer_load_dword v4, v2, s[4:7], s19 offen sc1
    s_waitcnt vmcnt(0)
    v_cmp_eq_u32 vcc, -1, v4
    s_cbranch_vccz Lpfgo_100197
    s_sleep 2
    s_sub_u32 s24, s24, 1
    s_cbranch_scc1 Lexit2_100184
    s_branch Lpfpoll_100196
Lpfgo_100197:
    v_cmp_ne_u32 vcc, 15, v12
    s_cbranch_vccz Lpfcg_100201
Lpfc_100200:
    buffer_load_dword v12, off, s[4:7], s21 sc1
    s_waitcnt vmcnt(0)
    v_cmp_ne_u32 vcc, 15, v12
    s_cbranch_vccz Lpfcg_100201
    s_sleep 2
    s_sub_u32 s24, s24, 1
    s_cbranch_scc1 Lexit2_100184
    s_branch Lpfc_100200
Lpfcg_100201:
    s_add_u32 s21, s21, 16384
    buffer_load_dword v12, off, s[4:7], s21 sc1
    s_add_u32 s19, s19, 8192
    buffer_load_dword v4, v2, s[4:7], s19 offen sc1
    buffer_load_dword v5, v1, s[4:7], s22 offen sc1
    s_add_u32 s25, s23, 0
    buffer_load_dword v6, v1, s[4:7], s25 offen sc1
    s_add_u32 s25, s23, 65536
    buffer_load_dword v7, v1, s[4:7], s25 offen sc1
    s_add_u32 s22, s22, s27
    s_add_u32 s23, s23, 458752
    s_waitcnt vmcnt(3)
    s_add_u32 s18, s18, 1
    s_cmp_lt_u32 s18, 64
    s_cbranch_scc1 Lpfstep_100195
    s_endpgm
LroleV_100024:
    v_and_b32 v1, 63, v0
    v_lshrrev_b32 v2, 4, v1
    v_and_b32 v3, 15, v1
    v_lshlrev_b32 v4, 4, v1
    s_mul_i32 s57, s17, 16384
    s_lshr_b32 s57, s57, 16
    s_mul_i32 s56, s57, 4
    s_sub_u32 s56, s17, s56
    s_mov_b32 s60, s56
    s_mov_b32 s62, 0
    s_mov_b32 s61, 0x40000000
    s_mov_b32 s24, 300000
    s_mul_i32 s25, s56, 28672
    s_mul_i32 s26, s16, 7168
    s_add_u32 s25, s25, s26
    s_mul_i32 s26, s16, 7296
    s_add_u32 s26, s26, s62
    s_mov_b32 exec_hi, 0x00ffffff
    s_mov_b32 m0, s26
    s_add_u32 s26, s26, 912
    buffer_load_dwordx4 v4, s[8:11], s25 offen lds
    s_add_u32 s25, s25, 896
    s_mov_b32 m0, s26
    s_add_u32 s26, s26, 912
    buffer_load_dwordx4 v4, s[8:11], s25 offen lds
    s_add_u32 s25, s25, 896
    s_mov_b32 m0, s26
    s_add_u32 s26, s26, 912
    buffer_load_dwordx4 v4, s[8:11], s25 offen lds
    s_add_u32 s25, s25, 896
    s_mov_b32 m0, s26
    s_add_u32 s26, s26, 912
    buffer_load_dwordx4 v4, s[8:11], s25 offen lds
    s_add_u32 s25, s25, 896
    s_mov_b32 m0, s26
    s_add_u32 s26, s26, 912
    buffer_load_dwordx4 v4, s[8:11], s25 offen lds
    s_add_u32 s25, s25, 896
    s_mov_b32 m0, s26
    s_add_u32 s26, s26, 912
    buffer_load_dwordx4 v4, s[8:11], s25 offen lds
    s_add_u32 s25, s25, 896
    s_mov_b32 m0, s26
    s_add_u32 s26, s26, 912
    buffer_load_dwordx4 v4, s[8:11], s25 offen lds
    s_add_u32 s25, s25, 896
    s_mov_b32 m0, s26
    s_add_u32 s26, s26, 912
    buffer_load_dwordx4 v4, s[8:11], s25 offen lds
    s_add_u32 s25, s25, 896
    s_mov_b32 exec_hi, -1
    s_mov_b32 s62, 32768
    s_add_u32 s58, s56, 4
    s_mul_i32 s25, s58, 28672
    s_mul_i32 s26, s16, 7168
    s_add_u32 s25, s25, s26
    s_mul_i32 s26, s16, 7296
    s_add_u32 s26, s26, s62
    s_mov_b32 exec_hi, 0x00ffffff
    s_mov_b32 m0, s26
    s_add_u32 s26, s26, 912
    buffer_load_dwordx4 v4, s[8:11], s25 offen lds
    s_add_u32 s25, s25, 896
    s_mov_b32 m0, s26
    s_add_u32 s26, s26, 912
    buffer_load_dwordx4 v4, s[8:11], s25 offen lds
    s_add_u32 s25, s25, 896
    s_mov_b32 m0, s26
    s_add_u32 s26, s26, 912
    buffer_load_dwordx4 v4, s[8:11], s25 offen lds
    s_add_u32 s25, s25, 896
    s_mov_b32 m0, s26
    s_add_u32 s26, s26, 912
    buffer_load_dwordx4 v4, s[8:11], s25 offen lds
    s_add_u32 s25, s25, 896
    s_mov_b32 m0, s26
    s_add_u32 s26, s26, 912
    buffer_load_dwordx4 v4, s[8:11], s25 offen lds
    s_add_u32 s25, s25, 896
    s_mov_b32 m0, s26
    s_add_u32 s26, s26, 912
    buffer_load_dwordx4 v4, s[8:11], s25 offen lds
    s_add_u32 s25, s25, 896
    s_mov_b32 m0, s26
    s_add_u32 s26, s26, 912
    buffer_load_dwordx4 v4, s[8:11], s25 offen lds
    s_add_u32 s25, s25, 896
    s_mov_b32 m0, s26
    s_add_u32 s26, s26, 912
    buffer_load_dwordx4 v4, s[8:11], s25 offen lds
    s_add_u32 s25, s25, 896
    s_mov_b32 exec_hi, -1
    v_lshrrev_b32 v5, 3, v3
    v_lshlrev_b32 v11, 4, v5
    v_and_b32 v5, 3, v3
    v_lshl_add_u32 v11, v5, 2, v11
    v_bfe_u32 v5, v3, 2, 1
    v_lshl_add_u32 v11, v5, 1, v11
    v_mul_u32_u24 v11, 912, v11
    v_mul_u32_u24 v5, 224, v2
    v_add_u32 v11, v11, v5
    s_cmp_ge_u32 s57, 7
    s_cselect_b32 s25, 688, 0
    s_lshl_b32 s26, s57, 5
    s_add_u32 s25, s25, s26
    v_add_u32 v11, s25, v11
    s_lshl_b32 s63, s57, 11
    s_add_u32 s63, s63, 0x3800000
    s_cmp_lt_u32 s57, 14
    s_cselect_b32 s63, s63, 0x40000000
    s_cmp_eq_u32 s16, 3
    s_cselect_b32 s63, s63, 0x40000000
    v_lshrrev_b32 v5, 2, v3
    v_lshlrev_b32 v6, 3, v5
    v_and_b32 v5, 3, v3
    v_add_u32 v6, v6, v5
    v_mul_u32_u24 v6, 912, v6
    v_lshl_add_u32 v6, v2, 4, v6
    v_add_u32 v7, 3648, v6
    v_and_b32 v5, 1, v3
    v_mul_u32_u24 v10, 0xAAAA, v5
    v_lshrrev_b32 v5, 3, v3
    v_mul_u32_u24 v5, 0xAAAA, v5
    v_lshl_add_u32 v10, v5, 16, v10
    v_add_u32 v10, 0x44444444, v10
    v_mov_b32 v8, v6
    v_mov_b32 v9, v7
    v_mov_b32 v12, v11
    s_waitcnt vmcnt(0)
    s_add_u32 s58, s57, 16
    s_barrier
    s_lshr_b32 s68, s58, 3
    s_and_b32 s69, s58, 7
    s_lshl_b32 s69, s69, 3
    s_add_u32 s69, s69, s16
    s_mov_b64 exec, 0x11
    s_lshl_b64 exec, exec, s69
    v_mov_b32 v15, v232
    s_mov_b32 s70, 64
    s_cmp_eq_u32 s68, 1
    s_cselect_b64 vcc, -1, 0
    v_cndmask_b32 v15, v15, v233, vcc
    s_cmp_eq_u32 s68, 2
    s_cselect_b64 vcc, -1, 0
    v_cndmask_b32 v15, v15, v234, vcc
    s_cmp_eq_u32 s68, 3
    s_cselect_b64 vcc, -1, 0
    v_cndmask_b32 v15, v15, v235, vcc
    s_lshl_b32 s68, s68, 11
    s_add_u32 s68, s68, 0x3d40000
LVww_100204:
    buffer_load_dword v14, v237, s[4:7], s68 offen sc1
    s_waitcnt vmcnt(0)
    v_cmp_eq_u32 vcc, v14, v15
    s_cbranch_vccz LVwg_100205
    s_sleep 12
    s_sub_u32 s70, s70, 1
    s_cbranch_scc0 LVww_100204
    s_mov_b64 exec, -1
    v_and_b32 v15, 31, v0
    v_lshlrev_b32 v15, 2, v15
LVwf_100206:
    buffer_load_dword v14, v15, s[12:15], 0 offen offset:64 sc1
    s_waitcnt vmcnt(0)
    v_cmp_gt_u32 vcc, 8, v14
    s_cbranch_vccz LVwg_100205
    s_sleep 30
    s_sub_u32 s24, s24, 1
    s_cbranch_scc1 Lexit2_100184
    s_branch LVwf_100206
LVwg_100205:
    s_mov_b64 exec, -1
    s_mul_i32 s25, s57, 401408
    s_mul_i32 s26, s16, 100352
    s_add_u32 s25, s25, s26
    s_add_u32 s25, s25, 0x700000
    s_add_u32 s26, s25, 0
    buffer_load_dwordx4 a[0:3], v4, s[4:7], s26 offen sc1
    s_add_u32 s26, s25, 14336
    buffer_load_dwordx4 a[56:59], v4, s[4:7], s26 offen sc1
    s_add_u32 s26, s25, 28672
    buffer_load_dwordx4 a[112:115], v4, s[4:7], s26 offen sc1
    s_add_u32 s26, s25, 43008
    buffer_load_dwordx4 a[168:171], v4, s[4:7], s26 offen sc1
    s_add_u32 s26, s25, 57344
    buffer_load_dwordx4 a[224:227], v4, s[4:7], s26 offen sc1
    s_add_u32 s26, s25, 71680
    buffer_load_dwordx4 v[144:147], v4, s[4:7], s26 offen sc1
    s_add_u32 s26, s25, 86016
    buffer_load_dwordx4 v[200:203], v4, s[4:7], s26 offen sc1
    s_add_u32 s26, s25, 1024
    buffer_load_dwordx4 a[4:7], v4, s[4:7], s26 offen sc1
    s_add_u32 s26, s25, 15360
    buffer_load_dwordx4 a[60:63], v4, s[4:7], s26 offen sc1
    s_add_u32 s26, s25, 29696
    buffer_load_dwordx4 a[116:119], v4, s[4:7], s26 offen sc1
    s_add_u32 s26, s25, 44032
    buffer_load_dwordx4 a[172:175], v4, s[4:7], s26 offen sc1
    s_add_u32 s26, s25, 58368
    buffer_load_dwordx4 a[228:231], v4, s[4:7], s26 offen sc1
    s_add_u32 s26, s25, 72704
    buffer_load_dwordx4 v[148:151], v4, s[4:7], s26 offen sc1
    s_add_u32 s26, s25, 87040
    buffer_load_dwordx4 v[204:207], v4, s[4:7], s26 offen sc1
    s_add_u32 s26, s25, 2048
    buffer_load_dwordx4 a[8:11], v4, s[4:7], s26 offen sc1
    s_add_u32 s26, s25, 16384
    buffer_load_dwordx4 a[64:67], v4, s[4:7], s26 offen sc1
    s_add_u32 s26, s25, 30720
    buffer_load_dwordx4 a[120:123], v4, s[4:7], s26 offen sc1
    s_add_u32 s26, s25, 45056
    buffer_load_dwordx4 a[176:179], v4, s[4:7], s26 offen sc1
    s_add_u32 s26, s25, 59392
    buffer_load_dwordx4 a[232:235], v4, s[4:7], s26 offen sc1
    s_add_u32 s26, s25, 73728
    buffer_load_dwordx4 v[152:155], v4, s[4:7], s26 offen sc1
    s_add_u32 s26, s25, 88064
    buffer_load_dwordx4 v[208:211], v4, s[4:7], s26 offen sc1
    s_add_u32 s26, s25, 3072
    buffer_load_dwordx4 a[12:15], v4, s[4:7], s26 offen sc1
    s_add_u32 s26, s25, 17408
    buffer_load_dwordx4 a[68:71], v4, s[4:7], s26 offen sc1
    s_add_u32 s26, s25, 31744
    buffer_load_dwordx4 a[124:127], v4, s[4:7], s26 offen sc1
    s_add_u32 s26, s25, 46080
    buffer_load_dwordx4 a[180:183], v4, s[4:7], s26 offen sc1
    s_add_u32 s26, s25, 60416
    buffer_load_dwordx4 a[236:239], v4, s[4:7], s26 offen sc1
    s_add_u32 s26, s25, 74752
    buffer_load_dwordx4 v[156:159], v4, s[4:7], s26 offen sc1
    s_add_u32 s26, s25, 89088
    buffer_load_dwordx4 v[212:215], v4, s[4:7], s26 offen sc1
    s_add_u32 s26, s25, 4096
    buffer_load_dwordx4 a[16:19], v4, s[4:7], s26 offen sc1
    s_add_u32 s26, s25, 18432
    buffer_load_dwordx4 a[72:75], v4, s[4:7], s26 offen sc1
    s_add_u32 s26, s25, 32768
    buffer_load_dwordx4 a[128:131], v4, s[4:7], s26 offen sc1
    s_add_u32 s26, s25, 47104
    buffer_load_dwordx4 a[184:187], v4, s[4:7], s26 offen sc1
    s_add_u32 s26, s25, 61440
    buffer_load_dwordx4 a[240:243], v4, s[4:7], s26 offen sc1
    s_add_u32 s26, s25, 75776
    buffer_load_dwordx4 v[160:163], v4, s[4:7], s26 offen sc1
    s_add_u32 s26, s25, 90112
    buffer_load_dwordx4 v[216:219], v4, s[4:7], s26 offen sc1
    ds_read_b128 v[72:75], v8 offset:0
    ds_read_b128 v[76:79], v9 offset:0
    s_add_u32 s26, s25, 5120
    buffer_load_dwordx4 a[20:23], v4, s[4:7], s26 offen sc1
    s_add_u32 s26, s25, 19456
    buffer_load_dwordx4 a[76:79], v4, s[4:7], s26 offen sc1
    s_add_u32 s26, s25, 33792
    buffer_load_dwordx4 a[132:135], v4, s[4:7], s26 offen sc1
    s_add_u32 s26, s25, 48128
    buffer_load_dwordx4 a[188:191], v4, s[4:7], s26 offen sc1
    s_add_u32 s26, s25, 62464
    buffer_load_dwordx4 a[244:247], v4, s[4:7], s26 offen sc1
    s_add_u32 s26, s25, 76800
    buffer_load_dwordx4 v[164:167], v4, s[4:7], s26 offen sc1
    s_add_u32 s26, s25, 91136
    buffer_load_dwordx4 v[220:223], v4, s[4:7], s26 offen sc1
    s_waitcnt vmcnt(35)
    ds_read_b128 v[80:83], v8 offset:64
    ds_read_b128 v[84:87], v9 offset:64
    s_waitcnt lgkmcnt(2)
    v_mfma_f32_16x16x32_bf16 v[16:19], v[72:75], a[0:3], 0
    v_mfma_f32_16x16x32_bf16 v[20:23], v[76:79], a[0:3], 0
    v_mfma_f32_16x16x32_bf16 v[24:27], v[72:75], a[56:59], 0
    v_mfma_f32_16x16x32_bf16 v[28:31], v[76:79], a[56:59], 0
    v_mfma_f32_16x16x32_bf16 v[32:35], v[72:75], a[112:115], 0
    v_mfma_f32_16x16x32_bf16 v[36:39], v[76:79], a[112:115], 0
    v_mfma_f32_16x16x32_bf16 v[40:43], v[72:75], a[168:171], 0
    v_mfma_f32_16x16x32_bf16 v[44:47], v[76:79], a[168:171], 0
    v_mfma_f32_16x16x32_bf16 v[48:51], v[72:75], a[224:227], 0
    v_mfma_f32_16x16x32_bf16 v[52:55], v[76:79], a[224:227], 0
    v_mfma_f32_16x16x32_bf16 v[56:59], v[72:75], v[144:147], 0
    v_mfma_f32_16x16x32_bf16 v[60:63], v[76:79], v[144:147], 0
    v_mfma_f32_16x16x32_bf16 v[64:67], v[72:75], v[200:203], 0
    v_mfma_f32_16x16x32_bf16 v[68:71], v[76:79], v[200:203], 0
    s_add_u32 s26, s25, 6144
    buffer_load_dwordx4 a[24:27], v4, s[4:7], s26 offen sc1
    s_add_u32 s26, s25, 20480
    buffer_load_dwordx4 a[80:83], v4, s[4:7], s26 offen sc1
    s_add_u32 s26, s25, 34816
    buffer_load_dwordx4 a[136:139], v4, s[4:7], s26 offen sc1
    s_add_u32 s26, s25, 49152
    buffer_load_dwordx4 a[192:195], v4, s[4:7], s26 offen sc1
    s_add_u32 s26, s25, 63488
    buffer_load_dwordx4 a[248:251], v4, s[4:7], s26 offen sc1
    s_add_u32 s26, s25, 77824
    buffer_load_dwordx4 v[168:171], v4, s[4:7], s26 offen sc1
    s_add_u32 s26, s25, 92160
    buffer_load_dwordx4 v[224:227], v4, s[4:7], s26 offen sc1
    s_waitcnt vmcnt(35)
    ds_read_b128 v[72:75], v8 offset:128
    ds_read_b128 v[76:79], v9 offset:128
    s_waitcnt lgkmcnt(2)
    v_mfma_f32_16x16x32_bf16 v[16:19], v[80:83], a[4:7], v[16:19]
    v_mfma_f32_16x16x32_bf16 v[20:23], v[84:87], a[4:7], v[20:23]
    v_mfma_f32_16x16x32_bf16 v[24:27], v[80:83], a[60:63], v[24:27]
    v_mfma_f32_16x16x32_bf16 v[28:31], v[84:87], a[60:63], v[28:31]
    v_mfma_f32_16x16x32_bf16 v[32:35], v[80:83], a[116:119], v[32:35]
    v_mfma_f32_16x16x32_bf16 v[36:39], v[84:87], a[116:119], v[36:39]
    v_mfma_f32_16x16x32_bf16 v[40:43], v[80:83], a[172:175], v[40:43]
    v_mfma_f32_16x16x32_bf16 v[44:47], v[84:87], a[172:175], v[44:47]
    v_mfma_f32_16x16x32_bf16 v[48:51], v[80:83], a[228:231], v[48:51]
    v_mfma_f32_16x16x32_bf16 v[52:55], v[84:87], a[228:231], v[52:55]
    v_mfma_f32_16x16x32_bf16 v[56:59], v[80:83], v[148:151], v[56:59]
    v_mfma_f32_16x16x32_bf16 v[60:63], v[84:87], v[148:151], v[60:63]
    v_mfma_f32_16x16x32_bf16 v[64:67], v[80:83], v[204:207], v[64:67]
    v_mfma_f32_16x16x32_bf16 v[68:71], v[84:87], v[204:207], v[68:71]
    s_add_u32 s26, s25, 7168
    buffer_load_dwordx4 a[28:31], v4, s[4:7], s26 offen sc1
    s_add_u32 s26, s25, 21504
    buffer_load_dwordx4 a[84:87], v4, s[4:7], s26 offen sc1
    s_add_u32 s26, s25, 35840
    buffer_load_dwordx4 a[140:143], v4, s[4:7], s26 offen sc1
    s_add_u32 s26, s25, 50176
    buffer_load_dwordx4 a[196:199], v4, s[4:7], s26 offen sc1
    s_add_u32 s26, s25, 64512
    buffer_load_dwordx4 a[252:255], v4, s[4:7], s26 offen sc1
    s_add_u32 s26, s25, 78848
    buffer_load_dwordx4 v[172:175], v4, s[4:7], s26 offen sc1
    s_add_u32 s26, s25, 93184
    buffer_load_dwordx4 v[228:231], v4, s[4:7], s26 offen sc1
    s_waitcnt vmcnt(35)
    ds_read_b128 v[80:83], v8 offset:192
    ds_read_b128 v[84:87], v9 offset:192
    s_waitcnt lgkmcnt(2)
    v_mfma_f32_16x16x32_bf16 v[16:19], v[72:75], a[8:11], v[16:19]
    v_mfma_f32_16x16x32_bf16 v[20:23], v[76:79], a[8:11], v[20:23]
    v_mfma_f32_16x16x32_bf16 v[24:27], v[72:75], a[64:67], v[24:27]
    v_mfma_f32_16x16x32_bf16 v[28:31], v[76:79], a[64:67], v[28:31]
    v_mfma_f32_16x16x32_bf16 v[32:35], v[72:75], a[120:123], v[32:35]
    v_mfma_f32_16x16x32_bf16 v[36:39], v[76:79], a[120:123], v[36:39]
    v_mfma_f32_16x16x32_bf16 v[40:43], v[72:75], a[176:179], v[40:43]
    v_mfma_f32_16x16x32_bf16 v[44:47], v[76:79], a[176:179], v[44:47]
    v_mfma_f32_16x16x32_bf16 v[48:51], v[72:75], a[232:235], v[48:51]
    v_mfma_f32_16x16x32_bf16 v[52:55], v[76:79], a[232:235], v[52:55]
    v_mfma_f32_16x16x32_bf16 v[56:59], v[72:75], v[152:155], v[56:59]
    v_mfma_f32_16x16x32_bf16 v[60:63], v[76:79], v[152:155], v[60:63]
    v_mfma_f32_16x16x32_bf16 v[64:67], v[72:75], v[208:211], v[64:67]
    v_mfma_f32_16x16x32_bf16 v[68:71], v[76:79], v[208:211], v[68:71]
    s_add_u32 s26, s25, 8192
    buffer_load_dwordx4 a[32:35], v4, s[4:7], s26 offen sc1
    s_add_u32 s26, s25, 22528
    buffer_load_dwordx4 a[88:91], v4, s[4:7], s26 offen sc1
    s_add_u32 s26, s25, 36864
    buffer_load_dwordx4 a[144:147], v4, s[4:7], s26 offen sc1
    s_add_u32 s26, s25, 51200
    buffer_load_dwordx4 a[200:203], v4, s[4:7], s26 offen sc1
    s_add_u32 s26, s25, 65536
    buffer_load_dwordx4 v[120:123], v4, s[4:7], s26 offen sc1
    s_add_u32 s26, s25, 79872
    buffer_load_dwordx4 v[176:179], v4, s[4:7], s26 offen sc1
    s_add_u32 s26, s25, 94208
    buffer_load_dwordx4 v[232:235], v4, s[4:7], s26 offen sc1
    s_waitcnt vmcnt(35)
    ds_read_b128 v[72:75], v8 offset:256
    ds_read_b128 v[76:79], v9 offset:256
    s_waitcnt lgkmcnt(2)
    v_mfma_f32_16x16x32_bf16 v[16:19], v[80:83], a[12:15], v[16:19]
    v_mfma_f32_16x16x32_bf16 v[20:23], v[84:87], a[12:15], v[20:23]
    v_mfma_f32_16x16x32_bf16 v[24:27], v[80:83], a[68:71], v[24:27]
    v_mfma_f32_16x16x32_bf16 v[28:31], v[84:87], a[68:71], v[28:31]
    v_mfma_f32_16x16x32_bf16 v[32:35], v[80:83], a[124:127], v[32:35]
    v_mfma_f32_16x16x32_bf16 v[36:39], v[84:87], a[124:127], v[36:39]
    v_mfma_f32_16x16x32_bf16 v[40:43], v[80:83], a[180:183], v[40:43]
    v_mfma_f32_16x16x32_bf16 v[44:47], v[84:87], a[180:183], v[44:47]
    v_mfma_f32_16x16x32_bf16 v[48:51], v[80:83], a[236:239], v[48:51]
    v_mfma_f32_16x16x32_bf16 v[52:55], v[84:87], a[236:239], v[52:55]
    v_mfma_f32_16x16x32_bf16 v[56:59], v[80:83], v[156:159], v[56:59]
    v_mfma_f32_16x16x32_bf16 v[60:63], v[84:87], v[156:159], v[60:63]
    v_mfma_f32_16x16x32_bf16 v[64:67], v[80:83], v[212:215], v[64:67]
    v_mfma_f32_16x16x32_bf16 v[68:71], v[84:87], v[212:215], v[68:71]
    s_add_u32 s26, s25, 9216
    buffer_load_dwordx4 a[36:39], v4, s[4:7], s26 offen sc1
    s_add_u32 s26, s25, 23552
    buffer_load_dwordx4 a[92:95], v4, s[4:7], s26 offen sc1
    s_add_u32 s26, s25, 37888
    buffer_load_dwordx4 a[148:151], v4, s[4:7], s26 offen sc1
    s_add_u32 s26, s25, 52224
    buffer_load_dwordx4 a[204:207], v4, s[4:7], s26 offen sc1
    s_add_u32 s26, s25, 66560
    buffer_load_dwordx4 v[124:127], v4, s[4:7], s26 offen sc1
    s_add_u32 s26, s25, 80896
    buffer_load_dwordx4 v[180:183], v4, s[4:7], s26 offen sc1
    s_add_u32 s26, s25, 95232
    buffer_load_dwordx4 v[236:239], v4, s[4:7], s26 offen sc1
    s_waitcnt vmcnt(35)
    ds_read_b128 v[80:83], v8 offset:320
    ds_read_b128 v[84:87], v9 offset:320
    s_waitcnt lgkmcnt(2)
    v_mfma_f32_16x16x32_bf16 v[16:19], v[72:75], a[16:19], v[16:19]
    v_mfma_f32_16x16x32_bf16 v[20:23], v[76:79], a[16:19], v[20:23]
    v_mfma_f32_16x16x32_bf16 v[24:27], v[72:75], a[72:75], v[24:27]
    v_mfma_f32_16x16x32_bf16 v[28:31], v[76:79], a[72:75], v[28:31]
    v_mfma_f32_16x16x32_bf16 v[32:35], v[72:75], a[128:131], v[32:35]
    v_mfma_f32_16x16x32_bf16 v[36:39], v[76:79], a[128:131], v[36:39]
    v_mfma_f32_16x16x32_bf16 v[40:43], v[72:75], a[184:187], v[40:43]
    v_mfma_f32_16x16x32_bf16 v[44:47], v[76:79], a[184:187], v[44:47]
    v_mfma_f32_16x16x32_bf16 v[48:51], v[72:75], a[240:243], v[48:51]
    v_mfma_f32_16x16x32_bf16 v[52:55], v[76:79], a[240:243], v[52:55]
    v_mfma_f32_16x16x32_bf16 v[56:59], v[72:75], v[160:163], v[56:59]
    v_mfma_f32_16x16x32_bf16 v[60:63], v[76:79], v[160:163], v[60:63]
    v_mfma_f32_16x16x32_bf16 v[64:67], v[72:75], v[216:219], v[64:67]
    v_mfma_f32_16x16x32_bf16 v[68:71], v[76:79], v[216:219], v[68:71]
    s_add_u32 s26, s25, 10240
    buffer_load_dwordx4 a[40:43], v4, s[4:7], s26 offen sc1
    s_add_u32 s26, s25, 24576
    buffer_load_dwordx4 a[96:99], v4, s[4:7], s26 offen sc1
    s_add_u32 s26, s25, 38912
    buffer_load_dwordx4 a[152:155], v4, s[4:7], s26 offen sc1
    s_add_u32 s26, s25, 53248
    buffer_load_dwordx4 a[208:211], v4, s[4:7], s26 offen sc1
    s_add_u32 s26, s25, 67584
    buffer_load_dwordx4 v[128:131], v4, s[4:7], s26 offen sc1
    s_add_u32 s26, s25, 81920
    buffer_load_dwordx4 v[184:187], v4, s[4:7], s26 offen sc1
    s_add_u32 s26, s25, 96256
    buffer_load_dwordx4 v[240:243], v4, s[4:7], s26 offen sc1
    s_waitcnt vmcnt(35)
    ds_read_b128 v[72:75], v8 offset:384
    ds_read_b128 v[76:79], v9 offset:384
    s_waitcnt lgkmcnt(2)
    v_mfma_f32_16x16x32_bf16 v[16:19], v[80:83], a[20:23], v[16:19]
    v_mfma_f32_16x16x32_bf16 v[20:23], v[84:87], a[20:23], v[20:23]
    v_mfma_f32_16x16x32_bf16 v[24:27], v[80:83], a[76:79], v[24:27]
    v_mfma_f32_16x16x32_bf16 v[28:31], v[84:87], a[76:79], v[28:31]
    v_mfma_f32_16x16x32_bf16 v[32:35], v[80:83], a[132:135], v[32:35]
    v_mfma_f32_16x16x32_bf16 v[36:39], v[84:87], a[132:135], v[36:39]
    v_mfma_f32_16x16x32_bf16 v[40:43], v[80:83], a[188:191], v[40:43]
    v_mfma_f32_16x16x32_bf16 v[44:47], v[84:87], a[188:191], v[44:47]
    v_mfma_f32_16x16x32_bf16 v[48:51], v[80:83], a[244:247], v[48:51]
    v_mfma_f32_16x16x32_bf16 v[52:55], v[84:87], a[244:247], v[52:55]
    v_mfma_f32_16x16x32_bf16 v[56:59], v[80:83], v[164:167], v[56:59]
    v_mfma_f32_16x16x32_bf16 v[60:63], v[84:87], v[164:167], v[60:63]
    v_mfma_f32_16x16x32_bf16 v[64:67], v[80:83], v[220:223], v[64:67]
    v_mfma_f32_16x16x32_bf16 v[68:71], v[84:87], v[220:223], v[68:71]
    s_add_u32 s26, s25, 11264
    buffer_load_dwordx4 a[44:47], v4, s[4:7], s26 offen sc1
    s_add_u32 s26, s25, 25600
    buffer_load_dwordx4 a[100:103], v4, s[4:7], s26 offen sc1
    s_add_u32 s26, s25, 39936
    buffer_load_dwordx4 a[156:159], v4, s[4:7], s26 offen sc1
    s_add_u32 s26, s25, 54272
    buffer_load_dwordx4 a[212:215], v4, s[4:7], s26 offen sc1
    s_add_u32 s26, s25, 68608
    buffer_load_dwordx4 v[132:135], v4, s[4:7], s26 offen sc1
    s_add_u32 s26, s25, 82944
    buffer_load_dwordx4 v[188:191], v4, s[4:7], s26 offen sc1
    s_add_u32 s26, s25, 97280
    buffer_load_dwordx4 v[244:247], v4, s[4:7], s26 offen sc1
    s_waitcnt vmcnt(35)
    ds_read_b128 v[80:83], v8 offset:448
    ds_read_b128 v[84:87], v9 offset:448
    s_waitcnt lgkmcnt(2)
    v_mfma_f32_16x16x32_bf16 v[16:19], v[72:75], a[24:27], v[16:19]
    v_mfma_f32_16x16x32_bf16 v[20:23], v[76:79], a[24:27], v[20:23]
    v_mfma_f32_16x16x32_bf16 v[24:27], v[72:75], a[80:83], v[24:27]
    v_mfma_f32_16x16x32_bf16 v[28:31], v[76:79], a[80:83], v[28:31]
    v_mfma_f32_16x16x32_bf16 v[32:35], v[72:75], a[136:139], v[32:35]
    v_mfma_f32_16x16x32_bf16 v[36:39], v[76:79], a[136:139], v[36:39]
    v_mfma_f32_16x16x32_bf16 v[40:43], v[72:75], a[192:195], v[40:43]
    v_mfma_f32_16x16x32_bf16 v[44:47], v[76:79], a[192:195], v[44:47]
    v_mfma_f32_16x16x32_bf16 v[48:51], v[72:75], a[248:251], v[48:51]
    v_mfma_f32_16x16x32_bf16 v[52:55], v[76:79], a[248:251], v[52:55]
    v_mfma_f32_16x16x32_bf16 v[56:59], v[72:75], v[168:171], v[56:59]
    v_mfma_f32_16x16x32_bf16 v[60:63], v[76:79], v[168:171], v[60:63]
    v_mfma_f32_16x16x32_bf16 v[64:67], v[72:75], v[224:227], v[64:67]
    v_mfma_f32_16x16x32_bf16 v[68:71], v[76:79], v[224:227], v[68:71]
    s_add_u32 s26, s25, 12288
    buffer_load_dwordx4 a[48:51], v4, s[4:7], s26 offen sc1
    s_add_u32 s26, s25, 26624
    buffer_load_dwordx4 a[104:107], v4, s[4:7], s26 offen sc1
    s_add_u32 s26, s25, 40960
    buffer_load_dwordx4 a[160:163], v4, s[4:7], s26 offen sc1
    s_add_u32 s26, s25, 55296
    buffer_load_dwordx4 a[216:219], v4, s[4:7], s26 offen sc1
    s_add_u32 s26, s25, 69632
    buffer_load_dwordx4 v[136:139], v4, s[4:7], s26 offen sc1
    s_add_u32 s26, s25, 83968
    buffer_load_dwordx4 v[192:195], v4, s[4:7], s26 offen sc1
    s_add_u32 s26, s25, 98304
    buffer_load_dwordx4 v[248:251], v4, s[4:7], s26 offen sc1
    s_waitcnt vmcnt(35)
    ds_read_b128 v[72:75], v8 offset:512
    ds_read_b128 v[76:79], v9 offset:512
    s_waitcnt lgkmcnt(2)
    v_mfma_f32_16x16x32_bf16 v[16:19], v[80:83], a[28:31], v[16:19]
    v_mfma_f32_16x16x32_bf16 v[20:23], v[84:87], a[28:31], v[20:23]
    v_mfma_f32_16x16x32_bf16 v[24:27], v[80:83], a[84:87], v[24:27]
    v_mfma_f32_16x16x32_bf16 v[28:31], v[84:87], a[84:87], v[28:31]
    v_mfma_f32_16x16x32_bf16 v[32:35], v[80:83], a[140:143], v[32:35]
    v_mfma_f32_16x16x32_bf16 v[36:39], v[84:87], a[140:143], v[36:39]
    v_mfma_f32_16x16x32_bf16 v[40:43], v[80:83], a[196:199], v[40:43]
    v_mfma_f32_16x16x32_bf16 v[44:47], v[84:87], a[196:199], v[44:47]
    v_mfma_f32_16x16x32_bf16 v[48:51], v[80:83], a[252:255], v[48:51]
    v_mfma_f32_16x16x32_bf16 v[52:55], v[84:87], a[252:255], v[52:55]
    v_mfma_f32_16x16x32_bf16 v[56:59], v[80:83], v[172:175], v[56:59]
    v_mfma_f32_16x16x32_bf16 v[60:63], v[84:87], v[172:175], v[60:63]
    v_mfma_f32_16x16x32_bf16 v[64:67], v[80:83], v[228:231], v[64:67]
    v_mfma_f32_16x16x32_bf16 v[68:71], v[84:87], v[228:231], v[68:71]
    s_add_u32 s26, s25, 13312
    buffer_load_dwordx4 a[52:55], v4, s[4:7], s26 offen sc1
    s_add_u32 s26, s25, 27648
    buffer_load_dwordx4 a[108:111], v4, s[4:7], s26 offen sc1
    s_add_u32 s26, s25, 41984
    buffer_load_dwordx4 a[164:167], v4, s[4:7], s26 offen sc1
    s_add_u32 s26, s25, 56320
    buffer_load_dwordx4 a[220:223], v4, s[4:7], s26 offen sc1
    s_add_u32 s26, s25, 70656
    buffer_load_dwordx4 v[140:143], v4, s[4:7], s26 offen sc1
    s_add_u32 s26, s25, 84992
    buffer_load_dwordx4 v[196:199], v4, s[4:7], s26 offen sc1
    s_add_u32 s26, s25, 99328
    buffer_load_dwordx4 v[252:255], v4, s[4:7], s26 offen sc1
    s_waitcnt vmcnt(35)
    ds_read_b128 v[80:83], v8 offset:576
    ds_read_b128 v[84:87], v9 offset:576
    s_waitcnt lgkmcnt(2)
    v_mfma_f32_16x16x32_bf16 v[16:19], v[72:75], a[32:35], v[16:19]
    v_mfma_f32_16x16x32_bf16 v[20:23], v[76:79], a[32:35], v[20:23]
    v_mfma_f32_16x16x32_bf16 v[24:27], v[72:75], a[88:91], v[24:27]
    v_mfma_f32_16x16x32_bf16 v[28:31], v[76:79], a[88:91], v[28:31]
    v_mfma_f32_16x16x32_bf16 v[32:35], v[72:75], a[144:147], v[32:35]
    v_mfma_f32_16x16x32_bf16 v[36:39], v[76:79], a[144:147], v[36:39]
    v_mfma_f32_16x16x32_bf16 v[40:43], v[72:75], a[200:203], v[40:43]
    v_mfma_f32_16x16x32_bf16 v[44:47], v[76:79], a[200:203], v[44:47]
    v_mfma_f32_16x16x32_bf16 v[48:51], v[72:75], v[120:123], v[48:51]
    v_mfma_f32_16x16x32_bf16 v[52:55], v[76:79], v[120:123], v[52:55]
    v_mfma_f32_16x16x32_bf16 v[56:59], v[72:75], v[176:179], v[56:59]
    v_mfma_f32_16x16x32_bf16 v[60:63], v[76:79], v[176:179], v[60:63]
    v_mfma_f32_16x16x32_bf16 v[64:67], v[72:75], v[232:235], v[64:67]
    v_mfma_f32_16x16x32_bf16 v[68:71], v[76:79], v[232:235], v[68:71]
    s_waitcnt vmcnt(28)
    ds_read_b128 v[72:75], v8 offset:640
    ds_read_b128 v[76:79], v9 offset:640
    s_waitcnt lgkmcnt(2)
    v_mfma_f32_16x16x32_bf16 v[16:19], v[80:83], a[36:39], v[16:19]
    v_mfma_f32_16x16x32_bf16 v[20:23], v[84:87], a[36:39], v[20:23]
    v_mfma_f32_16x16x32_bf16 v[24:27], v[80:83], a[92:95], v[24:27]
    v_mfma_f32_16x16x32_bf16 v[28:31], v[84:87], a[92:95], v[28:31]
    v_mfma_f32_16x16x32_bf16 v[32:35], v[80:83], a[148:151], v[32:35]
    v_mfma_f32_16x16x32_bf16 v[36:39], v[84:87], a[148:151], v[36:39]
    v_mfma_f32_16x16x32_bf16 v[40:43], v[80:83], a[204:207], v[40:43]
    v_mfma_f32_16x16x32_bf16 v[44:47], v[84:87], a[204:207], v[44:47]
    v_mfma_f32_16x16x32_bf16 v[48:51], v[80:83], v[124:127], v[48:51]
    v_mfma_f32_16x16x32_bf16 v[52:55], v[84:87], v[124:127], v[52:55]
    v_mfma_f32_16x16x32_bf16 v[56:59], v[80:83], v[180:183], v[56:59]
    v_mfma_f32_16x16x32_bf16 v[60:63], v[84:87], v[180:183], v[60:63]
    v_mfma_f32_16x16x32_bf16 v[64:67], v[80:83], v[236:239], v[64:67]
    v_mfma_f32_16x16x32_bf16 v[68:71], v[84:87], v[236:239], v[68:71]
    s_waitcnt vmcnt(21)
    ds_read_b128 v[80:83], v8 offset:704
    ds_read_b128 v[84:87], v9 offset:704
    s_waitcnt lgkmcnt(2)
    v_mfma_f32_16x16x32_bf16 v[16:19], v[72:75], a[40:43], v[16:19]
    v_mfma_f32_16x16x32_bf16 v[20:23], v[76:79], a[40:43], v[20:23]
    v_mfma_f32_16x16x32_bf16 v[24:27], v[72:75], a[96:99], v[24:27]
    v_mfma_f32_16x16x32_bf16 v[28:31], v[76:79], a[96:99], v[28:31]
    v_mfma_f32_16x16x32_bf16 v[32:35], v[72:75], a[152:155], v[32:35]
    v_mfma_f32_16x16x32_bf16 v[36:39], v[76:79], a[152:155], v[36:39]
    v_mfma_f32_16x16x32_bf16 v[40:43], v[72:75], a[208:211], v[40:43]
    v_mfma_f32_16x16x32_bf16 v[44:47], v[76:79], a[208:211], v[44:47]
    v_mfma_f32_16x16x32_bf16 v[48:51], v[72:75], v[128:131], v[48:51]
    v_mfma_f32_16x16x32_bf16 v[52:55], v[76:79], v[128:131], v[52:55]
    v_mfma_f32_16x16x32_bf16 v[56:59], v[72:75], v[184:187], v[56:59]
    v_mfma_f32_16x16x32_bf16 v[60:63], v[76:79], v[184:187], v[60:63]
    v_mfma_f32_16x16x32_bf16 v[64:67], v[72:75], v[240:243], v[64:67]
    v_mfma_f32_16x16x32_bf16 v[68:71], v[76:79], v[240:243], v[68:71]
    s_waitcnt vmcnt(14)
    ds_read_b128 v[72:75], v8 offset:768
    ds_read_b128 v[76:79], v9 offset:768
    s_waitcnt lgkmcnt(2)
    v_mfma_f32_16x16x32_bf16 v[16:19], v[80:83], a[44:47], v[16:19]
    v_mfma_f32_16x16x32_bf16 v[20:23], v[84:87], a[44:47], v[20:23]
    v_mfma_f32_16x16x32_bf16 v[24:27], v[80:83], a[100:103], v[24:27]
    v_mfma_f32_16x16x32_bf16 v[28:31], v[84:87], a[100:103], v[28:31]
    v_mfma_f32_16x16x32_bf16 v[32:35], v[80:83], a[156:159], v[32:35]
    v_mfma_f32_16x16x32_bf16 v[36:39], v[84:87], a[156:159], v[36:39]
    v_mfma_f32_16x16x32_bf16 v[40:43], v[80:83], a[212:215], v[40:43]
    v_mfma_f32_16x16x32_bf16 v[44:47], v[84:87], a[212:215], v[44:47]
    v_mfma_f32_16x16x32_bf16 v[48:51], v[80:83], v[132:135], v[48:51]
    v_mfma_f32_16x16x32_bf16 v[52:55], v[84:87], v[132:135], v[52:55]
    v_mfma_f32_16x16x32_bf16 v[56:59], v[80:83], v[188:191], v[56:59]
    v_mfma_f32_16x16x32_bf16 v[60:63], v[84:87], v[188:191], v[60:63]
    v_mfma_f32_16x16x32_bf16 v[64:67], v[80:83], v[244:247], v[64:67]
    v_mfma_f32_16x16x32_bf16 v[68:71], v[84:87], v[244:247], v[68:71]
    s_waitcnt vmcnt(7)
    ds_read_b128 v[80:83], v8 offset:832
    ds_read_b128 v[84:87], v9 offset:832
    s_waitcnt lgkmcnt(2)
    v_mfma_f32_16x16x32_bf16 v[16:19], v[72:75], a[48:51], v[16:19]
    v_mfma_f32_16x16x32_bf16 v[20:23], v[76:79], a[48:51], v[20:23]
    v_mfma_f32_16x16x32_bf16 v[24:27], v[72:75], a[104:107], v[24:27]
    v_mfma_f32_16x16x32_bf16 v[28:31], v[76:79], a[104:107], v[28:31]
    v_mfma_f32_16x16x32_bf16 v[32:35], v[72:75], a[160:163], v[32:35]
    v_mfma_f32_16x16x32_bf16 v[36:39], v[76:79], a[160:163], v[36:39]
    v_mfma_f32_16x16x32_bf16 v[40:43], v[72:75], a[216:219], v[40:43]
    v_mfma_f32_16x16x32_bf16 v[44:47], v[76:79], a[216:219], v[44:47]
    v_mfma_f32_16x16x32_bf16 v[48:51], v[72:75], v[136:139], v[48:51]
    v_mfma_f32_16x16x32_bf16 v[52:55], v[76:79], v[136:139], v[52:55]
    v_mfma_f32_16x16x32_bf16 v[56:59], v[72:75], v[192:195], v[56:59]
    v_mfma_f32_16x16x32_bf16 v[60:63], v[76:79], v[192:195], v[60:63]
    v_mfma_f32_16x16x32_bf16 v[64:67], v[72:75], v[248:251], v[64:67]
    v_mfma_f32_16x16x32_bf16 v[68:71], v[76:79], v[248:251], v[68:71]
    s_waitcnt vmcnt(0)
    s_waitcnt lgkmcnt(0)
    v_mfma_f32_16x16x32_bf16 v[16:19], v[80:83], a[52:55], v[16:19]
    v_mfma_f32_16x16x32_bf16 v[20:23], v[84:87], a[52:55], v[20:23]
    v_mfma_f32_16x16x32_bf16 v[24:27], v[80:83], a[108:111], v[24:27]
    v_mfma_f32_16x16x32_bf16 v[28:31], v[84:87], a[108:111], v[28:31]
    v_mfma_f32_16x16x32_bf16 v[32:35], v[80:83], a[164:167], v[32:35]
    v_mfma_f32_16x16x32_bf16 v[36:39], v[84:87], a[164:167], v[36:39]
    v_mfma_f32_16x16x32_bf16 v[40:43], v[80:83], a[220:223], v[40:43]
    v_mfma_f32_16x16x32_bf16 v[44:47], v[84:87], a[220:223], v[44:47]
    v_mfma_f32_16x16x32_bf16 v[48:51], v[80:83], v[140:143], v[48:51]
    v_mfma_f32_16x16x32_bf16 v[52:55], v[84:87], v[140:143], v[52:55]
    v_mfma_f32_16x16x32_bf16 v[56:59], v[80:83], v[196:199], v[56:59]
    v_mfma_f32_16x16x32_bf16 v[60:63], v[84:87], v[196:199], v[60:63]
    v_mfma_f32_16x16x32_bf16 v[64:67], v[80:83], v[252:255], v[64:67]
    v_mfma_f32_16x16x32_bf16 v[68:71], v[84:87], v[252:255], v[68:71]
    s_branch LVepi_100203
LVloop_100202:
    v_add_u32 v8, s62, v6
    v_add_u32 v9, s62, v7
    v_add_u32 v12, s62, v11
    s_xor_b32 s62, s62, 32768
    s_add_u32 s58, s56, 4
    s_mul_i32 s71, s58, 28672
    s_mul_i32 s72, s16, 7168
    s_add_u32 s71, s71, s72
    s_mul_i32 s72, s16, 7296
    s_add_u32 s72, s72, s62
    ds_read_b128 v[72:75], v8 offset:0
    ds_read_b128 v[76:79], v9 offset:0
    s_mov_b32 m0, s72
    s_mov_b32 exec_hi, 0x00ffffff
    buffer_load_dwordx4 v4, s[8:11], s71 offen lds
    s_mov_b32 exec_hi, -1
    s_add_u32 s72, s72, 912
    s_add_u32 s71, s71, 896
    ds_read_b128 v[80:83], v8 offset:64
    ds_read_b128 v[84:87], v9 offset:64
    s_waitcnt lgkmcnt(2)
    v_mfma_f32_16x16x32_bf16 v[16:19], v[72:75], a[0:3], 0
    v_mfma_f32_16x16x32_bf16 v[20:23], v[76:79], a[0:3], 0
    v_mfma_f32_16x16x32_bf16 v[24:27], v[72:75], a[56:59], 0
    v_mfma_f32_16x16x32_bf16 v[28:31], v[76:79], a[56:59], 0
    v_mfma_f32_16x16x32_bf16 v[32:35], v[72:75], a[112:115], 0
    v_mfma_f32_16x16x32_bf16 v[36:39], v[76:79], a[112:115], 0
    v_mfma_f32_16x16x32_bf16 v[40:43], v[72:75], a[168:171], 0
    v_mfma_f32_16x16x32_bf16 v[44:47], v[76:79], a[168:171], 0
    v_mfma_f32_16x16x32_bf16 v[48:51], v[72:75], a[224:227], 0
    v_mfma_f32_16x16x32_bf16 v[52:55], v[76:79], a[224:227], 0
    v_mfma_f32_16x16x32_bf16 v[56:59], v[72:75], v[144:147], 0
    v_mfma_f32_16x16x32_bf16 v[60:63], v[76:79], v[144:147], 0
    v_mfma_f32_16x16x32_bf16 v[64:67], v[72:75], v[200:203], 0
    v_mfma_f32_16x16x32_bf16 v[68:71], v[76:79], v[200:203], 0
    s_mov_b32 m0, s72
    s_mov_b32 exec_hi, 0x00ffffff
    buffer_load_dwordx4 v4, s[8:11], s71 offen lds
    s_mov_b32 exec_hi, -1
    s_add_u32 s72, s72, 912
    s_add_u32 s71, s71, 896
    ds_read_b128 v[72:75], v8 offset:128
    ds_read_b128 v[76:79], v9 offset:128
    s_waitcnt lgkmcnt(2)
    v_mfma_f32_16x16x32_bf16 v[16:19], v[80:83], a[4:7], v[16:19]
    v_mfma_f32_16x16x32_bf16 v[20:23], v[84:87], a[4:7], v[20:23]
    v_mfma_f32_16x16x32_bf16 v[24:27], v[80:83], a[60:63], v[24:27]
    v_mfma_f32_16x16x32_bf16 v[28:31], v[84:87], a[60:63], v[28:31]
    v_mfma_f32_16x16x32_bf16 v[32:35], v[80:83], a[116:119], v[32:35]
    v_mfma_f32_16x16x32_bf16 v[36:39], v[84:87], a[116:119], v[36:39]
    v_mfma_f32_16x16x32_bf16 v[40:43], v[80:83], a[172:175], v[40:43]
    v_mfma_f32_16x16x32_bf16 v[44:47], v[84:87], a[172:175], v[44:47]
    v_mfma_f32_16x16x32_bf16 v[48:51], v[80:83], a[228:231], v[48:51]
    v_mfma_f32_16x16x32_bf16 v[52:55], v[84:87], a[228:231], v[52:55]
    v_mfma_f32_16x16x32_bf16 v[56:59], v[80:83], v[148:151], v[56:59]
    v_mfma_f32_16x16x32_bf16 v[60:63], v[84:87], v[148:151], v[60:63]
    v_mfma_f32_16x16x32_bf16 v[64:67], v[80:83], v[204:207], v[64:67]
    v_mfma_f32_16x16x32_bf16 v[68:71], v[84:87], v[204:207], v[68:71]
    s_mov_b32 m0, s72
    s_mov_b32 exec_hi, 0x00ffffff
    buffer_load_dwordx4 v4, s[8:11], s71 offen lds
    s_mov_b32 exec_hi, -1
    s_add_u32 s72, s72, 912
    s_add_u32 s71, s71, 896
    ds_read_b128 v[80:83], v8 offset:192
    ds_read_b128 v[84:87], v9 offset:192
    s_waitcnt lgkmcnt(2)
    v_mfma_f32_16x16x32_bf16 v[16:19], v[72:75], a[8:11], v[16:19]
    v_mfma_f32_16x16x32_bf16 v[20:23], v[76:79], a[8:11], v[20:23]
    v_mfma_f32_16x16x32_bf16 v[24:27], v[72:75], a[64:67], v[24:27]
    v_mfma_f32_16x16x32_bf16 v[28:31], v[76:79], a[64:67], v[28:31]
    v_mfma_f32_16x16x32_bf16 v[32:35], v[72:75], a[120:123], v[32:35]
    v_mfma_f32_16x16x32_bf16 v[36:39], v[76:79], a[120:123], v[36:39]
    v_mfma_f32_16x16x32_bf16 v[40:43], v[72:75], a[176:179], v[40:43]
    v_mfma_f32_16x16x32_bf16 v[44:47], v[76:79], a[176:179], v[44:47]
    v_mfma_f32_16x16x32_bf16 v[48:51], v[72:75], a[232:235], v[48:51]
    v_mfma_f32_16x16x32_bf16 v[52:55], v[76:79], a[232:235], v[52:55]
    v_mfma_f32_16x16x32_bf16 v[56:59], v[72:75], v[152:155], v[56:59]
    v_mfma_f32_16x16x32_bf16 v[60:63], v[76:79], v[152:155], v[60:63]
    v_mfma_f32_16x16x32_bf16 v[64:67], v[72:75], v[208:211], v[64:67]
    v_mfma_f32_16x16x32_bf16 v[68:71], v[76:79], v[208:211], v[68:71]
    s_mov_b32 m0, s72
    s_mov_b32 exec_hi, 0x00ffffff
    buffer_load_dwordx4 v4, s[8:11], s71 offen lds
    s_mov_b32 exec_hi, -1
    s_add_u32 s72, s72, 912
    s_add_u32 s71, s71, 896
    ds_read_b128 v[72:75], v8 offset:256
    ds_read_b128 v[76:79], v9 offset:256
    s_waitcnt lgkmcnt(2)
    v_mfma_f32_16x16x32_bf16 v[16:19], v[80:83], a[12:15], v[16:19]
    v_mfma_f32_16x16x32_bf16 v[20:23], v[84:87], a[12:15], v[20:23]
    v_mfma_f32_16x16x32_bf16 v[24:27], v[80:83], a[68:71], v[24:27]
    v_mfma_f32_16x16x32_bf16 v[28:31], v[84:87], a[68:71], v[28:31]
    v_mfma_f32_16x16x32_bf16 v[32:35], v[80:83], a[124:127], v[32:35]
    v_mfma_f32_16x16x32_bf16 v[36:39], v[84:87], a[124:127], v[36:39]
    v_mfma_f32_16x16x32_bf16 v[40:43], v[80:83], a[180:183], v[40:43]
    v_mfma_f32_16x16x32_bf16 v[44:47], v[84:87], a[180:183], v[44:47]
    v_mfma_f32_16x16x32_bf16 v[48:51], v[80:83], a[236:239], v[48:51]
    v_mfma_f32_16x16x32_bf16 v[52:55], v[84:87], a[236:239], v[52:55]
    v_mfma_f32_16x16x32_bf16 v[56:59], v[80:83], v[156:159], v[56:59]
    v_mfma_f32_16x16x32_bf16 v[60:63], v[84:87], v[156:159], v[60:63]
    v_mfma_f32_16x16x32_bf16 v[64:67], v[80:83], v[212:215], v[64:67]
    v_mfma_f32_16x16x32_bf16 v[68:71], v[84:87], v[212:215], v[68:71]
    s_mov_b32 m0, s72
    s_mov_b32 exec_hi, 0x00ffffff
    buffer_load_dwordx4 v4, s[8:11], s71 offen lds
    s_mov_b32 exec_hi, -1
    s_add_u32 s72, s72, 912
    s_add_u32 s71, s71, 896
    ds_read_b128 v[80:83], v8 offset:320
    ds_read_b128 v[84:87], v9 offset:320
    s_waitcnt lgkmcnt(2)
    v_mfma_f32_16x16x32_bf16 v[16:19], v[72:75], a[16:19], v[16:19]
    v_mfma_f32_16x16x32_bf16 v[20:23], v[76:79], a[16:19], v[20:23]
    v_mfma_f32_16x16x32_bf16 v[24:27], v[72:75], a[72:75], v[24:27]
    v_mfma_f32_16x16x32_bf16 v[28:31], v[76:79], a[72:75], v[28:31]
    v_mfma_f32_16x16x32_bf16 v[32:35], v[72:75], a[128:131], v[32:35]
    v_mfma_f32_16x16x32_bf16 v[36:39], v[76:79], a[128:131], v[36:39]
    v_mfma_f32_16x16x32_bf16 v[40:43], v[72:75], a[184:187], v[40:43]
    v_mfma_f32_16x16x32_bf16 v[44:47], v[76:79], a[184:187], v[44:47]
    v_mfma_f32_16x16x32_bf16 v[48:51], v[72:75], a[240:243], v[48:51]
    v_mfma_f32_16x16x32_bf16 v[52:55], v[76:79], a[240:243], v[52:55]
    v_mfma_f32_16x16x32_bf16 v[56:59], v[72:75], v[160:163], v[56:59]
    v_mfma_f32_16x16x32_bf16 v[60:63], v[76:79], v[160:163], v[60:63]
    v_mfma_f32_16x16x32_bf16 v[64:67], v[72:75], v[216:219], v[64:67]
    v_mfma_f32_16x16x32_bf16 v[68:71], v[76:79], v[216:219], v[68:71]
    s_mov_b32 m0, s72
    s_mov_b32 exec_hi, 0x00ffffff
    buffer_load_dwordx4 v4, s[8:11], s71 offen lds
    s_mov_b32 exec_hi, -1
    s_add_u32 s72, s72, 912
    s_add_u32 s71, s71, 896
    ds_read_b128 v[72:75], v8 offset:384
    ds_read_b128 v[76:79], v9 offset:384
    s_waitcnt lgkmcnt(2)
    v_mfma_f32_16x16x32_bf16 v[16:19], v[80:83], a[20:23], v[16:19]
    v_mfma_f32_16x16x32_bf16 v[20:23], v[84:87], a[20:23], v[20:23]
    v_mfma_f32_16x16x32_bf16 v[24:27], v[80:83], a[76:79], v[24:27]
    v_mfma_f32_16x16x32_bf16 v[28:31], v[84:87], a[76:79], v[28:31]
    v_mfma_f32_16x16x32_bf16 v[32:35], v[80:83], a[132:135], v[32:35]
    v_mfma_f32_16x16x32_bf16 v[36:39], v[84:87], a[132:135], v[36:39]
    v_mfma_f32_16x16x32_bf16 v[40:43], v[80:83], a[188:191], v[40:43]
    v_mfma_f32_16x16x32_bf16 v[44:47], v[84:87], a[188:191], v[44:47]
    v_mfma_f32_16x16x32_bf16 v[48:51], v[80:83], a[244:247], v[48:51]
    v_mfma_f32_16x16x32_bf16 v[52:55], v[84:87], a[244:247], v[52:55]
    v_mfma_f32_16x16x32_bf16 v[56:59], v[80:83], v[164:167], v[56:59]
    v_mfma_f32_16x16x32_bf16 v[60:63], v[84:87], v[164:167], v[60:63]
    v_mfma_f32_16x16x32_bf16 v[64:67], v[80:83], v[220:223], v[64:67]
    v_mfma_f32_16x16x32_bf16 v[68:71], v[84:87], v[220:223], v[68:71]
    s_mov_b32 m0, s72
    s_mov_b32 exec_hi, 0x00ffffff
    buffer_load_dwordx4 v4, s[8:11], s71 offen lds
    s_mov_b32 exec_hi, -1
    s_add_u32 s72, s72, 912
    s_add_u32 s71, s71, 896
    ds_read_b128 v[80:83], v8 offset:448
    ds_read_b128 v[84:87], v9 offset:448
    s_waitcnt lgkmcnt(2)
    v_mfma_f32_16x16x32_bf16 v[16:19], v[72:75], a[24:27], v[16:19]
    v_mfma_f32_16x16x32_bf16 v[20:23], v[76:79], a[24:27], v[20:23]
    v_mfma_f32_16x16x32_bf16 v[24:27], v[72:75], a[80:83], v[24:27]
    v_mfma_f32_16x16x32_bf16 v[28:31], v[76:79], a[80:83], v[28:31]
    v_mfma_f32_16x16x32_bf16 v[32:35], v[72:75], a[136:139], v[32:35]
    v_mfma_f32_16x16x32_bf16 v[36:39], v[76:79], a[136:139], v[36:39]
    v_mfma_f32_16x16x32_bf16 v[40:43], v[72:75], a[192:195], v[40:43]
    v_mfma_f32_16x16x32_bf16 v[44:47], v[76:79], a[192:195], v[44:47]
    v_mfma_f32_16x16x32_bf16 v[48:51], v[72:75], a[248:251], v[48:51]
    v_mfma_f32_16x16x32_bf16 v[52:55], v[76:79], a[248:251], v[52:55]
    v_mfma_f32_16x16x32_bf16 v[56:59], v[72:75], v[168:171], v[56:59]
    v_mfma_f32_16x16x32_bf16 v[60:63], v[76:79], v[168:171], v[60:63]
    v_mfma_f32_16x16x32_bf16 v[64:67], v[72:75], v[224:227], v[64:67]
    v_mfma_f32_16x16x32_bf16 v[68:71], v[76:79], v[224:227], v[68:71]
    s_mov_b32 m0, s72
    s_mov_b32 exec_hi, 0x00ffffff
    buffer_load_dwordx4 v4, s[8:11], s71 offen lds
    s_mov_b32 exec_hi, -1
    s_add_u32 s72, s72, 912
    s_add_u32 s71, s71, 896
    ds_read_b128 v[72:75], v8 offset:512
    ds_read_b128 v[76:79], v9 offset:512
    s_waitcnt lgkmcnt(2)
    v_mfma_f32_16x16x32_bf16 v[16:19], v[80:83], a[28:31], v[16:19]
    v_mfma_f32_16x16x32_bf16 v[20:23], v[84:87], a[28:31], v[20:23]
    v_mfma_f32_16x16x32_bf16 v[24:27], v[80:83], a[84:87], v[24:27]
    v_mfma_f32_16x16x32_bf16 v[28:31], v[84:87], a[84:87], v[28:31]
    v_mfma_f32_16x16x32_bf16 v[32:35], v[80:83], a[140:143], v[32:35]
    v_mfma_f32_16x16x32_bf16 v[36:39], v[84:87], a[140:143], v[36:39]
    v_mfma_f32_16x16x32_bf16 v[40:43], v[80:83], a[196:199], v[40:43]
    v_mfma_f32_16x16x32_bf16 v[44:47], v[84:87], a[196:199], v[44:47]
    v_mfma_f32_16x16x32_bf16 v[48:51], v[80:83], a[252:255], v[48:51]
    v_mfma_f32_16x16x32_bf16 v[52:55], v[84:87], a[252:255], v[52:55]
    v_mfma_f32_16x16x32_bf16 v[56:59], v[80:83], v[172:175], v[56:59]
    v_mfma_f32_16x16x32_bf16 v[60:63], v[84:87], v[172:175], v[60:63]
    v_mfma_f32_16x16x32_bf16 v[64:67], v[80:83], v[228:231], v[64:67]
    v_mfma_f32_16x16x32_bf16 v[68:71], v[84:87], v[228:231], v[68:71]
    s_waitcnt vmcnt(8)
    s_barrier
    s_cmp_eq_u32 s16, 0
    s_cselect_b32 s59, s61, 0x40000000
    v_mov_b32 v5, 1
    s_mov_b64 exec, 1
    buffer_atomic_add v5, off, s[4:7], s59 sc1
    s_mov_b64 exec, -1
    s_nop 3
    ds_read_b128 v[80:83], v8 offset:576
    ds_read_b128 v[84:87], v9 offset:576
    s_waitcnt lgkmcnt(2)
    v_mfma_f32_16x16x32_bf16 v[16:19], v[72:75], a[32:35], v[16:19]
    v_mfma_f32_16x16x32_bf16 v[20:23], v[76:79], a[32:35], v[20:23]
    v_mfma_f32_16x16x32_bf16 v[24:27], v[72:75], a[88:91], v[24:27]
    v_mfma_f32_16x16x32_bf16 v[28:31], v[76:79], a[88:91], v[28:31]
    v_mfma_f32_16x16x32_bf16 v[32:35], v[72:75], a[144:147], v[32:35]
    v_mfma_f32_16x16x32_bf16 v[36:39], v[76:79], a[144:147], v[36:39]
    v_mfma_f32_16x16x32_bf16 v[40:43], v[72:75], a[200:203], v[40:43]
    v_mfma_f32_16x16x32_bf16 v[44:47], v[76:79], a[200:203], v[44:47]
    v_mfma_f32_16x16x32_bf16 v[48:51], v[72:75], v[120:123], v[48:51]
    v_mfma_f32_16x16x32_bf16 v[52:55], v[76:79], v[120:123], v[52:55]
    v_mfma_f32_16x16x32_bf16 v[56:59], v[72:75], v[176:179], v[56:59]
    v_mfma_f32_16x16x32_bf16 v[60:63], v[76:79], v[176:179], v[60:63]
    v_mfma_f32_16x16x32_bf16 v[64:67], v[72:75], v[232:235], v[64:67]
    v_mfma_f32_16x16x32_bf16 v[68:71], v[76:79], v[232:235], v[68:71]
    ds_read_b128 v[72:75], v8 offset:640
    ds_read_b128 v[76:79], v9 offset:640
    s_waitcnt lgkmcnt(2)
    v_mfma_f32_16x16x32_bf16 v[16:19], v[80:83], a[36:39], v[16:19]
    v_mfma_f32_16x16x32_bf16 v[20:23], v[84:87], a[36:39], v[20:23]
    v_mfma_f32_16x16x32_bf16 v[24:27], v[80:83], a[92:95], v[24:27]
    v_mfma_f32_16x16x32_bf16 v[28:31], v[84:87], a[92:95], v[28:31]
    v_mfma_f32_16x16x32_bf16 v[32:35], v[80:83], a[148:151], v[32:35]
    v_mfma_f32_16x16x32_bf16 v[36:39], v[84:87], a[148:151], v[36:39]
    v_mfma_f32_16x16x32_bf16 v[40:43], v[80:83], a[204:207], v[40:43]
    v_mfma_f32_16x16x32_bf16 v[44:47], v[84:87], a[204:207], v[44:47]
    v_mfma_f32_16x16x32_bf16 v[48:51], v[80:83], v[124:127], v[48:51]
    v_mfma_f32_16x16x32_bf16 v[52:55], v[84:87], v[124:127], v[52:55]
    v_mfma_f32_16x16x32_bf16 v[56:59], v[80:83], v[180:183], v[56:59]
    v_mfma_f32_16x16x32_bf16 v[60:63], v[84:87], v[180:183], v[60:63]
    v_mfma_f32_16x16x32_bf16 v[64:67], v[80:83], v[236:239], v[64:67]
    v_mfma_f32_16x16x32_bf16 v[68:71], v[84:87], v[236:239], v[68:71]
    ds_read_b128 v[80:83], v8 offset:704
    ds_read_b128 v[84:87], v9 offset:704
    s_waitcnt lgkmcnt(2)
    v_mfma_f32_16x16x32_bf16 v[16:19], v[72:75], a[40:43], v[16:19]
    v_mfma_f32_16x16x32_bf16 v[20:23], v[76:79], a[40:43], v[20:23]
    v_mfma_f32_16x16x32_bf16 v[24:27], v[72:75], a[96:99], v[24:27]
    v_mfma_f32_16x16x32_bf16 v[28:31], v[76:79], a[96:99], v[28:31]
    v_mfma_f32_16x16x32_bf16 v[32:35], v[72:75], a[152:155], v[32:35]
    v_mfma_f32_16x16x32_bf16 v[36:39], v[76:79], a[152:155], v[36:39]
    v_mfma_f32_16x16x32_bf16 v[40:43], v[72:75], a[208:211], v[40:43]
    v_mfma_f32_16x16x32_bf16 v[44:47], v[76:79], a[208:211], v[44:47]
    v_mfma_f32_16x16x32_bf16 v[48:51], v[72:75], v[128:131], v[48:51]
    v_mfma_f32_16x16x32_bf16 v[52:55], v[76:79], v[128:131], v[52:55]
    v_mfma_f32_16x16x32_bf16 v[56:59], v[72:75], v[184:187], v[56:59]
    v_mfma_f32_16x16x32_bf16 v[60:63], v[76:79], v[184:187], v[60:63]
    v_mfma_f32_16x16x32_bf16 v[64:67], v[72:75], v[240:243], v[64:67]
    v_mfma_f32_16x16x32_bf16 v[68:71], v[76:79], v[240:243], v[68:71]
    ds_read_b128 v[72:75], v8 offset:768
    ds_read_b128 v[76:79], v9 offset:768
    s_waitcnt lgkmcnt(2)
    v_mfma_f32_16x16x32_bf16 v[16:19], v[80:83], a[44:47], v[16:19]
    v_mfma_f32_16x16x32_bf16 v[20:23], v[84:87], a[44:47], v[20:23]
    v_mfma_f32_16x16x32_bf16 v[24:27], v[80:83], a[100:103], v[24:27]
    v_mfma_f32_16x16x32_bf16 v[28:31], v[84:87], a[100:103], v[28:31]
    v_mfma_f32_16x16x32_bf16 v[32:35], v[80:83], a[156:159], v[32:35]
    v_mfma_f32_16x16x32_bf16 v[36:39], v[84:87], a[156:159], v[36:39]
    v_mfma_f32_16x16x32_bf16 v[40:43], v[80:83], a[212:215], v[40:43]
    v_mfma_f32_16x16x32_bf16 v[44:47], v[84:87], a[212:215], v[44:47]
    v_mfma_f32_16x16x32_bf16 v[48:51], v[80:83], v[132:135], v[48:51]
    v_mfma_f32_16x16x32_bf16 v[52:55], v[84:87], v[132:135], v[52:55]
    v_mfma_f32_16x16x32_bf16 v[56:59], v[80:83], v[188:191], v[56:59]
    v_mfma_f32_16x16x32_bf16 v[60:63], v[84:87], v[188:191], v[60:63]
    v_mfma_f32_16x16x32_bf16 v[64:67], v[80:83], v[244:247], v[64:67]
    v_mfma_f32_16x16x32_bf16 v[68:71], v[84:87], v[244:247], v[68:71]
    ds_read_b128 v[80:83], v8 offset:832
    ds_read_b128 v[84:87], v9 offset:832
    s_waitcnt lgkmcnt(2)
    v_mfma_f32_16x16x32_bf16 v[16:19], v[72:75], a[48:51], v[16:19]
    v_mfma_f32_16x16x32_bf16 v[20:23], v[76:79], a[48:51], v[20:23]
    v_mfma_f32_16x16x32_bf16 v[24:27], v[72:75], a[104:107], v[24:27]
    v_mfma_f32_16x16x32_bf16 v[28:31], v[76:79], a[104:107], v[28:31]
    v_mfma_f32_16x16x32_bf16 v[32:35], v[72:75], a[160:163], v[32:35]
    v_mfma_f32_16x16x32_bf16 v[36:39], v[76:79], a[160:163], v[36:39]
    v_mfma_f32_16x16x32_bf16 v[40:43], v[72:75], a[216:219], v[40:43]
    v_mfma_f32_16x16x32_bf16 v[44:47], v[76:79], a[216:219], v[44:47]
    v_mfma_f32_16x16x32_bf16 v[48:51], v[72:75], v[136:139], v[48:51]
    v_mfma_f32_16x16x32_bf16 v[52:55], v[76:79], v[136:139], v[52:55]
    v_mfma_f32_16x16x32_bf16 v[56:59], v[72:75], v[192:195], v[56:59]
    v_mfma_f32_16x16x32_bf16 v[60:63], v[76:79], v[192:195], v[60:63]
    v_mfma_f32_16x16x32_bf16 v[64:67], v[72:75], v[248:251], v[64:67]
    v_mfma_f32_16x16x32_bf16 v[68:71], v[76:79], v[248:251], v[68:71]
    s_waitcnt lgkmcnt(0)
    v_mfma_f32_16x16x32_bf16 v[16:19], v[80:83], a[52:55], v[16:19]
    v_mfma_f32_16x16x32_bf16 v[20:23], v[84:87], a[52:55], v[20:23]
    v_mfma_f32_16x16x32_bf16 v[24:27], v[80:83], a[108:111], v[24:27]
    v_mfma_f32_16x16x32_bf16 v[28:31], v[84:87], a[108:111], v[28:31]
    v_mfma_f32_16x16x32_bf16 v[32:35], v[80:83], a[164:167], v[32:35]
    v_mfma_f32_16x16x32_bf16 v[36:39], v[84:87], a[164:167], v[36:39]
    v_mfma_f32_16x16x32_bf16 v[40:43], v[80:83], a[220:223], v[40:43]
    v_mfma_f32_16x16x32_bf16 v[44:47], v[84:87], a[220:223], v[44:47]
    v_mfma_f32_16x16x32_bf16 v[48:51], v[80:83], v[140:143], v[48:51]
    v_mfma_f32_16x16x32_bf16 v[52:55], v[84:87], v[140:143], v[52:55]
    v_mfma_f32_16x16x32_bf16 v[56:59], v[80:83], v[196:199], v[56:59]
    v_mfma_f32_16x16x32_bf16 v[60:63], v[84:87], v[196:199], v[60:63]
    v_mfma_f32_16x16x32_bf16 v[64:67], v[80:83], v[252:255], v[64:67]
    v_mfma_f32_16x16x32_bf16 v[68:71], v[84:87], v[252:255], v[68:71]
LVepi_100203:
    s_mul_i32 s25, s56, 458752
    s_mul_i32 s26, s16, 114688
    s_add_u32 s25, s25, s26
    s_lshl_b32 s26, s57, 10
    s_add_u32 s25, s25, s26
    s_add_u32 s25, s25, 0xe00000
    s_lshl_b32 s61, s56, 14
    s_add_u32 s61, s61, 0x2a83800
    ds_read_b128 v[72:75], v12
    ds_read_b128 v[76:79], v12 offset:16
    s_mul_i32 s26, s56, 28672
    s_add_u32 s26, s26, s63
    s_waitcnt vmcnt(1) lgkmcnt(0)
    s_barrier
    v_swap_b32 v73, v74
    v_swap_b32 v74, v76
    v_swap_b32 v75, v78
    v_swap_b32 v78, v77
    buffer_store_dwordx4 v[72:75], v4, s[4:7], s26 offen sc1
    buffer_store_dwordx4 v[76:79], v4, s[4:7], s26 offen offset:1024 sc1
    v_cvt_pk_bf16_f32 v88, v16, v17
    v_cvt_pk_bf16_f32 v89, v18, v19
    v_cvt_pk_bf16_f32 v90, v20, v21
    v_cvt_pk_bf16_f32 v91, v22, v23
    buffer_store_dwordx4 v[88:91], v4, s[4:7], s25 offen sc1
    s_add_u32 s25, s25, 16384
    v_cvt_pk_bf16_f32 v92, v24, v25
    v_cvt_pk_bf16_f32 v93, v26, v27
    v_cvt_pk_bf16_f32 v94, v28, v29
    v_cvt_pk_bf16_f32 v95, v30, v31
    buffer_store_dwordx4 v[92:95], v4, s[4:7], s25 offen sc1
    s_add_u32 s25, s25, 16384
    v_cvt_pk_bf16_f32 v96, v32, v33
    v_cvt_pk_bf16_f32 v97, v34, v35
    v_cvt_pk_bf16_f32 v98, v36, v37
    v_cvt_pk_bf16_f32 v99, v38, v39
    buffer_store_dwordx4 v[96:99], v4, s[4:7], s25 offen sc1
    s_add_u32 s25, s25, 16384
    v_cvt_pk_bf16_f32 v100, v40, v41
    v_cvt_pk_bf16_f32 v101, v42, v43
    v_cvt_pk_bf16_f32 v102, v44, v45
    v_cvt_pk_bf16_f32 v103, v46, v47
    buffer_store_dwordx4 v[100:103], v4, s[4:7], s25 offen sc1
    s_add_u32 s25, s25, 16384
    v_cvt_pk_bf16_f32 v104, v48, v49
    v_cvt_pk_bf16_f32 v105, v50, v51
    v_cvt_pk_bf16_f32 v106, v52, v53
    v_cvt_pk_bf16_f32 v107, v54, v55
    buffer_store_dwordx4 v[104:107], v4, s[4:7], s25 offen sc1
    s_add_u32 s25, s25, 16384
    v_cvt_pk_bf16_f32 v108, v56, v57
    v_cvt_pk_bf16_f32 v109, v58, v59
    v_cvt_pk_bf16_f32 v110, v60, v61
    v_cvt_pk_bf16_f32 v111, v62, v63
    buffer_store_dwordx4 v[108:111], v4, s[4:7], s25 offen sc1
    s_add_u32 s25, s25, 16384
    v_cvt_pk_bf16_f32 v112, v64, v65
    v_cvt_pk_bf16_f32 v113, v66, v67
    v_cvt_pk_bf16_f32 v114, v68, v69
    v_cvt_pk_bf16_f32 v115, v70, v71
    buffer_store_dwordx4 v[112:115], v4, s[4:7], s25 offen sc1
    s_add_u32 s25, s25, 16384
    s_cmp_ge_u32 s56, 4
    s_cbranch_scc1 LVnf_100207
    s_waitcnt vmcnt(0)
    s_cmp_lg_u32 s16, 0
    s_cbranch_scc1 LVcg_100209
    v_and_b32 v15, 31, v0
    v_add_lshl_u32 v15, v15, 0, 2
LVcw_100208:
    buffer_load_dword v14, v15, s[12:15], 0 offen offset:64 sc1
    s_waitcnt vmcnt(0)
    v_cmp_gt_u32 vcc, 8, v14
    s_cbranch_vccz LVcg_100209
    s_sleep 12
    s_sub_u32 s24, s24, 1
    s_cbranch_scc1 Lexit2_100184
    s_branch LVcw_100208
LVcg_100209:
    s_barrier
    s_cmp_eq_u32 s16, 0
    s_cselect_b32 s59, s61, 0x40000000
    v_mov_b32 v5, 1
    s_mov_b64 exec, 1
    buffer_atomic_add v5, off, s[4:7], s59 sc1
    s_mov_b64 exec, -1
    s_nop 3
    s_mov_b32 s61, 0x40000000
LVnf_100207:
    s_add_u32 s56, s56, 4
    s_cmp_lt_u32 s56, 16
    s_cbranch_scc1 LVloop_100202
    s_waitcnt vmcnt(0)
    s_barrier
    s_cmp_eq_u32 s16, 0
    s_cselect_b32 s59, s61, 0x40000000
    v_mov_b32 v5, 1
    s_mov_b64 exec, 1
    buffer_atomic_add v5, off, s[4:7], s59 sc1
    s_mov_b64 exec, -1
    s_nop 3
    s_mov_b32 s61, 0x40000000
LVq_100210:
    v_mov_b32 v16, 0
    v_mov_b32 v17, 0
    v_mov_b32 v18, 0
    v_mov_b32 v19, 0
    v_mov_b32 v20, 0
    v_mov_b32 v21, 0
    v_mov_b32 v22, 0
    v_mov_b32 v23, 0
    v_mov_b32 v24, 0
    v_mov_b32 v25, 0
    v_mov_b32 v26, 0
    v_mov_b32 v27, 0
    v_mov_b32 v28, 0
    v_mov_b32 v29, 0
    v_mov_b32 v30, 0
    v_mov_b32 v31, 0
    v_mov_b32 v32, 0
    v_mov_b32 v33, 0
    v_mov_b32 v34, 0
    v_mov_b32 v35, 0
    v_mov_b32 v36, 0
    v_mov_b32 v37, 0
    v_mov_b32 v38, 0
    v_mov_b32 v39, 0
    v_mov_b32 v40, 0
    v_mov_b32 v41, 0
    v_mov_b32 v42, 0
    v_mov_b32 v43, 0
    s_lshl_b32 s58, s60, 13
    s_add_u32 s58, s58, 0x2b80000
    s_add_u32 s59, s58, 4096
    v_mov_b32 v12, 7164
    s_min_u32 s25, s58, 0x2bfc000
Lvmp_100213:
    buffer_load_dword v5, v12, s[4:7], s25 offen sc1
    s_waitcnt vmcnt(0)
    v_cmp_eq_u32 vcc, -1, v5
    s_cbranch_vccz Lvmgo_100214
    s_sleep 1
    s_sub_u32 s24, s24, 1
    s_cbranch_scc1 Lexit2_100184
    s_branch Lvmp_100213
Lvmgo_100214:
LVm_100211:
    buffer_load_dwordx4 v[72:75], v4, s[4:7], s58 offen offset:0 sc1
    buffer_load_dwordx4 v[76:79], v4, s[4:7], s58 offen offset:1024 sc1
    buffer_load_dwordx4 v[80:83], v4, s[4:7], s58 offen offset:2048 sc1
    buffer_load_dwordx4 v[84:87], v4, s[4:7], s58 offen offset:3072 sc1
    buffer_load_dwordx4 v[88:91], v4, s[4:7], s59 offen offset:0 sc1
    buffer_load_dwordx4 v[92:95], v4, s[4:7], s59 offen offset:1024 sc1
    buffer_load_dwordx4 v[96:99], v4, s[4:7], s59 offen offset:2048 sc1
    s_waitcnt vmcnt(0)
    v_max3_u32 v5, v72, v73, v74
    v_max_u32 v5, v5, v75
    v_max3_u32 v5, v5, v76, v77
    v_max3_u32 v5, v5, v78, v79
    v_max3_u32 v5, v5, v80, v81
    v_max3_u32 v5, v5, v82, v83
    v_max3_u32 v5, v5, v84, v85
    v_max3_u32 v5, v5, v86, v87
    v_max3_u32 v5, v5, v88, v89
    v_max3_u32 v5, v5, v90, v91
    v_max3_u32 v5, v5, v92, v93
    v_max3_u32 v5, v5, v94, v95
    v_max3_u32 v5, v5, v96, v97
    v_max3_u32 v5, v5, v98, v99
    v_cmp_eq_u32 vcc, -1, v5
    s_cbranch_vccz LVmo_100212
    s_sub_u32 s24, s24, 1
    s_cbranch_scc1 Lexit2_100184
    s_branch LVm_100211
LVmo_100212:
    v_smfmac_f32_16x16x64_bf16 v[16:19], v[72:75], a[0:7], v10
    v_smfmac_f32_16x16x64_bf16 v[20:23], v[72:75], a[56:63], v10
    v_smfmac_f32_16x16x64_bf16 v[24:27], v[72:75], a[112:119], v10
    v_smfmac_f32_16x16x64_bf16 v[28:31], v[72:75], a[168:175], v10
    v_smfmac_f32_16x16x64_bf16 v[32:35], v[72:75], a[224:231], v10
    v_smfmac_f32_16x16x64_bf16 v[36:39], v[72:75], v[144:151], v10
    v_smfmac_f32_16x16x64_bf16 v[40:43], v[72:75], v[200:207], v10
    v_smfmac_f32_16x16x64_bf16 v[16:19], v[76:79], a[8:15], v10
    v_smfmac_f32_16x16x64_bf16 v[20:23], v[76:79], a[64:71], v10
    v_smfmac_f32_16x16x64_bf16 v[24:27], v[76:79], a[120:127], v10
    v_smfmac_f32_16x16x64_bf16 v[28:31], v[76:79], a[176:183], v10
    v_smfmac_f32_16x16x64_bf16 v[32:35], v[76:79], a[232:239], v10
    v_smfmac_f32_16x16x64_bf16 v[36:39], v[76:79], v[152:159], v10
    v_smfmac_f32_16x16x64_bf16 v[40:43], v[76:79], v[208:215], v10
    v_smfmac_f32_16x16x64_bf16 v[16:19], v[80:83], a[16:23], v10
    v_smfmac_f32_16x16x64_bf16 v[20:23], v[80:83], a[72:79], v10
    v_smfmac_f32_16x16x64_bf16 v[24:27], v[80:83], a[128:135], v10
    v_smfmac_f32_16x16x64_bf16 v[28:31], v[80:83], a[184:191], v10
    v_smfmac_f32_16x16x64_bf16 v[32:35], v[80:83], a[240:247], v10
    v_smfmac_f32_16x16x64_bf16 v[36:39], v[80:83], v[160:167], v10
    v_smfmac_f32_16x16x64_bf16 v[40:43], v[80:83], v[216:223], v10
    v_smfmac_f32_16x16x64_bf16 v[16:19], v[84:87], a[24:31], v10
    v_smfmac_f32_16x16x64_bf16 v[20:23], v[84:87], a[80:87], v10
    v_smfmac_f32_16x16x64_bf16 v[24:27], v[84:87], a[136:143], v10
    v_smfmac_f32_16x16x64_bf16 v[28:31], v[84:87], a[192:199], v10
    v_smfmac_f32_16x16x64_bf16 v[32:35], v[84:87], a[248:255], v10
    v_smfmac_f32_16x16x64_bf16 v[36:39], v[84:87], v[168:175], v10
    v_smfmac_f32_16x16x64_bf16 v[40:43], v[84:87], v[224:231], v10
    v_smfmac_f32_16x16x64_bf16 v[16:19], v[88:91], a[32:39], v10
    v_smfmac_f32_16x16x64_bf16 v[20:23], v[88:91], a[88:95], v10
    v_smfmac_f32_16x16x64_bf16 v[24:27], v[88:91], a[144:151], v10
    v_smfmac_f32_16x16x64_bf16 v[28:31], v[88:91], a[200:207], v10
    v_smfmac_f32_16x16x64_bf16 v[32:35], v[88:91], v[120:127], v10
    v_smfmac_f32_16x16x64_bf16 v[36:39], v[88:91], v[176:183], v10
    v_smfmac_f32_16x16x64_bf16 v[40:43], v[88:91], v[232:239], v10
    v_smfmac_f32_16x16x64_bf16 v[16:19], v[92:95], a[40:47], v10
    v_smfmac_f32_16x16x64_bf16 v[20:23], v[92:95], a[96:103], v10
    v_smfmac_f32_16x16x64_bf16 v[24:27], v[92:95], a[152:159], v10
    v_smfmac_f32_16x16x64_bf16 v[28:31], v[92:95], a[208:215], v10
    v_smfmac_f32_16x16x64_bf16 v[32:35], v[92:95], v[128:135], v10
    v_smfmac_f32_16x16x64_bf16 v[36:39], v[92:95], v[184:191], v10
    v_smfmac_f32_16x16x64_bf16 v[40:43], v[92:95], v[240:247], v10
    v_smfmac_f32_16x16x64_bf16 v[16:19], v[96:99], a[48:55], v10
    v_smfmac_f32_16x16x64_bf16 v[20:23], v[96:99], a[104:111], v10
    v_smfmac_f32_16x16x64_bf16 v[24:27], v[96:99], a[160:167], v10
    v_smfmac_f32_16x16x64_bf16 v[28:31], v[96:99], a[216:223], v10
    v_smfmac_f32_16x16x64_bf16 v[32:35], v[96:99], v[136:143], v10
    v_smfmac_f32_16x16x64_bf16 v[36:39], v[96:99], v[192:199], v10
    v_smfmac_f32_16x16x64_bf16 v[40:43], v[96:99], v[248:255], v10
    s_mul_i32 s25, s60, 114688
    s_mul_i32 s26, s16, 28672
    s_add_u32 s25, s25, s26
    s_lshl_b32 s26, s57, 8
    s_add_u32 s25, s25, s26
    s_add_u32 s25, s25, 0x2d00000
    v_lshlrev_b32 v13, 2, v1
    s_nop 1
    v_add_f32 v16, v16, v17
    v_add_f32 v18, v18, v19
    v_cvt_pk_bf16_f32 v108, v16, v18
    v_min_u32 v108, -2, v108
    buffer_store_dword v108, v13, s[4:7], s25 offen sc1
    s_add_u32 s25, s25, 4096
    v_add_f32 v20, v20, v21
    v_add_f32 v22, v22, v23
    v_cvt_pk_bf16_f32 v109, v20, v22
    v_min_u32 v109, -2, v109
    buffer_store_dword v109, v13, s[4:7], s25 offen sc1
    s_add_u32 s25, s25, 4096
    v_add_f32 v24, v24, v25
    v_add_f32 v26, v26, v27
    v_cvt_pk_bf16_f32 v110, v24, v26
    v_min_u32 v110, -2, v110
    buffer_store_dword v110, v13, s[4:7], s25 offen sc1
    s_add_u32 s25, s25, 4096
    v_add_f32 v28, v28, v29
    v_add_f32 v30, v30, v31
    v_cvt_pk_bf16_f32 v111, v28, v30
    v_min_u32 v111, -2, v111
    buffer_store_dword v111, v13, s[4:7], s25 offen sc1
    s_add_u32 s25, s25, 4096
    v_add_f32 v32, v32, v33
    v_add_f32 v34, v34, v35
    v_cvt_pk_bf16_f32 v112, v32, v34
    v_min_u32 v112, -2, v112
    buffer_store_dword v112, v13, s[4:7], s25 offen sc1
    s_add_u32 s25, s25, 4096
    v_add_f32 v36, v36, v37
    v_add_f32 v38, v38, v39
    v_cvt_pk_bf16_f32 v113, v36, v38
    v_min_u32 v113, -2, v113
    buffer_store_dword v113, v13, s[4:7], s25 offen sc1
    s_add_u32 s25, s25, 4096
    v_add_f32 v40, v40, v41
    v_add_f32 v42, v42, v43
    v_cvt_pk_bf16_f32 v114, v40, v42
    v_min_u32 v114, -2, v114
    buffer_store_dword v114, v13, s[4:7], s25 offen sc1
    s_add_u32 s25, s25, 4096
    s_lshl_b32 s25, s60, 9
    s_lshl_b32 s26, s57, 4
    s_add_u32 s25, s25, s26
    s_lshl_b32 s26, s16, 2
    s_add_u32 s25, s25, s26
    s_add_u32 s25, s25, 0x3d20000
    v_mov_b32 v5, 1
    s_waitcnt vmcnt(0)
    s_mov_b64 exec, 1
    buffer_store_dword v5, off, s[4:7], s25 sc1
    s_mov_b64 exec, -1
    s_add_u32 s60, s60, 4
    s_cmp_lt_u32 s56, 64
    s_cbranch_scc1 LVloop_100202
    s_cmp_lt_u32 s60, 64
    s_cbranch_scc1 LVq_100210
    s_endpgm
LroleX_100025:
    v_and_b32 v1, 63, v0
    v_lshrrev_b32 v2, 4, v1
    v_and_b32 v3, 15, v1
    v_lshlrev_b32 v4, 4, v1
    s_mul_i32 s57, s17, 21846
    s_lshr_b32 s57, s57, 16
    s_mul_i32 s56, s57, 3
    s_sub_u32 s56, s17, s56
    s_mov_b32 s62, 0
    s_mov_b32 s24, 300000
    s_mul_i32 s25, s56, 28672
    s_mul_i32 s26, s16, 7168
    s_add_u32 s25, s25, s26
    s_mul_i32 s26, s16, 7296
    s_add_u32 s26, s26, s62
    s_mov_b32 exec_hi, 0x00ffffff
    s_mov_b32 m0, s26
    s_add_u32 s26, s26, 912
    buffer_load_dwordx4 v4, s[8:11], s25 offen lds
    s_add_u32 s25, s25, 896
    s_mov_b32 m0, s26
    s_add_u32 s26, s26, 912
    buffer_load_dwordx4 v4, s[8:11], s25 offen lds
    s_add_u32 s25, s25, 896
    s_mov_b32 m0, s26
    s_add_u32 s26, s26, 912
    buffer_load_dwordx4 v4, s[8:11], s25 offen lds
    s_add_u32 s25, s25, 896
    s_mov_b32 m0, s26
    s_add_u32 s26, s26, 912
    buffer_load_dwordx4 v4, s[8:11], s25 offen lds
    s_add_u32 s25, s25, 896
    s_mov_b32 m0, s26
    s_add_u32 s26, s26, 912
    buffer_load_dwordx4 v4, s[8:11], s25 offen lds
    s_add_u32 s25, s25, 896
    s_mov_b32 m0, s26
    s_add_u32 s26, s26, 912
    buffer_load_dwordx4 v4, s[8:11], s25 offen lds
    s_add_u32 s25, s25, 896
    s_mov_b32 m0, s26
    s_add_u32 s26, s26, 912
    buffer_load_dwordx4 v4, s[8:11], s25 offen lds
    s_add_u32 s25, s25, 896
    s_mov_b32 m0, s26
    s_add_u32 s26, s26, 912
    buffer_load_dwordx4 v4, s[8:11], s25 offen lds
    s_add_u32 s25, s25, 896
    s_mov_b32 exec_hi, -1
    s_cmp_lg_u32 s16, 0
    s_cbranch_scc1 Lxcg_100216
    v_and_b32 v16, 31, v0
    v_add_lshl_u32 v16, v16, 0, 2
Lxcw_100215:
    s_sleep 127
    s_sleep 127
    buffer_load_dword v17, v16, s[12:15], 0 offen offset:64 sc1
    s_waitcnt vmcnt(0)
    v_cmp_gt_u32 vcc, 8, v17
    s_cbranch_vccz Lxcg_100216
    s_sub_u32 s24, s24, 40
    s_cbranch_scc1 Lexit2_100184
    s_branch Lxcw_100215
Lxcg_100216:
    s_barrier
    s_cmp_lg_u32 s16, 0
    s_cbranch_scc1 Lys_100217
    v_mov_b32 v16, 0
    s_mov_b32 s58, 0x2a8f800
Lxyp_100218:
    buffer_load_dword v17, v16, s[4:7], s58 offen sc1
    s_waitcnt vmcnt(0)
    v_cmp_ne_u32 vcc, 15, v17
    s_cbranch_vccz Lxygo_100219
    s_sleep 30
    s_sub_u32 s24, s24, 1
    s_cbranch_scc1 Lexit2_100184
    s_branch Lxyp_100218
Lxygo_100219:
Lys_100217:
    s_barrier
    s_mul_i32 s25, s57, 401408
    s_mul_i32 s26, s16, 100352
    s_add_u32 s25, s25, s26
    s_add_u32 s25, s25, 0x0
    buffer_load_dwordx4 a[0:3], v4, s[4:7], s25 offen offset:0 sc1
    buffer_load_dwordx4 a[4:7], v4, s[4:7], s25 offen offset:1024 sc1
    buffer_load_dwordx4 a[8:11], v4, s[4:7], s25 offen offset:2048 sc1
    buffer_load_dwordx4 a[12:15], v4, s[4:7], s25 offen offset:3072 sc1
    s_add_u32 s25, s25, 4096
    buffer_load_dwordx4 a[16:19], v4, s[4:7], s25 offen offset:0 sc1
    buffer_load_dwordx4 a[20:23], v4, s[4:7], s25 offen offset:1024 sc1
    buffer_load_dwordx4 a[24:27], v4, s[4:7], s25 offen offset:2048 sc1
    buffer_load_dwordx4 a[28:31], v4, s[4:7], s25 offen offset:3072 sc1
    s_add_u32 s25, s25, 4096
    buffer_load_dwordx4 a[32:35], v4, s[4:7], s25 offen offset:0 sc1
    buffer_load_dwordx4 a[36:39], v4, s[4:7], s25 offen offset:1024 sc1
    buffer_load_dwordx4 a[40:43], v4, s[4:7], s25 offen offset:2048 sc1
    buffer_load_dwordx4 a[44:47], v4, s[4:7], s25 offen offset:3072 sc1
    s_add_u32 s25, s25, 4096
    buffer_load_dwordx4 a[48:51], v4, s[4:7], s25 offen offset:0 sc1
    buffer_load_dwordx4 a[52:55], v4, s[4:7], s25 offen offset:1024 sc1
    buffer_load_dwordx4 a[56:59], v4, s[4:7], s25 offen offset:2048 sc1
    buffer_load_dwordx4 a[60:63], v4, s[4:7], s25 offen offset:3072 sc1
    s_add_u32 s25, s25, 4096
    buffer_load_dwordx4 a[64:67], v4, s[4:7], s25 offen offset:0 sc1
    buffer_load_dwordx4 a[68:71], v4, s[4:7], s25 offen offset:1024 sc1
    buffer_load_dwordx4 a[72:75], v4, s[4:7], s25 offen offset:2048 sc1
    buffer_load_dwordx4 a[76:79], v4, s[4:7], s25 offen offset:3072 sc1
    s_add_u32 s25, s25, 4096
    buffer_load_dwordx4 a[80:83], v4, s[4:7], s25 offen offset:0 sc1
    buffer_load_dwordx4 a[84:87], v4, s[4:7], s25 offen offset:1024 sc1
    buffer_load_dwordx4 a[88:91], v4, s[4:7], s25 offen offset:2048 sc1
    buffer_load_dwordx4 a[92:95], v4, s[4:7], s25 offen offset:3072 sc1
    s_add_u32 s25, s25, 4096
    buffer_load_dwordx4 a[96:99], v4, s[4:7], s25 offen offset:0 sc1
    buffer_load_dwordx4 a[100:103], v4, s[4:7], s25 offen offset:1024 sc1
    buffer_load_dwordx4 a[104:107], v4, s[4:7], s25 offen offset:2048 sc1
    buffer_load_dwordx4 a[108:111], v4, s[4:7], s25 offen offset:3072 sc1
    s_add_u32 s25, s25, 4096
    buffer_load_dwordx4 a[112:115], v4, s[4:7], s25 offen offset:0 sc1
    buffer_load_dwordx4 a[116:119], v4, s[4:7], s25 offen offset:1024 sc1
    buffer_load_dwordx4 a[120:123], v4, s[4:7], s25 offen offset:2048 sc1
    buffer_load_dwordx4 a[124:127], v4, s[4:7], s25 offen offset:3072 sc1
    s_add_u32 s25, s25, 4096
    s_waitcnt vmcnt(32)
    buffer_load_dwordx4 a[128:131], v4, s[4:7], s25 offen offset:0 sc1
    buffer_load_dwordx4 a[132:135], v4, s[4:7], s25 offen offset:1024 sc1
    buffer_load_dwordx4 a[136:139], v4, s[4:7], s25 offen offset:2048 sc1
    buffer_load_dwordx4 a[140:143], v4, s[4:7], s25 offen offset:3072 sc1
    s_add_u32 s25, s25, 4096
    buffer_load_dwordx4 a[144:147], v4, s[4:7], s25 offen offset:0 sc1
    buffer_load_dwordx4 a[148:151], v4, s[4:7], s25 offen offset:1024 sc1
    buffer_load_dwordx4 a[152:155], v4, s[4:7], s25 offen offset:2048 sc1
    buffer_load_dwordx4 a[156:159], v4, s[4:7], s25 offen offset:3072 sc1
    s_add_u32 s25, s25, 4096
    buffer_load_dwordx4 a[160:163], v4, s[4:7], s25 offen offset:0 sc1
    buffer_load_dwordx4 a[164:167], v4, s[4:7], s25 offen offset:1024 sc1
    buffer_load_dwordx4 a[168:171], v4, s[4:7], s25 offen offset:2048 sc1
    buffer_load_dwordx4 a[172:175], v4, s[4:7], s25 offen offset:3072 sc1
    s_add_u32 s25, s25, 4096
    buffer_load_dwordx4 a[176:179], v4, s[4:7], s25 offen offset:0 sc1
    buffer_load_dwordx4 a[180:183], v4, s[4:7], s25 offen offset:1024 sc1
    buffer_load_dwordx4 a[184:187], v4, s[4:7], s25 offen offset:2048 sc1
    buffer_load_dwordx4 a[188:191], v4, s[4:7], s25 offen offset:3072 sc1
    s_add_u32 s25, s25, 4096
    s_waitcnt vmcnt(32)
    buffer_load_dwordx4 a[192:195], v4, s[4:7], s25 offen offset:0 sc1
    buffer_load_dwordx4 a[196:199], v4, s[4:7], s25 offen offset:1024 sc1
    buffer_load_dwordx4 a[200:203], v4, s[4:7], s25 offen offset:2048 sc1
    buffer_load_dwordx4 a[204:207], v4, s[4:7], s25 offen offset:3072 sc1
    s_add_u32 s25, s25, 4096
    buffer_load_dwordx4 a[208:211], v4, s[4:7], s25 offen offset:0 sc1
    buffer_load_dwordx4 a[212:215], v4, s[4:7], s25 offen offset:1024 sc1
    buffer_load_dwordx4 a[216:219], v4, s[4:7], s25 offen offset:2048 sc1
    buffer_load_dwordx4 a[220:223], v4, s[4:7], s25 offen offset:3072 sc1
    s_add_u32 s25, s25, 4096
    buffer_load_dwordx4 a[224:227], v4, s[4:7], s25 offen offset:0 sc1
    buffer_load_dwordx4 a[228:231], v4, s[4:7], s25 offen offset:1024 sc1
    buffer_load_dwordx4 a[232:235], v4, s[4:7], s25 offen offset:2048 sc1
    buffer_load_dwordx4 a[236:239], v4, s[4:7], s25 offen offset:3072 sc1
    s_add_u32 s25, s25, 4096
    buffer_load_dwordx4 a[240:243], v4, s[4:7], s25 offen offset:0 sc1
    buffer_load_dwordx4 a[244:247], v4, s[4:7], s25 offen offset:1024 sc1
    buffer_load_dwordx4 a[248:251], v4, s[4:7], s25 offen offset:2048 sc1
    buffer_load_dwordx4 a[252:255], v4, s[4:7], s25 offen offset:3072 sc1
    s_add_u32 s25, s25, 4096
    s_waitcnt vmcnt(32)
    buffer_load_dwordx4 v[120:123], v4, s[4:7], s25 offen offset:0 sc1
    buffer_load_dwordx4 v[124:127], v4, s[4:7], s25 offen offset:1024 sc1
    buffer_load_dwordx4 v[128:131], v4, s[4:7], s25 offen offset:2048 sc1
    buffer_load_dwordx4 v[132:135], v4, s[4:7], s25 offen offset:3072 sc1
    s_add_u32 s25, s25, 4096
    buffer_load_dwordx4 v[136:139], v4, s[4:7], s25 offen offset:0 sc1
    buffer_load_dwordx4 v[140:143], v4, s[4:7], s25 offen offset:1024 sc1
    buffer_load_dwordx4 v[144:147], v4, s[4:7], s25 offen offset:2048 sc1
    buffer_load_dwordx4 v[148:151], v4, s[4:7], s25 offen offset:3072 sc1
    s_add_u32 s25, s25, 4096
    buffer_load_dwordx4 v[152:155], v4, s[4:7], s25 offen offset:0 sc1
    buffer_load_dwordx4 v[156:159], v4, s[4:7], s25 offen offset:1024 sc1
    buffer_load_dwordx4 v[160:163], v4, s[4:7], s25 offen offset:2048 sc1
    buffer_load_dwordx4 v[164:167], v4, s[4:7], s25 offen offset:3072 sc1
    s_add_u32 s25, s25, 4096
    buffer_load_dwordx4 v[168:171], v4, s[4:7], s25 offen offset:0 sc1
    buffer_load_dwordx4 v[172:175], v4, s[4:7], s25 offen offset:1024 sc1
    buffer_load_dwordx4 v[176:179], v4, s[4:7], s25 offen offset:2048 sc1
    buffer_load_dwordx4 v[180:183], v4, s[4:7], s25 offen offset:3072 sc1
    s_add_u32 s25, s25, 4096
    s_waitcnt vmcnt(32)
    buffer_load_dwordx4 v[184:187], v4, s[4:7], s25 offen offset:0 sc1
    buffer_load_dwordx4 v[188:191], v4, s[4:7], s25 offen offset:1024 sc1
    buffer_load_dwordx4 v[192:195], v4, s[4:7], s25 offen offset:2048 sc1
    buffer_load_dwordx4 v[196:199], v4, s[4:7], s25 offen offset:3072 sc1
    s_add_u32 s25, s25, 4096
    buffer_load_dwordx4 v[200:203], v4, s[4:7], s25 offen offset:0 sc1
    buffer_load_dwordx4 v[204:207], v4, s[4:7], s25 offen offset:1024 sc1
    buffer_load_dwordx4 v[208:211], v4, s[4:7], s25 offen offset:2048 sc1
    buffer_load_dwordx4 v[212:215], v4, s[4:7], s25 offen offset:3072 sc1
    s_add_u32 s25, s25, 4096
    buffer_load_dwordx4 v[216:219], v4, s[4:7], s25 offen offset:0 sc1
    buffer_load_dwordx4 v[220:223], v4, s[4:7], s25 offen offset:1024 sc1
    buffer_load_dwordx4 v[224:227], v4, s[4:7], s25 offen offset:2048 sc1
    buffer_load_dwordx4 v[228:231], v4, s[4:7], s25 offen offset:3072 sc1
    s_add_u32 s25, s25, 4096
    buffer_load_dwordx4 v[232:235], v4, s[4:7], s25 offen offset:0 sc1
    buffer_load_dwordx4 v[236:239], v4, s[4:7], s25 offen offset:1024 sc1
    buffer_load_dwordx4 v[240:243], v4, s[4:7], s25 offen offset:2048 sc1
    buffer_load_dwordx4 v[244:247], v4, s[4:7], s25 offen offset:3072 sc1
    s_add_u32 s25, s25, 4096
    s_waitcnt vmcnt(32)
    buffer_load_dwordx4 v[248:251], v4, s[4:7], s25 offen offset:0 sc1
    buffer_load_dwordx4 v[252:255], v4, s[4:7], s25 offen offset:1024 sc1
    v_mul_u32_u24 v6, 912, v3
    v_lshl_add_u32 v6, v2, 4, v6
    v_lshrrev_b32 v5, 2, v3
    v_lshlrev_b32 v7, 3, v5
    v_and_b32 v5, 3, v3
    v_add_u32 v7, v7, v5
    v_mul_u32_u24 v7, 912, v7
    v_lshl_add_u32 v7, v2, 3, v7
    s_mul_i32 s25, s16, 224
    v_add_u32 v7, s25, v7
    v_lshrrev_b32 v5, 2, v3
    v_lshlrev_b32 v11, 6, v5
    v_and_b32 v5, 1, v3
    v_lshl_add_u32 v11, v5, 5, v11
    v_lshl_add_u32 v11, v2, 2, v11
    s_mul_i32 s25, s16, 1792
    s_add_u32 s25, s25, 65536
    v_add_u32 v11, s25, v11
    v_add_u32 v14, s25, v4
    s_lshl_b32 s25, s16, 12
    s_add_u32 s25, s25, 73728
    v_add_u32 v12, s25, v4
    s_lshl_b32 s25, s16, 10
    s_add_u32 s25, s25, 73728
    v_add_u32 v13, s25, v4
    s_mov_b32 s61, 0x40000000
    s_waitcnt vmcnt(0)
    s_barrier
LXloop_100220:
    v_add_u32 v8, s62, v6
    v_add_u32 v9, 14592, v8
    v_add_u32 v10, s62, v7
    s_xor_b32 s62, s62, 32768
    s_add_u32 s58, s56, 3
    s_mul_i32 s71, s58, 28672
    s_mul_i32 s72, s16, 7168
    s_add_u32 s71, s71, s72
    s_mul_i32 s72, s16, 7296
    s_add_u32 s72, s72, s62
    s_lshl_b32 s59, s56, 13
    s_mul_i32 s25, s16, 1792
    s_add_u32 s59, s59, s25
    s_add_u32 s59, s59, 0x2b80000
    s_add_u32 s74, s25, 65536
    s_lshl_b32 s60, s56, 13
    s_add_u32 s60, s60, 0x2b81bfc
    s_mov_b32 s73, 0
    ds_read_b128 v[72:75], v8 offset:0
    ds_read_b128 v[76:79], v9 offset:0
    s_mov_b32 m0, s72
    s_mov_b32 exec_hi, 0x00ffffff
    buffer_load_dwordx4 v4, s[8:11], s71 offen lds
    s_mov_b32 exec_hi, -1
    s_add_u32 s72, s72, 912
    s_add_u32 s71, s71, 896
    ds_read_b128 v[80:83], v8 offset:64
    ds_read_b128 v[84:87], v9 offset:64
    s_waitcnt lgkmcnt(2)
    v_mfma_f32_16x16x32_bf16 v[16:19], a[0:3], v[72:75], 0
    v_mfma_f32_16x16x32_bf16 v[20:23], a[0:3], v[76:79], 0
    v_mfma_f32_16x16x32_bf16 v[24:27], a[56:59], v[72:75], 0
    v_mfma_f32_16x16x32_bf16 v[28:31], a[56:59], v[76:79], 0
    v_mfma_f32_16x16x32_bf16 v[32:35], a[112:115], v[72:75], 0
    v_mfma_f32_16x16x32_bf16 v[36:39], a[112:115], v[76:79], 0
    v_mfma_f32_16x16x32_bf16 v[40:43], a[168:171], v[72:75], 0
    v_mfma_f32_16x16x32_bf16 v[44:47], a[168:171], v[76:79], 0
    v_mfma_f32_16x16x32_bf16 v[48:51], a[224:227], v[72:75], 0
    v_mfma_f32_16x16x32_bf16 v[52:55], a[224:227], v[76:79], 0
    v_mfma_f32_16x16x32_bf16 v[56:59], v[144:147], v[72:75], 0
    v_mfma_f32_16x16x32_bf16 v[60:63], v[144:147], v[76:79], 0
    v_mfma_f32_16x16x32_bf16 v[64:67], v[200:203], v[72:75], 0
    v_mfma_f32_16x16x32_bf16 v[68:71], v[200:203], v[76:79], 0
    s_mov_b32 m0, s72
    s_mov_b32 exec_hi, 0x00ffffff
    buffer_load_dwordx4 v4, s[8:11], s71 offen lds
    s_mov_b32 exec_hi, -1
    s_add_u32 s72, s72, 912
    s_add_u32 s71, s71, 896
    ds_read_b128 v[72:75], v8 offset:128
    ds_read_b128 v[76:79], v9 offset:128
    s_waitcnt lgkmcnt(2)
    v_mfma_f32_16x16x32_bf16 v[16:19], a[4:7], v[80:83], v[16:19]
    v_mfma_f32_16x16x32_bf16 v[20:23], a[4:7], v[84:87], v[20:23]
    v_mfma_f32_16x16x32_bf16 v[24:27], a[60:63], v[80:83], v[24:27]
    v_mfma_f32_16x16x32_bf16 v[28:31], a[60:63], v[84:87], v[28:31]
    v_mfma_f32_16x16x32_bf16 v[32:35], a[116:119], v[80:83], v[32:35]
    v_mfma_f32_16x16x32_bf16 v[36:39], a[116:119], v[84:87], v[36:39]
    v_mfma_f32_16x16x32_bf16 v[40:43], a[172:175], v[80:83], v[40:43]
    v_mfma_f32_16x16x32_bf16 v[44:47], a[172:175], v[84:87], v[44:47]
    v_mfma_f32_16x16x32_bf16 v[48:51], a[228:231], v[80:83], v[48:51]
    v_mfma_f32_16x16x32_bf16 v[52:55], a[228:231], v[84:87], v[52:55]
    v_mfma_f32_16x16x32_bf16 v[56:59], v[148:151], v[80:83], v[56:59]
    v_mfma_f32_16x16x32_bf16 v[60:63], v[148:151], v[84:87], v[60:63]
    v_mfma_f32_16x16x32_bf16 v[64:67], v[204:207], v[80:83], v[64:67]
    v_mfma_f32_16x16x32_bf16 v[68:71], v[204:207], v[84:87], v[68:71]
    s_mov_b32 m0, s72
    s_mov_b32 exec_hi, 0x00ffffff
    buffer_load_dwordx4 v4, s[8:11], s71 offen lds
    s_mov_b32 exec_hi, -1
    s_add_u32 s72, s72, 912
    s_add_u32 s71, s71, 896
    ds_read_b128 v[80:83], v8 offset:192
    ds_read_b128 v[84:87], v9 offset:192
    s_waitcnt lgkmcnt(2)
    v_mfma_f32_16x16x32_bf16 v[16:19], a[8:11], v[72:75], v[16:19]
    v_mfma_f32_16x16x32_bf16 v[20:23], a[8:11], v[76:79], v[20:23]
    v_mfma_f32_16x16x32_bf16 v[24:27], a[64:67], v[72:75], v[24:27]
    v_mfma_f32_16x16x32_bf16 v[28:31], a[64:67], v[76:79], v[28:31]
    v_mfma_f32_16x16x32_bf16 v[32:35], a[120:123], v[72:75], v[32:35]
    v_mfma_f32_16x16x32_bf16 v[36:39], a[120:123], v[76:79], v[36:39]
    v_mfma_f32_16x16x32_bf16 v[40:43], a[176:179], v[72:75], v[40:43]
    v_mfma_f32_16x16x32_bf16 v[44:47], a[176:179], v[76:79], v[44:47]
    v_mfma_f32_16x16x32_bf16 v[48:51], a[232:235], v[72:75], v[48:51]
    v_mfma_f32_16x16x32_bf16 v[52:55], a[232:235], v[76:79], v[52:55]
    v_mfma_f32_16x16x32_bf16 v[56:59], v[152:155], v[72:75], v[56:59]
    v_mfma_f32_16x16x32_bf16 v[60:63], v[152:155], v[76:79], v[60:63]
    v_mfma_f32_16x16x32_bf16 v[64:67], v[208:211], v[72:75], v[64:67]
    v_mfma_f32_16x16x32_bf16 v[68:71], v[208:211], v[76:79], v[68:71]
    s_mov_b32 m0, s72
    s_mov_b32 exec_hi, 0x00ffffff
    buffer_load_dwordx4 v4, s[8:11], s71 offen lds
    s_mov_b32 exec_hi, -1
    s_add_u32 s72, s72, 912
    s_add_u32 s71, s71, 896
    ds_read_b128 v[72:75], v8 offset:256
    ds_read_b128 v[76:79], v9 offset:256
    s_waitcnt lgkmcnt(2)
    v_mfma_f32_16x16x32_bf16 v[16:19], a[12:15], v[80:83], v[16:19]
    v_mfma_f32_16x16x32_bf16 v[20:23], a[12:15], v[84:87], v[20:23]
    v_mfma_f32_16x16x32_bf16 v[24:27], a[68:71], v[80:83], v[24:27]
    v_mfma_f32_16x16x32_bf16 v[28:31], a[68:71], v[84:87], v[28:31]
    v_mfma_f32_16x16x32_bf16 v[32:35], a[124:127], v[80:83], v[32:35]
    v_mfma_f32_16x16x32_bf16 v[36:39], a[124:127], v[84:87], v[36:39]
    v_mfma_f32_16x16x32_bf16 v[40:43], a[180:183], v[80:83], v[40:43]
    v_mfma_f32_16x16x32_bf16 v[44:47], a[180:183], v[84:87], v[44:47]
    v_mfma_f32_16x16x32_bf16 v[48:51], a[236:239], v[80:83], v[48:51]
    v_mfma_f32_16x16x32_bf16 v[52:55], a[236:239], v[84:87], v[52:55]
    v_mfma_f32_16x16x32_bf16 v[56:59], v[156:159], v[80:83], v[56:59]
    v_mfma_f32_16x16x32_bf16 v[60:63], v[156:159], v[84:87], v[60:63]
    v_mfma_f32_16x16x32_bf16 v[64:67], v[212:215], v[80:83], v[64:67]
    v_mfma_f32_16x16x32_bf16 v[68:71], v[212:215], v[84:87], v[68:71]
    s_waitcnt vmcnt(4)
    v_mov_b32 v5, 1
    s_mov_b64 exec, 1
    buffer_store_dword v5, off, s[4:7], s61 sc1
    s_mov_b64 exec, -1
    s_nop 3
    s_mov_b32 m0, s72
    s_mov_b32 exec_hi, 0x00ffffff
    buffer_load_dwordx4 v4, s[8:11], s71 offen lds
    s_mov_b32 exec_hi, -1
    s_add_u32 s72, s72, 912
    s_add_u32 s71, s71, 896
    ds_read_b128 v[80:83], v8 offset:320
    ds_read_b128 v[84:87], v9 offset:320
    s_waitcnt lgkmcnt(2)
    v_mfma_f32_16x16x32_bf16 v[16:19], a[16:19], v[72:75], v[16:19]
    v_mfma_f32_16x16x32_bf16 v[20:23], a[16:19], v[76:79], v[20:23]
    v_mfma_f32_16x16x32_bf16 v[24:27], a[72:75], v[72:75], v[24:27]
    v_mfma_f32_16x16x32_bf16 v[28:31], a[72:75], v[76:79], v[28:31]
    v_mfma_f32_16x16x32_bf16 v[32:35], a[128:131], v[72:75], v[32:35]
    v_mfma_f32_16x16x32_bf16 v[36:39], a[128:131], v[76:79], v[36:39]
    v_mfma_f32_16x16x32_bf16 v[40:43], a[184:187], v[72:75], v[40:43]
    v_mfma_f32_16x16x32_bf16 v[44:47], a[184:187], v[76:79], v[44:47]
    v_mfma_f32_16x16x32_bf16 v[48:51], a[240:243], v[72:75], v[48:51]
    v_mfma_f32_16x16x32_bf16 v[52:55], a[240:243], v[76:79], v[52:55]
    v_mfma_f32_16x16x32_bf16 v[56:59], v[160:163], v[72:75], v[56:59]
    v_mfma_f32_16x16x32_bf16 v[60:63], v[160:163], v[76:79], v[60:63]
    v_mfma_f32_16x16x32_bf16 v[64:67], v[216:219], v[72:75], v[64:67]
    v_mfma_f32_16x16x32_bf16 v[68:71], v[216:219], v[76:79], v[68:71]
    s_mov_b32 m0, s72
    s_mov_b32 exec_hi, 0x00ffffff
    buffer_load_dwordx4 v4, s[8:11], s71 offen lds
    s_mov_b32 exec_hi, -1
    s_add_u32 s72, s72, 912
    s_add_u32 s71, s71, 896
    ds_read_b128 v[72:75], v8 offset:384
    ds_read_b128 v[76:79], v9 offset:384
    s_waitcnt lgkmcnt(2)
    v_mfma_f32_16x16x32_bf16 v[16:19], a[20:23], v[80:83], v[16:19]
    v_mfma_f32_16x16x32_bf16 v[20:23], a[20:23], v[84:87], v[20:23]
    v_mfma_f32_16x16x32_bf16 v[24:27], a[76:79], v[80:83], v[24:27]
    v_mfma_f32_16x16x32_bf16 v[28:31], a[76:79], v[84:87], v[28:31]
    v_mfma_f32_16x16x32_bf16 v[32:35], a[132:135], v[80:83], v[32:35]
    v_mfma_f32_16x16x32_bf16 v[36:39], a[132:135], v[84:87], v[36:39]
    v_mfma_f32_16x16x32_bf16 v[40:43], a[188:191], v[80:83], v[40:43]
    v_mfma_f32_16x16x32_bf16 v[44:47], a[188:191], v[84:87], v[44:47]
    v_mfma_f32_16x16x32_bf16 v[48:51], a[244:247], v[80:83], v[48:51]
    v_mfma_f32_16x16x32_bf16 v[52:55], a[244:247], v[84:87], v[52:55]
    v_mfma_f32_16x16x32_bf16 v[56:59], v[164:167], v[80:83], v[56:59]
    v_mfma_f32_16x16x32_bf16 v[60:63], v[164:167], v[84:87], v[60:63]
    v_mfma_f32_16x16x32_bf16 v[64:67], v[220:223], v[80:83], v[64:67]
    v_mfma_f32_16x16x32_bf16 v[68:71], v[220:223], v[84:87], v[68:71]
    s_mov_b32 m0, s72
    s_mov_b32 exec_hi, 0x00ffffff
    buffer_load_dwordx4 v4, s[8:11], s71 offen lds
    s_mov_b32 exec_hi, -1
    s_add_u32 s72, s72, 912
    s_add_u32 s71, s71, 896
    ds_read_b128 v[80:83], v8 offset:448
    ds_read_b128 v[84:87], v9 offset:448
    s_waitcnt lgkmcnt(2)
    v_mfma_f32_16x16x32_bf16 v[16:19], a[24:27], v[72:75], v[16:19]
    v_mfma_f32_16x16x32_bf16 v[20:23], a[24:27], v[76:79], v[20:23]
    v_mfma_f32_16x16x32_bf16 v[24:27], a[80:83], v[72:75], v[24:27]
    v_mfma_f32_16x16x32_bf16 v[28:31], a[80:83], v[76:79], v[28:31]
    v_mfma_f32_16x16x32_bf16 v[32:35], a[136:139], v[72:75], v[32:35]
    v_mfma_f32_16x16x32_bf16 v[36:39], a[136:139], v[76:79], v[36:39]
    v_mfma_f32_16x16x32_bf16 v[40:43], a[192:195], v[72:75], v[40:43]
    v_mfma_f32_16x16x32_bf16 v[44:47], a[192:195], v[76:79], v[44:47]
    v_mfma_f32_16x16x32_bf16 v[48:51], a[248:251], v[72:75], v[48:51]
    v_mfma_f32_16x16x32_bf16 v[52:55], a[248:251], v[76:79], v[52:55]
    v_mfma_f32_16x16x32_bf16 v[56:59], v[168:171], v[72:75], v[56:59]
    v_mfma_f32_16x16x32_bf16 v[60:63], v[168:171], v[76:79], v[60:63]
    v_mfma_f32_16x16x32_bf16 v[64:67], v[224:227], v[72:75], v[64:67]
    v_mfma_f32_16x16x32_bf16 v[68:71], v[224:227], v[76:79], v[68:71]
    s_mov_b32 m0, s72
    s_mov_b32 exec_hi, 0x00ffffff
    buffer_load_dwordx4 v4, s[8:11], s71 offen lds
    s_mov_b32 exec_hi, -1
    s_add_u32 s72, s72, 912
    s_add_u32 s71, s71, 896
    ds_read_b128 v[72:75], v8 offset:512
    ds_read_b128 v[76:79], v9 offset:512
    s_waitcnt lgkmcnt(2)
    v_mfma_f32_16x16x32_bf16 v[16:19], a[28:31], v[80:83], v[16:19]
    v_mfma_f32_16x16x32_bf16 v[20:23], a[28:31], v[84:87], v[20:23]
    v_mfma_f32_16x16x32_bf16 v[24:27], a[84:87], v[80:83], v[24:27]
    v_mfma_f32_16x16x32_bf16 v[28:31], a[84:87], v[84:87], v[28:31]
    v_mfma_f32_16x16x32_bf16 v[32:35], a[140:143], v[80:83], v[32:35]
    v_mfma_f32_16x16x32_bf16 v[36:39], a[140:143], v[84:87], v[36:39]
    v_mfma_f32_16x16x32_bf16 v[40:43], a[196:199], v[80:83], v[40:43]
    v_mfma_f32_16x16x32_bf16 v[44:47], a[196:199], v[84:87], v[44:47]
    v_mfma_f32_16x16x32_bf16 v[48:51], a[252:255], v[80:83], v[48:51]
    v_mfma_f32_16x16x32_bf16 v[52:55], a[252:255], v[84:87], v[52:55]
    v_mfma_f32_16x16x32_bf16 v[56:59], v[172:175], v[80:83], v[56:59]
    v_mfma_f32_16x16x32_bf16 v[60:63], v[172:175], v[84:87], v[60:63]
    v_mfma_f32_16x16x32_bf16 v[64:67], v[228:231], v[80:83], v[64:67]
    v_mfma_f32_16x16x32_bf16 v[68:71], v[228:231], v[84:87], v[68:71]
    buffer_load_dword v15, off, s[4:7], s60 sc1
    ds_read_b128 v[80:83], v8 offset:576
    ds_read_b128 v[84:87], v9 offset:576
    s_waitcnt lgkmcnt(2)
    v_mfma_f32_16x16x32_bf16 v[16:19], a[32:35], v[72:75], v[16:19]
    v_mfma_f32_16x16x32_bf16 v[20:23], a[32:35], v[76:79], v[20:23]
    v_mfma_f32_16x16x32_bf16 v[24:27], a[88:91], v[72:75], v[24:27]
    v_mfma_f32_16x16x32_bf16 v[28:31], a[88:91], v[76:79], v[28:31]
    v_mfma_f32_16x16x32_bf16 v[32:35], a[144:147], v[72:75], v[32:35]
    v_mfma_f32_16x16x32_bf16 v[36:39], a[144:147], v[76:79], v[36:39]
    v_mfma_f32_16x16x32_bf16 v[40:43], a[200:203], v[72:75], v[40:43]
    v_mfma_f32_16x16x32_bf16 v[44:47], a[200:203], v[76:79], v[44:47]
    v_mfma_f32_16x16x32_bf16 v[48:51], v[120:123], v[72:75], v[48:51]
    v_mfma_f32_16x16x32_bf16 v[52:55], v[120:123], v[76:79], v[52:55]
    v_mfma_f32_16x16x32_bf16 v[56:59], v[176:179], v[72:75], v[56:59]
    v_mfma_f32_16x16x32_bf16 v[60:63], v[176:179], v[76:79], v[60:63]
    v_mfma_f32_16x16x32_bf16 v[64:67], v[232:235], v[72:75], v[64:67]
    v_mfma_f32_16x16x32_bf16 v[68:71], v[232:235], v[76:79], v[68:71]
    ds_read_b128 v[72:75], v8 offset:640
    ds_read_b128 v[76:79], v9 offset:640
    s_waitcnt lgkmcnt(2)
    v_mfma_f32_16x16x32_bf16 v[16:19], a[36:39], v[80:83], v[16:19]
    v_mfma_f32_16x16x32_bf16 v[20:23], a[36:39], v[84:87], v[20:23]
    v_mfma_f32_16x16x32_bf16 v[24:27], a[92:95], v[80:83], v[24:27]
    v_mfma_f32_16x16x32_bf16 v[28:31], a[92:95], v[84:87], v[28:31]
    v_mfma_f32_16x16x32_bf16 v[32:35], a[148:151], v[80:83], v[32:35]
    v_mfma_f32_16x16x32_bf16 v[36:39], a[148:151], v[84:87], v[36:39]
    v_mfma_f32_16x16x32_bf16 v[40:43], a[204:207], v[80:83], v[40:43]
    v_mfma_f32_16x16x32_bf16 v[44:47], a[204:207], v[84:87], v[44:47]
    v_mfma_f32_16x16x32_bf16 v[48:51], v[124:127], v[80:83], v[48:51]
    v_mfma_f32_16x16x32_bf16 v[52:55], v[124:127], v[84:87], v[52:55]
    v_mfma_f32_16x16x32_bf16 v[56:59], v[180:183], v[80:83], v[56:59]
    v_mfma_f32_16x16x32_bf16 v[60:63], v[180:183], v[84:87], v[60:63]
    v_mfma_f32_16x16x32_bf16 v[64:67], v[236:239], v[80:83], v[64:67]
    v_mfma_f32_16x16x32_bf16 v[68:71], v[236:239], v[84:87], v[68:71]
    ds_read_b128 v[80:83], v8 offset:704
    ds_read_b128 v[84:87], v9 offset:704
    s_waitcnt lgkmcnt(2)
    v_mfma_f32_16x16x32_bf16 v[16:19], a[40:43], v[72:75], v[16:19]
    v_mfma_f32_16x16x32_bf16 v[20:23], a[40:43], v[76:79], v[20:23]
    v_mfma_f32_16x16x32_bf16 v[24:27], a[96:99], v[72:75], v[24:27]
    v_mfma_f32_16x16x32_bf16 v[28:31], a[96:99], v[76:79], v[28:31]
    v_mfma_f32_16x16x32_bf16 v[32:35], a[152:155], v[72:75], v[32:35]
    v_mfma_f32_16x16x32_bf16 v[36:39], a[152:155], v[76:79], v[36:39]
    v_mfma_f32_16x16x32_bf16 v[40:43], a[208:211], v[72:75], v[40:43]
    v_mfma_f32_16x16x32_bf16 v[44:47], a[208:211], v[76:79], v[44:47]
    v_mfma_f32_16x16x32_bf16 v[48:51], v[128:131], v[72:75], v[48:51]
    v_mfma_f32_16x16x32_bf16 v[52:55], v[128:131], v[76:79], v[52:55]
    v_mfma_f32_16x16x32_bf16 v[56:59], v[184:187], v[72:75], v[56:59]
    v_mfma_f32_16x16x32_bf16 v[60:63], v[184:187], v[76:79], v[60:63]
    v_mfma_f32_16x16x32_bf16 v[64:67], v[240:243], v[72:75], v[64:67]
    v_mfma_f32_16x16x32_bf16 v[68:71], v[240:243], v[76:79], v[68:71]
    ds_read_b128 v[72:75], v8 offset:768
    ds_read_b128 v[76:79], v9 offset:768
    s_waitcnt lgkmcnt(2)
    v_mfma_f32_16x16x32_bf16 v[16:19], a[44:47], v[80:83], v[16:19]
    v_mfma_f32_16x16x32_bf16 v[20:23], a[44:47], v[84:87], v[20:23]
    v_mfma_f32_16x16x32_bf16 v[24:27], a[100:103], v[80:83], v[24:27]
    v_mfma_f32_16x16x32_bf16 v[28:31], a[100:103], v[84:87], v[28:31]
    v_mfma_f32_16x16x32_bf16 v[32:35], a[156:159], v[80:83], v[32:35]
    v_mfma_f32_16x16x32_bf16 v[36:39], a[156:159], v[84:87], v[36:39]
    v_mfma_f32_16x16x32_bf16 v[40:43], a[212:215], v[80:83], v[40:43]
    v_mfma_f32_16x16x32_bf16 v[44:47], a[212:215], v[84:87], v[44:47]
    v_mfma_f32_16x16x32_bf16 v[48:51], v[132:135], v[80:83], v[48:51]
    v_mfma_f32_16x16x32_bf16 v[52:55], v[132:135], v[84:87], v[52:55]
    v_mfma_f32_16x16x32_bf16 v[56:59], v[188:191], v[80:83], v[56:59]
    v_mfma_f32_16x16x32_bf16 v[60:63], v[188:191], v[84:87], v[60:63]
    v_mfma_f32_16x16x32_bf16 v[64:67], v[244:247], v[80:83], v[64:67]
    v_mfma_f32_16x16x32_bf16 v[68:71], v[244:247], v[84:87], v[68:71]
    s_waitcnt vmcnt(0)
    v_cmp_eq_u32 vcc, -1, v15
    s_mov_b32 m0, s74
    s_cbranch_vccnz LXe_100221
    s_mov_b32 s73, 1
    buffer_load_dwordx4 v4, s[4:7], s59 offen sc1 lds
    buffer_load_dwordx4 v4, s[4:7], s59 offen offset:768 sc1 lds
LXe_100221:
    ds_read_b128 v[80:83], v8 offset:832
    ds_read_b128 v[84:87], v9 offset:832
    s_waitcnt lgkmcnt(2)
    v_mfma_f32_16x16x32_bf16 v[16:19], a[48:51], v[72:75], v[16:19]
    v_mfma_f32_16x16x32_bf16 v[20:23], a[48:51], v[76:79], v[20:23]
    v_mfma_f32_16x16x32_bf16 v[24:27], a[104:107], v[72:75], v[24:27]
    v_mfma_f32_16x16x32_bf16 v[28:31], a[104:107], v[76:79], v[28:31]
    v_mfma_f32_16x16x32_bf16 v[32:35], a[160:163], v[72:75], v[32:35]
    v_mfma_f32_16x16x32_bf16 v[36:39], a[160:163], v[76:79], v[36:39]
    v_mfma_f32_16x16x32_bf16 v[40:43], a[216:219], v[72:75], v[40:43]
    v_mfma_f32_16x16x32_bf16 v[44:47], a[216:219], v[76:79], v[44:47]
    v_mfma_f32_16x16x32_bf16 v[48:51], v[136:139], v[72:75], v[48:51]
    v_mfma_f32_16x16x32_bf16 v[52:55], v[136:139], v[76:79], v[52:55]
    v_mfma_f32_16x16x32_bf16 v[56:59], v[192:195], v[72:75], v[56:59]
    v_mfma_f32_16x16x32_bf16 v[60:63], v[192:195], v[76:79], v[60:63]
    v_mfma_f32_16x16x32_bf16 v[64:67], v[248:251], v[72:75], v[64:67]
    v_mfma_f32_16x16x32_bf16 v[68:71], v[248:251], v[76:79], v[68:71]
    s_waitcnt lgkmcnt(0)
    v_mfma_f32_16x16x32_bf16 v[16:19], a[52:55], v[80:83], v[16:19]
    v_mfma_f32_16x16x32_bf16 v[20:23], a[52:55], v[84:87], v[20:23]
    v_mfma_f32_16x16x32_bf16 v[24:27], a[108:111], v[80:83], v[24:27]
    v_mfma_f32_16x16x32_bf16 v[28:31], a[108:111], v[84:87], v[28:31]
    v_mfma_f32_16x16x32_bf16 v[32:35], a[164:167], v[80:83], v[32:35]
    v_mfma_f32_16x16x32_bf16 v[36:39], a[164:167], v[84:87], v[36:39]
    v_mfma_f32_16x16x32_bf16 v[40:43], a[220:223], v[80:83], v[40:43]
    v_mfma_f32_16x16x32_bf16 v[44:47], a[220:223], v[84:87], v[44:47]
    v_mfma_f32_16x16x32_bf16 v[48:51], v[140:143], v[80:83], v[48:51]
    v_mfma_f32_16x16x32_bf16 v[52:55], v[140:143], v[84:87], v[52:55]
    v_mfma_f32_16x16x32_bf16 v[56:59], v[196:199], v[80:83], v[56:59]
    v_mfma_f32_16x16x32_bf16 v[60:63], v[196:199], v[84:87], v[60:63]
    v_mfma_f32_16x16x32_bf16 v[64:67], v[252:255], v[80:83], v[64:67]
    v_mfma_f32_16x16x32_bf16 v[68:71], v[252:255], v[84:87], v[68:71]
    ds_read_b64 v[104:105], v10 offset:0
    ds_read_b64 v[106:107], v10 offset:3648
    ds_read_b64 v[108:109], v10 offset:32
    ds_read_b64 v[110:111], v10 offset:3680
    ds_read_b64 v[112:113], v10 offset:64
    ds_read_b64 v[114:115], v10 offset:3712
    ds_read_b64 v[116:117], v10 offset:96
    ds_read_b64 v[118:119], v10 offset:3744
    ds_read_b64 v[72:73], v10 offset:128
    ds_read_b64 v[74:75], v10 offset:3776
    ds_read_b64 v[76:77], v10 offset:160
    ds_read_b64 v[78:79], v10 offset:3808
    ds_read_b64 v[80:81], v10 offset:192
    ds_read_b64 v[82:83], v10 offset:3840
    v_cvt_pk_bf16_f32 v16, v16, v17
    v_cvt_pk_bf16_f32 v17, v18, v19
    v_cvt_pk_bf16_f32 v20, v20, v21
    v_cvt_pk_bf16_f32 v21, v22, v23
    v_cvt_pk_bf16_f32 v24, v24, v25
    v_cvt_pk_bf16_f32 v25, v26, v27
    v_cvt_pk_bf16_f32 v28, v28, v29
    v_cvt_pk_bf16_f32 v29, v30, v31
    v_cvt_pk_bf16_f32 v32, v32, v33
    v_cvt_pk_bf16_f32 v33, v34, v35
    v_cvt_pk_bf16_f32 v36, v36, v37
    v_cvt_pk_bf16_f32 v37, v38, v39
    v_cvt_pk_bf16_f32 v40, v40, v41
    v_cvt_pk_bf16_f32 v41, v42, v43
    v_cvt_pk_bf16_f32 v44, v44, v45
    v_cvt_pk_bf16_f32 v45, v46, v47
    v_cvt_pk_bf16_f32 v48, v48, v49
    v_cvt_pk_bf16_f32 v49, v50, v51
    v_cvt_pk_bf16_f32 v52, v52, v53
    v_cvt_pk_bf16_f32 v53, v54, v55
    v_cvt_pk_bf16_f32 v56, v56, v57
    v_cvt_pk_bf16_f32 v57, v58, v59
    v_cvt_pk_bf16_f32 v60, v60, v61
    v_cvt_pk_bf16_f32 v61, v62, v63
    v_cvt_pk_bf16_f32 v64, v64, v65
    v_cvt_pk_bf16_f32 v65, v66, v67
    v_cvt_pk_bf16_f32 v68, v68, v69
    v_cvt_pk_bf16_f32 v69, v70, v71
    s_waitcnt lgkmcnt(12)
    v_mfma_f32_16x16x16_bf16 v[88:91], v[104:105], v[16:17], 0
    v_mfma_f32_16x16x16_bf16 v[92:95], v[104:105], v[20:21], 0
    v_mfma_f32_16x16x16_bf16 v[96:99], v[106:107], v[16:17], 0
    v_mfma_f32_16x16x16_bf16 v[100:103], v[106:107], v[20:21], 0
    s_waitcnt lgkmcnt(10)
    v_mfma_f32_16x16x16_bf16 v[88:91], v[108:109], v[24:25], v[88:91]
    v_mfma_f32_16x16x16_bf16 v[92:95], v[108:109], v[28:29], v[92:95]
    v_mfma_f32_16x16x16_bf16 v[96:99], v[110:111], v[24:25], v[96:99]
    v_mfma_f32_16x16x16_bf16 v[100:103], v[110:111], v[28:29], v[100:103]
    s_waitcnt lgkmcnt(8)
    v_mfma_f32_16x16x16_bf16 v[88:91], v[112:113], v[32:33], v[88:91]
    v_mfma_f32_16x16x16_bf16 v[92:95], v[112:113], v[36:37], v[92:95]
    v_mfma_f32_16x16x16_bf16 v[96:99], v[114:115], v[32:33], v[96:99]
    v_mfma_f32_16x16x16_bf16 v[100:103], v[114:115], v[36:37], v[100:103]
    s_waitcnt lgkmcnt(6)
    v_mfma_f32_16x16x16_bf16 v[88:91], v[116:117], v[40:41], v[88:91]
    v_mfma_f32_16x16x16_bf16 v[92:95], v[116:117], v[44:45], v[92:95]
    v_mfma_f32_16x16x16_bf16 v[96:99], v[118:119], v[40:41], v[96:99]
    v_mfma_f32_16x16x16_bf16 v[100:103], v[118:119], v[44:45], v[100:103]
    s_waitcnt lgkmcnt(4)
    v_mfma_f32_16x16x16_bf16 v[88:91], v[72:73], v[48:49], v[88:91]
    v_mfma_f32_16x16x16_bf16 v[92:95], v[72:73], v[52:53], v[92:95]
    v_mfma_f32_16x16x16_bf16 v[96:99], v[74:75], v[48:49], v[96:99]
    v_mfma_f32_16x16x16_bf16 v[100:103], v[74:75], v[52:53], v[100:103]
    s_waitcnt lgkmcnt(2)
    v_mfma_f32_16x16x16_bf16 v[88:91], v[76:77], v[56:57], v[88:91]
    v_mfma_f32_16x16x16_bf16 v[92:95], v[76:77], v[60:61], v[92:95]
    v_mfma_f32_16x16x16_bf16 v[96:99], v[78:79], v[56:57], v[96:99]
    v_mfma_f32_16x16x16_bf16 v[100:103], v[78:79], v[60:61], v[100:103]
    s_waitcnt lgkmcnt(0)
    v_mfma_f32_16x16x16_bf16 v[88:91], v[80:81], v[64:65], v[88:91]
    v_mfma_f32_16x16x16_bf16 v[92:95], v[80:81], v[68:69], v[92:95]
    v_mfma_f32_16x16x16_bf16 v[96:99], v[82:83], v[64:65], v[96:99]
    v_mfma_f32_16x16x16_bf16 v[100:103], v[82:83], v[68:69], v[100:103]
    s_nop 7
    ds_write_b128 v12, v[88:91] offset:0
    ds_write_b128 v12, v[92:95] offset:1024
    ds_write_b128 v12, v[96:99] offset:2048
    ds_write_b128 v12, v[100:103] offset:3072
    s_waitcnt lgkmcnt(0)
    s_barrier
    s_cmp_ge_u32 s16, 2
    s_cbranch_scc1 LXr1_100222
    ds_read_b128 v[72:75], v13 offset:0
    ds_read_b128 v[76:79], v13 offset:4096
    ds_read_b128 v[80:83], v13 offset:8192
    ds_read_b128 v[84:87], v13 offset:12288
    s_waitcnt lgkmcnt(0)
    v_add_f32 v72, v72, v76
    v_add_f32 v80, v80, v84
    v_add_f32 v88, v72, v80
    v_add_f32 v73, v73, v77
    v_add_f32 v81, v81, v85
    v_add_f32 v89, v73, v81
    v_add_f32 v74, v74, v78
    v_add_f32 v82, v82, v86
    v_add_f32 v90, v74, v82
    v_add_f32 v75, v75, v79
    v_add_f32 v83, v83, v87
    v_add_f32 v91, v75, v83
    ds_read_b128 v[72:75], v13 offset:2048
    ds_read_b128 v[76:79], v13 offset:6144
    ds_read_b128 v[80:83], v13 offset:10240
    ds_read_b128 v[84:87], v13 offset:14336
    s_waitcnt lgkmcnt(0)
    v_add_f32 v72, v72, v76
    v_add_f32 v80, v80, v84
    v_add_f32 v92, v72, v80
    v_add_f32 v73, v73, v77
    v_add_f32 v81, v81, v85
    v_add_f32 v93, v73, v81
    v_add_f32 v74, v74, v78
    v_add_f32 v82, v82, v86
    v_add_f32 v94, v74, v82
    v_add_f32 v75, v75, v79
    v_add_f32 v83, v83, v87
    v_add_f32 v95, v75, v83
    s_lshl_b32 s25, s16, 4
    v_add_u32 v5, s25, v3
    v_lshlrev_b32 v15, 3, v2
    v_sub_u32 v5, v5, v15
    v_mov_b32 v15, 0xf149f2ca
    v_cmp_le_i32 vcc, 0, v5
    s_nop 1
    v_cndmask_b32 v88, v15, v88, vcc
    v_cmp_le_i32 vcc, 1, v5
    s_nop 1
    v_cndmask_b32 v89, v15, v89, vcc
    v_cmp_le_i32 vcc, 2, v5
    s_nop 1
    v_cndmask_b32 v90, v15, v90, vcc
    v_cmp_le_i32 vcc, 3, v5
    s_nop 1
    v_cndmask_b32 v91, v15, v91, vcc
    v_cmp_le_i32 vcc, 4, v5
    s_nop 1
    v_cndmask_b32 v92, v15, v92, vcc
    v_cmp_le_i32 vcc, 5, v5
    s_nop 1
    v_cndmask_b32 v93, v15, v93, vcc
    v_cmp_le_i32 vcc, 6, v5
    s_nop 1
    v_cndmask_b32 v94, v15, v94, vcc
    v_cmp_le_i32 vcc, 7, v5
    s_nop 1
    v_cndmask_b32 v95, v15, v95, vcc
LXr1_100222:
    s_cmp_eq_u32 s73, 0
    s_cbranch_scc1 LXn_100225
    s_waitcnt vmcnt(0)
    v_add_u32 v5, 0, v11
    ds_read2_b32 v[72:73], v5 offset0:0 offset1:4
    v_add_u32 v5, 256, v11
    ds_read2_b32 v[74:75], v5 offset0:0 offset1:4
    v_add_u32 v5, 512, v11
    ds_read2_b32 v[76:77], v5 offset0:0 offset1:4
    v_add_u32 v5, 768, v11
    ds_read2_b32 v[78:79], v5 offset0:0 offset1:4
    v_add_u32 v5, 1024, v11
    ds_read2_b32 v[80:81], v5 offset0:0 offset1:4
    v_add_u32 v5, 1280, v11
    ds_read2_b32 v[82:83], v5 offset0:0 offset1:4
    v_add_u32 v5, 1536, v11
    ds_read2_b32 v[84:85], v5 offset0:0 offset1:4
    s_waitcnt lgkmcnt(0)
    v_max_u32 v5, v72, v73
    v_max3_u32 v5, v5, v74, v75
    v_max3_u32 v5, v5, v76, v77
    v_max3_u32 v5, v5, v78, v79
    v_max3_u32 v5, v5, v80, v81
    v_max3_u32 v5, v5, v82, v83
    v_max3_u32 v5, v5, v84, v85
    v_cmp_eq_u32 vcc, -1, v5
    s_cbranch_vccz LXh_100226
LXn_100225:
    s_min_u32 s60, s56, 62
    s_lshl_b32 s60, s60, 13
    s_add_u32 s60, s60, 0x2b81bfc
    v_mov_b32 v15, 0
Lxgp_100227:
    buffer_load_dword v5, v15, s[4:7], s60 offen sc1
    s_waitcnt vmcnt(0)
    v_cmp_eq_u32 vcc, -1, v5
    s_cbranch_vccz Lxggo_100228
    s_sleep 1
    s_sub_u32 s24, s24, 1
    s_cbranch_scc1 Lexit2_100184
    s_branch Lxgp_100227
Lxggo_100228:
LXm_100223:
    buffer_load_dwordx4 v[104:107], v4, s[4:7], s59 offen sc1
    buffer_load_dwordx4 v[108:111], v4, s[4:7], s59 offen offset:768 sc1
    s_waitcnt vmcnt(0)
    v_max3_u32 v5, v104, v105, v106
    v_max3_u32 v5, v5, v107, v108
    v_max3_u32 v5, v5, v109, v110
    v_max_u32 v5, v5, v111
    v_cmp_eq_u32 vcc, -1, v5
    s_cbranch_vccz LXmo_100224
    s_sub_u32 s24, s24, 1
    s_cbranch_scc1 Lexit2_100184
    s_branch LXm_100223
LXmo_100224:
    ds_write_b128 v14, v[104:107]
    ds_write_b128 v14, v[108:111] offset:768
    v_add_u32 v5, 0, v11
    ds_read2_b32 v[72:73], v5 offset0:0 offset1:4
    v_add_u32 v5, 256, v11
    ds_read2_b32 v[74:75], v5 offset0:0 offset1:4
    v_add_u32 v5, 512, v11
    ds_read2_b32 v[76:77], v5 offset0:0 offset1:4
    v_add_u32 v5, 768, v11
    ds_read2_b32 v[78:79], v5 offset0:0 offset1:4
    v_add_u32 v5, 1024, v11
    ds_read2_b32 v[80:81], v5 offset0:0 offset1:4
    v_add_u32 v5, 1280, v11
    ds_read2_b32 v[82:83], v5 offset0:0 offset1:4
    v_add_u32 v5, 1536, v11
    ds_read2_b32 v[84:85], v5 offset0:0 offset1:4
    s_waitcnt lgkmcnt(0)
LXh_100226:
    v_mfma_f32_16x16x16_bf16 v[96:99], v[72:73], v[16:17], 0
    v_mfma_f32_16x16x16_bf16 v[100:103], v[72:73], v[20:21], 0
    v_mfma_f32_16x16x16_bf16 v[96:99], v[74:75], v[24:25], v[96:99]
    v_mfma_f32_16x16x16_bf16 v[100:103], v[74:75], v[28:29], v[100:103]
    v_mfma_f32_16x16x16_bf16 v[96:99], v[76:77], v[32:33], v[96:99]
    v_mfma_f32_16x16x16_bf16 v[100:103], v[76:77], v[36:37], v[100:103]
    v_mfma_f32_16x16x16_bf16 v[96:99], v[78:79], v[40:41], v[96:99]
    v_mfma_f32_16x16x16_bf16 v[100:103], v[78:79], v[44:45], v[100:103]
    v_mfma_f32_16x16x16_bf16 v[96:99], v[80:81], v[48:49], v[96:99]
    v_mfma_f32_16x16x16_bf16 v[100:103], v[80:81], v[52:53], v[100:103]
    v_mfma_f32_16x16x16_bf16 v[96:99], v[82:83], v[56:57], v[96:99]
    v_mfma_f32_16x16x16_bf16 v[100:103], v[82:83], v[60:61], v[100:103]
    v_mfma_f32_16x16x16_bf16 v[96:99], v[84:85], v[64:65], v[96:99]
    v_mfma_f32_16x16x16_bf16 v[100:103], v[84:85], v[68:69], v[100:103]
    s_barrier
    s_nop 6
    ds_write_b64 v12, v[96:97] offset:0
    ds_write_b64 v12, v[100:101] offset:1024
    s_waitcnt lgkmcnt(0)
    s_barrier
    s_cmp_ge_u32 s16, 2
    s_cbranch_scc1 LXr2_100229
    ds_read_b64 v[72:73], v13 offset:0
    ds_read_b64 v[74:75], v13 offset:4096
    ds_read_b64 v[76:77], v13 offset:8192
    ds_read_b64 v[78:79], v13 offset:12288
    s_waitcnt lgkmcnt(0)
    v_add_f32 v72, v72, v74
    v_add_f32 v76, v76, v78
    v_add_f32 v96, v72, v76
    v_add_f32 v73, v73, v75
    v_add_f32 v77, v77, v79
    v_add_f32 v97, v73, v77
    v_max3_f32 v5, v88, v89, v90
    v_max3_f32 v5, v5, v91, v92
    v_max3_f32 v5, v5, v93, v94
    v_max3_f32 v5, v5, v95, v96
    v_max_f32 v5, v5, v97
    v_mov_b32 v15, v5
    s_nop 1
    v_permlane16_swap_b32 v5, v15
    v_max_f32 v5, v5, v15
    v_mov_b32 v15, v5
    s_nop 1
    v_permlane32_swap_b32 v5, v15
    v_max_f32 v5, v5, v15
    v_sub_f32 v88, v88, v5
    v_sub_f32 v89, v89, v5
    v_sub_f32 v90, v90, v5
    v_sub_f32 v91, v91, v5
    v_sub_f32 v92, v92, v5
    v_sub_f32 v93, v93, v5
    v_sub_f32 v94, v94, v5
    v_sub_f32 v95, v95, v5
    v_sub_f32 v96, v96, v5
    v_sub_f32 v97, v97, v5
    v_exp_f32 v88, v88
    v_exp_f32 v89, v89
    v_exp_f32 v90, v90
    v_exp_f32 v91, v91
    v_exp_f32 v92, v92
    v_exp_f32 v93, v93
    v_exp_f32 v94, v94
    v_exp_f32 v95, v95
    v_exp_f32 v96, v96
    v_exp_f32 v97, v97
    v_add_f32 v5, v88, v89
    v_add_f32 v5, v5, v90
    v_add_f32 v5, v5, v91
    v_add_f32 v5, v5, v92
    v_add_f32 v5, v5, v93
    v_add_f32 v5, v5, v94
    v_add_f32 v5, v5, v95
    v_add_f32 v5, v5, v96
    v_add_f32 v5, v5, v97
    v_mov_b32 v15, v5
    s_nop 1
    v_permlane16_swap_b32 v5, v15
    v_add_f32 v5, v5, v15
    v_mov_b32 v15, v5
    s_nop 1
    v_permlane32_swap_b32 v5, v15
    v_add_f32 v5, v5, v15
    v_rcp_f32 v5, v5
    s_nop 0
    v_mul_f32 v88, v88, v5
    v_mul_f32 v89, v89, v5
    v_mul_f32 v90, v90, v5
    v_mul_f32 v91, v91, v5
    v_mul_f32 v92, v92, v5
    v_mul_f32 v93, v93, v5
    v_mul_f32 v94, v94, v5
    v_mul_f32 v95, v95, v5
    v_mul_f32 v96, v96, v5
    v_mul_f32 v97, v97, v5
    v_cvt_pk_bf16_f32 v72, v88, v89
    v_min_u32 v72, -2, v72
    v_cvt_pk_bf16_f32 v73, v90, v91
    v_min_u32 v73, -2, v73
    v_cvt_pk_bf16_f32 v74, v92, v93
    v_min_u32 v74, -2, v74
    v_cvt_pk_bf16_f32 v75, v94, v95
    v_min_u32 v75, -2, v75
    v_cvt_pk_bf16_f32 v76, v96, v97
    v_min_u32 v76, -2, v76
    s_mul_i32 s25, s56, 40960
    s_mul_i32 s26, s16, 20480
    s_add_u32 s25, s25, s26
    s_add_u32 s25, s25, 0x3400000
    s_lshl_b32 s26, s57, 10
    s_add_u32 s26, s26, s25
    buffer_store_dwordx4 v[72:75], v4, s[4:7], s26 offen sc1
    s_lshl_b32 s26, s57, 8
    s_add_u32 s25, s25, s26
    s_add_u32 s25, s25, 16384
    v_lshlrev_b32 v15, 2, v1
    buffer_store_dword v76, v15, s[4:7], s25 offen sc1
    s_lshl_b32 s25, s56, 9
    s_lshl_b32 s26, s16, 6
    s_add_u32 s25, s25, s26
    s_lshl_b32 s26, s57, 2
    s_add_u32 s25, s25, s26
    s_add_u32 s61, s25, 0x3d20100
LXr2_100229:
    s_barrier
    s_add_u32 s56, s56, 3
    s_cmp_lt_u32 s56, 64
    s_cbranch_scc1 LXloop_100220
    s_waitcnt vmcnt(0)
    v_mov_b32 v5, 1
    s_mov_b64 exec, 1
    buffer_store_dword v5, off, s[4:7], s61 sc1
    s_mov_b64 exec, -1
    s_nop 3
    s_endpgm
LrolePV_100027:
    v_and_b32 v1, 63, v0
    v_lshrrev_b32 v2, 4, v1
    v_and_b32 v3, 15, v1
    v_lshlrev_b32 v4, 4, v1
    s_mul_i32 s56, s17, 4682
    s_lshr_b32 s56, s56, 16
    s_mul_i32 s25, s56, 14
    s_sub_u32 s25, s17, s25
    s_and_b32 s60, s25, 1
    s_lshr_b32 s61, s25, 1
    s_mov_b32 s24, 300000
    v_mov_b32 v6, 0
    v_and_b32 v5, 3, v1
    v_lshlrev_b32 v7, 2, v5
    s_lshl_b32 s25, s60, 6
    s_lshl_b32 s26, s16, 4
    s_add_u32 s25, s25, s26
    s_add_u32 s25, s25, 256
    v_add_u32 v7, s25, v7
    v_lshlrev_b32 v8, 2, v3
    s_lshl_b32 s25, s16, 6
    v_add_u32 v8, s25, v8
    v_cmp_gt_u32 vcc, 16, v1
    s_nop 1
    v_cndmask_b32 v7, v7, v8, vcc
    v_lshlrev_b32 v8, 2, v1
    s_lshl_b32 s25, s16, 12
    v_add_u32 v9, s25, v4
    s_lshl_b32 s25, s16, 10
    v_add_u32 v10, s25, v4
    v_mul_u32_u24 v11, 1792, v3
    v_lshl_add_u32 v11, v2, 3, v11
    s_mul_i32 s25, s60, 28672
    s_lshl_b32 s26, s61, 7
    s_add_u32 s25, s25, s26
    s_lshl_b32 s26, s16, 5
    s_add_u32 s25, s25, s26
    s_add_u32 s25, s25, 896
    v_add_u32 v11, s25, v11
    s_cmp_lg_u32 s16, 0
    s_cbranch_scc1 Lpcg_100231
    v_and_b32 v16, 31, v0
    v_add_lshl_u32 v16, v16, 0, 2
Lpcw_100230:
    s_sleep 127
    s_sleep 127
    buffer_load_dword v17, v16, s[12:15], 0 offen offset:64 sc1
    s_waitcnt vmcnt(0)
    v_cmp_gt_u32 vcc, 8, v17
    s_cbranch_vccz Lpcg_100231
    s_sub_u32 s24, s24, 40
    s_cbranch_scc1 Lexit2_100184
    s_branch Lpcw_100230
Lpcg_100231:
    s_barrier
    s_cmp_lg_u32 s16, 0
    s_cbranch_scc1 Lys_100232
    v_mov_b32 v16, 0
    s_mov_b32 s58, 0x2a8f800
Lpyp_100233:
    buffer_load_dword v17, v16, s[4:7], s58 offen sc1
    s_waitcnt vmcnt(0)
    v_cmp_ne_u32 vcc, 15, v17
    s_cbranch_vccz Lpygo_100234
    s_sleep 30
    s_sub_u32 s24, s24, 1
    s_cbranch_scc1 Lexit2_100184
    s_branch Lpyp_100233
Lpygo_100234:
Lys_100232:
    s_barrier
LPVloop_100235:
    s_lshl_b32 s59, s56, 9
    s_add_u32 s59, s59, 0x3d20000
    s_cmp_ge_u32 s56, 0
    s_cbranch_scc1 LPVpre_100239
Lf0p_100241:
    buffer_load_dword v5, v7, s[4:7], s59 offen sc1
    s_waitcnt vmcnt(0)
    v_cmp_ne_u32 vcc, 1, v5
    s_cbranch_vccz Lf0go_100242
    s_sleep 2
    s_sub_u32 s24, s24, 1
    s_cbranch_scc1 Lexit2_100184
    s_branch Lf0p_100241
Lf0go_100242:
    s_branch LPVvx_100240
LPVpre_100239:
    s_lshl_b32 s58, s56, 14
    s_add_u32 s58, s58, 0x2a83800
Lcvp_100243:
    buffer_load_dword v5, v6, s[4:7], s58 offen sc1
    s_waitcnt vmcnt(0)
    v_cmp_ne_u32 vcc, 15, v5
    s_cbranch_vccz Lcvgo_100244
    s_sleep 4
    s_sub_u32 s24, s24, 1
    s_cbranch_scc1 Lexit2_100184
    s_branch Lcvp_100243
Lcvgo_100244:
LPVvx_100240:
    s_mul_i32 s25, s56, 458752
    s_lshl_b32 s26, s61, 16
    s_add_u32 s25, s25, s26
    s_lshl_b32 s26, s16, 12
    s_add_u32 s25, s25, s26
    s_add_u32 s25, s25, 0xe00000
    buffer_load_dwordx4 v[16:19], v4, s[4:7], s25 offen offset:0 sc1
    buffer_load_dwordx4 v[20:23], v4, s[4:7], s25 offen offset:1024 sc1
    buffer_load_dwordx4 v[24:27], v4, s[4:7], s25 offen offset:2048 sc1
    buffer_load_dwordx4 v[28:31], v4, s[4:7], s25 offen offset:3072 sc1
    s_add_u32 s25, s25, 16384
    buffer_load_dwordx4 v[32:35], v4, s[4:7], s25 offen offset:0 sc1
    buffer_load_dwordx4 v[36:39], v4, s[4:7], s25 offen offset:1024 sc1
    buffer_load_dwordx4 v[40:43], v4, s[4:7], s25 offen offset:2048 sc1
    buffer_load_dwordx4 v[44:47], v4, s[4:7], s25 offen offset:3072 sc1
    s_add_u32 s25, s25, 16384
    buffer_load_dwordx4 v[48:51], v4, s[4:7], s25 offen offset:0 sc1
    buffer_load_dwordx4 v[52:55], v4, s[4:7], s25 offen offset:1024 sc1
    buffer_load_dwordx4 v[56:59], v4, s[4:7], s25 offen offset:2048 sc1
    buffer_load_dwordx4 v[60:63], v4, s[4:7], s25 offen offset:3072 sc1
    s_add_u32 s25, s25, 16384
    buffer_load_dwordx4 v[64:67], v4, s[4:7], s25 offen offset:0 sc1
    buffer_load_dwordx4 v[68:71], v4, s[4:7], s25 offen offset:1024 sc1
    buffer_load_dwordx4 v[72:75], v4, s[4:7], s25 offen offset:2048 sc1
    buffer_load_dwordx4 v[76:79], v4, s[4:7], s25 offen offset:3072 sc1
    s_add_u32 s25, s25, 16384
    s_cmp_lt_u32 s56, 0
    s_cbranch_scc1 LPVld_100237
    s_cmp_ge_u32 s56, 62
    s_cbranch_scc1 LPVlast_100236
Lfxp_100245:
    buffer_load_dword v5, v7, s[4:7], s59 offen sc1
    s_waitcnt vmcnt(0)
    v_cmp_ne_u32 vcc, 1, v5
    s_cbranch_vccz Lfxgo_100246
    s_sleep 2
    s_sub_u32 s24, s24, 1
    s_cbranch_scc1 Lexit2_100184
    s_branch Lfxp_100245
Lfxgo_100246:
    s_branch LPVld_100237
LPVlast_100236:
    s_lshl_b32 s58, s56, 13
    s_add_u32 s58, s58, 0x2b81bfc
Lpgp_100247:
    buffer_load_dword v5, v6, s[4:7], s58 offen sc1
    s_waitcnt vmcnt(0)
    v_cmp_eq_u32 vcc, -1, v5
    s_cbranch_vccz Lpggo_100248
    s_sleep 1
    s_sub_u32 s24, s24, 1
    s_cbranch_scc1 Lexit2_100184
    s_branch Lpgp_100247
Lpggo_100248:
LPVld_100237:
    s_mul_i32 s25, s56, 40960
    s_mul_i32 s26, s60, 20480
    s_add_u32 s25, s25, s26
    s_add_u32 s25, s25, 0x3400000
    s_lshl_b32 s26, s16, 12
    s_add_u32 s26, s26, s25
    buffer_load_dwordx4 v[96:99], v4, s[4:7], s26 offen offset:0 sc1
    buffer_load_dwordx4 v[100:103], v4, s[4:7], s26 offen offset:1024 sc1
    buffer_load_dwordx4 v[104:107], v4, s[4:7], s26 offen offset:2048 sc1
    buffer_load_dwordx4 v[108:111], v4, s[4:7], s26 offen offset:3072 sc1
    s_lshl_b32 s26, s16, 10
    s_add_u32 s25, s25, s26
    s_add_u32 s25, s25, 16384
    buffer_load_dword v112, v8, s[4:7], s25 offen offset:0 sc1
    buffer_load_dword v113, v8, s[4:7], s25 offen offset:256 sc1
    buffer_load_dword v114, v8, s[4:7], s25 offen offset:512 sc1
    buffer_load_dword v115, v8, s[4:7], s25 offen offset:768 sc1
    s_mul_i32 s25, s56, 114688
    s_lshl_b32 s26, s61, 14
    s_add_u32 s25, s25, s26
    s_lshl_b32 s26, s16, 10
    s_add_u32 s25, s25, s26
    s_add_u32 s25, s25, 0x2d00000
    buffer_load_dword v80, v8, s[4:7], s25 offen offset:0 sc1
    buffer_load_dword v81, v8, s[4:7], s25 offen offset:256 sc1
    buffer_load_dword v82, v8, s[4:7], s25 offen offset:512 sc1
    buffer_load_dword v83, v8, s[4:7], s25 offen offset:768 sc1
    s_add_u32 s25, s25, 4096
    buffer_load_dword v84, v8, s[4:7], s25 offen offset:0 sc1
    buffer_load_dword v85, v8, s[4:7], s25 offen offset:256 sc1
    buffer_load_dword v86, v8, s[4:7], s25 offen offset:512 sc1
    buffer_load_dword v87, v8, s[4:7], s25 offen offset:768 sc1
    s_add_u32 s25, s25, 4096
    buffer_load_dword v88, v8, s[4:7], s25 offen offset:0 sc1
    buffer_load_dword v89, v8, s[4:7], s25 offen offset:256 sc1
    buffer_load_dword v90, v8, s[4:7], s25 offen offset:512 sc1
    buffer_load_dword v91, v8, s[4:7], s25 offen offset:768 sc1
    s_add_u32 s25, s25, 4096
    buffer_load_dword v92, v8, s[4:7], s25 offen offset:0 sc1
    buffer_load_dword v93, v8, s[4:7], s25 offen offset:256 sc1
    buffer_load_dword v94, v8, s[4:7], s25 offen offset:512 sc1
    buffer_load_dword v95, v8, s[4:7], s25 offen offset:768 sc1
    s_add_u32 s25, s25, 4096
    s_waitcnt vmcnt(23)
    v_mfma_f32_16x16x32_bf16 v[116:119], v[16:19], v[96:99], 0
    v_mfma_f32_16x16x32_bf16 v[120:123], v[32:35], v[96:99], 0
    v_mfma_f32_16x16x32_bf16 v[124:127], v[48:51], v[96:99], 0
    v_mfma_f32_16x16x32_bf16 v[128:131], v[64:67], v[96:99], 0
    s_waitcnt vmcnt(22)
    v_mfma_f32_16x16x32_bf16 v[116:119], v[20:23], v[100:103], v[116:119]
    v_mfma_f32_16x16x32_bf16 v[120:123], v[36:39], v[100:103], v[120:123]
    v_mfma_f32_16x16x32_bf16 v[124:127], v[52:55], v[100:103], v[124:127]
    v_mfma_f32_16x16x32_bf16 v[128:131], v[68:71], v[100:103], v[128:131]
    s_waitcnt vmcnt(21)
    v_mfma_f32_16x16x32_bf16 v[116:119], v[24:27], v[104:107], v[116:119]
    v_mfma_f32_16x16x32_bf16 v[120:123], v[40:43], v[104:107], v[120:123]
    v_mfma_f32_16x16x32_bf16 v[124:127], v[56:59], v[104:107], v[124:127]
    v_mfma_f32_16x16x32_bf16 v[128:131], v[72:75], v[104:107], v[128:131]
    s_waitcnt vmcnt(20)
    v_mfma_f32_16x16x32_bf16 v[116:119], v[28:31], v[108:111], v[116:119]
    v_mfma_f32_16x16x32_bf16 v[120:123], v[44:47], v[108:111], v[120:123]
    v_mfma_f32_16x16x32_bf16 v[124:127], v[60:63], v[108:111], v[124:127]
    v_mfma_f32_16x16x32_bf16 v[128:131], v[76:79], v[108:111], v[128:131]
    s_waitcnt vmcnt(0)
    v_max3_u32 v5, v80, v81, v82
    v_max_u32 v5, v5, v83
    v_max3_u32 v5, v5, v84, v85
    v_max3_u32 v5, v5, v86, v87
    v_max3_u32 v5, v5, v88, v89
    v_max3_u32 v5, v5, v90, v91
    v_max3_u32 v5, v5, v92, v93
    v_max3_u32 v5, v5, v94, v95
    v_max3_u32 v5, v5, v96, v97
    v_max3_u32 v5, v5, v98, v99
    v_max3_u32 v5, v5, v100, v101
    v_max3_u32 v5, v5, v102, v103
    v_max3_u32 v5, v5, v104, v105
    v_max3_u32 v5, v5, v106, v107
    v_max3_u32 v5, v5, v108, v109
    v_max3_u32 v5, v5, v110, v111
    v_max3_u32 v5, v5, v112, v113
    v_max3_u32 v5, v5, v114, v115
    v_cmp_eq_u32 vcc, -1, v5
    s_cbranch_vccz LPVok_100238
    s_sub_u32 s24, s24, 1
    s_cbranch_scc1 Lexit2_100184
    s_branch LPVld_100237
LPVok_100238:
    v_mfma_f32_16x16x32_bf16 v[116:119], v[80:83], v[112:115], v[116:119]
    v_mfma_f32_16x16x32_bf16 v[120:123], v[84:87], v[112:115], v[120:123]
    v_mfma_f32_16x16x32_bf16 v[124:127], v[88:91], v[112:115], v[124:127]
    v_mfma_f32_16x16x32_bf16 v[128:131], v[92:95], v[112:115], v[128:131]
    s_nop 7
    ds_write_b128 v9, v[116:119] offset:0
    ds_write_b128 v9, v[120:123] offset:1024
    ds_write_b128 v9, v[124:127] offset:2048
    ds_write_b128 v9, v[128:131] offset:3072
    s_waitcnt lgkmcnt(0)
    s_barrier
    ds_read_b128 v[132:135], v10 offset:0
    ds_read_b128 v[136:139], v10 offset:4096
    ds_read_b128 v[140:143], v10 offset:8192
    ds_read_b128 v[144:147], v10 offset:12288
    s_waitcnt lgkmcnt(0)
    s_barrier
    v_add_f32 v132, v132, v136
    v_add_f32 v140, v140, v144
    v_add_f32 v132, v132, v140
    v_add_f32 v133, v133, v137
    v_add_f32 v141, v141, v145
    v_add_f32 v133, v133, v141
    v_add_f32 v134, v134, v138
    v_add_f32 v142, v142, v146
    v_add_f32 v134, v134, v142
    v_add_f32 v135, v135, v139
    v_add_f32 v143, v143, v147
    v_add_f32 v135, v135, v143
    v_cvt_pk_bf16_f32 v136, v132, v133
    v_cvt_pk_bf16_f32 v137, v134, v135
    s_mul_i32 s25, s56, 57344
    buffer_store_dwordx2 v[136:137], v11, s[48:51], s25 offen
    s_add_u32 s56, s56, 3
    s_cmp_lt_u32 s56, 64
    s_cbranch_scc1 LPVloop_100235
    s_endpgm
LroleL_100026:
    s_cmp_lg_u32 s16, 0
    s_cbranch_scc1 Llcg_100250
    v_and_b32 v14, 31, v0
    v_add_lshl_u32 v14, v14, 0, 2
Llcw_100249:
    s_sleep 127
    s_sleep 127
    buffer_load_dword v15, v14, s[12:15], 0 offen offset:64 sc1
    s_waitcnt vmcnt(0)
    v_cmp_gt_u32 vcc, 8, v15
    s_cbranch_vccz Llcg_100250
    s_sub_u32 s24, s24, 40
    s_cbranch_scc1 Lexit2_100184
    s_branch Llcw_100249
Llcg_100250:
    s_barrier
    s_cmp_lg_u32 s16, 0
    s_cbranch_scc1 Lys_100251
    v_mov_b32 v14, 0
    s_mov_b32 s58, 0x2a8f800
Llyp_100252:
    buffer_load_dword v15, v14, s[4:7], s58 offen sc1
    s_waitcnt vmcnt(0)
    v_cmp_ne_u32 vcc, 15, v15
    s_cbranch_vccz Llygo_100253
    s_sleep 30
    s_sub_u32 s24, s24, 1
    s_cbranch_scc1 Lexit2_100184
    s_branch Llyp_100252
Llygo_100253:
Lys_100251:
    s_barrier
    v_and_b32 v1, 63, v0
    v_lshrrev_b32 v2, 4, v1
    v_and_b32 v3, 15, v1
    v_lshlrev_b32 v4, 4, v1
    s_mov_b32 s62, 0
    s_mov_b32 s24, 300000
    s_mov_b32 s61, 0x3fb8aa3b
    s_mov_b32 s57, 0x358637bd
    s_mul_i32 s77, s17, 2
    s_add_u32 s77, s77, 0
    s_mov_b32 s62, 0
    s_mul_i32 s25, s77, 28672
    s_mul_i32 s26, s16, 7168
    s_add_u32 s25, s25, s26
    s_mul_i32 s26, s16, 7296
    s_add_u32 s26, s26, s62
    s_mov_b32 exec_hi, 0x00ffffff
    s_mov_b32 m0, s26
    s_add_u32 s26, s26, 912
    buffer_load_dwordx4 v4, s[52:55], s25 offen lds
    s_add_u32 s25, s25, 896
    s_mov_b32 m0, s26
    s_add_u32 s26, s26, 912
    buffer_load_dwordx4 v4, s[52:55], s25 offen lds
    s_add_u32 s25, s25, 896
    s_mov_b32 m0, s26
    s_add_u32 s26, s26, 912
    buffer_load_dwordx4 v4, s[52:55], s25 offen lds
    s_add_u32 s25, s25, 896
    s_mov_b32 m0, s26
    s_add_u32 s26, s26, 912
    buffer_load_dwordx4 v4, s[52:55], s25 offen lds
    s_add_u32 s25, s25, 896
    s_mov_b32 m0, s26
    s_add_u32 s26, s26, 912
    buffer_load_dwordx4 v4, s[52:55], s25 offen lds
    s_add_u32 s25, s25, 896
    s_mov_b32 m0, s26
    s_add_u32 s26, s26, 912
    buffer_load_dwordx4 v4, s[52:55], s25 offen lds
    s_add_u32 s25, s25, 896
    s_mov_b32 m0, s26
    s_add_u32 s26, s26, 912
    buffer_load_dwordx4 v4, s[52:55], s25 offen lds
    s_add_u32 s25, s25, 896
    s_mov_b32 m0, s26
    s_add_u32 s26, s26, 912
    buffer_load_dwordx4 v4, s[52:55], s25 offen lds
    s_add_u32 s25, s25, 896
    s_mov_b32 exec_hi, -1
    s_mul_i32 s77, s17, 2
    s_add_u32 s77, s77, 1
    s_mov_b32 s62, 32768
    s_mul_i32 s25, s77, 28672
    s_mul_i32 s26, s16, 7168
    s_add_u32 s25, s25, s26
    s_mul_i32 s26, s16, 7296
    s_add_u32 s26, s26, s62
    s_mov_b32 exec_hi, 0x00ffffff
    s_mov_b32 m0, s26
    s_add_u32 s26, s26, 912
    buffer_load_dwordx4 v4, s[52:55], s25 offen lds
    s_add_u32 s25, s25, 896
    s_mov_b32 m0, s26
    s_add_u32 s26, s26, 912
    buffer_load_dwordx4 v4, s[52:55], s25 offen lds
    s_add_u32 s25, s25, 896
    s_mov_b32 m0, s26
    s_add_u32 s26, s26, 912
    buffer_load_dwordx4 v4, s[52:55], s25 offen lds
    s_add_u32 s25, s25, 896
    s_mov_b32 m0, s26
    s_add_u32 s26, s26, 912
    buffer_load_dwordx4 v4, s[52:55], s25 offen lds
    s_add_u32 s25, s25, 896
    s_mov_b32 m0, s26
    s_add_u32 s26, s26, 912
    buffer_load_dwordx4 v4, s[52:55], s25 offen lds
    s_add_u32 s25, s25, 896
    s_mov_b32 m0, s26
    s_add_u32 s26, s26, 912
    buffer_load_dwordx4 v4, s[52:55], s25 offen lds
    s_add_u32 s25, s25, 896
    s_mov_b32 m0, s26
    s_add_u32 s26, s26, 912
    buffer_load_dwordx4 v4, s[52:55], s25 offen lds
    s_add_u32 s25, s25, 896
    s_mov_b32 m0, s26
    s_add_u32 s26, s26, 912
    buffer_load_dwordx4 v4, s[52:55], s25 offen lds
    s_add_u32 s25, s25, 896
    s_mov_b32 exec_hi, -1
    s_waitcnt vmcnt(0)
    v_lshlrev_b32 v8, 2, v1
    v_mov_b32 v12, 0
    v_lshrrev_b32 v5, 2, v3
    v_lshlrev_b32 v6, 3, v5
    v_and_b32 v5, 3, v3
    v_add_u32 v6, v6, v5
    v_mul_u32_u24 v7, 912, v6
    v_lshl_add_u32 v7, v2, 4, v7
    v_mul_u32_u24 v11, 1792, v6
    v_lshl_add_u32 v11, v2, 3, v11
    s_mul_i32 s25, s17, 114688
    s_mul_i32 s26, s16, 224
    s_add_u32 s25, s25, s26
    v_add_u32 v11, s25, v11
    v_cmp_gt_u32 vcc, 12, v3
    s_nop 1
    v_cndmask_b32 v9, 0, -1, vcc
    v_mov_b32 v5, 0x3f803f80
    v_cmp_eq_u32 vcc, 12, v3
    s_nop 1
    v_cndmask_b32 v10, 0, v5, vcc
    s_mul_i32 s25, s16, 16384
    s_add_u32 s25, s25, 65536
    v_add_u32 v13, s25, v4
    s_load_dwordx2 s[64:65], s[0:1], 8
    s_mov_b32 s66, 0x126000
    s_mov_b32 s67, 0x00020000
    s_load_dwordx2 s[68:69], s[0:1], 16
    s_mov_b32 s70, 0x62000
    s_mov_b32 s71, 0x00020000
    s_lshl_b32 s72, s17, 2
    s_add_u32 s72, s72, s16
    s_waitcnt lgkmcnt(0)
    s_add_u32 s73, s72, 0
    s_mul_i32 s74, s73, 18725
    s_lshr_b32 s74, s74, 18
    s_mul_i32 s75, s74, 14
    s_sub_u32 s75, s73, s75
    s_mul_i32 s75, s75, 86016
    s_lshr_b32 s76, s74, 1
    s_mul_i32 s76, s76, 56
    s_add_u32 s75, s75, s76
    s_and_b32 s74, s74, 1
    s_lshl_b32 s74, s74, 2
    v_lshrrev_b32 v5, 2, v3
    v_lshlrev_b32 v6, 3, v5
    v_and_b32 v5, 3, v3
    v_add3_u32 v6, v6, v5, s74
    v_cmp_lt_u32 vcc, 27, v6
    v_lshlrev_b32 v6, 1, v6
    v_mul_u32_u24 v5, 21504, v2
    v_add_u32 v6, v6, v5
    v_mov_b32 v5, 0x40000000
    v_cndmask_b32 v6, v6, v5, vcc
    buffer_load_ushort v16, v6, s[64:67], s75 offen
    s_add_u32 s75, s75, 2688
    buffer_load_ushort v20, v6, s[64:67], s75 offen
    s_add_u32 s75, s75, 2688
    buffer_load_ushort v17, v6, s[64:67], s75 offen
    s_add_u32 s75, s75, 2688
    buffer_load_ushort v21, v6, s[64:67], s75 offen
    s_add_u32 s75, s75, 2688
    buffer_load_ushort v18, v6, s[64:67], s75 offen
    s_add_u32 s75, s75, 2688
    buffer_load_ushort v22, v6, s[64:67], s75 offen
    s_add_u32 s75, s75, 2688
    buffer_load_ushort v19, v6, s[64:67], s75 offen
    s_add_u32 s75, s75, 2688
    buffer_load_ushort v23, v6, s[64:67], s75 offen
    s_add_u32 s75, s75, 2688
    s_add_u32 s73, s72, 128
    s_mul_i32 s74, s73, 18725
    s_lshr_b32 s74, s74, 18
    s_mul_i32 s75, s74, 14
    s_sub_u32 s75, s73, s75
    s_mul_i32 s75, s75, 86016
    s_lshr_b32 s76, s74, 1
    s_mul_i32 s76, s76, 56
    s_add_u32 s75, s75, s76
    s_and_b32 s74, s74, 1
    s_lshl_b32 s74, s74, 2
    v_lshrrev_b32 v5, 2, v3
    v_lshlrev_b32 v6, 3, v5
    v_and_b32 v5, 3, v3
    v_add3_u32 v6, v6, v5, s74
    v_cmp_lt_u32 vcc, 27, v6
    v_lshlrev_b32 v6, 1, v6
    v_mul_u32_u24 v5, 21504, v2
    v_add_u32 v6, v6, v5
    v_mov_b32 v5, 0x40000000
    v_cndmask_b32 v6, v6, v5, vcc
    buffer_load_ushort v24, v6, s[64:67], s75 offen
    s_add_u32 s75, s75, 2688
    buffer_load_ushort v28, v6, s[64:67], s75 offen
    s_add_u32 s75, s75, 2688
    buffer_load_ushort v25, v6, s[64:67], s75 offen
    s_add_u32 s75, s75, 2688
    buffer_load_ushort v29, v6, s[64:67], s75 offen
    s_add_u32 s75, s75, 2688
    buffer_load_ushort v26, v6, s[64:67], s75 offen
    s_add_u32 s75, s75, 2688
    buffer_load_ushort v30, v6, s[64:67], s75 offen
    s_add_u32 s75, s75, 2688
    buffer_load_ushort v27, v6, s[64:67], s75 offen
    s_add_u32 s75, s75, 2688
    buffer_load_ushort v31, v6, s[64:67], s75 offen
    s_add_u32 s75, s75, 2688
    s_add_u32 s73, s72, 256
    s_mul_i32 s74, s73, 18725
    s_lshr_b32 s74, s74, 18
    s_mul_i32 s75, s74, 14
    s_sub_u32 s75, s73, s75
    s_mul_i32 s75, s75, 86016
    s_lshr_b32 s76, s74, 1
    s_mul_i32 s76, s76, 56
    s_add_u32 s75, s75, s76
    s_and_b32 s74, s74, 1
    s_lshl_b32 s74, s74, 2
    v_lshrrev_b32 v5, 2, v3
    v_lshlrev_b32 v6, 3, v5
    v_and_b32 v5, 3, v3
    v_add3_u32 v6, v6, v5, s74
    v_cmp_lt_u32 vcc, 27, v6
    v_lshlrev_b32 v6, 1, v6
    v_mul_u32_u24 v5, 21504, v2
    v_add_u32 v6, v6, v5
    v_mov_b32 v5, 0x40000000
    v_cndmask_b32 v6, v6, v5, vcc
    buffer_load_ushort v32, v6, s[64:67], s75 offen
    s_add_u32 s75, s75, 2688
    buffer_load_ushort v36, v6, s[64:67], s75 offen
    s_add_u32 s75, s75, 2688
    buffer_load_ushort v33, v6, s[64:67], s75 offen
    s_add_u32 s75, s75, 2688
    buffer_load_ushort v37, v6, s[64:67], s75 offen
    s_add_u32 s75, s75, 2688
    buffer_load_ushort v34, v6, s[64:67], s75 offen
    s_add_u32 s75, s75, 2688
    buffer_load_ushort v38, v6, s[64:67], s75 offen
    s_add_u32 s75, s75, 2688
    buffer_load_ushort v35, v6, s[64:67], s75 offen
    s_add_u32 s75, s75, 2688
    buffer_load_ushort v39, v6, s[64:67], s75 offen
    s_add_u32 s75, s75, 2688
    s_add_u32 s73, s72, 384
    s_mul_i32 s74, s73, 18725
    s_lshr_b32 s74, s74, 18
    s_mul_i32 s75, s74, 14
    s_sub_u32 s75, s73, s75
    s_mul_i32 s75, s75, 86016
    s_lshr_b32 s76, s74, 1
    s_mul_i32 s76, s76, 56
    s_add_u32 s75, s75, s76
    s_and_b32 s74, s74, 1
    s_lshl_b32 s74, s74, 2
    v_lshrrev_b32 v5, 2, v3
    v_lshlrev_b32 v6, 3, v5
    v_and_b32 v5, 3, v3
    v_add3_u32 v6, v6, v5, s74
    v_cmp_lt_u32 vcc, 27, v6
    v_lshlrev_b32 v6, 1, v6
    v_mul_u32_u24 v5, 21504, v2
    v_add_u32 v6, v6, v5
    v_mov_b32 v5, 0x40000000
    v_cndmask_b32 v6, v6, v5, vcc
    buffer_load_ushort v40, v6, s[64:67], s75 offen
    s_add_u32 s75, s75, 2688
    buffer_load_ushort v44, v6, s[64:67], s75 offen
    s_add_u32 s75, s75, 2688
    buffer_load_ushort v41, v6, s[64:67], s75 offen
    s_add_u32 s75, s75, 2688
    buffer_load_ushort v45, v6, s[64:67], s75 offen
    s_add_u32 s75, s75, 2688
    buffer_load_ushort v42, v6, s[64:67], s75 offen
    s_add_u32 s75, s75, 2688
    buffer_load_ushort v46, v6, s[64:67], s75 offen
    s_add_u32 s75, s75, 2688
    buffer_load_ushort v43, v6, s[64:67], s75 offen
    s_add_u32 s75, s75, 2688
    buffer_load_ushort v47, v6, s[64:67], s75 offen
    s_add_u32 s75, s75, 2688
    s_add_u32 s73, s72, 512
    s_mul_i32 s74, s73, 18725
    s_lshr_b32 s74, s74, 18
    s_mul_i32 s75, s74, 14
    s_sub_u32 s75, s73, s75
    s_mul_i32 s75, s75, 86016
    s_lshr_b32 s76, s74, 1
    s_mul_i32 s76, s76, 56
    s_add_u32 s75, s75, s76
    s_and_b32 s74, s74, 1
    s_lshl_b32 s74, s74, 2
    v_lshrrev_b32 v5, 2, v3
    v_lshlrev_b32 v6, 3, v5
    v_and_b32 v5, 3, v3
    v_add3_u32 v6, v6, v5, s74
    v_cmp_lt_u32 vcc, 27, v6
    v_lshlrev_b32 v6, 1, v6
    v_mul_u32_u24 v5, 21504, v2
    v_add_u32 v6, v6, v5
    v_mov_b32 v5, 0x40000000
    v_cndmask_b32 v6, v6, v5, vcc
    buffer_load_ushort v48, v6, s[64:67], s75 offen
    s_add_u32 s75, s75, 2688
    buffer_load_ushort v52, v6, s[64:67], s75 offen
    s_add_u32 s75, s75, 2688
    buffer_load_ushort v49, v6, s[64:67], s75 offen
    s_add_u32 s75, s75, 2688
    buffer_load_ushort v53, v6, s[64:67], s75 offen
    s_add_u32 s75, s75, 2688
    buffer_load_ushort v50, v6, s[64:67], s75 offen
    s_add_u32 s75, s75, 2688
    buffer_load_ushort v54, v6, s[64:67], s75 offen
    s_add_u32 s75, s75, 2688
    buffer_load_ushort v51, v6, s[64:67], s75 offen
    s_add_u32 s75, s75, 2688
    buffer_load_ushort v55, v6, s[64:67], s75 offen
    s_add_u32 s75, s75, 2688
    s_add_u32 s73, s72, 640
    s_mul_i32 s74, s73, 18725
    s_lshr_b32 s74, s74, 18
    s_mul_i32 s75, s74, 14
    s_sub_u32 s75, s73, s75
    s_mul_i32 s75, s75, 86016
    s_lshr_b32 s76, s74, 1
    s_mul_i32 s76, s76, 56
    s_add_u32 s75, s75, s76
    s_and_b32 s74, s74, 1
    s_lshl_b32 s74, s74, 2
    v_lshrrev_b32 v5, 2, v3
    v_lshlrev_b32 v6, 3, v5
    v_and_b32 v5, 3, v3
    v_add3_u32 v6, v6, v5, s74
    v_cmp_lt_u32 vcc, 27, v6
    v_lshlrev_b32 v6, 1, v6
    v_mul_u32_u24 v5, 21504, v2
    v_add_u32 v6, v6, v5
    v_mov_b32 v5, 0x40000000
    v_cndmask_b32 v6, v6, v5, vcc
    buffer_load_ushort v56, v6, s[64:67], s75 offen
    s_add_u32 s75, s75, 2688
    buffer_load_ushort v60, v6, s[64:67], s75 offen
    s_add_u32 s75, s75, 2688
    buffer_load_ushort v57, v6, s[64:67], s75 offen
    s_add_u32 s75, s75, 2688
    buffer_load_ushort v61, v6, s[64:67], s75 offen
    s_add_u32 s75, s75, 2688
    buffer_load_ushort v58, v6, s[64:67], s75 offen
    s_add_u32 s75, s75, 2688
    buffer_load_ushort v62, v6, s[64:67], s75 offen
    s_add_u32 s75, s75, 2688
    buffer_load_ushort v59, v6, s[64:67], s75 offen
    s_add_u32 s75, s75, 2688
    buffer_load_ushort v63, v6, s[64:67], s75 offen
    s_add_u32 s75, s75, 2688
    s_waitcnt vmcnt(0)
    v_lshl_or_b32 v16, v20, 16, v16
    v_lshl_or_b32 v17, v21, 16, v17
    v_lshl_or_b32 v18, v22, 16, v18
    v_lshl_or_b32 v19, v23, 16, v19
    s_add_u32 s73, s72, 0
    s_lshl_b32 s74, s73, 10
    s_add_u32 s74, s74, 0x3a00000
    s_cmp_lt_u32 s73, 1344
    s_cselect_b32 s74, s74, 0x40000000
    buffer_store_dwordx4 v[16:19], v4, s[4:7], s74 offen sc1
    v_lshl_or_b32 v24, v28, 16, v24
    v_lshl_or_b32 v25, v29, 16, v25
    v_lshl_or_b32 v26, v30, 16, v26
    v_lshl_or_b32 v27, v31, 16, v27
    s_add_u32 s73, s72, 128
    s_lshl_b32 s74, s73, 10
    s_add_u32 s74, s74, 0x3a00000
    s_cmp_lt_u32 s73, 1344
    s_cselect_b32 s74, s74, 0x40000000
    buffer_store_dwordx4 v[24:27], v4, s[4:7], s74 offen sc1
    v_lshl_or_b32 v32, v36, 16, v32
    v_lshl_or_b32 v33, v37, 16, v33
    v_lshl_or_b32 v34, v38, 16, v34
    v_lshl_or_b32 v35, v39, 16, v35
    s_add_u32 s73, s72, 256
    s_lshl_b32 s74, s73, 10
    s_add_u32 s74, s74, 0x3a00000
    s_cmp_lt_u32 s73, 1344
    s_cselect_b32 s74, s74, 0x40000000
    buffer_store_dwordx4 v[32:35], v4, s[4:7], s74 offen sc1
    v_lshl_or_b32 v40, v44, 16, v40
    v_lshl_or_b32 v41, v45, 16, v41
    v_lshl_or_b32 v42, v46, 16, v42
    v_lshl_or_b32 v43, v47, 16, v43
    s_add_u32 s73, s72, 384
    s_lshl_b32 s74, s73, 10
    s_add_u32 s74, s74, 0x3a00000
    s_cmp_lt_u32 s73, 1344
    s_cselect_b32 s74, s74, 0x40000000
    buffer_store_dwordx4 v[40:43], v4, s[4:7], s74 offen sc1
    v_lshl_or_b32 v48, v52, 16, v48
    v_lshl_or_b32 v49, v53, 16, v49
    v_lshl_or_b32 v50, v54, 16, v50
    v_lshl_or_b32 v51, v55, 16, v51
    s_add_u32 s73, s72, 512
    s_lshl_b32 s74, s73, 10
    s_add_u32 s74, s74, 0x3a00000
    s_cmp_lt_u32 s73, 1344
    s_cselect_b32 s74, s74, 0x40000000
    buffer_store_dwordx4 v[48:51], v4, s[4:7], s74 offen sc1
    v_lshl_or_b32 v56, v60, 16, v56
    v_lshl_or_b32 v57, v61, 16, v57
    v_lshl_or_b32 v58, v62, 16, v58
    v_lshl_or_b32 v59, v63, 16, v59
    s_add_u32 s73, s72, 640
    s_lshl_b32 s74, s73, 10
    s_add_u32 s74, s74, 0x3a00000
    s_cmp_lt_u32 s73, 1344
    s_cselect_b32 s74, s74, 0x40000000
    buffer_store_dwordx4 v[56:59], v4, s[4:7], s74 offen sc1
    s_add_u32 s73, s72, 768
    s_mul_i32 s74, s73, 18725
    s_lshr_b32 s74, s74, 18
    s_mul_i32 s75, s74, 14
    s_sub_u32 s75, s73, s75
    s_mul_i32 s75, s75, 86016
    s_lshr_b32 s76, s74, 1
    s_mul_i32 s76, s76, 56
    s_add_u32 s75, s75, s76
    s_and_b32 s74, s74, 1
    s_lshl_b32 s74, s74, 2
    v_lshrrev_b32 v5, 2, v3
    v_lshlrev_b32 v6, 3, v5
    v_and_b32 v5, 3, v3
    v_add3_u32 v6, v6, v5, s74
    v_cmp_lt_u32 vcc, 27, v6
    v_lshlrev_b32 v6, 1, v6
    v_mul_u32_u24 v5, 21504, v2
    v_add_u32 v6, v6, v5
    v_mov_b32 v5, 0x40000000
    v_cndmask_b32 v6, v6, v5, vcc
    buffer_load_ushort v64, v6, s[64:67], s75 offen
    s_add_u32 s75, s75, 2688
    buffer_load_ushort v68, v6, s[64:67], s75 offen
    s_add_u32 s75, s75, 2688
    buffer_load_ushort v65, v6, s[64:67], s75 offen
    s_add_u32 s75, s75, 2688
    buffer_load_ushort v69, v6, s[64:67], s75 offen
    s_add_u32 s75, s75, 2688
    buffer_load_ushort v66, v6, s[64:67], s75 offen
    s_add_u32 s75, s75, 2688
    buffer_load_ushort v70, v6, s[64:67], s75 offen
    s_add_u32 s75, s75, 2688
    buffer_load_ushort v67, v6, s[64:67], s75 offen
    s_add_u32 s75, s75, 2688
    buffer_load_ushort v71, v6, s[64:67], s75 offen
    s_add_u32 s75, s75, 2688
    s_add_u32 s73, s72, 896
    s_mul_i32 s74, s73, 18725
    s_lshr_b32 s74, s74, 18
    s_mul_i32 s75, s74, 14
    s_sub_u32 s75, s73, s75
    s_mul_i32 s75, s75, 86016
    s_lshr_b32 s76, s74, 1
    s_mul_i32 s76, s76, 56
    s_add_u32 s75, s75, s76
    s_and_b32 s74, s74, 1
    s_lshl_b32 s74, s74, 2
    v_lshrrev_b32 v5, 2, v3
    v_lshlrev_b32 v6, 3, v5
    v_and_b32 v5, 3, v3
    v_add3_u32 v6, v6, v5, s74
    v_cmp_lt_u32 vcc, 27, v6
    v_lshlrev_b32 v6, 1, v6
    v_mul_u32_u24 v5, 21504, v2
    v_add_u32 v6, v6, v5
    v_mov_b32 v5, 0x40000000
    v_cndmask_b32 v6, v6, v5, vcc
    buffer_load_ushort v72, v6, s[64:67], s75 offen
    s_add_u32 s75, s75, 2688
    buffer_load_ushort v76, v6, s[64:67], s75 offen
    s_add_u32 s75, s75, 2688
    buffer_load_ushort v73, v6, s[64:67], s75 offen
    s_add_u32 s75, s75, 2688
    buffer_load_ushort v77, v6, s[64:67], s75 offen
    s_add_u32 s75, s75, 2688
    buffer_load_ushort v74, v6, s[64:67], s75 offen
    s_add_u32 s75, s75, 2688
    buffer_load_ushort v78, v6, s[64:67], s75 offen
    s_add_u32 s75, s75, 2688
    buffer_load_ushort v75, v6, s[64:67], s75 offen
    s_add_u32 s75, s75, 2688
    buffer_load_ushort v79, v6, s[64:67], s75 offen
    s_add_u32 s75, s75, 2688
    s_add_u32 s73, s72, 1024
    s_mul_i32 s74, s73, 18725
    s_lshr_b32 s74, s74, 18
    s_mul_i32 s75, s74, 14
    s_sub_u32 s75, s73, s75
    s_mul_i32 s75, s75, 86016
    s_lshr_b32 s76, s74, 1
    s_mul_i32 s76, s76, 56
    s_add_u32 s75, s75, s76
    s_and_b32 s74, s74, 1
    s_lshl_b32 s74, s74, 2
    v_lshrrev_b32 v5, 2, v3
    v_lshlrev_b32 v6, 3, v5
    v_and_b32 v5, 3, v3
    v_add3_u32 v6, v6, v5, s74
    v_cmp_lt_u32 vcc, 27, v6
    v_lshlrev_b32 v6, 1, v6
    v_mul_u32_u24 v5, 21504, v2
    v_add_u32 v6, v6, v5
    v_mov_b32 v5, 0x40000000
    v_cndmask_b32 v6, v6, v5, vcc
    buffer_load_ushort v80, v6, s[64:67], s75 offen
    s_add_u32 s75, s75, 2688
    buffer_load_ushort v84, v6, s[64:67], s75 offen
    s_add_u32 s75, s75, 2688
    buffer_load_ushort v81, v6, s[64:67], s75 offen
    s_add_u32 s75, s75, 2688
    buffer_load_ushort v85, v6, s[64:67], s75 offen
    s_add_u32 s75, s75, 2688
    buffer_load_ushort v82, v6, s[64:67], s75 offen
    s_add_u32 s75, s75, 2688
    buffer_load_ushort v86, v6, s[64:67], s75 offen
    s_add_u32 s75, s75, 2688
    buffer_load_ushort v83, v6, s[64:67], s75 offen
    s_add_u32 s75, s75, 2688
    buffer_load_ushort v87, v6, s[64:67], s75 offen
    s_add_u32 s75, s75, 2688
    s_add_u32 s73, s72, 1152
    s_mul_i32 s74, s73, 18725
    s_lshr_b32 s74, s74, 18
    s_mul_i32 s75, s74, 14
    s_sub_u32 s75, s73, s75
    s_mul_i32 s75, s75, 86016
    s_lshr_b32 s76, s74, 1
    s_mul_i32 s76, s76, 56
    s_add_u32 s75, s75, s76
    s_and_b32 s74, s74, 1
    s_lshl_b32 s74, s74, 2
    v_lshrrev_b32 v5, 2, v3
    v_lshlrev_b32 v6, 3, v5
    v_and_b32 v5, 3, v3
    v_add3_u32 v6, v6, v5, s74
    v_cmp_lt_u32 vcc, 27, v6
    v_lshlrev_b32 v6, 1, v6
    v_mul_u32_u24 v5, 21504, v2
    v_add_u32 v6, v6, v5
    v_mov_b32 v5, 0x40000000
    v_cndmask_b32 v6, v6, v5, vcc
    buffer_load_ushort v88, v6, s[64:67], s75 offen
    s_add_u32 s75, s75, 2688
    buffer_load_ushort v92, v6, s[64:67], s75 offen
    s_add_u32 s75, s75, 2688
    buffer_load_ushort v89, v6, s[64:67], s75 offen
    s_add_u32 s75, s75, 2688
    buffer_load_ushort v93, v6, s[64:67], s75 offen
    s_add_u32 s75, s75, 2688
    buffer_load_ushort v90, v6, s[64:67], s75 offen
    s_add_u32 s75, s75, 2688
    buffer_load_ushort v94, v6, s[64:67], s75 offen
    s_add_u32 s75, s75, 2688
    buffer_load_ushort v91, v6, s[64:67], s75 offen
    s_add_u32 s75, s75, 2688
    buffer_load_ushort v95, v6, s[64:67], s75 offen
    s_add_u32 s75, s75, 2688
    s_add_u32 s73, s72, 1280
    s_mul_i32 s74, s73, 18725
    s_lshr_b32 s74, s74, 18
    s_mul_i32 s75, s74, 14
    s_sub_u32 s75, s73, s75
    s_mul_i32 s75, s75, 86016
    s_lshr_b32 s76, s74, 1
    s_mul_i32 s76, s76, 56
    s_add_u32 s75, s75, s76
    s_and_b32 s74, s74, 1
    s_lshl_b32 s74, s74, 2
    v_lshrrev_b32 v5, 2, v3
    v_lshlrev_b32 v6, 3, v5
    v_and_b32 v5, 3, v3
    v_add3_u32 v6, v6, v5, s74
    v_cmp_lt_u32 vcc, 27, v6
    v_lshlrev_b32 v6, 1, v6
    v_mul_u32_u24 v5, 21504, v2
    v_add_u32 v6, v6, v5
    v_mov_b32 v5, 0x40000000
    v_cndmask_b32 v6, v6, v5, vcc
    buffer_load_ushort v96, v6, s[64:67], s75 offen
    s_add_u32 s75, s75, 2688
    buffer_load_ushort v100, v6, s[64:67], s75 offen
    s_add_u32 s75, s75, 2688
    buffer_load_ushort v97, v6, s[64:67], s75 offen
    s_add_u32 s75, s75, 2688
    buffer_load_ushort v101, v6, s[64:67], s75 offen
    s_add_u32 s75, s75, 2688
    buffer_load_ushort v98, v6, s[64:67], s75 offen
    s_add_u32 s75, s75, 2688
    buffer_load_ushort v102, v6, s[64:67], s75 offen
    s_add_u32 s75, s75, 2688
    buffer_load_ushort v99, v6, s[64:67], s75 offen
    s_add_u32 s75, s75, 2688
    buffer_load_ushort v103, v6, s[64:67], s75 offen
    s_add_u32 s75, s75, 2688
    s_add_u32 s73, s72, 0
    s_lshr_b32 s74, s73, 4
    s_lshl_b32 s74, s74, 5
    s_and_b32 s75, s73, 15
    s_mul_i32 s75, s75, 25088
    s_add_u32 s75, s75, s74
    v_mul_u32_u24 v6, 7168, v2
    v_lshl_add_u32 v6, v3, 1, v6
    v_cmp_eq_u32 vcc, 3, v2
    v_mov_b32 v5, 0x40000000
    s_nop 0
    v_cndmask_b32 v5, v6, v5, vcc
    buffer_load_ushort v104, v6, s[68:71], s75 offen
    s_add_u32 s75, s75, 896
    buffer_load_ushort v108, v6, s[68:71], s75 offen
    s_add_u32 s75, s75, 896
    buffer_load_ushort v105, v6, s[68:71], s75 offen
    s_add_u32 s75, s75, 896
    buffer_load_ushort v109, v6, s[68:71], s75 offen
    s_add_u32 s75, s75, 896
    buffer_load_ushort v106, v5, s[68:71], s75 offen
    s_add_u32 s75, s75, 896
    buffer_load_ushort v110, v5, s[68:71], s75 offen
    s_add_u32 s75, s75, 896
    buffer_load_ushort v107, v5, s[68:71], s75 offen
    s_add_u32 s75, s75, 896
    buffer_load_ushort v111, v5, s[68:71], s75 offen
    s_add_u32 s75, s75, 896
    s_waitcnt vmcnt(0)
    v_lshl_or_b32 v64, v68, 16, v64
    v_lshl_or_b32 v65, v69, 16, v65
    v_lshl_or_b32 v66, v70, 16, v66
    v_lshl_or_b32 v67, v71, 16, v67
    s_add_u32 s73, s72, 768
    s_lshl_b32 s74, s73, 10
    s_add_u32 s74, s74, 0x3a00000
    s_cmp_lt_u32 s73, 1344
    s_cselect_b32 s74, s74, 0x40000000
    buffer_store_dwordx4 v[64:67], v4, s[4:7], s74 offen sc1
    v_lshl_or_b32 v72, v76, 16, v72
    v_lshl_or_b32 v73, v77, 16, v73
    v_lshl_or_b32 v74, v78, 16, v74
    v_lshl_or_b32 v75, v79, 16, v75
    s_add_u32 s73, s72, 896
    s_lshl_b32 s74, s73, 10
    s_add_u32 s74, s74, 0x3a00000
    s_cmp_lt_u32 s73, 1344
    s_cselect_b32 s74, s74, 0x40000000
    buffer_store_dwordx4 v[72:75], v4, s[4:7], s74 offen sc1
    v_lshl_or_b32 v80, v84, 16, v80
    v_lshl_or_b32 v81, v85, 16, v81
    v_lshl_or_b32 v82, v86, 16, v82
    v_lshl_or_b32 v83, v87, 16, v83
    s_add_u32 s73, s72, 1024
    s_lshl_b32 s74, s73, 10
    s_add_u32 s74, s74, 0x3a00000
    s_cmp_lt_u32 s73, 1344
    s_cselect_b32 s74, s74, 0x40000000
    buffer_store_dwordx4 v[80:83], v4, s[4:7], s74 offen sc1
    v_lshl_or_b32 v88, v92, 16, v88
    v_lshl_or_b32 v89, v93, 16, v89
    v_lshl_or_b32 v90, v94, 16, v90
    v_lshl_or_b32 v91, v95, 16, v91
    s_add_u32 s73, s72, 1152
    s_lshl_b32 s74, s73, 10
    s_add_u32 s74, s74, 0x3a00000
    s_cmp_lt_u32 s73, 1344
    s_cselect_b32 s74, s74, 0x40000000
    buffer_store_dwordx4 v[88:91], v4, s[4:7], s74 offen sc1
    v_lshl_or_b32 v96, v100, 16, v96
    v_lshl_or_b32 v97, v101, 16, v97
    v_lshl_or_b32 v98, v102, 16, v98
    v_lshl_or_b32 v99, v103, 16, v99
    s_add_u32 s73, s72, 1280
    s_lshl_b32 s74, s73, 10
    s_add_u32 s74, s74, 0x3a00000
    s_cmp_lt_u32 s73, 1344
    s_cselect_b32 s74, s74, 0x40000000
    buffer_store_dwordx4 v[96:99], v4, s[4:7], s74 offen sc1
    v_lshl_or_b32 v104, v108, 16, v104
    v_lshl_or_b32 v105, v109, 16, v105
    v_lshl_or_b32 v106, v110, 16, v106
    v_lshl_or_b32 v107, v111, 16, v107
    s_add_u32 s73, s72, 0
    s_lshl_b32 s74, s73, 10
    s_add_u32 s74, s74, 0x3c00000
    s_cmp_lt_u32 s73, 448
    s_cselect_b32 s74, s74, 0x40000000
    buffer_store_dwordx4 v[104:107], v4, s[4:7], s74 offen sc1
    s_add_u32 s73, s72, 128
    s_lshr_b32 s74, s73, 4
    s_lshl_b32 s74, s74, 5
    s_and_b32 s75, s73, 15
    s_mul_i32 s75, s75, 25088
    s_add_u32 s75, s75, s74
    v_mul_u32_u24 v6, 7168, v2
    v_lshl_add_u32 v6, v3, 1, v6
    v_cmp_eq_u32 vcc, 3, v2
    v_mov_b32 v5, 0x40000000
    s_nop 0
    v_cndmask_b32 v5, v6, v5, vcc
    buffer_load_ushort v112, v6, s[68:71], s75 offen
    s_add_u32 s75, s75, 896
    buffer_load_ushort v116, v6, s[68:71], s75 offen
    s_add_u32 s75, s75, 896
    buffer_load_ushort v113, v6, s[68:71], s75 offen
    s_add_u32 s75, s75, 896
    buffer_load_ushort v117, v6, s[68:71], s75 offen
    s_add_u32 s75, s75, 896
    buffer_load_ushort v114, v5, s[68:71], s75 offen
    s_add_u32 s75, s75, 896
    buffer_load_ushort v118, v5, s[68:71], s75 offen
    s_add_u32 s75, s75, 896
    buffer_load_ushort v115, v5, s[68:71], s75 offen
    s_add_u32 s75, s75, 896
    buffer_load_ushort v119, v5, s[68:71], s75 offen
    s_add_u32 s75, s75, 896
    s_add_u32 s73, s72, 256
    s_lshr_b32 s74, s73, 4
    s_lshl_b32 s74, s74, 5
    s_and_b32 s75, s73, 15
    s_mul_i32 s75, s75, 25088
    s_add_u32 s75, s75, s74
    v_mul_u32_u24 v6, 7168, v2
    v_lshl_add_u32 v6, v3, 1, v6
    v_cmp_eq_u32 vcc, 3, v2
    v_mov_b32 v5, 0x40000000
    s_nop 0
    v_cndmask_b32 v5, v6, v5, vcc
    buffer_load_ushort v120, v6, s[68:71], s75 offen
    s_add_u32 s75, s75, 896
    buffer_load_ushort v124, v6, s[68:71], s75 offen
    s_add_u32 s75, s75, 896
    buffer_load_ushort v121, v6, s[68:71], s75 offen
    s_add_u32 s75, s75, 896
    buffer_load_ushort v125, v6, s[68:71], s75 offen
    s_add_u32 s75, s75, 896
    buffer_load_ushort v122, v5, s[68:71], s75 offen
    s_add_u32 s75, s75, 896
    buffer_load_ushort v126, v5, s[68:71], s75 offen
    s_add_u32 s75, s75, 896
    buffer_load_ushort v123, v5, s[68:71], s75 offen
    s_add_u32 s75, s75, 896
    buffer_load_ushort v127, v5, s[68:71], s75 offen
    s_add_u32 s75, s75, 896
    s_add_u32 s73, s72, 384
    s_lshr_b32 s74, s73, 4
    s_lshl_b32 s74, s74, 5
    s_and_b32 s75, s73, 15
    s_mul_i32 s75, s75, 25088
    s_add_u32 s75, s75, s74
    v_mul_u32_u24 v6, 7168, v2
    v_lshl_add_u32 v6, v3, 1, v6
    v_cmp_eq_u32 vcc, 3, v2
    v_mov_b32 v5, 0x40000000
    s_nop 0
    v_cndmask_b32 v5, v6, v5, vcc
    buffer_load_ushort v128, v6, s[68:71], s75 offen
    s_add_u32 s75, s75, 896
    buffer_load_ushort v132, v6, s[68:71], s75 offen
    s_add_u32 s75, s75, 896
    buffer_load_ushort v129, v6, s[68:71], s75 offen
    s_add_u32 s75, s75, 896
    buffer_load_ushort v133, v6, s[68:71], s75 offen
    s_add_u32 s75, s75, 896
    buffer_load_ushort v130, v5, s[68:71], s75 offen
    s_add_u32 s75, s75, 896
    buffer_load_ushort v134, v5, s[68:71], s75 offen
    s_add_u32 s75, s75, 896
    buffer_load_ushort v131, v5, s[68:71], s75 offen
    s_add_u32 s75, s75, 896
    buffer_load_ushort v135, v5, s[68:71], s75 offen
    s_add_u32 s75, s75, 896
    s_waitcnt vmcnt(0)
    v_lshl_or_b32 v112, v116, 16, v112
    v_lshl_or_b32 v113, v117, 16, v113
    v_lshl_or_b32 v114, v118, 16, v114
    v_lshl_or_b32 v115, v119, 16, v115
    s_add_u32 s73, s72, 128
    s_lshl_b32 s74, s73, 10
    s_add_u32 s74, s74, 0x3c00000
    s_cmp_lt_u32 s73, 448
    s_cselect_b32 s74, s74, 0x40000000
    buffer_store_dwordx4 v[112:115], v4, s[4:7], s74 offen sc1
    v_lshl_or_b32 v120, v124, 16, v120
    v_lshl_or_b32 v121, v125, 16, v121
    v_lshl_or_b32 v122, v126, 16, v122
    v_lshl_or_b32 v123, v127, 16, v123
    s_add_u32 s73, s72, 256
    s_lshl_b32 s74, s73, 10
    s_add_u32 s74, s74, 0x3c00000
    s_cmp_lt_u32 s73, 448
    s_cselect_b32 s74, s74, 0x40000000
    buffer_store_dwordx4 v[120:123], v4, s[4:7], s74 offen sc1
    v_lshl_or_b32 v128, v132, 16, v128
    v_lshl_or_b32 v129, v133, 16, v129
    v_lshl_or_b32 v130, v134, 16, v130
    v_lshl_or_b32 v131, v135, 16, v131
    s_add_u32 s73, s72, 384
    s_lshl_b32 s74, s73, 10
    s_add_u32 s74, s74, 0x3c00000
    s_cmp_lt_u32 s73, 448
    s_cselect_b32 s74, s74, 0x40000000
    buffer_store_dwordx4 v[128:131], v4, s[4:7], s74 offen sc1
    s_waitcnt vmcnt(0)
    s_barrier
    s_cmp_eq_u32 s16, 0
    s_cselect_b32 s74, 0, 0x40000000
    v_mov_b32 v5, 1
    s_mov_b64 exec, 1
    buffer_atomic_add v5, off, s[12:15], s74 offset:40 sc1
    s_mov_b64 exec, -1
LLw_100254:
    buffer_load_dword v5, off, s[12:15], 0 offset:40 sc1
    s_waitcnt vmcnt(0)
    v_cmp_ne_u32 vcc, 32, v5
    s_cbranch_vccz LLwg_100255
    s_sleep 2
    s_sub_u32 s24, s24, 1
    s_cbranch_scc1 Lexit2_100184
    s_branch LLw_100254
LLwg_100255:
    s_mul_i32 s58, s16, 114688
    s_add_u32 s58, s58, 0x3a00000
    s_waitcnt vmcnt(0)
    s_barrier
    s_add_u32 s25, s58, 458752
    buffer_load_dwordx4 v[16:19], v4, s[4:7], s25 offen offset:0 sc1
    buffer_load_dwordx4 v[20:23], v4, s[4:7], s25 offen offset:1024 sc1
    buffer_load_dwordx4 v[24:27], v4, s[4:7], s25 offen offset:2048 sc1
    buffer_load_dwordx4 v[28:31], v4, s[4:7], s25 offen offset:3072 sc1
    s_add_u32 s25, s25, 4096
    buffer_load_dwordx4 v[32:35], v4, s[4:7], s25 offen offset:0 sc1
    buffer_load_dwordx4 v[36:39], v4, s[4:7], s25 offen offset:1024 sc1
    buffer_load_dwordx4 v[40:43], v4, s[4:7], s25 offen offset:2048 sc1
    buffer_load_dwordx4 v[44:47], v4, s[4:7], s25 offen offset:3072 sc1
    s_add_u32 s25, s25, 4096
    buffer_load_dwordx4 v[48:51], v4, s[4:7], s25 offen offset:0 sc1
    buffer_load_dwordx4 v[52:55], v4, s[4:7], s25 offen offset:1024 sc1
    buffer_load_dwordx4 v[56:59], v4, s[4:7], s25 offen offset:2048 sc1
    buffer_load_dwordx4 v[60:63], v4, s[4:7], s25 offen offset:3072 sc1
    s_add_u32 s25, s25, 4096
    buffer_load_dwordx4 v[64:67], v4, s[4:7], s25 offen offset:0 sc1
    buffer_load_dwordx4 v[68:71], v4, s[4:7], s25 offen offset:1024 sc1
    s_add_u32 s25, s58, 473088
    buffer_load_dwordx4 v[72:75], v4, s[4:7], s25 offen offset:0 sc1
    buffer_load_dwordx4 v[76:79], v4, s[4:7], s25 offen offset:1024 sc1
    buffer_load_dwordx4 v[80:83], v4, s[4:7], s25 offen offset:2048 sc1
    buffer_load_dwordx4 v[84:87], v4, s[4:7], s25 offen offset:3072 sc1
    s_add_u32 s25, s25, 4096
    buffer_load_dwordx4 v[88:91], v4, s[4:7], s25 offen offset:0 sc1
    buffer_load_dwordx4 v[92:95], v4, s[4:7], s25 offen offset:1024 sc1
    buffer_load_dwordx4 v[96:99], v4, s[4:7], s25 offen offset:2048 sc1
    buffer_load_dwordx4 v[100:103], v4, s[4:7], s25 offen offset:3072 sc1
    s_add_u32 s25, s25, 4096
    buffer_load_dwordx4 v[104:107], v4, s[4:7], s25 offen offset:0 sc1
    buffer_load_dwordx4 v[108:111], v4, s[4:7], s25 offen offset:1024 sc1
    buffer_load_dwordx4 v[112:115], v4, s[4:7], s25 offen offset:2048 sc1
    buffer_load_dwordx4 v[116:119], v4, s[4:7], s25 offen offset:3072 sc1
    s_add_u32 s25, s25, 4096
    buffer_load_dwordx4 v[120:123], v4, s[4:7], s25 offen offset:0 sc1
    buffer_load_dwordx4 v[124:127], v4, s[4:7], s25 offen offset:1024 sc1
    s_add_u32 s25, s58, 917504
    buffer_load_dwordx4 v[128:131], v4, s[4:7], s25 offen offset:0 sc1
    buffer_load_dwordx4 v[132:135], v4, s[4:7], s25 offen offset:1024 sc1
    buffer_load_dwordx4 v[136:139], v4, s[4:7], s25 offen offset:2048 sc1
    buffer_load_dwordx4 v[140:143], v4, s[4:7], s25 offen offset:3072 sc1
    s_add_u32 s25, s25, 4096
    buffer_load_dwordx4 v[144:147], v4, s[4:7], s25 offen offset:0 sc1
    buffer_load_dwordx4 v[148:151], v4, s[4:7], s25 offen offset:1024 sc1
    buffer_load_dwordx4 v[152:155], v4, s[4:7], s25 offen offset:2048 sc1
    buffer_load_dwordx4 v[156:159], v4, s[4:7], s25 offen offset:3072 sc1
    s_add_u32 s25, s25, 4096
    buffer_load_dwordx4 v[160:163], v4, s[4:7], s25 offen offset:0 sc1
    buffer_load_dwordx4 v[164:167], v4, s[4:7], s25 offen offset:1024 sc1
    buffer_load_dwordx4 v[168:171], v4, s[4:7], s25 offen offset:2048 sc1
    buffer_load_dwordx4 v[172:175], v4, s[4:7], s25 offen offset:3072 sc1
    s_add_u32 s25, s25, 4096
    buffer_load_dwordx4 v[176:179], v4, s[4:7], s25 offen offset:0 sc1
    buffer_load_dwordx4 v[180:183], v4, s[4:7], s25 offen offset:1024 sc1
    s_add_u32 s25, s58, 931840
    buffer_load_dwordx4 v[184:187], v4, s[4:7], s25 offen offset:0 sc1
    buffer_load_dwordx4 v[188:191], v4, s[4:7], s25 offen offset:1024 sc1
    buffer_load_dwordx4 v[192:195], v4, s[4:7], s25 offen offset:2048 sc1
    buffer_load_dwordx4 v[196:199], v4, s[4:7], s25 offen offset:3072 sc1
    s_add_u32 s25, s25, 4096
    buffer_load_dwordx4 v[200:203], v4, s[4:7], s25 offen offset:0 sc1
    buffer_load_dwordx4 v[204:207], v4, s[4:7], s25 offen offset:1024 sc1
    buffer_load_dwordx4 v[208:211], v4, s[4:7], s25 offen offset:2048 sc1
    buffer_load_dwordx4 v[212:215], v4, s[4:7], s25 offen offset:3072 sc1
    s_add_u32 s25, s25, 4096
    buffer_load_dwordx4 v[216:219], v4, s[4:7], s25 offen offset:0 sc1
    buffer_load_dwordx4 v[220:223], v4, s[4:7], s25 offen offset:1024 sc1
    buffer_load_dwordx4 v[224:227], v4, s[4:7], s25 offen offset:2048 sc1
    buffer_load_dwordx4 v[228:231], v4, s[4:7], s25 offen offset:3072 sc1
    s_add_u32 s25, s25, 4096
    buffer_load_dwordx4 v[232:235], v4, s[4:7], s25 offen offset:0 sc1
    buffer_load_dwordx4 v[236:239], v4, s[4:7], s25 offen offset:1024 sc1
    ds_read_b128 a[0:3], v7 offset:0
    ds_read_b128 a[4:7], v7 offset:64
    ds_read_b128 a[8:11], v7 offset:128
    ds_read_b128 a[12:15], v7 offset:192
    ds_read_b128 a[16:19], v7 offset:256
    ds_read_b128 a[20:23], v7 offset:320
    ds_read_b128 a[24:27], v7 offset:384
    ds_read_b128 a[28:31], v7 offset:448
    ds_read_b128 a[32:35], v7 offset:512
    ds_read_b128 a[36:39], v7 offset:576
    ds_read_b128 a[40:43], v7 offset:640
    ds_read_b128 a[44:47], v7 offset:704
    ds_read_b128 a[48:51], v7 offset:768
    ds_read_b128 a[52:55], v7 offset:832
    s_waitcnt lgkmcnt(0)
    ds_read_b128 a[56:59], v7 offset:3648
    ds_read_b128 a[60:63], v7 offset:3712
    ds_read_b128 a[64:67], v7 offset:3776
    ds_read_b128 a[68:71], v7 offset:3840
    ds_read_b128 a[72:75], v7 offset:3904
    ds_read_b128 a[76:79], v7 offset:3968
    ds_read_b128 a[80:83], v7 offset:4032
    ds_read_b128 a[84:87], v7 offset:4096
    ds_read_b128 a[88:91], v7 offset:4160
    ds_read_b128 a[92:95], v7 offset:4224
    ds_read_b128 a[96:99], v7 offset:4288
    ds_read_b128 a[100:103], v7 offset:4352
    ds_read_b128 a[104:107], v7 offset:4416
    ds_read_b128 a[108:111], v7 offset:4480
    s_waitcnt lgkmcnt(0)
    ds_read_b128 a[112:115], v7 offset:32768
    ds_read_b128 a[116:119], v7 offset:32832
    ds_read_b128 a[120:123], v7 offset:32896
    ds_read_b128 a[124:127], v7 offset:32960
    ds_read_b128 a[128:131], v7 offset:33024
    ds_read_b128 a[132:135], v7 offset:33088
    ds_read_b128 a[136:139], v7 offset:33152
    ds_read_b128 a[140:143], v7 offset:33216
    ds_read_b128 a[144:147], v7 offset:33280
    ds_read_b128 a[148:151], v7 offset:33344
    ds_read_b128 a[152:155], v7 offset:33408
    ds_read_b128 a[156:159], v7 offset:33472
    ds_read_b128 a[160:163], v7 offset:33536
    ds_read_b128 a[164:167], v7 offset:33600
    s_waitcnt lgkmcnt(0)
    ds_read_b128 a[168:171], v7 offset:36416
    ds_read_b128 a[172:175], v7 offset:36480
    ds_read_b128 a[176:179], v7 offset:36544
    ds_read_b128 a[180:183], v7 offset:36608
    ds_read_b128 a[184:187], v7 offset:36672
    ds_read_b128 a[188:191], v7 offset:36736
    ds_read_b128 a[192:195], v7 offset:36800
    ds_read_b128 a[196:199], v7 offset:36864
    ds_read_b128 a[200:203], v7 offset:36928
    ds_read_b128 a[204:207], v7 offset:36992
    ds_read_b128 a[208:211], v7 offset:37056
    ds_read_b128 a[212:215], v7 offset:37120
    ds_read_b128 a[216:219], v7 offset:37184
    ds_read_b128 a[220:223], v7 offset:37248
    s_waitcnt lgkmcnt(0)
    s_mov_b32 s59, 0
    s_lshl_b32 s60, s16, 14
    s_add_u32 s60, s60, 0x3d00000
LL1_100256:
    s_add_u32 s58, s58, 28672
    s_waitcnt vmcnt(42)
    v_mfma_f32_16x16x32_bf16 v[240:243], a[0:3], v[16:19], 0
    v_mfma_f32_16x16x32_bf16 v[244:247], a[56:59], v[16:19], 0
    v_mfma_f32_16x16x32_bf16 v[240:243], a[4:7], v[20:23], v[240:243]
    v_mfma_f32_16x16x32_bf16 v[244:247], a[60:63], v[20:23], v[244:247]
    v_mfma_f32_16x16x32_bf16 v[240:243], a[8:11], v[24:27], v[240:243]
    v_mfma_f32_16x16x32_bf16 v[244:247], a[64:67], v[24:27], v[244:247]
    v_mfma_f32_16x16x32_bf16 v[240:243], a[12:15], v[28:31], v[240:243]
    v_mfma_f32_16x16x32_bf16 v[244:247], a[68:71], v[28:31], v[244:247]
    v_mfma_f32_16x16x32_bf16 v[240:243], a[16:19], v[32:35], v[240:243]
    v_mfma_f32_16x16x32_bf16 v[244:247], a[72:75], v[32:35], v[244:247]
    v_mfma_f32_16x16x32_bf16 v[240:243], a[20:23], v[36:39], v[240:243]
    v_mfma_f32_16x16x32_bf16 v[244:247], a[76:79], v[36:39], v[244:247]
    v_mfma_f32_16x16x32_bf16 v[240:243], a[24:27], v[40:43], v[240:243]
    v_mfma_f32_16x16x32_bf16 v[244:247], a[80:83], v[40:43], v[244:247]
    v_mfma_f32_16x16x32_bf16 v[240:243], a[28:31], v[44:47], v[240:243]
    v_mfma_f32_16x16x32_bf16 v[244:247], a[84:87], v[44:47], v[244:247]
    v_mfma_f32_16x16x32_bf16 v[240:243], a[32:35], v[48:51], v[240:243]
    v_mfma_f32_16x16x32_bf16 v[244:247], a[88:91], v[48:51], v[244:247]
    v_mfma_f32_16x16x32_bf16 v[240:243], a[36:39], v[52:55], v[240:243]
    v_mfma_f32_16x16x32_bf16 v[244:247], a[92:95], v[52:55], v[244:247]
    v_mfma_f32_16x16x32_bf16 v[240:243], a[40:43], v[56:59], v[240:243]
    v_mfma_f32_16x16x32_bf16 v[244:247], a[96:99], v[56:59], v[244:247]
    v_mfma_f32_16x16x32_bf16 v[240:243], a[44:47], v[60:63], v[240:243]
    v_mfma_f32_16x16x32_bf16 v[244:247], a[100:103], v[60:63], v[244:247]
    v_mfma_f32_16x16x32_bf16 v[240:243], a[48:51], v[64:67], v[240:243]
    v_mfma_f32_16x16x32_bf16 v[244:247], a[104:107], v[64:67], v[244:247]
    v_mfma_f32_16x16x32_bf16 v[240:243], a[52:55], v[68:71], v[240:243]
    v_mfma_f32_16x16x32_bf16 v[244:247], a[108:111], v[68:71], v[244:247]
    s_nop 7
    v_cvt_pk_bf16_f32 v250, v240, v241
    v_lshlrev_b32 v249, 16, v250
    v_and_b32 v250, 0xffff0000, v250
    v_mul_f32 v251, s61, v249
    v_mul_f32 v252, s61, v250
    v_exp_f32 v251, v251
    v_exp_f32 v252, v252
    v_add_f32 v249, 1.0, v249
    v_add_f32 v250, 1.0, v250
    v_med3_f32 v249, v249, v251, 1.0
    v_med3_f32 v250, v250, v252, 1.0
    v_cvt_pk_bf16_f32 v250, v249, v250
    v_lshlrev_b32 v249, 16, v250
    v_and_b32 v250, 0xffff0000, v250
    v_add_f32 v249, s57, v249
    v_add_f32 v250, s57, v250
    v_cvt_pk_bf16_f32 v248, v249, v250
    v_accvgpr_write_b32 a224, v248
    v_cvt_pk_bf16_f32 v250, v242, v243
    v_lshlrev_b32 v249, 16, v250
    v_and_b32 v250, 0xffff0000, v250
    v_mul_f32 v251, s61, v249
    v_mul_f32 v252, s61, v250
    v_exp_f32 v251, v251
    v_exp_f32 v252, v252
    v_add_f32 v249, 1.0, v249
    v_add_f32 v250, 1.0, v250
    v_med3_f32 v249, v249, v251, 1.0
    v_med3_f32 v250, v250, v252, 1.0
    v_cvt_pk_bf16_f32 v250, v249, v250
    v_lshlrev_b32 v249, 16, v250
    v_and_b32 v250, 0xffff0000, v250
    v_add_f32 v249, s57, v249
    v_add_f32 v250, s57, v250
    v_cvt_pk_bf16_f32 v248, v249, v250
    v_accvgpr_write_b32 a225, v248
    v_cvt_pk_bf16_f32 v250, v244, v245
    v_lshlrev_b32 v249, 16, v250
    v_and_b32 v250, 0xffff0000, v250
    v_mul_f32 v251, s61, v249
    v_mul_f32 v252, s61, v250
    v_exp_f32 v251, v251
    v_exp_f32 v252, v252
    v_add_f32 v249, 1.0, v249
    v_add_f32 v250, 1.0, v250
    v_med3_f32 v249, v249, v251, 1.0
    v_med3_f32 v250, v250, v252, 1.0
    v_cvt_pk_bf16_f32 v250, v249, v250
    v_lshlrev_b32 v249, 16, v250
    v_and_b32 v250, 0xffff0000, v250
    v_add_f32 v249, s57, v249
    v_add_f32 v250, s57, v250
    v_cvt_pk_bf16_f32 v248, v249, v250
    v_accvgpr_write_b32 a226, v248
    v_cvt_pk_bf16_f32 v250, v246, v247
    v_lshlrev_b32 v249, 16, v250
    v_and_b32 v250, 0xffff0000, v250
    v_mul_f32 v251, s61, v249
    v_mul_f32 v252, s61, v250
    v_exp_f32 v251, v251
    v_exp_f32 v252, v252
    v_add_f32 v249, 1.0, v249
    v_add_f32 v250, 1.0, v250
    v_med3_f32 v249, v249, v251, 1.0
    v_med3_f32 v250, v250, v252, 1.0
    v_cvt_pk_bf16_f32 v250, v249, v250
    v_lshlrev_b32 v249, 16, v250
    v_and_b32 v250, 0xffff0000, v250
    v_add_f32 v249, s57, v249
    v_add_f32 v250, s57, v250
    v_cvt_pk_bf16_f32 v248, v249, v250
    v_accvgpr_write_b32 a227, v248
    v_mfma_f32_16x16x32_bf16 v[240:243], a[112:115], v[16:19], 0
    v_mfma_f32_16x16x32_bf16 v[244:247], a[168:171], v[16:19], 0
    v_mfma_f32_16x16x32_bf16 v[240:243], a[116:119], v[20:23], v[240:243]
    v_mfma_f32_16x16x32_bf16 v[244:247], a[172:175], v[20:23], v[244:247]
    v_mfma_f32_16x16x32_bf16 v[240:243], a[120:123], v[24:27], v[240:243]
    v_mfma_f32_16x16x32_bf16 v[244:247], a[176:179], v[24:27], v[244:247]
    v_mfma_f32_16x16x32_bf16 v[240:243], a[124:127], v[28:31], v[240:243]
    v_mfma_f32_16x16x32_bf16 v[244:247], a[180:183], v[28:31], v[244:247]
    v_mfma_f32_16x16x32_bf16 v[240:243], a[128:131], v[32:35], v[240:243]
    v_mfma_f32_16x16x32_bf16 v[244:247], a[184:187], v[32:35], v[244:247]
    v_mfma_f32_16x16x32_bf16 v[240:243], a[132:135], v[36:39], v[240:243]
    v_mfma_f32_16x16x32_bf16 v[244:247], a[188:191], v[36:39], v[244:247]
    v_mfma_f32_16x16x32_bf16 v[240:243], a[136:139], v[40:43], v[240:243]
    v_mfma_f32_16x16x32_bf16 v[244:247], a[192:195], v[40:43], v[244:247]
    v_mfma_f32_16x16x32_bf16 v[240:243], a[140:143], v[44:47], v[240:243]
    v_mfma_f32_16x16x32_bf16 v[244:247], a[196:199], v[44:47], v[244:247]
    v_mfma_f32_16x16x32_bf16 v[240:243], a[144:147], v[48:51], v[240:243]
    v_mfma_f32_16x16x32_bf16 v[244:247], a[200:203], v[48:51], v[244:247]
    v_mfma_f32_16x16x32_bf16 v[240:243], a[148:151], v[52:55], v[240:243]
    v_mfma_f32_16x16x32_bf16 v[244:247], a[204:207], v[52:55], v[244:247]
    v_mfma_f32_16x16x32_bf16 v[240:243], a[152:155], v[56:59], v[240:243]
    v_mfma_f32_16x16x32_bf16 v[244:247], a[208:211], v[56:59], v[244:247]
    v_mfma_f32_16x16x32_bf16 v[240:243], a[156:159], v[60:63], v[240:243]
    v_mfma_f32_16x16x32_bf16 v[244:247], a[212:215], v[60:63], v[244:247]
    v_mfma_f32_16x16x32_bf16 v[240:243], a[160:163], v[64:67], v[240:243]
    v_mfma_f32_16x16x32_bf16 v[244:247], a[216:219], v[64:67], v[244:247]
    v_mfma_f32_16x16x32_bf16 v[240:243], a[164:167], v[68:71], v[240:243]
    v_mfma_f32_16x16x32_bf16 v[244:247], a[220:223], v[68:71], v[244:247]
    s_add_u32 s25, s58, 458752
    buffer_load_dwordx4 v[16:19], v4, s[4:7], s25 offen offset:0 sc1
    buffer_load_dwordx4 v[20:23], v4, s[4:7], s25 offen offset:1024 sc1
    buffer_load_dwordx4 v[24:27], v4, s[4:7], s25 offen offset:2048 sc1
    buffer_load_dwordx4 v[28:31], v4, s[4:7], s25 offen offset:3072 sc1
    s_add_u32 s25, s25, 4096
    buffer_load_dwordx4 v[32:35], v4, s[4:7], s25 offen offset:0 sc1
    buffer_load_dwordx4 v[36:39], v4, s[4:7], s25 offen offset:1024 sc1
    buffer_load_dwordx4 v[40:43], v4, s[4:7], s25 offen offset:2048 sc1
    buffer_load_dwordx4 v[44:47], v4, s[4:7], s25 offen offset:3072 sc1
    s_add_u32 s25, s25, 4096
    buffer_load_dwordx4 v[48:51], v4, s[4:7], s25 offen offset:0 sc1
    buffer_load_dwordx4 v[52:55], v4, s[4:7], s25 offen offset:1024 sc1
    buffer_load_dwordx4 v[56:59], v4, s[4:7], s25 offen offset:2048 sc1
    buffer_load_dwordx4 v[60:63], v4, s[4:7], s25 offen offset:3072 sc1
    s_add_u32 s25, s25, 4096
    buffer_load_dwordx4 v[64:67], v4, s[4:7], s25 offen offset:0 sc1
    buffer_load_dwordx4 v[68:71], v4, s[4:7], s25 offen offset:1024 sc1
    v_cvt_pk_bf16_f32 v250, v240, v241
    v_lshlrev_b32 v249, 16, v250
    v_and_b32 v250, 0xffff0000, v250
    v_mul_f32 v251, s61, v249
    v_mul_f32 v252, s61, v250
    v_exp_f32 v251, v251
    v_exp_f32 v252, v252
    v_add_f32 v249, 1.0, v249
    v_add_f32 v250, 1.0, v250
    v_med3_f32 v249, v249, v251, 1.0
    v_med3_f32 v250, v250, v252, 1.0
    v_cvt_pk_bf16_f32 v250, v249, v250
    v_lshlrev_b32 v249, 16, v250
    v_and_b32 v250, 0xffff0000, v250
    v_add_f32 v249, s57, v249
    v_add_f32 v250, s57, v250
    v_cvt_pk_bf16_f32 v248, v249, v250
    v_accvgpr_write_b32 a240, v248
    v_cvt_pk_bf16_f32 v250, v242, v243
    v_lshlrev_b32 v249, 16, v250
    v_and_b32 v250, 0xffff0000, v250
    v_mul_f32 v251, s61, v249
    v_mul_f32 v252, s61, v250
    v_exp_f32 v251, v251
    v_exp_f32 v252, v252
    v_add_f32 v249, 1.0, v249
    v_add_f32 v250, 1.0, v250
    v_med3_f32 v249, v249, v251, 1.0
    v_med3_f32 v250, v250, v252, 1.0
    v_cvt_pk_bf16_f32 v250, v249, v250
    v_lshlrev_b32 v249, 16, v250
    v_and_b32 v250, 0xffff0000, v250
    v_add_f32 v249, s57, v249
    v_add_f32 v250, s57, v250
    v_cvt_pk_bf16_f32 v248, v249, v250
    v_accvgpr_write_b32 a241, v248
    v_cvt_pk_bf16_f32 v250, v244, v245
    v_lshlrev_b32 v249, 16, v250
    v_and_b32 v250, 0xffff0000, v250
    v_mul_f32 v251, s61, v249
    v_mul_f32 v252, s61, v250
    v_exp_f32 v251, v251
    v_exp_f32 v252, v252
    v_add_f32 v249, 1.0, v249
    v_add_f32 v250, 1.0, v250
    v_med3_f32 v249, v249, v251, 1.0
    v_med3_f32 v250, v250, v252, 1.0
    v_cvt_pk_bf16_f32 v250, v249, v250
    v_lshlrev_b32 v249, 16, v250
    v_and_b32 v250, 0xffff0000, v250
    v_add_f32 v249, s57, v249
    v_add_f32 v250, s57, v250
    v_cvt_pk_bf16_f32 v248, v249, v250
    v_accvgpr_write_b32 a242, v248
    v_cvt_pk_bf16_f32 v250, v246, v247
    v_lshlrev_b32 v249, 16, v250
    v_and_b32 v250, 0xffff0000, v250
    v_mul_f32 v251, s61, v249
    v_mul_f32 v252, s61, v250
    v_exp_f32 v251, v251
    v_exp_f32 v252, v252
    v_add_f32 v249, 1.0, v249
    v_add_f32 v250, 1.0, v250
    v_med3_f32 v249, v249, v251, 1.0
    v_med3_f32 v250, v250, v252, 1.0
    v_cvt_pk_bf16_f32 v250, v249, v250
    v_lshlrev_b32 v249, 16, v250
    v_and_b32 v250, 0xffff0000, v250
    v_add_f32 v249, s57, v249
    v_add_f32 v250, s57, v250
    v_cvt_pk_bf16_f32 v248, v249, v250
    v_accvgpr_write_b32 a243, v248
    s_waitcnt vmcnt(42)
    v_mfma_f32_16x16x32_bf16 v[240:243], a[0:3], v[72:75], 0
    v_mfma_f32_16x16x32_bf16 v[244:247], a[56:59], v[72:75], 0
    v_mfma_f32_16x16x32_bf16 v[240:243], a[4:7], v[76:79], v[240:243]
    v_mfma_f32_16x16x32_bf16 v[244:247], a[60:63], v[76:79], v[244:247]
    v_mfma_f32_16x16x32_bf16 v[240:243], a[8:11], v[80:83], v[240:243]
    v_mfma_f32_16x16x32_bf16 v[244:247], a[64:67], v[80:83], v[244:247]
    v_mfma_f32_16x16x32_bf16 v[240:243], a[12:15], v[84:87], v[240:243]
    v_mfma_f32_16x16x32_bf16 v[244:247], a[68:71], v[84:87], v[244:247]
    v_mfma_f32_16x16x32_bf16 v[240:243], a[16:19], v[88:91], v[240:243]
    v_mfma_f32_16x16x32_bf16 v[244:247], a[72:75], v[88:91], v[244:247]
    v_mfma_f32_16x16x32_bf16 v[240:243], a[20:23], v[92:95], v[240:243]
    v_mfma_f32_16x16x32_bf16 v[244:247], a[76:79], v[92:95], v[244:247]
    v_mfma_f32_16x16x32_bf16 v[240:243], a[24:27], v[96:99], v[240:243]
    v_mfma_f32_16x16x32_bf16 v[244:247], a[80:83], v[96:99], v[244:247]
    v_mfma_f32_16x16x32_bf16 v[240:243], a[28:31], v[100:103], v[240:243]
    v_mfma_f32_16x16x32_bf16 v[244:247], a[84:87], v[100:103], v[244:247]
    v_mfma_f32_16x16x32_bf16 v[240:243], a[32:35], v[104:107], v[240:243]
    v_mfma_f32_16x16x32_bf16 v[244:247], a[88:91], v[104:107], v[244:247]
    v_mfma_f32_16x16x32_bf16 v[240:243], a[36:39], v[108:111], v[240:243]
    v_mfma_f32_16x16x32_bf16 v[244:247], a[92:95], v[108:111], v[244:247]
    v_mfma_f32_16x16x32_bf16 v[240:243], a[40:43], v[112:115], v[240:243]
    v_mfma_f32_16x16x32_bf16 v[244:247], a[96:99], v[112:115], v[244:247]
    v_mfma_f32_16x16x32_bf16 v[240:243], a[44:47], v[116:119], v[240:243]
    v_mfma_f32_16x16x32_bf16 v[244:247], a[100:103], v[116:119], v[244:247]
    v_mfma_f32_16x16x32_bf16 v[240:243], a[48:51], v[120:123], v[240:243]
    v_mfma_f32_16x16x32_bf16 v[244:247], a[104:107], v[120:123], v[244:247]
    v_mfma_f32_16x16x32_bf16 v[240:243], a[52:55], v[124:127], v[240:243]
    v_mfma_f32_16x16x32_bf16 v[244:247], a[108:111], v[124:127], v[244:247]
    s_nop 7
    v_cvt_pk_bf16_f32 v250, v240, v241
    v_lshlrev_b32 v249, 16, v250
    v_and_b32 v250, 0xffff0000, v250
    v_mul_f32 v251, s61, v249
    v_mul_f32 v252, s61, v250
    v_exp_f32 v251, v251
    v_exp_f32 v252, v252
    v_add_f32 v249, 1.0, v249
    v_add_f32 v250, 1.0, v250
    v_med3_f32 v249, v249, v251, 1.0
    v_med3_f32 v250, v250, v252, 1.0
    v_cvt_pk_bf16_f32 v250, v249, v250
    v_lshlrev_b32 v249, 16, v250
    v_and_b32 v250, 0xffff0000, v250
    v_add_f32 v249, s57, v249
    v_add_f32 v250, s57, v250
    v_cvt_pk_bf16_f32 v248, v249, v250
    v_and_b32 v248, v248, v9
    v_accvgpr_write_b32 a228, v248
    v_cvt_pk_bf16_f32 v250, v242, v243
    v_lshlrev_b32 v249, 16, v250
    v_and_b32 v250, 0xffff0000, v250
    v_mul_f32 v251, s61, v249
    v_mul_f32 v252, s61, v250
    v_exp_f32 v251, v251
    v_exp_f32 v252, v252
    v_add_f32 v249, 1.0, v249
    v_add_f32 v250, 1.0, v250
    v_med3_f32 v249, v249, v251, 1.0
    v_med3_f32 v250, v250, v252, 1.0
    v_cvt_pk_bf16_f32 v250, v249, v250
    v_lshlrev_b32 v249, 16, v250
    v_and_b32 v250, 0xffff0000, v250
    v_add_f32 v249, s57, v249
    v_add_f32 v250, s57, v250
    v_cvt_pk_bf16_f32 v248, v249, v250
    v_and_b32 v248, v248, v9
    v_accvgpr_write_b32 a229, v248
    v_cvt_pk_bf16_f32 v250, v244, v245
    v_lshlrev_b32 v249, 16, v250
    v_and_b32 v250, 0xffff0000, v250
    v_mul_f32 v251, s61, v249
    v_mul_f32 v252, s61, v250
    v_exp_f32 v251, v251
    v_exp_f32 v252, v252
    v_add_f32 v249, 1.0, v249
    v_add_f32 v250, 1.0, v250
    v_med3_f32 v249, v249, v251, 1.0
    v_med3_f32 v250, v250, v252, 1.0
    v_cvt_pk_bf16_f32 v250, v249, v250
    v_lshlrev_b32 v249, 16, v250
    v_and_b32 v250, 0xffff0000, v250
    v_add_f32 v249, s57, v249
    v_add_f32 v250, s57, v250
    v_cvt_pk_bf16_f32 v248, v249, v250
    v_and_b32 v248, v248, v9
    v_accvgpr_write_b32 a230, v248
    v_cvt_pk_bf16_f32 v250, v246, v247
    v_lshlrev_b32 v249, 16, v250
    v_and_b32 v250, 0xffff0000, v250
    v_mul_f32 v251, s61, v249
    v_mul_f32 v252, s61, v250
    v_exp_f32 v251, v251
    v_exp_f32 v252, v252
    v_add_f32 v249, 1.0, v249
    v_add_f32 v250, 1.0, v250
    v_med3_f32 v249, v249, v251, 1.0
    v_med3_f32 v250, v250, v252, 1.0
    v_cvt_pk_bf16_f32 v250, v249, v250
    v_lshlrev_b32 v249, 16, v250
    v_and_b32 v250, 0xffff0000, v250
    v_add_f32 v249, s57, v249
    v_add_f32 v250, s57, v250
    v_cvt_pk_bf16_f32 v248, v249, v250
    v_and_b32 v248, v248, v9
    v_accvgpr_write_b32 a231, v248
    v_mfma_f32_16x16x32_bf16 v[240:243], a[112:115], v[72:75], 0
    v_mfma_f32_16x16x32_bf16 v[244:247], a[168:171], v[72:75], 0
    v_mfma_f32_16x16x32_bf16 v[240:243], a[116:119], v[76:79], v[240:243]
    v_mfma_f32_16x16x32_bf16 v[244:247], a[172:175], v[76:79], v[244:247]
    v_mfma_f32_16x16x32_bf16 v[240:243], a[120:123], v[80:83], v[240:243]
    v_mfma_f32_16x16x32_bf16 v[244:247], a[176:179], v[80:83], v[244:247]
    v_mfma_f32_16x16x32_bf16 v[240:243], a[124:127], v[84:87], v[240:243]
    v_mfma_f32_16x16x32_bf16 v[244:247], a[180:183], v[84:87], v[244:247]
    v_mfma_f32_16x16x32_bf16 v[240:243], a[128:131], v[88:91], v[240:243]
    v_mfma_f32_16x16x32_bf16 v[244:247], a[184:187], v[88:91], v[244:247]
    v_mfma_f32_16x16x32_bf16 v[240:243], a[132:135], v[92:95], v[240:243]
    v_mfma_f32_16x16x32_bf16 v[244:247], a[188:191], v[92:95], v[244:247]
    v_mfma_f32_16x16x32_bf16 v[240:243], a[136:139], v[96:99], v[240:243]
    v_mfma_f32_16x16x32_bf16 v[244:247], a[192:195], v[96:99], v[244:247]
    v_mfma_f32_16x16x32_bf16 v[240:243], a[140:143], v[100:103], v[240:243]
    v_mfma_f32_16x16x32_bf16 v[244:247], a[196:199], v[100:103], v[244:247]
    v_mfma_f32_16x16x32_bf16 v[240:243], a[144:147], v[104:107], v[240:243]
    v_mfma_f32_16x16x32_bf16 v[244:247], a[200:203], v[104:107], v[244:247]
    v_mfma_f32_16x16x32_bf16 v[240:243], a[148:151], v[108:111], v[240:243]
    v_mfma_f32_16x16x32_bf16 v[244:247], a[204:207], v[108:111], v[244:247]
    v_mfma_f32_16x16x32_bf16 v[240:243], a[152:155], v[112:115], v[240:243]
    v_mfma_f32_16x16x32_bf16 v[244:247], a[208:211], v[112:115], v[244:247]
    v_mfma_f32_16x16x32_bf16 v[240:243], a[156:159], v[116:119], v[240:243]
    v_mfma_f32_16x16x32_bf16 v[244:247], a[212:215], v[116:119], v[244:247]
    v_mfma_f32_16x16x32_bf16 v[240:243], a[160:163], v[120:123], v[240:243]
    v_mfma_f32_16x16x32_bf16 v[244:247], a[216:219], v[120:123], v[244:247]
    v_mfma_f32_16x16x32_bf16 v[240:243], a[164:167], v[124:127], v[240:243]
    v_mfma_f32_16x16x32_bf16 v[244:247], a[220:223], v[124:127], v[244:247]
    s_add_u32 s25, s58, 473088
    buffer_load_dwordx4 v[72:75], v4, s[4:7], s25 offen offset:0 sc1
    buffer_load_dwordx4 v[76:79], v4, s[4:7], s25 offen offset:1024 sc1
    buffer_load_dwordx4 v[80:83], v4, s[4:7], s25 offen offset:2048 sc1
    buffer_load_dwordx4 v[84:87], v4, s[4:7], s25 offen offset:3072 sc1
    s_add_u32 s25, s25, 4096
    buffer_load_dwordx4 v[88:91], v4, s[4:7], s25 offen offset:0 sc1
    buffer_load_dwordx4 v[92:95], v4, s[4:7], s25 offen offset:1024 sc1
    buffer_load_dwordx4 v[96:99], v4, s[4:7], s25 offen offset:2048 sc1
    buffer_load_dwordx4 v[100:103], v4, s[4:7], s25 offen offset:3072 sc1
    s_add_u32 s25, s25, 4096
    buffer_load_dwordx4 v[104:107], v4, s[4:7], s25 offen offset:0 sc1
    buffer_load_dwordx4 v[108:111], v4, s[4:7], s25 offen offset:1024 sc1
    buffer_load_dwordx4 v[112:115], v4, s[4:7], s25 offen offset:2048 sc1
    buffer_load_dwordx4 v[116:119], v4, s[4:7], s25 offen offset:3072 sc1
    s_add_u32 s25, s25, 4096
    buffer_load_dwordx4 v[120:123], v4, s[4:7], s25 offen offset:0 sc1
    buffer_load_dwordx4 v[124:127], v4, s[4:7], s25 offen offset:1024 sc1
    v_cvt_pk_bf16_f32 v250, v240, v241
    v_lshlrev_b32 v249, 16, v250
    v_and_b32 v250, 0xffff0000, v250
    v_mul_f32 v251, s61, v249
    v_mul_f32 v252, s61, v250
    v_exp_f32 v251, v251
    v_exp_f32 v252, v252
    v_add_f32 v249, 1.0, v249
    v_add_f32 v250, 1.0, v250
    v_med3_f32 v249, v249, v251, 1.0
    v_med3_f32 v250, v250, v252, 1.0
    v_cvt_pk_bf16_f32 v250, v249, v250
    v_lshlrev_b32 v249, 16, v250
    v_and_b32 v250, 0xffff0000, v250
    v_add_f32 v249, s57, v249
    v_add_f32 v250, s57, v250
    v_cvt_pk_bf16_f32 v248, v249, v250
    v_and_b32 v248, v248, v9
    v_accvgpr_write_b32 a244, v248
    v_cvt_pk_bf16_f32 v250, v242, v243
    v_lshlrev_b32 v249, 16, v250
    v_and_b32 v250, 0xffff0000, v250
    v_mul_f32 v251, s61, v249
    v_mul_f32 v252, s61, v250
    v_exp_f32 v251, v251
    v_exp_f32 v252, v252
    v_add_f32 v249, 1.0, v249
    v_add_f32 v250, 1.0, v250
    v_med3_f32 v249, v249, v251, 1.0
    v_med3_f32 v250, v250, v252, 1.0
    v_cvt_pk_bf16_f32 v250, v249, v250
    v_lshlrev_b32 v249, 16, v250
    v_and_b32 v250, 0xffff0000, v250
    v_add_f32 v249, s57, v249
    v_add_f32 v250, s57, v250
    v_cvt_pk_bf16_f32 v248, v249, v250
    v_and_b32 v248, v248, v9
    v_accvgpr_write_b32 a245, v248
    v_cvt_pk_bf16_f32 v250, v244, v245
    v_lshlrev_b32 v249, 16, v250
    v_and_b32 v250, 0xffff0000, v250
    v_mul_f32 v251, s61, v249
    v_mul_f32 v252, s61, v250
    v_exp_f32 v251, v251
    v_exp_f32 v252, v252
    v_add_f32 v249, 1.0, v249
    v_add_f32 v250, 1.0, v250
    v_med3_f32 v249, v249, v251, 1.0
    v_med3_f32 v250, v250, v252, 1.0
    v_cvt_pk_bf16_f32 v250, v249, v250
    v_lshlrev_b32 v249, 16, v250
    v_and_b32 v250, 0xffff0000, v250
    v_add_f32 v249, s57, v249
    v_add_f32 v250, s57, v250
    v_cvt_pk_bf16_f32 v248, v249, v250
    v_and_b32 v248, v248, v9
    v_accvgpr_write_b32 a246, v248
    v_cvt_pk_bf16_f32 v250, v246, v247
    v_lshlrev_b32 v249, 16, v250
    v_and_b32 v250, 0xffff0000, v250
    v_mul_f32 v251, s61, v249
    v_mul_f32 v252, s61, v250
    v_exp_f32 v251, v251
    v_exp_f32 v252, v252
    v_add_f32 v249, 1.0, v249
    v_add_f32 v250, 1.0, v250
    v_med3_f32 v249, v249, v251, 1.0
    v_med3_f32 v250, v250, v252, 1.0
    v_cvt_pk_bf16_f32 v250, v249, v250
    v_lshlrev_b32 v249, 16, v250
    v_and_b32 v250, 0xffff0000, v250
    v_add_f32 v249, s57, v249
    v_add_f32 v250, s57, v250
    v_cvt_pk_bf16_f32 v248, v249, v250
    v_and_b32 v248, v248, v9
    v_accvgpr_write_b32 a247, v248
    s_waitcnt vmcnt(42)
    v_mfma_f32_16x16x32_bf16 v[240:243], a[0:3], v[128:131], 0
    v_mfma_f32_16x16x32_bf16 v[244:247], a[56:59], v[128:131], 0
    v_mfma_f32_16x16x32_bf16 v[240:243], a[4:7], v[132:135], v[240:243]
    v_mfma_f32_16x16x32_bf16 v[244:247], a[60:63], v[132:135], v[244:247]
    v_mfma_f32_16x16x32_bf16 v[240:243], a[8:11], v[136:139], v[240:243]
    v_mfma_f32_16x16x32_bf16 v[244:247], a[64:67], v[136:139], v[244:247]
    v_mfma_f32_16x16x32_bf16 v[240:243], a[12:15], v[140:143], v[240:243]
    v_mfma_f32_16x16x32_bf16 v[244:247], a[68:71], v[140:143], v[244:247]
    v_mfma_f32_16x16x32_bf16 v[240:243], a[16:19], v[144:147], v[240:243]
    v_mfma_f32_16x16x32_bf16 v[244:247], a[72:75], v[144:147], v[244:247]
    v_mfma_f32_16x16x32_bf16 v[240:243], a[20:23], v[148:151], v[240:243]
    v_mfma_f32_16x16x32_bf16 v[244:247], a[76:79], v[148:151], v[244:247]
    v_mfma_f32_16x16x32_bf16 v[240:243], a[24:27], v[152:155], v[240:243]
    v_mfma_f32_16x16x32_bf16 v[244:247], a[80:83], v[152:155], v[244:247]
    v_mfma_f32_16x16x32_bf16 v[240:243], a[28:31], v[156:159], v[240:243]
    v_mfma_f32_16x16x32_bf16 v[244:247], a[84:87], v[156:159], v[244:247]
    v_mfma_f32_16x16x32_bf16 v[240:243], a[32:35], v[160:163], v[240:243]
    v_mfma_f32_16x16x32_bf16 v[244:247], a[88:91], v[160:163], v[244:247]
    v_mfma_f32_16x16x32_bf16 v[240:243], a[36:39], v[164:167], v[240:243]
    v_mfma_f32_16x16x32_bf16 v[244:247], a[92:95], v[164:167], v[244:247]
    v_mfma_f32_16x16x32_bf16 v[240:243], a[40:43], v[168:171], v[240:243]
    v_mfma_f32_16x16x32_bf16 v[244:247], a[96:99], v[168:171], v[244:247]
    v_mfma_f32_16x16x32_bf16 v[240:243], a[44:47], v[172:175], v[240:243]
    v_mfma_f32_16x16x32_bf16 v[244:247], a[100:103], v[172:175], v[244:247]
    v_mfma_f32_16x16x32_bf16 v[240:243], a[48:51], v[176:179], v[240:243]
    v_mfma_f32_16x16x32_bf16 v[244:247], a[104:107], v[176:179], v[244:247]
    v_mfma_f32_16x16x32_bf16 v[240:243], a[52:55], v[180:183], v[240:243]
    v_mfma_f32_16x16x32_bf16 v[244:247], a[108:111], v[180:183], v[244:247]
    s_nop 7
    v_cvt_pk_bf16_f32 v248, v240, v241
    v_accvgpr_write_b32 a232, v248
    v_cvt_pk_bf16_f32 v248, v242, v243
    v_accvgpr_write_b32 a233, v248
    v_cvt_pk_bf16_f32 v248, v244, v245
    v_accvgpr_write_b32 a234, v248
    v_cvt_pk_bf16_f32 v248, v246, v247
    v_accvgpr_write_b32 a235, v248
    v_mfma_f32_16x16x32_bf16 v[240:243], a[112:115], v[128:131], 0
    v_mfma_f32_16x16x32_bf16 v[244:247], a[168:171], v[128:131], 0
    v_mfma_f32_16x16x32_bf16 v[240:243], a[116:119], v[132:135], v[240:243]
    v_mfma_f32_16x16x32_bf16 v[244:247], a[172:175], v[132:135], v[244:247]
    v_mfma_f32_16x16x32_bf16 v[240:243], a[120:123], v[136:139], v[240:243]
    v_mfma_f32_16x16x32_bf16 v[244:247], a[176:179], v[136:139], v[244:247]
    v_mfma_f32_16x16x32_bf16 v[240:243], a[124:127], v[140:143], v[240:243]
    v_mfma_f32_16x16x32_bf16 v[244:247], a[180:183], v[140:143], v[244:247]
    v_mfma_f32_16x16x32_bf16 v[240:243], a[128:131], v[144:147], v[240:243]
    v_mfma_f32_16x16x32_bf16 v[244:247], a[184:187], v[144:147], v[244:247]
    v_mfma_f32_16x16x32_bf16 v[240:243], a[132:135], v[148:151], v[240:243]
    v_mfma_f32_16x16x32_bf16 v[244:247], a[188:191], v[148:151], v[244:247]
    v_mfma_f32_16x16x32_bf16 v[240:243], a[136:139], v[152:155], v[240:243]
    v_mfma_f32_16x16x32_bf16 v[244:247], a[192:195], v[152:155], v[244:247]
    v_mfma_f32_16x16x32_bf16 v[240:243], a[140:143], v[156:159], v[240:243]
    v_mfma_f32_16x16x32_bf16 v[244:247], a[196:199], v[156:159], v[244:247]
    v_mfma_f32_16x16x32_bf16 v[240:243], a[144:147], v[160:163], v[240:243]
    v_mfma_f32_16x16x32_bf16 v[244:247], a[200:203], v[160:163], v[244:247]
    v_mfma_f32_16x16x32_bf16 v[240:243], a[148:151], v[164:167], v[240:243]
    v_mfma_f32_16x16x32_bf16 v[244:247], a[204:207], v[164:167], v[244:247]
    v_mfma_f32_16x16x32_bf16 v[240:243], a[152:155], v[168:171], v[240:243]
    v_mfma_f32_16x16x32_bf16 v[244:247], a[208:211], v[168:171], v[244:247]
    v_mfma_f32_16x16x32_bf16 v[240:243], a[156:159], v[172:175], v[240:243]
    v_mfma_f32_16x16x32_bf16 v[244:247], a[212:215], v[172:175], v[244:247]
    v_mfma_f32_16x16x32_bf16 v[240:243], a[160:163], v[176:179], v[240:243]
    v_mfma_f32_16x16x32_bf16 v[244:247], a[216:219], v[176:179], v[244:247]
    v_mfma_f32_16x16x32_bf16 v[240:243], a[164:167], v[180:183], v[240:243]
    v_mfma_f32_16x16x32_bf16 v[244:247], a[220:223], v[180:183], v[244:247]
    s_add_u32 s25, s58, 917504
    buffer_load_dwordx4 v[128:131], v4, s[4:7], s25 offen offset:0 sc1
    buffer_load_dwordx4 v[132:135], v4, s[4:7], s25 offen offset:1024 sc1
    buffer_load_dwordx4 v[136:139], v4, s[4:7], s25 offen offset:2048 sc1
    buffer_load_dwordx4 v[140:143], v4, s[4:7], s25 offen offset:3072 sc1
    s_add_u32 s25, s25, 4096
    buffer_load_dwordx4 v[144:147], v4, s[4:7], s25 offen offset:0 sc1
    buffer_load_dwordx4 v[148:151], v4, s[4:7], s25 offen offset:1024 sc1
    buffer_load_dwordx4 v[152:155], v4, s[4:7], s25 offen offset:2048 sc1
    buffer_load_dwordx4 v[156:159], v4, s[4:7], s25 offen offset:3072 sc1
    s_add_u32 s25, s25, 4096
    buffer_load_dwordx4 v[160:163], v4, s[4:7], s25 offen offset:0 sc1
    buffer_load_dwordx4 v[164:167], v4, s[4:7], s25 offen offset:1024 sc1
    buffer_load_dwordx4 v[168:171], v4, s[4:7], s25 offen offset:2048 sc1
    buffer_load_dwordx4 v[172:175], v4, s[4:7], s25 offen offset:3072 sc1
    s_add_u32 s25, s25, 4096
    buffer_load_dwordx4 v[176:179], v4, s[4:7], s25 offen offset:0 sc1
    buffer_load_dwordx4 v[180:183], v4, s[4:7], s25 offen offset:1024 sc1
    v_cvt_pk_bf16_f32 v248, v240, v241
    v_accvgpr_write_b32 a248, v248
    v_cvt_pk_bf16_f32 v248, v242, v243
    v_accvgpr_write_b32 a249, v248
    v_cvt_pk_bf16_f32 v248, v244, v245
    v_accvgpr_write_b32 a250, v248
    v_cvt_pk_bf16_f32 v248, v246, v247
    v_accvgpr_write_b32 a251, v248
    s_waitcnt vmcnt(42)
    v_mfma_f32_16x16x32_bf16 v[240:243], a[0:3], v[184:187], 0
    v_mfma_f32_16x16x32_bf16 v[244:247], a[56:59], v[184:187], 0
    v_mfma_f32_16x16x32_bf16 v[240:243], a[4:7], v[188:191], v[240:243]
    v_mfma_f32_16x16x32_bf16 v[244:247], a[60:63], v[188:191], v[244:247]
    v_mfma_f32_16x16x32_bf16 v[240:243], a[8:11], v[192:195], v[240:243]
    v_mfma_f32_16x16x32_bf16 v[244:247], a[64:67], v[192:195], v[244:247]
    v_mfma_f32_16x16x32_bf16 v[240:243], a[12:15], v[196:199], v[240:243]
    v_mfma_f32_16x16x32_bf16 v[244:247], a[68:71], v[196:199], v[244:247]
    v_mfma_f32_16x16x32_bf16 v[240:243], a[16:19], v[200:203], v[240:243]
    v_mfma_f32_16x16x32_bf16 v[244:247], a[72:75], v[200:203], v[244:247]
    v_mfma_f32_16x16x32_bf16 v[240:243], a[20:23], v[204:207], v[240:243]
    v_mfma_f32_16x16x32_bf16 v[244:247], a[76:79], v[204:207], v[244:247]
    v_mfma_f32_16x16x32_bf16 v[240:243], a[24:27], v[208:211], v[240:243]
    v_mfma_f32_16x16x32_bf16 v[244:247], a[80:83], v[208:211], v[244:247]
    v_mfma_f32_16x16x32_bf16 v[240:243], a[28:31], v[212:215], v[240:243]
    v_mfma_f32_16x16x32_bf16 v[244:247], a[84:87], v[212:215], v[244:247]
    v_mfma_f32_16x16x32_bf16 v[240:243], a[32:35], v[216:219], v[240:243]
    v_mfma_f32_16x16x32_bf16 v[244:247], a[88:91], v[216:219], v[244:247]
    v_mfma_f32_16x16x32_bf16 v[240:243], a[36:39], v[220:223], v[240:243]
    v_mfma_f32_16x16x32_bf16 v[244:247], a[92:95], v[220:223], v[244:247]
    v_mfma_f32_16x16x32_bf16 v[240:243], a[40:43], v[224:227], v[240:243]
    v_mfma_f32_16x16x32_bf16 v[244:247], a[96:99], v[224:227], v[244:247]
    v_mfma_f32_16x16x32_bf16 v[240:243], a[44:47], v[228:231], v[240:243]
    v_mfma_f32_16x16x32_bf16 v[244:247], a[100:103], v[228:231], v[244:247]
    v_mfma_f32_16x16x32_bf16 v[240:243], a[48:51], v[232:235], v[240:243]
    v_mfma_f32_16x16x32_bf16 v[244:247], a[104:107], v[232:235], v[244:247]
    v_mfma_f32_16x16x32_bf16 v[240:243], a[52:55], v[236:239], v[240:243]
    v_mfma_f32_16x16x32_bf16 v[244:247], a[108:111], v[236:239], v[244:247]
    s_nop 7
    v_cvt_pk_bf16_f32 v248, v240, v241
    v_or_b32 v248, v248, v10
    v_accvgpr_write_b32 a236, v248
    v_cvt_pk_bf16_f32 v248, v242, v243
    v_or_b32 v248, v248, v10
    v_accvgpr_write_b32 a237, v248
    v_cvt_pk_bf16_f32 v248, v244, v245
    v_or_b32 v248, v248, v10
    v_accvgpr_write_b32 a238, v248
    v_cvt_pk_bf16_f32 v248, v246, v247
    v_or_b32 v248, v248, v10
    v_accvgpr_write_b32 a239, v248
    v_mfma_f32_16x16x32_bf16 v[240:243], a[112:115], v[184:187], 0
    v_mfma_f32_16x16x32_bf16 v[244:247], a[168:171], v[184:187], 0
    v_mfma_f32_16x16x32_bf16 v[240:243], a[116:119], v[188:191], v[240:243]
    v_mfma_f32_16x16x32_bf16 v[244:247], a[172:175], v[188:191], v[244:247]
    v_mfma_f32_16x16x32_bf16 v[240:243], a[120:123], v[192:195], v[240:243]
    v_mfma_f32_16x16x32_bf16 v[244:247], a[176:179], v[192:195], v[244:247]
    v_mfma_f32_16x16x32_bf16 v[240:243], a[124:127], v[196:199], v[240:243]
    v_mfma_f32_16x16x32_bf16 v[244:247], a[180:183], v[196:199], v[244:247]
    v_mfma_f32_16x16x32_bf16 v[240:243], a[128:131], v[200:203], v[240:243]
    v_mfma_f32_16x16x32_bf16 v[244:247], a[184:187], v[200:203], v[244:247]
    v_mfma_f32_16x16x32_bf16 v[240:243], a[132:135], v[204:207], v[240:243]
    v_mfma_f32_16x16x32_bf16 v[244:247], a[188:191], v[204:207], v[244:247]
    v_mfma_f32_16x16x32_bf16 v[240:243], a[136:139], v[208:211], v[240:243]
    v_mfma_f32_16x16x32_bf16 v[244:247], a[192:195], v[208:211], v[244:247]
    v_mfma_f32_16x16x32_bf16 v[240:243], a[140:143], v[212:215], v[240:243]
    v_mfma_f32_16x16x32_bf16 v[244:247], a[196:199], v[212:215], v[244:247]
    v_mfma_f32_16x16x32_bf16 v[240:243], a[144:147], v[216:219], v[240:243]
    v_mfma_f32_16x16x32_bf16 v[244:247], a[200:203], v[216:219], v[244:247]
    v_mfma_f32_16x16x32_bf16 v[240:243], a[148:151], v[220:223], v[240:243]
    v_mfma_f32_16x16x32_bf16 v[244:247], a[204:207], v[220:223], v[244:247]
    v_mfma_f32_16x16x32_bf16 v[240:243], a[152:155], v[224:227], v[240:243]
    v_mfma_f32_16x16x32_bf16 v[244:247], a[208:211], v[224:227], v[244:247]
    v_mfma_f32_16x16x32_bf16 v[240:243], a[156:159], v[228:231], v[240:243]
    v_mfma_f32_16x16x32_bf16 v[244:247], a[212:215], v[228:231], v[244:247]
    v_mfma_f32_16x16x32_bf16 v[240:243], a[160:163], v[232:235], v[240:243]
    v_mfma_f32_16x16x32_bf16 v[244:247], a[216:219], v[232:235], v[244:247]
    v_mfma_f32_16x16x32_bf16 v[240:243], a[164:167], v[236:239], v[240:243]
    v_mfma_f32_16x16x32_bf16 v[244:247], a[220:223], v[236:239], v[244:247]
    s_add_u32 s25, s58, 931840
    buffer_load_dwordx4 v[184:187], v4, s[4:7], s25 offen offset:0 sc1
    buffer_load_dwordx4 v[188:191], v4, s[4:7], s25 offen offset:1024 sc1
    buffer_load_dwordx4 v[192:195], v4, s[4:7], s25 offen offset:2048 sc1
    buffer_load_dwordx4 v[196:199], v4, s[4:7], s25 offen offset:3072 sc1
    s_add_u32 s25, s25, 4096
    buffer_load_dwordx4 v[200:203], v4, s[4:7], s25 offen offset:0 sc1
    buffer_load_dwordx4 v[204:207], v4, s[4:7], s25 offen offset:1024 sc1
    buffer_load_dwordx4 v[208:211], v4, s[4:7], s25 offen offset:2048 sc1
    buffer_load_dwordx4 v[212:215], v4, s[4:7], s25 offen offset:3072 sc1
    s_add_u32 s25, s25, 4096
    buffer_load_dwordx4 v[216:219], v4, s[4:7], s25 offen offset:0 sc1
    buffer_load_dwordx4 v[220:223], v4, s[4:7], s25 offen offset:1024 sc1
    buffer_load_dwordx4 v[224:227], v4, s[4:7], s25 offen offset:2048 sc1
    buffer_load_dwordx4 v[228:231], v4, s[4:7], s25 offen offset:3072 sc1
    s_add_u32 s25, s25, 4096
    buffer_load_dwordx4 v[232:235], v4, s[4:7], s25 offen offset:0 sc1
    buffer_load_dwordx4 v[236:239], v4, s[4:7], s25 offen offset:1024 sc1
    v_cvt_pk_bf16_f32 v248, v240, v241
    v_or_b32 v248, v248, v10
    v_accvgpr_write_b32 a252, v248
    v_cvt_pk_bf16_f32 v248, v242, v243
    v_or_b32 v248, v248, v10
    v_accvgpr_write_b32 a253, v248
    v_cvt_pk_bf16_f32 v248, v244, v245
    v_or_b32 v248, v248, v10
    v_accvgpr_write_b32 a254, v248
    v_cvt_pk_bf16_f32 v248, v246, v247
    v_or_b32 v248, v248, v10
    v_accvgpr_write_b32 a255, v248
    s_nop 1
    v_mfma_f32_16x16x32_bf16 v[240:243], a[224:227], a[232:235], 0
    v_mfma_f32_16x16x32_bf16 v[244:247], a[224:227], a[236:239], 0
    v_mfma_f32_16x16x32_bf16 v[248:251], a[228:231], a[232:235], 0
    v_mfma_f32_16x16x32_bf16 v[252:255], a[228:231], a[236:239], 0
    v_mfma_f32_16x16x32_bf16 v[240:243], a[240:243], a[248:251], v[240:243]
    v_mfma_f32_16x16x32_bf16 v[244:247], a[240:243], a[252:255], v[244:247]
    v_mfma_f32_16x16x32_bf16 v[248:251], a[244:247], a[248:251], v[248:251]
    v_mfma_f32_16x16x32_bf16 v[252:255], a[244:247], a[252:255], v[252:255]
    s_waitcnt vmcnt(40)
    s_nop 7
    buffer_atomic_add_f32 v240, v8, s[4:7], s60 offen offset:0
    buffer_atomic_add_f32 v241, v8, s[4:7], s60 offen offset:256
    buffer_atomic_add_f32 v242, v8, s[4:7], s60 offen offset:512
    buffer_atomic_add_f32 v243, v8, s[4:7], s60 offen offset:768
    buffer_atomic_add_f32 v244, v8, s[4:7], s60 offen offset:1024
    buffer_atomic_add_f32 v245, v8, s[4:7], s60 offen offset:1280
    buffer_atomic_add_f32 v246, v8, s[4:7], s60 offen offset:1536
    buffer_atomic_add_f32 v247, v8, s[4:7], s60 offen offset:1792
    buffer_atomic_add_f32 v248, v8, s[4:7], s60 offen offset:2048
    buffer_atomic_add_f32 v249, v8, s[4:7], s60 offen offset:2304
    buffer_atomic_add_f32 v250, v8, s[4:7], s60 offen offset:2560
    buffer_atomic_add_f32 v251, v8, s[4:7], s60 offen offset:2816
    buffer_atomic_add_f32 v252, v8, s[4:7], s60 offen offset:3072
    buffer_atomic_add_f32 v253, v8, s[4:7], s60 offen offset:3328
    buffer_atomic_add_f32 v254, v8, s[4:7], s60 offen offset:3584
    buffer_atomic_add_f32 v255, v8, s[4:7], s60 offen offset:3840
    s_add_u32 s60, s60, 4096
    s_add_u32 s59, s59, 1
    s_cmp_lt_u32 s59, 4
    s_cbranch_scc1 LL1_100256
    s_waitcnt vmcnt(0)
    s_barrier
    s_mov_b32 s60, 0x3d2c000
    s_cmp_lg_u32 s16, 0
    s_cbranch_scc1 LLns_100257
    v_mov_b32 v5, 1
    s_mov_b64 exec, 1
    buffer_atomic_add v5, off, s[4:7], s60 sc1
    s_mov_b64 exec, -1
LLns_100257:
    s_mul_i32 s58, s16, 114688
    s_add_u32 s58, s58, 0x3a00000
    s_add_u32 s25, s58, 0
    buffer_load_dwordx4 v[16:19], v4, s[4:7], s25 offen offset:0 sc1
    buffer_load_dwordx4 v[20:23], v4, s[4:7], s25 offen offset:1024 sc1
    buffer_load_dwordx4 v[24:27], v4, s[4:7], s25 offen offset:2048 sc1
    buffer_load_dwordx4 v[28:31], v4, s[4:7], s25 offen offset:3072 sc1
    s_add_u32 s25, s25, 4096
    buffer_load_dwordx4 v[32:35], v4, s[4:7], s25 offen offset:0 sc1
    buffer_load_dwordx4 v[36:39], v4, s[4:7], s25 offen offset:1024 sc1
    buffer_load_dwordx4 v[40:43], v4, s[4:7], s25 offen offset:2048 sc1
    buffer_load_dwordx4 v[44:47], v4, s[4:7], s25 offen offset:3072 sc1
    s_add_u32 s25, s25, 4096
    buffer_load_dwordx4 v[48:51], v4, s[4:7], s25 offen offset:0 sc1
    buffer_load_dwordx4 v[52:55], v4, s[4:7], s25 offen offset:1024 sc1
    buffer_load_dwordx4 v[56:59], v4, s[4:7], s25 offen offset:2048 sc1
    buffer_load_dwordx4 v[60:63], v4, s[4:7], s25 offen offset:3072 sc1
    s_add_u32 s25, s25, 4096
    buffer_load_dwordx4 v[64:67], v4, s[4:7], s25 offen offset:0 sc1
    buffer_load_dwordx4 v[68:71], v4, s[4:7], s25 offen offset:1024 sc1
    s_add_u32 s25, s58, 14336
    buffer_load_dwordx4 v[72:75], v4, s[4:7], s25 offen offset:0 sc1
    buffer_load_dwordx4 v[76:79], v4, s[4:7], s25 offen offset:1024 sc1
    buffer_load_dwordx4 v[80:83], v4, s[4:7], s25 offen offset:2048 sc1
    buffer_load_dwordx4 v[84:87], v4, s[4:7], s25 offen offset:3072 sc1
    s_add_u32 s25, s25, 4096
    buffer_load_dwordx4 v[88:91], v4, s[4:7], s25 offen offset:0 sc1
    buffer_load_dwordx4 v[92:95], v4, s[4:7], s25 offen offset:1024 sc1
    buffer_load_dwordx4 v[96:99], v4, s[4:7], s25 offen offset:2048 sc1
    buffer_load_dwordx4 v[100:103], v4, s[4:7], s25 offen offset:3072 sc1
    s_add_u32 s25, s25, 4096
    buffer_load_dwordx4 v[104:107], v4, s[4:7], s25 offen offset:0 sc1
    buffer_load_dwordx4 v[108:111], v4, s[4:7], s25 offen offset:1024 sc1
    buffer_load_dwordx4 v[112:115], v4, s[4:7], s25 offen offset:2048 sc1
    buffer_load_dwordx4 v[116:119], v4, s[4:7], s25 offen offset:3072 sc1
    s_add_u32 s25, s25, 4096
    buffer_load_dwordx4 v[120:123], v4, s[4:7], s25 offen offset:0 sc1
    buffer_load_dwordx4 v[124:127], v4, s[4:7], s25 offen offset:1024 sc1
Lclp_100258:
    buffer_load_dword v5, v12, s[4:7], s60 offen sc1
    s_waitcnt vmcnt(0)
    v_cmp_ne_u32 vcc, 32, v5
    s_cbranch_vccz Lclgo_100259
    s_sleep 4
    s_sub_u32 s24, s24, 1
    s_cbranch_scc1 Lexit2_100184
    s_branch Lclp_100258
Lclgo_100259:
    s_mov_b32 s59, 0
    s_lshl_b32 s60, s16, 14
    s_add_u32 s60, s60, 0x3d00000
LL2_100260:
    buffer_load_dword v144, v8, s[4:7], s60 offen offset:0 sc1
    buffer_load_dword v145, v8, s[4:7], s60 offen offset:256 sc1
    buffer_load_dword v146, v8, s[4:7], s60 offen offset:512 sc1
    buffer_load_dword v147, v8, s[4:7], s60 offen offset:768 sc1
    buffer_load_dword v148, v8, s[4:7], s60 offen offset:1024 sc1
    buffer_load_dword v149, v8, s[4:7], s60 offen offset:1280 sc1
    buffer_load_dword v150, v8, s[4:7], s60 offen offset:1536 sc1
    buffer_load_dword v151, v8, s[4:7], s60 offen offset:1792 sc1
    buffer_load_dword v152, v8, s[4:7], s60 offen offset:2048 sc1
    buffer_load_dword v153, v8, s[4:7], s60 offen offset:2304 sc1
    buffer_load_dword v154, v8, s[4:7], s60 offen offset:2560 sc1
    buffer_load_dword v155, v8, s[4:7], s60 offen offset:2816 sc1
    buffer_load_dword v156, v8, s[4:7], s60 offen offset:3072 sc1
    buffer_load_dword v157, v8, s[4:7], s60 offen offset:3328 sc1
    buffer_load_dword v158, v8, s[4:7], s60 offen offset:3584 sc1
    buffer_load_dword v159, v8, s[4:7], s60 offen offset:3840 sc1
    s_add_u32 s58, s58, 28672
    s_waitcnt vmcnt(16)
    v_mfma_f32_16x16x32_bf16 v[128:131], v[16:19], a[0:3], 0
    v_mfma_f32_16x16x32_bf16 v[136:139], v[16:19], a[56:59], 0
    v_mfma_f32_16x16x32_bf16 v[128:131], v[20:23], a[4:7], v[128:131]
    v_mfma_f32_16x16x32_bf16 v[136:139], v[20:23], a[60:63], v[136:139]
    v_mfma_f32_16x16x32_bf16 v[128:131], v[24:27], a[8:11], v[128:131]
    v_mfma_f32_16x16x32_bf16 v[136:139], v[24:27], a[64:67], v[136:139]
    v_mfma_f32_16x16x32_bf16 v[128:131], v[28:31], a[12:15], v[128:131]
    v_mfma_f32_16x16x32_bf16 v[136:139], v[28:31], a[68:71], v[136:139]
    v_mfma_f32_16x16x32_bf16 v[128:131], v[32:35], a[16:19], v[128:131]
    v_mfma_f32_16x16x32_bf16 v[136:139], v[32:35], a[72:75], v[136:139]
    v_mfma_f32_16x16x32_bf16 v[128:131], v[36:39], a[20:23], v[128:131]
    v_mfma_f32_16x16x32_bf16 v[136:139], v[36:39], a[76:79], v[136:139]
    v_mfma_f32_16x16x32_bf16 v[128:131], v[40:43], a[24:27], v[128:131]
    v_mfma_f32_16x16x32_bf16 v[136:139], v[40:43], a[80:83], v[136:139]
    v_mfma_f32_16x16x32_bf16 v[128:131], v[44:47], a[28:31], v[128:131]
    v_mfma_f32_16x16x32_bf16 v[136:139], v[44:47], a[84:87], v[136:139]
    v_mfma_f32_16x16x32_bf16 v[128:131], v[48:51], a[32:35], v[128:131]
    v_mfma_f32_16x16x32_bf16 v[136:139], v[48:51], a[88:91], v[136:139]
    v_mfma_f32_16x16x32_bf16 v[128:131], v[52:55], a[36:39], v[128:131]
    v_mfma_f32_16x16x32_bf16 v[136:139], v[52:55], a[92:95], v[136:139]
    v_mfma_f32_16x16x32_bf16 v[128:131], v[56:59], a[40:43], v[128:131]
    v_mfma_f32_16x16x32_bf16 v[136:139], v[56:59], a[96:99], v[136:139]
    v_mfma_f32_16x16x32_bf16 v[128:131], v[60:63], a[44:47], v[128:131]
    v_mfma_f32_16x16x32_bf16 v[136:139], v[60:63], a[100:103], v[136:139]
    v_mfma_f32_16x16x32_bf16 v[128:131], v[64:67], a[48:51], v[128:131]
    v_mfma_f32_16x16x32_bf16 v[136:139], v[64:67], a[104:107], v[136:139]
    v_mfma_f32_16x16x32_bf16 v[128:131], v[68:71], a[52:55], v[128:131]
    v_mfma_f32_16x16x32_bf16 v[136:139], v[68:71], a[108:111], v[136:139]
    v_mfma_f32_16x16x32_bf16 v[132:135], v[72:75], a[0:3], 0
    v_mfma_f32_16x16x32_bf16 v[140:143], v[72:75], a[56:59], 0
    v_mfma_f32_16x16x32_bf16 v[132:135], v[76:79], a[4:7], v[132:135]
    v_mfma_f32_16x16x32_bf16 v[140:143], v[76:79], a[60:63], v[140:143]
    v_mfma_f32_16x16x32_bf16 v[132:135], v[80:83], a[8:11], v[132:135]
    v_mfma_f32_16x16x32_bf16 v[140:143], v[80:83], a[64:67], v[140:143]
    v_mfma_f32_16x16x32_bf16 v[132:135], v[84:87], a[12:15], v[132:135]
    v_mfma_f32_16x16x32_bf16 v[140:143], v[84:87], a[68:71], v[140:143]
    v_mfma_f32_16x16x32_bf16 v[132:135], v[88:91], a[16:19], v[132:135]
    v_mfma_f32_16x16x32_bf16 v[140:143], v[88:91], a[72:75], v[140:143]
    v_mfma_f32_16x16x32_bf16 v[132:135], v[92:95], a[20:23], v[132:135]
    v_mfma_f32_16x16x32_bf16 v[140:143], v[92:95], a[76:79], v[140:143]
    v_mfma_f32_16x16x32_bf16 v[132:135], v[96:99], a[24:27], v[132:135]
    v_mfma_f32_16x16x32_bf16 v[140:143], v[96:99], a[80:83], v[140:143]
    v_mfma_f32_16x16x32_bf16 v[132:135], v[100:103], a[28:31], v[132:135]
    v_mfma_f32_16x16x32_bf16 v[140:143], v[100:103], a[84:87], v[140:143]
    v_mfma_f32_16x16x32_bf16 v[132:135], v[104:107], a[32:35], v[132:135]
    v_mfma_f32_16x16x32_bf16 v[140:143], v[104:107], a[88:91], v[140:143]
    v_mfma_f32_16x16x32_bf16 v[132:135], v[108:111], a[36:39], v[132:135]
    v_mfma_f32_16x16x32_bf16 v[140:143], v[108:111], a[92:95], v[140:143]
    v_mfma_f32_16x16x32_bf16 v[132:135], v[112:115], a[40:43], v[132:135]
    v_mfma_f32_16x16x32_bf16 v[140:143], v[112:115], a[96:99], v[140:143]
    v_mfma_f32_16x16x32_bf16 v[132:135], v[116:119], a[44:47], v[132:135]
    v_mfma_f32_16x16x32_bf16 v[140:143], v[116:119], a[100:103], v[140:143]
    v_mfma_f32_16x16x32_bf16 v[132:135], v[120:123], a[48:51], v[132:135]
    v_mfma_f32_16x16x32_bf16 v[140:143], v[120:123], a[104:107], v[140:143]
    v_mfma_f32_16x16x32_bf16 v[132:135], v[124:127], a[52:55], v[132:135]
    v_mfma_f32_16x16x32_bf16 v[140:143], v[124:127], a[108:111], v[140:143]
    s_waitcnt vmcnt(0)
    s_nop 7
    v_cvt_pk_bf16_f32 v193, v128, v129
    v_lshlrev_b32 v192, 16, v193
    v_and_b32 v193, 0xffff0000, v193
    v_mul_f32 v194, s61, v192
    v_mul_f32 v195, s61, v193
    v_exp_f32 v194, v194
    v_exp_f32 v195, v195
    v_add_f32 v192, 1.0, v192
    v_add_f32 v193, 1.0, v193
    v_med3_f32 v192, v192, v194, 1.0
    v_med3_f32 v193, v193, v195, 1.0
    v_cvt_pk_bf16_f32 v193, v192, v193
    v_lshlrev_b32 v192, 16, v193
    v_and_b32 v193, 0xffff0000, v193
    v_add_f32 v192, s57, v192
    v_add_f32 v193, s57, v193
    v_cvt_pk_bf16_f32 v172, v192, v193
    v_cvt_pk_bf16_f32 v193, v130, v131
    v_lshlrev_b32 v192, 16, v193
    v_and_b32 v193, 0xffff0000, v193
    v_mul_f32 v194, s61, v192
    v_mul_f32 v195, s61, v193
    v_exp_f32 v194, v194
    v_exp_f32 v195, v195
    v_add_f32 v192, 1.0, v192
    v_add_f32 v193, 1.0, v193
    v_med3_f32 v192, v192, v194, 1.0
    v_med3_f32 v193, v193, v195, 1.0
    v_cvt_pk_bf16_f32 v193, v192, v193
    v_lshlrev_b32 v192, 16, v193
    v_and_b32 v193, 0xffff0000, v193
    v_add_f32 v192, s57, v192
    v_add_f32 v193, s57, v193
    v_cvt_pk_bf16_f32 v173, v192, v193
    v_cvt_pk_bf16_f32 v193, v132, v133
    v_lshlrev_b32 v192, 16, v193
    v_and_b32 v193, 0xffff0000, v193
    v_mul_f32 v194, s61, v192
    v_mul_f32 v195, s61, v193
    v_exp_f32 v194, v194
    v_exp_f32 v195, v195
    v_add_f32 v192, 1.0, v192
    v_add_f32 v193, 1.0, v193
    v_med3_f32 v192, v192, v194, 1.0
    v_med3_f32 v193, v193, v195, 1.0
    v_cvt_pk_bf16_f32 v193, v192, v193
    v_lshlrev_b32 v192, 16, v193
    v_and_b32 v193, 0xffff0000, v193
    v_add_f32 v192, s57, v192
    v_add_f32 v193, s57, v193
    v_cvt_pk_bf16_f32 v174, v192, v193
    v_cvt_pk_bf16_f32 v193, v134, v135
    v_lshlrev_b32 v192, 16, v193
    v_and_b32 v193, 0xffff0000, v193
    v_mul_f32 v194, s61, v192
    v_mul_f32 v195, s61, v193
    v_exp_f32 v194, v194
    v_exp_f32 v195, v195
    v_add_f32 v192, 1.0, v192
    v_add_f32 v193, 1.0, v193
    v_med3_f32 v192, v192, v194, 1.0
    v_med3_f32 v193, v193, v195, 1.0
    v_cvt_pk_bf16_f32 v193, v192, v193
    v_lshlrev_b32 v192, 16, v193
    v_and_b32 v193, 0xffff0000, v193
    v_add_f32 v192, s57, v192
    v_add_f32 v193, s57, v193
    v_cvt_pk_bf16_f32 v175, v192, v193
    v_cvt_pk_bf16_f32 v193, v136, v137
    v_lshlrev_b32 v192, 16, v193
    v_and_b32 v193, 0xffff0000, v193
    v_mul_f32 v194, s61, v192
    v_mul_f32 v195, s61, v193
    v_exp_f32 v194, v194
    v_exp_f32 v195, v195
    v_add_f32 v192, 1.0, v192
    v_add_f32 v193, 1.0, v193
    v_med3_f32 v192, v192, v194, 1.0
    v_med3_f32 v193, v193, v195, 1.0
    v_cvt_pk_bf16_f32 v193, v192, v193
    v_lshlrev_b32 v192, 16, v193
    v_and_b32 v193, 0xffff0000, v193
    v_add_f32 v192, s57, v192
    v_add_f32 v193, s57, v193
    v_cvt_pk_bf16_f32 v176, v192, v193
    v_cvt_pk_bf16_f32 v193, v138, v139
    v_lshlrev_b32 v192, 16, v193
    v_and_b32 v193, 0xffff0000, v193
    v_mul_f32 v194, s61, v192
    v_mul_f32 v195, s61, v193
    v_exp_f32 v194, v194
    v_exp_f32 v195, v195
    v_add_f32 v192, 1.0, v192
    v_add_f32 v193, 1.0, v193
    v_med3_f32 v192, v192, v194, 1.0
    v_med3_f32 v193, v193, v195, 1.0
    v_cvt_pk_bf16_f32 v193, v192, v193
    v_lshlrev_b32 v192, 16, v193
    v_and_b32 v193, 0xffff0000, v193
    v_add_f32 v192, s57, v192
    v_add_f32 v193, s57, v193
    v_cvt_pk_bf16_f32 v177, v192, v193
    v_cvt_pk_bf16_f32 v193, v140, v141
    v_lshlrev_b32 v192, 16, v193
    v_and_b32 v193, 0xffff0000, v193
    v_mul_f32 v194, s61, v192
    v_mul_f32 v195, s61, v193
    v_exp_f32 v194, v194
    v_exp_f32 v195, v195
    v_add_f32 v192, 1.0, v192
    v_add_f32 v193, 1.0, v193
    v_med3_f32 v192, v192, v194, 1.0
    v_med3_f32 v193, v193, v195, 1.0
    v_cvt_pk_bf16_f32 v193, v192, v193
    v_lshlrev_b32 v192, 16, v193
    v_and_b32 v193, 0xffff0000, v193
    v_add_f32 v192, s57, v192
    v_add_f32 v193, s57, v193
    v_cvt_pk_bf16_f32 v178, v192, v193
    v_cvt_pk_bf16_f32 v193, v142, v143
    v_lshlrev_b32 v192, 16, v193
    v_and_b32 v193, 0xffff0000, v193
    v_mul_f32 v194, s61, v192
    v_mul_f32 v195, s61, v193
    v_exp_f32 v194, v194
    v_exp_f32 v195, v195
    v_add_f32 v192, 1.0, v192
    v_add_f32 v193, 1.0, v193
    v_med3_f32 v192, v192, v194, 1.0
    v_med3_f32 v193, v193, v195, 1.0
    v_cvt_pk_bf16_f32 v193, v192, v193
    v_lshlrev_b32 v192, 16, v193
    v_and_b32 v193, 0xffff0000, v193
    v_add_f32 v192, s57, v192
    v_add_f32 v193, s57, v193
    v_cvt_pk_bf16_f32 v179, v192, v193
    v_cvt_pk_bf16_f32 v160, v144, v145
    v_cvt_pk_bf16_f32 v161, v146, v147
    v_cvt_pk_bf16_f32 v162, v152, v153
    v_cvt_pk_bf16_f32 v163, v154, v155
    v_cvt_pk_bf16_f32 v164, v148, v149
    v_cvt_pk_bf16_f32 v165, v150, v151
    v_cvt_pk_bf16_f32 v166, v156, v157
    v_cvt_pk_bf16_f32 v167, v158, v159
    s_nop 1
    v_mov_b32_dpp v168, v164 row_newbcast:12 row_mask:0xf bank_mask:0xf
    v_mov_b32_dpp v169, v165 row_newbcast:12 row_mask:0xf bank_mask:0xf
    v_mov_b32_dpp v170, v166 row_newbcast:12 row_mask:0xf bank_mask:0xf
    v_mov_b32_dpp v171, v167 row_newbcast:12 row_mask:0xf bank_mask:0xf
    s_nop 1
    v_mfma_f32_16x16x32_bf16 v[180:183], v[160:163], v[172:175], 0
    v_mfma_f32_16x16x32_bf16 v[184:187], v[164:167], v[172:175], 0
    v_mfma_f32_16x16x32_bf16 v[188:191], v[168:171], v[172:175], 0
    s_nop 7
    v_cvt_pk_bf16_f32 v192, v188, v188
    v_and_b32 v192, 0xffff0000, v192
    v_add_f32 v192, s57, v192
    v_cvt_pk_bf16_f32 v192, v192, v192
    v_and_b32 v192, 0xffff0000, v192
    v_rcp_f32 v192, v192
    v_cvt_pk_bf16_f32 v194, v180, v181
    v_lshlrev_b32 v193, 16, v194
    v_and_b32 v194, 0xffff0000, v194
    v_mul_f32 v193, v193, v192
    v_mul_f32 v194, v194, v192
    v_cvt_pk_bf16_f32 v196, v193, v194
    v_cvt_pk_bf16_f32 v194, v182, v183
    v_lshlrev_b32 v193, 16, v194
    v_and_b32 v194, 0xffff0000, v194
    v_mul_f32 v193, v193, v192
    v_mul_f32 v194, v194, v192
    v_cvt_pk_bf16_f32 v197, v193, v194
    v_cvt_pk_bf16_f32 v194, v184, v185
    v_lshlrev_b32 v193, 16, v194
    v_and_b32 v194, 0xffff0000, v194
    v_mul_f32 v193, v193, v192
    v_mul_f32 v194, v194, v192
    v_cvt_pk_bf16_f32 v198, v193, v194
    v_cvt_pk_bf16_f32 v194, v186, v187
    v_lshlrev_b32 v193, 16, v194
    v_and_b32 v194, 0xffff0000, v194
    v_mul_f32 v193, v193, v192
    v_mul_f32 v194, v194, v192
    v_cvt_pk_bf16_f32 v199, v193, v194
    ds_write_b128 v13, v[196:199] offset:0
    s_waitcnt lgkmcnt(0)
    v_mfma_f32_16x16x32_bf16 v[180:183], v[160:163], v[176:179], 0
    v_mfma_f32_16x16x32_bf16 v[184:187], v[164:167], v[176:179], 0
    v_mfma_f32_16x16x32_bf16 v[188:191], v[168:171], v[176:179], 0
    s_nop 7
    v_cvt_pk_bf16_f32 v192, v188, v188
    v_and_b32 v192, 0xffff0000, v192
    v_add_f32 v192, s57, v192
    v_cvt_pk_bf16_f32 v192, v192, v192
    v_and_b32 v192, 0xffff0000, v192
    v_rcp_f32 v192, v192
    v_cvt_pk_bf16_f32 v194, v180, v181
    v_lshlrev_b32 v193, 16, v194
    v_and_b32 v194, 0xffff0000, v194
    v_mul_f32 v193, v193, v192
    v_mul_f32 v194, v194, v192
    v_cvt_pk_bf16_f32 v196, v193, v194
    v_cvt_pk_bf16_f32 v194, v182, v183
    v_lshlrev_b32 v193, 16, v194
    v_and_b32 v194, 0xffff0000, v194
    v_mul_f32 v193, v193, v192
    v_mul_f32 v194, v194, v192
    v_cvt_pk_bf16_f32 v197, v193, v194
    v_cvt_pk_bf16_f32 v194, v184, v185
    v_lshlrev_b32 v193, 16, v194
    v_and_b32 v194, 0xffff0000, v194
    v_mul_f32 v193, v193, v192
    v_mul_f32 v194, v194, v192
    v_cvt_pk_bf16_f32 v198, v193, v194
    v_cvt_pk_bf16_f32 v194, v186, v187
    v_lshlrev_b32 v193, 16, v194
    v_and_b32 v194, 0xffff0000, v194
    v_mul_f32 v193, v193, v192
    v_mul_f32 v194, v194, v192
    v_cvt_pk_bf16_f32 v199, v193, v194
    ds_write_b128 v13, v[196:199] offset:1024
    s_waitcnt lgkmcnt(0)
    v_mfma_f32_16x16x32_bf16 v[128:131], v[16:19], a[112:115], 0
    v_mfma_f32_16x16x32_bf16 v[136:139], v[16:19], a[168:171], 0
    v_mfma_f32_16x16x32_bf16 v[128:131], v[20:23], a[116:119], v[128:131]
    v_mfma_f32_16x16x32_bf16 v[136:139], v[20:23], a[172:175], v[136:139]
    v_mfma_f32_16x16x32_bf16 v[128:131], v[24:27], a[120:123], v[128:131]
    v_mfma_f32_16x16x32_bf16 v[136:139], v[24:27], a[176:179], v[136:139]
    v_mfma_f32_16x16x32_bf16 v[128:131], v[28:31], a[124:127], v[128:131]
    v_mfma_f32_16x16x32_bf16 v[136:139], v[28:31], a[180:183], v[136:139]
    v_mfma_f32_16x16x32_bf16 v[128:131], v[32:35], a[128:131], v[128:131]
    v_mfma_f32_16x16x32_bf16 v[136:139], v[32:35], a[184:187], v[136:139]
    v_mfma_f32_16x16x32_bf16 v[128:131], v[36:39], a[132:135], v[128:131]
    v_mfma_f32_16x16x32_bf16 v[136:139], v[36:39], a[188:191], v[136:139]
    v_mfma_f32_16x16x32_bf16 v[128:131], v[40:43], a[136:139], v[128:131]
    v_mfma_f32_16x16x32_bf16 v[136:139], v[40:43], a[192:195], v[136:139]
    v_mfma_f32_16x16x32_bf16 v[128:131], v[44:47], a[140:143], v[128:131]
    v_mfma_f32_16x16x32_bf16 v[136:139], v[44:47], a[196:199], v[136:139]
    v_mfma_f32_16x16x32_bf16 v[128:131], v[48:51], a[144:147], v[128:131]
    v_mfma_f32_16x16x32_bf16 v[136:139], v[48:51], a[200:203], v[136:139]
    v_mfma_f32_16x16x32_bf16 v[128:131], v[52:55], a[148:151], v[128:131]
    v_mfma_f32_16x16x32_bf16 v[136:139], v[52:55], a[204:207], v[136:139]
    v_mfma_f32_16x16x32_bf16 v[128:131], v[56:59], a[152:155], v[128:131]
    v_mfma_f32_16x16x32_bf16 v[136:139], v[56:59], a[208:211], v[136:139]
    v_mfma_f32_16x16x32_bf16 v[128:131], v[60:63], a[156:159], v[128:131]
    v_mfma_f32_16x16x32_bf16 v[136:139], v[60:63], a[212:215], v[136:139]
    v_mfma_f32_16x16x32_bf16 v[128:131], v[64:67], a[160:163], v[128:131]
    v_mfma_f32_16x16x32_bf16 v[136:139], v[64:67], a[216:219], v[136:139]
    v_mfma_f32_16x16x32_bf16 v[128:131], v[68:71], a[164:167], v[128:131]
    v_mfma_f32_16x16x32_bf16 v[136:139], v[68:71], a[220:223], v[136:139]
    v_mfma_f32_16x16x32_bf16 v[132:135], v[72:75], a[112:115], 0
    v_mfma_f32_16x16x32_bf16 v[140:143], v[72:75], a[168:171], 0
    v_mfma_f32_16x16x32_bf16 v[132:135], v[76:79], a[116:119], v[132:135]
    v_mfma_f32_16x16x32_bf16 v[140:143], v[76:79], a[172:175], v[140:143]
    v_mfma_f32_16x16x32_bf16 v[132:135], v[80:83], a[120:123], v[132:135]
    v_mfma_f32_16x16x32_bf16 v[140:143], v[80:83], a[176:179], v[140:143]
    v_mfma_f32_16x16x32_bf16 v[132:135], v[84:87], a[124:127], v[132:135]
    v_mfma_f32_16x16x32_bf16 v[140:143], v[84:87], a[180:183], v[140:143]
    v_mfma_f32_16x16x32_bf16 v[132:135], v[88:91], a[128:131], v[132:135]
    v_mfma_f32_16x16x32_bf16 v[140:143], v[88:91], a[184:187], v[140:143]
    v_mfma_f32_16x16x32_bf16 v[132:135], v[92:95], a[132:135], v[132:135]
    v_mfma_f32_16x16x32_bf16 v[140:143], v[92:95], a[188:191], v[140:143]
    v_mfma_f32_16x16x32_bf16 v[132:135], v[96:99], a[136:139], v[132:135]
    v_mfma_f32_16x16x32_bf16 v[140:143], v[96:99], a[192:195], v[140:143]
    v_mfma_f32_16x16x32_bf16 v[132:135], v[100:103], a[140:143], v[132:135]
    v_mfma_f32_16x16x32_bf16 v[140:143], v[100:103], a[196:199], v[140:143]
    v_mfma_f32_16x16x32_bf16 v[132:135], v[104:107], a[144:147], v[132:135]
    v_mfma_f32_16x16x32_bf16 v[140:143], v[104:107], a[200:203], v[140:143]
    v_mfma_f32_16x16x32_bf16 v[132:135], v[108:111], a[148:151], v[132:135]
    v_mfma_f32_16x16x32_bf16 v[140:143], v[108:111], a[204:207], v[140:143]
    v_mfma_f32_16x16x32_bf16 v[132:135], v[112:115], a[152:155], v[132:135]
    v_mfma_f32_16x16x32_bf16 v[140:143], v[112:115], a[208:211], v[140:143]
    v_mfma_f32_16x16x32_bf16 v[132:135], v[116:119], a[156:159], v[132:135]
    v_mfma_f32_16x16x32_bf16 v[140:143], v[116:119], a[212:215], v[140:143]
    v_mfma_f32_16x16x32_bf16 v[132:135], v[120:123], a[160:163], v[132:135]
    v_mfma_f32_16x16x32_bf16 v[140:143], v[120:123], a[216:219], v[140:143]
    v_mfma_f32_16x16x32_bf16 v[132:135], v[124:127], a[164:167], v[132:135]
    v_mfma_f32_16x16x32_bf16 v[140:143], v[124:127], a[220:223], v[140:143]
    s_add_u32 s25, s58, 0
    buffer_load_dwordx4 v[16:19], v4, s[4:7], s25 offen offset:0 sc1
    buffer_load_dwordx4 v[20:23], v4, s[4:7], s25 offen offset:1024 sc1
    buffer_load_dwordx4 v[24:27], v4, s[4:7], s25 offen offset:2048 sc1
    buffer_load_dwordx4 v[28:31], v4, s[4:7], s25 offen offset:3072 sc1
    s_add_u32 s25, s25, 4096
    buffer_load_dwordx4 v[32:35], v4, s[4:7], s25 offen offset:0 sc1
    buffer_load_dwordx4 v[36:39], v4, s[4:7], s25 offen offset:1024 sc1
    buffer_load_dwordx4 v[40:43], v4, s[4:7], s25 offen offset:2048 sc1
    buffer_load_dwordx4 v[44:47], v4, s[4:7], s25 offen offset:3072 sc1
    s_add_u32 s25, s25, 4096
    buffer_load_dwordx4 v[48:51], v4, s[4:7], s25 offen offset:0 sc1
    buffer_load_dwordx4 v[52:55], v4, s[4:7], s25 offen offset:1024 sc1
    buffer_load_dwordx4 v[56:59], v4, s[4:7], s25 offen offset:2048 sc1
    buffer_load_dwordx4 v[60:63], v4, s[4:7], s25 offen offset:3072 sc1
    s_add_u32 s25, s25, 4096
    buffer_load_dwordx4 v[64:67], v4, s[4:7], s25 offen offset:0 sc1
    buffer_load_dwordx4 v[68:71], v4, s[4:7], s25 offen offset:1024 sc1
    s_add_u32 s25, s58, 14336
    buffer_load_dwordx4 v[72:75], v4, s[4:7], s25 offen offset:0 sc1
    buffer_load_dwordx4 v[76:79], v4, s[4:7], s25 offen offset:1024 sc1
    buffer_load_dwordx4 v[80:83], v4, s[4:7], s25 offen offset:2048 sc1
    buffer_load_dwordx4 v[84:87], v4, s[4:7], s25 offen offset:3072 sc1
    s_add_u32 s25, s25, 4096
    buffer_load_dwordx4 v[88:91], v4, s[4:7], s25 offen offset:0 sc1
    buffer_load_dwordx4 v[92:95], v4, s[4:7], s25 offen offset:1024 sc1
    buffer_load_dwordx4 v[96:99], v4, s[4:7], s25 offen offset:2048 sc1
    buffer_load_dwordx4 v[100:103], v4, s[4:7], s25 offen offset:3072 sc1
    s_add_u32 s25, s25, 4096
    buffer_load_dwordx4 v[104:107], v4, s[4:7], s25 offen offset:0 sc1
    buffer_load_dwordx4 v[108:111], v4, s[4:7], s25 offen offset:1024 sc1
    buffer_load_dwordx4 v[112:115], v4, s[4:7], s25 offen offset:2048 sc1
    buffer_load_dwordx4 v[116:119], v4, s[4:7], s25 offen offset:3072 sc1
    s_add_u32 s25, s25, 4096
    buffer_load_dwordx4 v[120:123], v4, s[4:7], s25 offen offset:0 sc1
    buffer_load_dwordx4 v[124:127], v4, s[4:7], s25 offen offset:1024 sc1
    v_cvt_pk_bf16_f32 v193, v128, v129
    v_lshlrev_b32 v192, 16, v193
    v_and_b32 v193, 0xffff0000, v193
    v_mul_f32 v194, s61, v192
    v_mul_f32 v195, s61, v193
    v_exp_f32 v194, v194
    v_exp_f32 v195, v195
    v_add_f32 v192, 1.0, v192
    v_add_f32 v193, 1.0, v193
    v_med3_f32 v192, v192, v194, 1.0
    v_med3_f32 v193, v193, v195, 1.0
    v_cvt_pk_bf16_f32 v193, v192, v193
    v_lshlrev_b32 v192, 16, v193
    v_and_b32 v193, 0xffff0000, v193
    v_add_f32 v192, s57, v192
    v_add_f32 v193, s57, v193
    v_cvt_pk_bf16_f32 v172, v192, v193
    v_cvt_pk_bf16_f32 v193, v130, v131
    v_lshlrev_b32 v192, 16, v193
    v_and_b32 v193, 0xffff0000, v193
    v_mul_f32 v194, s61, v192
    v_mul_f32 v195, s61, v193
    v_exp_f32 v194, v194
    v_exp_f32 v195, v195
    v_add_f32 v192, 1.0, v192
    v_add_f32 v193, 1.0, v193
    v_med3_f32 v192, v192, v194, 1.0
    v_med3_f32 v193, v193, v195, 1.0
    v_cvt_pk_bf16_f32 v193, v192, v193
    v_lshlrev_b32 v192, 16, v193
    v_and_b32 v193, 0xffff0000, v193
    v_add_f32 v192, s57, v192
    v_add_f32 v193, s57, v193
    v_cvt_pk_bf16_f32 v173, v192, v193
    v_cvt_pk_bf16_f32 v193, v132, v133
    v_lshlrev_b32 v192, 16, v193
    v_and_b32 v193, 0xffff0000, v193
    v_mul_f32 v194, s61, v192
    v_mul_f32 v195, s61, v193
    v_exp_f32 v194, v194
    v_exp_f32 v195, v195
    v_add_f32 v192, 1.0, v192
    v_add_f32 v193, 1.0, v193
    v_med3_f32 v192, v192, v194, 1.0
    v_med3_f32 v193, v193, v195, 1.0
    v_cvt_pk_bf16_f32 v193, v192, v193
    v_lshlrev_b32 v192, 16, v193
    v_and_b32 v193, 0xffff0000, v193
    v_add_f32 v192, s57, v192
    v_add_f32 v193, s57, v193
    v_cvt_pk_bf16_f32 v174, v192, v193
    v_cvt_pk_bf16_f32 v193, v134, v135
    v_lshlrev_b32 v192, 16, v193
    v_and_b32 v193, 0xffff0000, v193
    v_mul_f32 v194, s61, v192
    v_mul_f32 v195, s61, v193
    v_exp_f32 v194, v194
    v_exp_f32 v195, v195
    v_add_f32 v192, 1.0, v192
    v_add_f32 v193, 1.0, v193
    v_med3_f32 v192, v192, v194, 1.0
    v_med3_f32 v193, v193, v195, 1.0
    v_cvt_pk_bf16_f32 v193, v192, v193
    v_lshlrev_b32 v192, 16, v193
    v_and_b32 v193, 0xffff0000, v193
    v_add_f32 v192, s57, v192
    v_add_f32 v193, s57, v193
    v_cvt_pk_bf16_f32 v175, v192, v193
    v_cvt_pk_bf16_f32 v193, v136, v137
    v_lshlrev_b32 v192, 16, v193
    v_and_b32 v193, 0xffff0000, v193
    v_mul_f32 v194, s61, v192
    v_mul_f32 v195, s61, v193
    v_exp_f32 v194, v194
    v_exp_f32 v195, v195
    v_add_f32 v192, 1.0, v192
    v_add_f32 v193, 1.0, v193
    v_med3_f32 v192, v192, v194, 1.0
    v_med3_f32 v193, v193, v195, 1.0
    v_cvt_pk_bf16_f32 v193, v192, v193
    v_lshlrev_b32 v192, 16, v193
    v_and_b32 v193, 0xffff0000, v193
    v_add_f32 v192, s57, v192
    v_add_f32 v193, s57, v193
    v_cvt_pk_bf16_f32 v176, v192, v193
    v_cvt_pk_bf16_f32 v193, v138, v139
    v_lshlrev_b32 v192, 16, v193
    v_and_b32 v193, 0xffff0000, v193
    v_mul_f32 v194, s61, v192
    v_mul_f32 v195, s61, v193
    v_exp_f32 v194, v194
    v_exp_f32 v195, v195
    v_add_f32 v192, 1.0, v192
    v_add_f32 v193, 1.0, v193
    v_med3_f32 v192, v192, v194, 1.0
    v_med3_f32 v193, v193, v195, 1.0
    v_cvt_pk_bf16_f32 v193, v192, v193
    v_lshlrev_b32 v192, 16, v193
    v_and_b32 v193, 0xffff0000, v193
    v_add_f32 v192, s57, v192
    v_add_f32 v193, s57, v193
    v_cvt_pk_bf16_f32 v177, v192, v193
    v_cvt_pk_bf16_f32 v193, v140, v141
    v_lshlrev_b32 v192, 16, v193
    v_and_b32 v193, 0xffff0000, v193
    v_mul_f32 v194, s61, v192
    v_mul_f32 v195, s61, v193
    v_exp_f32 v194, v194
    v_exp_f32 v195, v195
    v_add_f32 v192, 1.0, v192
    v_add_f32 v193, 1.0, v193
    v_med3_f32 v192, v192, v194, 1.0
    v_med3_f32 v193, v193, v195, 1.0
    v_cvt_pk_bf16_f32 v193, v192, v193
    v_lshlrev_b32 v192, 16, v193
    v_and_b32 v193, 0xffff0000, v193
    v_add_f32 v192, s57, v192
    v_add_f32 v193, s57, v193
    v_cvt_pk_bf16_f32 v178, v192, v193
    v_cvt_pk_bf16_f32 v193, v142, v143
    v_lshlrev_b32 v192, 16, v193
    v_and_b32 v193, 0xffff0000, v193
    v_mul_f32 v194, s61, v192
    v_mul_f32 v195, s61, v193
    v_exp_f32 v194, v194
    v_exp_f32 v195, v195
    v_add_f32 v192, 1.0, v192
    v_add_f32 v193, 1.0, v193
    v_med3_f32 v192, v192, v194, 1.0
    v_med3_f32 v193, v193, v195, 1.0
    v_cvt_pk_bf16_f32 v193, v192, v193
    v_lshlrev_b32 v192, 16, v193
    v_and_b32 v193, 0xffff0000, v193
    v_add_f32 v192, s57, v192
    v_add_f32 v193, s57, v193
    v_cvt_pk_bf16_f32 v179, v192, v193
    s_nop 1
    v_mfma_f32_16x16x32_bf16 v[180:183], v[160:163], v[172:175], 0
    v_mfma_f32_16x16x32_bf16 v[184:187], v[164:167], v[172:175], 0
    v_mfma_f32_16x16x32_bf16 v[188:191], v[168:171], v[172:175], 0
    s_nop 7
    v_cvt_pk_bf16_f32 v192, v188, v188
    v_and_b32 v192, 0xffff0000, v192
    v_add_f32 v192, s57, v192
    v_cvt_pk_bf16_f32 v192, v192, v192
    v_and_b32 v192, 0xffff0000, v192
    v_rcp_f32 v192, v192
    v_cvt_pk_bf16_f32 v194, v180, v181
    v_lshlrev_b32 v193, 16, v194
    v_and_b32 v194, 0xffff0000, v194
    v_mul_f32 v193, v193, v192
    v_mul_f32 v194, v194, v192
    v_cvt_pk_bf16_f32 v196, v193, v194
    v_cvt_pk_bf16_f32 v194, v182, v183
    v_lshlrev_b32 v193, 16, v194
    v_and_b32 v194, 0xffff0000, v194
    v_mul_f32 v193, v193, v192
    v_mul_f32 v194, v194, v192
    v_cvt_pk_bf16_f32 v197, v193, v194
    v_cvt_pk_bf16_f32 v194, v184, v185
    v_lshlrev_b32 v193, 16, v194
    v_and_b32 v194, 0xffff0000, v194
    v_mul_f32 v193, v193, v192
    v_mul_f32 v194, v194, v192
    v_cvt_pk_bf16_f32 v198, v193, v194
    v_cvt_pk_bf16_f32 v194, v186, v187
    v_lshlrev_b32 v193, 16, v194
    v_and_b32 v194, 0xffff0000, v194
    v_mul_f32 v193, v193, v192
    v_mul_f32 v194, v194, v192
    v_cvt_pk_bf16_f32 v199, v193, v194
    ds_write_b128 v13, v[196:199] offset:2048
    s_waitcnt lgkmcnt(0)
    v_mfma_f32_16x16x32_bf16 v[180:183], v[160:163], v[176:179], 0
    v_mfma_f32_16x16x32_bf16 v[184:187], v[164:167], v[176:179], 0
    v_mfma_f32_16x16x32_bf16 v[188:191], v[168:171], v[176:179], 0
    s_nop 7
    v_cvt_pk_bf16_f32 v192, v188, v188
    v_and_b32 v192, 0xffff0000, v192
    v_add_f32 v192, s57, v192
    v_cvt_pk_bf16_f32 v192, v192, v192
    v_and_b32 v192, 0xffff0000, v192
    v_rcp_f32 v192, v192
    v_cvt_pk_bf16_f32 v194, v180, v181
    v_lshlrev_b32 v193, 16, v194
    v_and_b32 v194, 0xffff0000, v194
    v_mul_f32 v193, v193, v192
    v_mul_f32 v194, v194, v192
    v_cvt_pk_bf16_f32 v196, v193, v194
    v_cvt_pk_bf16_f32 v194, v182, v183
    v_lshlrev_b32 v193, 16, v194
    v_and_b32 v194, 0xffff0000, v194
    v_mul_f32 v193, v193, v192
    v_mul_f32 v194, v194, v192
    v_cvt_pk_bf16_f32 v197, v193, v194
    v_cvt_pk_bf16_f32 v194, v184, v185
    v_lshlrev_b32 v193, 16, v194
    v_and_b32 v194, 0xffff0000, v194
    v_mul_f32 v193, v193, v192
    v_mul_f32 v194, v194, v192
    v_cvt_pk_bf16_f32 v198, v193, v194
    v_cvt_pk_bf16_f32 v194, v186, v187
    v_lshlrev_b32 v193, 16, v194
    v_and_b32 v194, 0xffff0000, v194
    v_mul_f32 v193, v193, v192
    v_mul_f32 v194, v194, v192
    v_cvt_pk_bf16_f32 v199, v193, v194
    ds_write_b128 v13, v[196:199] offset:3072
    s_waitcnt lgkmcnt(0)
    v_add_u32 v13, 4096, v13
    s_add_u32 s60, s60, 4096
    s_add_u32 s59, s59, 1
    s_cmp_lt_u32 s59, 4
    s_cbranch_scc1 LL2_100260
    s_waitcnt vmcnt(0)
    s_barrier
    s_mul_i32 s58, s16, 114688
    s_add_u32 s58, s58, 0x3c00000
    s_add_u32 s25, s58, 0
    buffer_load_dwordx4 v[16:19], v4, s[4:7], s25 offen offset:0 sc1
    buffer_load_dwordx4 v[20:23], v4, s[4:7], s25 offen offset:1024 sc1
    buffer_load_dwordx4 v[24:27], v4, s[4:7], s25 offen offset:2048 sc1
    buffer_load_dwordx4 v[28:31], v4, s[4:7], s25 offen offset:3072 sc1
    s_add_u32 s25, s58, 4096
    buffer_load_dwordx4 v[32:35], v4, s[4:7], s25 offen offset:0 sc1
    buffer_load_dwordx4 v[36:39], v4, s[4:7], s25 offen offset:1024 sc1
    buffer_load_dwordx4 v[40:43], v4, s[4:7], s25 offen offset:2048 sc1
    buffer_load_dwordx4 v[44:47], v4, s[4:7], s25 offen offset:3072 sc1
    s_add_u32 s25, s58, 8192
    buffer_load_dwordx4 v[48:51], v4, s[4:7], s25 offen offset:0 sc1
    buffer_load_dwordx4 v[52:55], v4, s[4:7], s25 offen offset:1024 sc1
    buffer_load_dwordx4 v[56:59], v4, s[4:7], s25 offen offset:2048 sc1
    buffer_load_dwordx4 v[60:63], v4, s[4:7], s25 offen offset:3072 sc1
    s_add_u32 s25, s58, 12288
    buffer_load_dwordx4 v[64:67], v4, s[4:7], s25 offen offset:0 sc1
    buffer_load_dwordx4 v[68:71], v4, s[4:7], s25 offen offset:1024 sc1
    buffer_load_dwordx4 v[72:75], v4, s[4:7], s25 offen offset:2048 sc1
    buffer_load_dwordx4 v[76:79], v4, s[4:7], s25 offen offset:3072 sc1
    s_add_u32 s25, s58, 16384
    buffer_load_dwordx4 v[80:83], v4, s[4:7], s25 offen offset:0 sc1
    buffer_load_dwordx4 v[84:87], v4, s[4:7], s25 offen offset:1024 sc1
    buffer_load_dwordx4 v[88:91], v4, s[4:7], s25 offen offset:2048 sc1
    buffer_load_dwordx4 v[92:95], v4, s[4:7], s25 offen offset:3072 sc1
    s_add_u32 s25, s58, 20480
    buffer_load_dwordx4 v[96:99], v4, s[4:7], s25 offen offset:0 sc1
    buffer_load_dwordx4 v[100:103], v4, s[4:7], s25 offen offset:1024 sc1
    buffer_load_dwordx4 v[104:107], v4, s[4:7], s25 offen offset:2048 sc1
    buffer_load_dwordx4 v[108:111], v4, s[4:7], s25 offen offset:3072 sc1
    s_add_u32 s25, s58, 24576
    buffer_load_dwordx4 v[112:115], v4, s[4:7], s25 offen offset:0 sc1
    buffer_load_dwordx4 v[116:119], v4, s[4:7], s25 offen offset:1024 sc1
    buffer_load_dwordx4 v[120:123], v4, s[4:7], s25 offen offset:2048 sc1
    buffer_load_dwordx4 v[124:127], v4, s[4:7], s25 offen offset:3072 sc1
    s_add_u32 s25, s58, 28672
    buffer_load_dwordx4 v[128:131], v4, s[4:7], s25 offen offset:0 sc1
    buffer_load_dwordx4 v[132:135], v4, s[4:7], s25 offen offset:1024 sc1
    buffer_load_dwordx4 v[136:139], v4, s[4:7], s25 offen offset:2048 sc1
    buffer_load_dwordx4 v[140:143], v4, s[4:7], s25 offen offset:3072 sc1
    v_add_u32 v5, 65536, v4
    ds_read_b128 a[0:3], v5 offset:0
    ds_read_b128 a[4:7], v5 offset:1024
    ds_read_b128 a[8:11], v5 offset:2048
    ds_read_b128 a[12:15], v5 offset:3072
    ds_read_b128 a[16:19], v5 offset:4096
    ds_read_b128 a[20:23], v5 offset:5120
    ds_read_b128 a[24:27], v5 offset:6144
    ds_read_b128 a[28:31], v5 offset:7168
    s_waitcnt lgkmcnt(0)
    ds_read_b128 a[32:35], v5 offset:8192
    ds_read_b128 a[36:39], v5 offset:9216
    ds_read_b128 a[40:43], v5 offset:10240
    ds_read_b128 a[44:47], v5 offset:11264
    ds_read_b128 a[48:51], v5 offset:12288
    ds_read_b128 a[52:55], v5 offset:13312
    ds_read_b128 a[56:59], v5 offset:14336
    ds_read_b128 a[60:63], v5 offset:15360
    s_waitcnt lgkmcnt(0)
    ds_read_b128 a[64:67], v5 offset:16384
    ds_read_b128 a[68:71], v5 offset:17408
    ds_read_b128 a[72:75], v5 offset:18432
    ds_read_b128 a[76:79], v5 offset:19456
    ds_read_b128 a[80:83], v5 offset:20480
    ds_read_b128 a[84:87], v5 offset:21504
    ds_read_b128 a[88:91], v5 offset:22528
    ds_read_b128 a[92:95], v5 offset:23552
    s_waitcnt lgkmcnt(0)
    ds_read_b128 a[96:99], v5 offset:24576
    ds_read_b128 a[100:103], v5 offset:25600
    ds_read_b128 a[104:107], v5 offset:26624
    ds_read_b128 a[108:111], v5 offset:27648
    ds_read_b128 a[112:115], v5 offset:28672
    ds_read_b128 a[116:119], v5 offset:29696
    ds_read_b128 a[120:123], v5 offset:30720
    ds_read_b128 a[124:127], v5 offset:31744
    s_waitcnt lgkmcnt(0)
    ds_read_b128 a[128:131], v5 offset:32768
    ds_read_b128 a[132:135], v5 offset:33792
    ds_read_b128 a[136:139], v5 offset:34816
    ds_read_b128 a[140:143], v5 offset:35840
    ds_read_b128 a[144:147], v5 offset:36864
    ds_read_b128 a[148:151], v5 offset:37888
    ds_read_b128 a[152:155], v5 offset:38912
    ds_read_b128 a[156:159], v5 offset:39936
    s_waitcnt lgkmcnt(0)
    ds_read_b128 a[160:163], v5 offset:40960
    ds_read_b128 a[164:167], v5 offset:41984
    ds_read_b128 a[168:171], v5 offset:43008
    ds_read_b128 a[172:175], v5 offset:44032
    ds_read_b128 a[176:179], v5 offset:45056
    ds_read_b128 a[180:183], v5 offset:46080
    ds_read_b128 a[184:187], v5 offset:47104
    ds_read_b128 a[188:191], v5 offset:48128
    s_waitcnt lgkmcnt(0)
    ds_read_b128 a[192:195], v5 offset:49152
    ds_read_b128 a[196:199], v5 offset:50176
    ds_read_b128 a[200:203], v5 offset:51200
    ds_read_b128 a[204:207], v5 offset:52224
    ds_read_b128 a[208:211], v5 offset:53248
    ds_read_b128 a[212:215], v5 offset:54272
    ds_read_b128 a[216:219], v5 offset:55296
    ds_read_b128 a[220:223], v5 offset:56320
    s_waitcnt lgkmcnt(0)
    ds_read_b128 a[224:227], v5 offset:57344
    ds_read_b128 a[228:231], v5 offset:58368
    ds_read_b128 a[232:235], v5 offset:59392
    ds_read_b128 a[236:239], v5 offset:60416
    ds_read_b128 a[240:243], v5 offset:61440
    ds_read_b128 a[244:247], v5 offset:62464
    ds_read_b128 a[248:251], v5 offset:63488
    ds_read_b128 a[252:255], v5 offset:64512
    s_waitcnt lgkmcnt(0)
    s_add_u32 s25, s58, 32768
    buffer_load_dwordx4 v[144:147], v4, s[4:7], s25 offen offset:0 sc1
    buffer_load_dwordx4 v[148:151], v4, s[4:7], s25 offen offset:1024 sc1
    buffer_load_dwordx4 v[152:155], v4, s[4:7], s25 offen offset:2048 sc1
    buffer_load_dwordx4 v[156:159], v4, s[4:7], s25 offen offset:3072 sc1
    s_add_u32 s25, s58, 36864
    buffer_load_dwordx4 v[160:163], v4, s[4:7], s25 offen offset:0 sc1
    buffer_load_dwordx4 v[164:167], v4, s[4:7], s25 offen offset:1024 sc1
    buffer_load_dwordx4 v[168:171], v4, s[4:7], s25 offen offset:2048 sc1
    buffer_load_dwordx4 v[172:175], v4, s[4:7], s25 offen offset:3072 sc1
    s_add_u32 s25, s58, 40960
    buffer_load_dwordx4 v[176:179], v4, s[4:7], s25 offen offset:0 sc1
    buffer_load_dwordx4 v[180:183], v4, s[4:7], s25 offen offset:1024 sc1
    buffer_load_dwordx4 v[184:187], v4, s[4:7], s25 offen offset:2048 sc1
    buffer_load_dwordx4 v[188:191], v4, s[4:7], s25 offen offset:3072 sc1
    s_add_u32 s25, s58, 45056
    buffer_load_dwordx4 v[192:195], v4, s[4:7], s25 offen offset:0 sc1
    buffer_load_dwordx4 v[196:199], v4, s[4:7], s25 offen offset:1024 sc1
    buffer_load_dwordx4 v[200:203], v4, s[4:7], s25 offen offset:2048 sc1
    buffer_load_dwordx4 v[204:207], v4, s[4:7], s25 offen offset:3072 sc1
    s_waitcnt vmcnt(32)
    v_mfma_f32_16x16x32_bf16 v[208:211], v[16:19], a[0:3], 0
    v_mfma_f32_16x16x32_bf16 v[212:215], v[16:19], a[4:7], 0
    v_mfma_f32_16x16x32_bf16 v[216:219], v[16:19], a[8:11], 0
    v_mfma_f32_16x16x32_bf16 v[220:223], v[16:19], a[12:15], 0
    v_mfma_f32_16x16x32_bf16 v[208:211], v[20:23], a[16:19], v[208:211]
    v_mfma_f32_16x16x32_bf16 v[212:215], v[20:23], a[20:23], v[212:215]
    v_mfma_f32_16x16x32_bf16 v[216:219], v[20:23], a[24:27], v[216:219]
    v_mfma_f32_16x16x32_bf16 v[220:223], v[20:23], a[28:31], v[220:223]
    v_mfma_f32_16x16x32_bf16 v[208:211], v[24:27], a[32:35], v[208:211]
    v_mfma_f32_16x16x32_bf16 v[212:215], v[24:27], a[36:39], v[212:215]
    v_mfma_f32_16x16x32_bf16 v[216:219], v[24:27], a[40:43], v[216:219]
    v_mfma_f32_16x16x32_bf16 v[220:223], v[24:27], a[44:47], v[220:223]
    v_mfma_f32_16x16x32_bf16 v[208:211], v[28:31], a[48:51], v[208:211]
    v_mfma_f32_16x16x32_bf16 v[212:215], v[28:31], a[52:55], v[212:215]
    v_mfma_f32_16x16x32_bf16 v[216:219], v[28:31], a[56:59], v[216:219]
    v_mfma_f32_16x16x32_bf16 v[220:223], v[28:31], a[60:63], v[220:223]
    v_mfma_f32_16x16x32_bf16 v[208:211], v[32:35], a[64:67], v[208:211]
    v_mfma_f32_16x16x32_bf16 v[212:215], v[32:35], a[68:71], v[212:215]
    v_mfma_f32_16x16x32_bf16 v[216:219], v[32:35], a[72:75], v[216:219]
    v_mfma_f32_16x16x32_bf16 v[220:223], v[32:35], a[76:79], v[220:223]
    v_mfma_f32_16x16x32_bf16 v[208:211], v[36:39], a[80:83], v[208:211]
    v_mfma_f32_16x16x32_bf16 v[212:215], v[36:39], a[84:87], v[212:215]
    v_mfma_f32_16x16x32_bf16 v[216:219], v[36:39], a[88:91], v[216:219]
    v_mfma_f32_16x16x32_bf16 v[220:223], v[36:39], a[92:95], v[220:223]
    v_mfma_f32_16x16x32_bf16 v[208:211], v[40:43], a[96:99], v[208:211]
    v_mfma_f32_16x16x32_bf16 v[212:215], v[40:43], a[100:103], v[212:215]
    v_mfma_f32_16x16x32_bf16 v[216:219], v[40:43], a[104:107], v[216:219]
    v_mfma_f32_16x16x32_bf16 v[220:223], v[40:43], a[108:111], v[220:223]
    v_mfma_f32_16x16x32_bf16 v[208:211], v[44:47], a[112:115], v[208:211]
    v_mfma_f32_16x16x32_bf16 v[212:215], v[44:47], a[116:119], v[212:215]
    v_mfma_f32_16x16x32_bf16 v[216:219], v[44:47], a[120:123], v[216:219]
    v_mfma_f32_16x16x32_bf16 v[220:223], v[44:47], a[124:127], v[220:223]
    v_mfma_f32_16x16x32_bf16 v[208:211], v[48:51], a[128:131], v[208:211]
    v_mfma_f32_16x16x32_bf16 v[212:215], v[48:51], a[132:135], v[212:215]
    v_mfma_f32_16x16x32_bf16 v[216:219], v[48:51], a[136:139], v[216:219]
    v_mfma_f32_16x16x32_bf16 v[220:223], v[48:51], a[140:143], v[220:223]
    v_mfma_f32_16x16x32_bf16 v[208:211], v[52:55], a[144:147], v[208:211]
    v_mfma_f32_16x16x32_bf16 v[212:215], v[52:55], a[148:151], v[212:215]
    v_mfma_f32_16x16x32_bf16 v[216:219], v[52:55], a[152:155], v[216:219]
    v_mfma_f32_16x16x32_bf16 v[220:223], v[52:55], a[156:159], v[220:223]
    v_mfma_f32_16x16x32_bf16 v[208:211], v[56:59], a[160:163], v[208:211]
    v_mfma_f32_16x16x32_bf16 v[212:215], v[56:59], a[164:167], v[212:215]
    v_mfma_f32_16x16x32_bf16 v[216:219], v[56:59], a[168:171], v[216:219]
    v_mfma_f32_16x16x32_bf16 v[220:223], v[56:59], a[172:175], v[220:223]
    v_mfma_f32_16x16x32_bf16 v[208:211], v[60:63], a[176:179], v[208:211]
    v_mfma_f32_16x16x32_bf16 v[212:215], v[60:63], a[180:183], v[212:215]
    v_mfma_f32_16x16x32_bf16 v[216:219], v[60:63], a[184:187], v[216:219]
    v_mfma_f32_16x16x32_bf16 v[220:223], v[60:63], a[188:191], v[220:223]
    v_mfma_f32_16x16x32_bf16 v[208:211], v[64:67], a[192:195], v[208:211]
    v_mfma_f32_16x16x32_bf16 v[212:215], v[64:67], a[196:199], v[212:215]
    v_mfma_f32_16x16x32_bf16 v[216:219], v[64:67], a[200:203], v[216:219]
    v_mfma_f32_16x16x32_bf16 v[220:223], v[64:67], a[204:207], v[220:223]
    v_mfma_f32_16x16x32_bf16 v[208:211], v[68:71], a[208:211], v[208:211]
    v_mfma_f32_16x16x32_bf16 v[212:215], v[68:71], a[212:215], v[212:215]
    v_mfma_f32_16x16x32_bf16 v[216:219], v[68:71], a[216:219], v[216:219]
    v_mfma_f32_16x16x32_bf16 v[220:223], v[68:71], a[220:223], v[220:223]
    v_mfma_f32_16x16x32_bf16 v[208:211], v[72:75], a[224:227], v[208:211]
    v_mfma_f32_16x16x32_bf16 v[212:215], v[72:75], a[228:231], v[212:215]
    v_mfma_f32_16x16x32_bf16 v[216:219], v[72:75], a[232:235], v[216:219]
    v_mfma_f32_16x16x32_bf16 v[220:223], v[72:75], a[236:239], v[220:223]
    v_mfma_f32_16x16x32_bf16 v[208:211], v[76:79], a[240:243], v[208:211]
    v_mfma_f32_16x16x32_bf16 v[212:215], v[76:79], a[244:247], v[212:215]
    v_mfma_f32_16x16x32_bf16 v[216:219], v[76:79], a[248:251], v[216:219]
    v_mfma_f32_16x16x32_bf16 v[220:223], v[76:79], a[252:255], v[220:223]
    s_nop 7
    v_cvt_pk_bf16_f32 v224, v208, v209
    v_cvt_pk_bf16_f32 v225, v210, v211
    s_mov_b32 s25, 0
    buffer_store_dwordx2 v[224:225], v11, s[48:51], s25 offen offset:0
    v_cvt_pk_bf16_f32 v226, v212, v213
    v_cvt_pk_bf16_f32 v227, v214, v215
    s_mov_b32 s25, 7168
    buffer_store_dwordx2 v[226:227], v11, s[48:51], s25 offen offset:0
    v_cvt_pk_bf16_f32 v228, v216, v217
    v_cvt_pk_bf16_f32 v229, v218, v219
    s_mov_b32 s25, 57344
    buffer_store_dwordx2 v[228:229], v11, s[48:51], s25 offen offset:0
    v_cvt_pk_bf16_f32 v230, v220, v221
    v_cvt_pk_bf16_f32 v231, v222, v223
    s_mov_b32 s25, 64512
    buffer_store_dwordx2 v[230:231], v11, s[48:51], s25 offen offset:0
    s_add_u32 s25, s58, 49152
    buffer_load_dwordx4 v[16:19], v4, s[4:7], s25 offen offset:0 sc1
    buffer_load_dwordx4 v[20:23], v4, s[4:7], s25 offen offset:1024 sc1
    buffer_load_dwordx4 v[24:27], v4, s[4:7], s25 offen offset:2048 sc1
    buffer_load_dwordx4 v[28:31], v4, s[4:7], s25 offen offset:3072 sc1
    s_add_u32 s25, s58, 53248
    buffer_load_dwordx4 v[32:35], v4, s[4:7], s25 offen offset:0 sc1
    buffer_load_dwordx4 v[36:39], v4, s[4:7], s25 offen offset:1024 sc1
    buffer_load_dwordx4 v[40:43], v4, s[4:7], s25 offen offset:2048 sc1
    buffer_load_dwordx4 v[44:47], v4, s[4:7], s25 offen offset:3072 sc1
    s_add_u32 s25, s58, 57344
    buffer_load_dwordx4 v[48:51], v4, s[4:7], s25 offen offset:0 sc1
    buffer_load_dwordx4 v[52:55], v4, s[4:7], s25 offen offset:1024 sc1
    buffer_load_dwordx4 v[56:59], v4, s[4:7], s25 offen offset:2048 sc1
    buffer_load_dwordx4 v[60:63], v4, s[4:7], s25 offen offset:3072 sc1
    s_add_u32 s25, s58, 61440
    buffer_load_dwordx4 v[64:67], v4, s[4:7], s25 offen offset:0 sc1
    buffer_load_dwordx4 v[68:71], v4, s[4:7], s25 offen offset:1024 sc1
    buffer_load_dwordx4 v[72:75], v4, s[4:7], s25 offen offset:2048 sc1
    buffer_load_dwordx4 v[76:79], v4, s[4:7], s25 offen offset:3072 sc1
    s_waitcnt vmcnt(32)
    v_mfma_f32_16x16x32_bf16 v[208:211], v[80:83], a[0:3], 0
    v_mfma_f32_16x16x32_bf16 v[212:215], v[80:83], a[4:7], 0
    v_mfma_f32_16x16x32_bf16 v[216:219], v[80:83], a[8:11], 0
    v_mfma_f32_16x16x32_bf16 v[220:223], v[80:83], a[12:15], 0
    v_mfma_f32_16x16x32_bf16 v[208:211], v[84:87], a[16:19], v[208:211]
    v_mfma_f32_16x16x32_bf16 v[212:215], v[84:87], a[20:23], v[212:215]
    v_mfma_f32_16x16x32_bf16 v[216:219], v[84:87], a[24:27], v[216:219]
    v_mfma_f32_16x16x32_bf16 v[220:223], v[84:87], a[28:31], v[220:223]
    v_mfma_f32_16x16x32_bf16 v[208:211], v[88:91], a[32:35], v[208:211]
    v_mfma_f32_16x16x32_bf16 v[212:215], v[88:91], a[36:39], v[212:215]
    v_mfma_f32_16x16x32_bf16 v[216:219], v[88:91], a[40:43], v[216:219]
    v_mfma_f32_16x16x32_bf16 v[220:223], v[88:91], a[44:47], v[220:223]
    v_mfma_f32_16x16x32_bf16 v[208:211], v[92:95], a[48:51], v[208:211]
    v_mfma_f32_16x16x32_bf16 v[212:215], v[92:95], a[52:55], v[212:215]
    v_mfma_f32_16x16x32_bf16 v[216:219], v[92:95], a[56:59], v[216:219]
    v_mfma_f32_16x16x32_bf16 v[220:223], v[92:95], a[60:63], v[220:223]
    v_mfma_f32_16x16x32_bf16 v[208:211], v[96:99], a[64:67], v[208:211]
    v_mfma_f32_16x16x32_bf16 v[212:215], v[96:99], a[68:71], v[212:215]
    v_mfma_f32_16x16x32_bf16 v[216:219], v[96:99], a[72:75], v[216:219]
    v_mfma_f32_16x16x32_bf16 v[220:223], v[96:99], a[76:79], v[220:223]
    v_mfma_f32_16x16x32_bf16 v[208:211], v[100:103], a[80:83], v[208:211]
    v_mfma_f32_16x16x32_bf16 v[212:215], v[100:103], a[84:87], v[212:215]
    v_mfma_f32_16x16x32_bf16 v[216:219], v[100:103], a[88:91], v[216:219]
    v_mfma_f32_16x16x32_bf16 v[220:223], v[100:103], a[92:95], v[220:223]
    v_mfma_f32_16x16x32_bf16 v[208:211], v[104:107], a[96:99], v[208:211]
    v_mfma_f32_16x16x32_bf16 v[212:215], v[104:107], a[100:103], v[212:215]
    v_mfma_f32_16x16x32_bf16 v[216:219], v[104:107], a[104:107], v[216:219]
    v_mfma_f32_16x16x32_bf16 v[220:223], v[104:107], a[108:111], v[220:223]
    v_mfma_f32_16x16x32_bf16 v[208:211], v[108:111], a[112:115], v[208:211]
    v_mfma_f32_16x16x32_bf16 v[212:215], v[108:111], a[116:119], v[212:215]
    v_mfma_f32_16x16x32_bf16 v[216:219], v[108:111], a[120:123], v[216:219]
    v_mfma_f32_16x16x32_bf16 v[220:223], v[108:111], a[124:127], v[220:223]
    v_mfma_f32_16x16x32_bf16 v[208:211], v[112:115], a[128:131], v[208:211]
    v_mfma_f32_16x16x32_bf16 v[212:215], v[112:115], a[132:135], v[212:215]
    v_mfma_f32_16x16x32_bf16 v[216:219], v[112:115], a[136:139], v[216:219]
    v_mfma_f32_16x16x32_bf16 v[220:223], v[112:115], a[140:143], v[220:223]
    v_mfma_f32_16x16x32_bf16 v[208:211], v[116:119], a[144:147], v[208:211]
    v_mfma_f32_16x16x32_bf16 v[212:215], v[116:119], a[148:151], v[212:215]
    v_mfma_f32_16x16x32_bf16 v[216:219], v[116:119], a[152:155], v[216:219]
    v_mfma_f32_16x16x32_bf16 v[220:223], v[116:119], a[156:159], v[220:223]
    v_mfma_f32_16x16x32_bf16 v[208:211], v[120:123], a[160:163], v[208:211]
    v_mfma_f32_16x16x32_bf16 v[212:215], v[120:123], a[164:167], v[212:215]
    v_mfma_f32_16x16x32_bf16 v[216:219], v[120:123], a[168:171], v[216:219]
    v_mfma_f32_16x16x32_bf16 v[220:223], v[120:123], a[172:175], v[220:223]
    v_mfma_f32_16x16x32_bf16 v[208:211], v[124:127], a[176:179], v[208:211]
    v_mfma_f32_16x16x32_bf16 v[212:215], v[124:127], a[180:183], v[212:215]
    v_mfma_f32_16x16x32_bf16 v[216:219], v[124:127], a[184:187], v[216:219]
    v_mfma_f32_16x16x32_bf16 v[220:223], v[124:127], a[188:191], v[220:223]
    v_mfma_f32_16x16x32_bf16 v[208:211], v[128:131], a[192:195], v[208:211]
    v_mfma_f32_16x16x32_bf16 v[212:215], v[128:131], a[196:199], v[212:215]
    v_mfma_f32_16x16x32_bf16 v[216:219], v[128:131], a[200:203], v[216:219]
    v_mfma_f32_16x16x32_bf16 v[220:223], v[128:131], a[204:207], v[220:223]
    v_mfma_f32_16x16x32_bf16 v[208:211], v[132:135], a[208:211], v[208:211]
    v_mfma_f32_16x16x32_bf16 v[212:215], v[132:135], a[212:215], v[212:215]
    v_mfma_f32_16x16x32_bf16 v[216:219], v[132:135], a[216:219], v[216:219]
    v_mfma_f32_16x16x32_bf16 v[220:223], v[132:135], a[220:223], v[220:223]
    v_mfma_f32_16x16x32_bf16 v[208:211], v[136:139], a[224:227], v[208:211]
    v_mfma_f32_16x16x32_bf16 v[212:215], v[136:139], a[228:231], v[212:215]
    v_mfma_f32_16x16x32_bf16 v[216:219], v[136:139], a[232:235], v[216:219]
    v_mfma_f32_16x16x32_bf16 v[220:223], v[136:139], a[236:239], v[220:223]
    v_mfma_f32_16x16x32_bf16 v[208:211], v[140:143], a[240:243], v[208:211]
    v_mfma_f32_16x16x32_bf16 v[212:215], v[140:143], a[244:247], v[212:215]
    v_mfma_f32_16x16x32_bf16 v[216:219], v[140:143], a[248:251], v[216:219]
    v_mfma_f32_16x16x32_bf16 v[220:223], v[140:143], a[252:255], v[220:223]
    s_nop 7
    v_cvt_pk_bf16_f32 v224, v208, v209
    v_cvt_pk_bf16_f32 v225, v210, v211
    s_mov_b32 s25, 0
    buffer_store_dwordx2 v[224:225], v11, s[48:51], s25 offen offset:32
    v_cvt_pk_bf16_f32 v226, v212, v213
    v_cvt_pk_bf16_f32 v227, v214, v215
    s_mov_b32 s25, 7168
    buffer_store_dwordx2 v[226:227], v11, s[48:51], s25 offen offset:32
    v_cvt_pk_bf16_f32 v228, v216, v217
    v_cvt_pk_bf16_f32 v229, v218, v219
    s_mov_b32 s25, 57344
    buffer_store_dwordx2 v[228:229], v11, s[48:51], s25 offen offset:32
    v_cvt_pk_bf16_f32 v230, v220, v221
    v_cvt_pk_bf16_f32 v231, v222, v223
    s_mov_b32 s25, 64512
    buffer_store_dwordx2 v[230:231], v11, s[48:51], s25 offen offset:32
    s_add_u32 s25, s58, 65536
    buffer_load_dwordx4 v[80:83], v4, s[4:7], s25 offen offset:0 sc1
    buffer_load_dwordx4 v[84:87], v4, s[4:7], s25 offen offset:1024 sc1
    buffer_load_dwordx4 v[88:91], v4, s[4:7], s25 offen offset:2048 sc1
    buffer_load_dwordx4 v[92:95], v4, s[4:7], s25 offen offset:3072 sc1
    s_add_u32 s25, s58, 69632
    buffer_load_dwordx4 v[96:99], v4, s[4:7], s25 offen offset:0 sc1
    buffer_load_dwordx4 v[100:103], v4, s[4:7], s25 offen offset:1024 sc1
    buffer_load_dwordx4 v[104:107], v4, s[4:7], s25 offen offset:2048 sc1
    buffer_load_dwordx4 v[108:111], v4, s[4:7], s25 offen offset:3072 sc1
    s_add_u32 s25, s58, 73728
    buffer_load_dwordx4 v[112:115], v4, s[4:7], s25 offen offset:0 sc1
    buffer_load_dwordx4 v[116:119], v4, s[4:7], s25 offen offset:1024 sc1
    buffer_load_dwordx4 v[120:123], v4, s[4:7], s25 offen offset:2048 sc1
    buffer_load_dwordx4 v[124:127], v4, s[4:7], s25 offen offset:3072 sc1
    s_add_u32 s25, s58, 77824
    buffer_load_dwordx4 v[128:131], v4, s[4:7], s25 offen offset:0 sc1
    buffer_load_dwordx4 v[132:135], v4, s[4:7], s25 offen offset:1024 sc1
    buffer_load_dwordx4 v[136:139], v4, s[4:7], s25 offen offset:2048 sc1
    buffer_load_dwordx4 v[140:143], v4, s[4:7], s25 offen offset:3072 sc1
    s_waitcnt vmcnt(32)
    v_mfma_f32_16x16x32_bf16 v[208:211], v[144:147], a[0:3], 0
    v_mfma_f32_16x16x32_bf16 v[212:215], v[144:147], a[4:7], 0
    v_mfma_f32_16x16x32_bf16 v[216:219], v[144:147], a[8:11], 0
    v_mfma_f32_16x16x32_bf16 v[220:223], v[144:147], a[12:15], 0
    v_mfma_f32_16x16x32_bf16 v[208:211], v[148:151], a[16:19], v[208:211]
    v_mfma_f32_16x16x32_bf16 v[212:215], v[148:151], a[20:23], v[212:215]
    v_mfma_f32_16x16x32_bf16 v[216:219], v[148:151], a[24:27], v[216:219]
    v_mfma_f32_16x16x32_bf16 v[220:223], v[148:151], a[28:31], v[220:223]
    v_mfma_f32_16x16x32_bf16 v[208:211], v[152:155], a[32:35], v[208:211]
    v_mfma_f32_16x16x32_bf16 v[212:215], v[152:155], a[36:39], v[212:215]
    v_mfma_f32_16x16x32_bf16 v[216:219], v[152:155], a[40:43], v[216:219]
    v_mfma_f32_16x16x32_bf16 v[220:223], v[152:155], a[44:47], v[220:223]
    v_mfma_f32_16x16x32_bf16 v[208:211], v[156:159], a[48:51], v[208:211]
    v_mfma_f32_16x16x32_bf16 v[212:215], v[156:159], a[52:55], v[212:215]
    v_mfma_f32_16x16x32_bf16 v[216:219], v[156:159], a[56:59], v[216:219]
    v_mfma_f32_16x16x32_bf16 v[220:223], v[156:159], a[60:63], v[220:223]
    v_mfma_f32_16x16x32_bf16 v[208:211], v[160:163], a[64:67], v[208:211]
    v_mfma_f32_16x16x32_bf16 v[212:215], v[160:163], a[68:71], v[212:215]
    v_mfma_f32_16x16x32_bf16 v[216:219], v[160:163], a[72:75], v[216:219]
    v_mfma_f32_16x16x32_bf16 v[220:223], v[160:163], a[76:79], v[220:223]
    v_mfma_f32_16x16x32_bf16 v[208:211], v[164:167], a[80:83], v[208:211]
    v_mfma_f32_16x16x32_bf16 v[212:215], v[164:167], a[84:87], v[212:215]
    v_mfma_f32_16x16x32_bf16 v[216:219], v[164:167], a[88:91], v[216:219]
    v_mfma_f32_16x16x32_bf16 v[220:223], v[164:167], a[92:95], v[220:223]
    v_mfma_f32_16x16x32_bf16 v[208:211], v[168:171], a[96:99], v[208:211]
    v_mfma_f32_16x16x32_bf16 v[212:215], v[168:171], a[100:103], v[212:215]
    v_mfma_f32_16x16x32_bf16 v[216:219], v[168:171], a[104:107], v[216:219]
    v_mfma_f32_16x16x32_bf16 v[220:223], v[168:171], a[108:111], v[220:223]
    v_mfma_f32_16x16x32_bf16 v[208:211], v[172:175], a[112:115], v[208:211]
    v_mfma_f32_16x16x32_bf16 v[212:215], v[172:175], a[116:119], v[212:215]
    v_mfma_f32_16x16x32_bf16 v[216:219], v[172:175], a[120:123], v[216:219]
    v_mfma_f32_16x16x32_bf16 v[220:223], v[172:175], a[124:127], v[220:223]
    v_mfma_f32_16x16x32_bf16 v[208:211], v[176:179], a[128:131], v[208:211]
    v_mfma_f32_16x16x32_bf16 v[212:215], v[176:179], a[132:135], v[212:215]
    v_mfma_f32_16x16x32_bf16 v[216:219], v[176:179], a[136:139], v[216:219]
    v_mfma_f32_16x16x32_bf16 v[220:223], v[176:179], a[140:143], v[220:223]
    v_mfma_f32_16x16x32_bf16 v[208:211], v[180:183], a[144:147], v[208:211]
    v_mfma_f32_16x16x32_bf16 v[212:215], v[180:183], a[148:151], v[212:215]
    v_mfma_f32_16x16x32_bf16 v[216:219], v[180:183], a[152:155], v[216:219]
    v_mfma_f32_16x16x32_bf16 v[220:223], v[180:183], a[156:159], v[220:223]
    v_mfma_f32_16x16x32_bf16 v[208:211], v[184:187], a[160:163], v[208:211]
    v_mfma_f32_16x16x32_bf16 v[212:215], v[184:187], a[164:167], v[212:215]
    v_mfma_f32_16x16x32_bf16 v[216:219], v[184:187], a[168:171], v[216:219]
    v_mfma_f32_16x16x32_bf16 v[220:223], v[184:187], a[172:175], v[220:223]
    v_mfma_f32_16x16x32_bf16 v[208:211], v[188:191], a[176:179], v[208:211]
    v_mfma_f32_16x16x32_bf16 v[212:215], v[188:191], a[180:183], v[212:215]
    v_mfma_f32_16x16x32_bf16 v[216:219], v[188:191], a[184:187], v[216:219]
    v_mfma_f32_16x16x32_bf16 v[220:223], v[188:191], a[188:191], v[220:223]
    v_mfma_f32_16x16x32_bf16 v[208:211], v[192:195], a[192:195], v[208:211]
    v_mfma_f32_16x16x32_bf16 v[212:215], v[192:195], a[196:199], v[212:215]
    v_mfma_f32_16x16x32_bf16 v[216:219], v[192:195], a[200:203], v[216:219]
    v_mfma_f32_16x16x32_bf16 v[220:223], v[192:195], a[204:207], v[220:223]
    v_mfma_f32_16x16x32_bf16 v[208:211], v[196:199], a[208:211], v[208:211]
    v_mfma_f32_16x16x32_bf16 v[212:215], v[196:199], a[212:215], v[212:215]
    v_mfma_f32_16x16x32_bf16 v[216:219], v[196:199], a[216:219], v[216:219]
    v_mfma_f32_16x16x32_bf16 v[220:223], v[196:199], a[220:223], v[220:223]
    v_mfma_f32_16x16x32_bf16 v[208:211], v[200:203], a[224:227], v[208:211]
    v_mfma_f32_16x16x32_bf16 v[212:215], v[200:203], a[228:231], v[212:215]
    v_mfma_f32_16x16x32_bf16 v[216:219], v[200:203], a[232:235], v[216:219]
    v_mfma_f32_16x16x32_bf16 v[220:223], v[200:203], a[236:239], v[220:223]
    v_mfma_f32_16x16x32_bf16 v[208:211], v[204:207], a[240:243], v[208:211]
    v_mfma_f32_16x16x32_bf16 v[212:215], v[204:207], a[244:247], v[212:215]
    v_mfma_f32_16x16x32_bf16 v[216:219], v[204:207], a[248:251], v[216:219]
    v_mfma_f32_16x16x32_bf16 v[220:223], v[204:207], a[252:255], v[220:223]
    s_nop 7
    v_cvt_pk_bf16_f32 v224, v208, v209
    v_cvt_pk_bf16_f32 v225, v210, v211
    s_mov_b32 s25, 0
    buffer_store_dwordx2 v[224:225], v11, s[48:51], s25 offen offset:64
    v_cvt_pk_bf16_f32 v226, v212, v213
    v_cvt_pk_bf16_f32 v227, v214, v215
    s_mov_b32 s25, 7168
    buffer_store_dwordx2 v[226:227], v11, s[48:51], s25 offen offset:64
    v_cvt_pk_bf16_f32 v228, v216, v217
    v_cvt_pk_bf16_f32 v229, v218, v219
    s_mov_b32 s25, 57344
    buffer_store_dwordx2 v[228:229], v11, s[48:51], s25 offen offset:64
    v_cvt_pk_bf16_f32 v230, v220, v221
    v_cvt_pk_bf16_f32 v231, v222, v223
    s_mov_b32 s25, 64512
    buffer_store_dwordx2 v[230:231], v11, s[48:51], s25 offen offset:64
    s_add_u32 s25, s58, 81920
    buffer_load_dwordx4 v[144:147], v4, s[4:7], s25 offen offset:0 sc1
    buffer_load_dwordx4 v[148:151], v4, s[4:7], s25 offen offset:1024 sc1
    buffer_load_dwordx4 v[152:155], v4, s[4:7], s25 offen offset:2048 sc1
    buffer_load_dwordx4 v[156:159], v4, s[4:7], s25 offen offset:3072 sc1
    s_add_u32 s25, s58, 86016
    buffer_load_dwordx4 v[160:163], v4, s[4:7], s25 offen offset:0 sc1
    buffer_load_dwordx4 v[164:167], v4, s[4:7], s25 offen offset:1024 sc1
    buffer_load_dwordx4 v[168:171], v4, s[4:7], s25 offen offset:2048 sc1
    buffer_load_dwordx4 v[172:175], v4, s[4:7], s25 offen offset:3072 sc1
    s_add_u32 s25, s58, 90112
    buffer_load_dwordx4 v[176:179], v4, s[4:7], s25 offen offset:0 sc1
    buffer_load_dwordx4 v[180:183], v4, s[4:7], s25 offen offset:1024 sc1
    buffer_load_dwordx4 v[184:187], v4, s[4:7], s25 offen offset:2048 sc1
    buffer_load_dwordx4 v[188:191], v4, s[4:7], s25 offen offset:3072 sc1
    s_add_u32 s25, s58, 94208
    buffer_load_dwordx4 v[192:195], v4, s[4:7], s25 offen offset:0 sc1
    buffer_load_dwordx4 v[196:199], v4, s[4:7], s25 offen offset:1024 sc1
    buffer_load_dwordx4 v[200:203], v4, s[4:7], s25 offen offset:2048 sc1
    buffer_load_dwordx4 v[204:207], v4, s[4:7], s25 offen offset:3072 sc1
    s_waitcnt vmcnt(32)
    v_mfma_f32_16x16x32_bf16 v[208:211], v[16:19], a[0:3], 0
    v_mfma_f32_16x16x32_bf16 v[212:215], v[16:19], a[4:7], 0
    v_mfma_f32_16x16x32_bf16 v[216:219], v[16:19], a[8:11], 0
    v_mfma_f32_16x16x32_bf16 v[220:223], v[16:19], a[12:15], 0
    v_mfma_f32_16x16x32_bf16 v[208:211], v[20:23], a[16:19], v[208:211]
    v_mfma_f32_16x16x32_bf16 v[212:215], v[20:23], a[20:23], v[212:215]
    v_mfma_f32_16x16x32_bf16 v[216:219], v[20:23], a[24:27], v[216:219]
    v_mfma_f32_16x16x32_bf16 v[220:223], v[20:23], a[28:31], v[220:223]
    v_mfma_f32_16x16x32_bf16 v[208:211], v[24:27], a[32:35], v[208:211]
    v_mfma_f32_16x16x32_bf16 v[212:215], v[24:27], a[36:39], v[212:215]
    v_mfma_f32_16x16x32_bf16 v[216:219], v[24:27], a[40:43], v[216:219]
    v_mfma_f32_16x16x32_bf16 v[220:223], v[24:27], a[44:47], v[220:223]
    v_mfma_f32_16x16x32_bf16 v[208:211], v[28:31], a[48:51], v[208:211]
    v_mfma_f32_16x16x32_bf16 v[212:215], v[28:31], a[52:55], v[212:215]
    v_mfma_f32_16x16x32_bf16 v[216:219], v[28:31], a[56:59], v[216:219]
    v_mfma_f32_16x16x32_bf16 v[220:223], v[28:31], a[60:63], v[220:223]
    v_mfma_f32_16x16x32_bf16 v[208:211], v[32:35], a[64:67], v[208:211]
    v_mfma_f32_16x16x32_bf16 v[212:215], v[32:35], a[68:71], v[212:215]
    v_mfma_f32_16x16x32_bf16 v[216:219], v[32:35], a[72:75], v[216:219]
    v_mfma_f32_16x16x32_bf16 v[220:223], v[32:35], a[76:79], v[220:223]
    v_mfma_f32_16x16x32_bf16 v[208:211], v[36:39], a[80:83], v[208:211]
    v_mfma_f32_16x16x32_bf16 v[212:215], v[36:39], a[84:87], v[212:215]
    v_mfma_f32_16x16x32_bf16 v[216:219], v[36:39], a[88:91], v[216:219]
    v_mfma_f32_16x16x32_bf16 v[220:223], v[36:39], a[92:95], v[220:223]
    v_mfma_f32_16x16x32_bf16 v[208:211], v[40:43], a[96:99], v[208:211]
    v_mfma_f32_16x16x32_bf16 v[212:215], v[40:43], a[100:103], v[212:215]
    v_mfma_f32_16x16x32_bf16 v[216:219], v[40:43], a[104:107], v[216:219]
    v_mfma_f32_16x16x32_bf16 v[220:223], v[40:43], a[108:111], v[220:223]
    v_mfma_f32_16x16x32_bf16 v[208:211], v[44:47], a[112:115], v[208:211]
    v_mfma_f32_16x16x32_bf16 v[212:215], v[44:47], a[116:119], v[212:215]
    v_mfma_f32_16x16x32_bf16 v[216:219], v[44:47], a[120:123], v[216:219]
    v_mfma_f32_16x16x32_bf16 v[220:223], v[44:47], a[124:127], v[220:223]
    v_mfma_f32_16x16x32_bf16 v[208:211], v[48:51], a[128:131], v[208:211]
    v_mfma_f32_16x16x32_bf16 v[212:215], v[48:51], a[132:135], v[212:215]
    v_mfma_f32_16x16x32_bf16 v[216:219], v[48:51], a[136:139], v[216:219]
    v_mfma_f32_16x16x32_bf16 v[220:223], v[48:51], a[140:143], v[220:223]
    v_mfma_f32_16x16x32_bf16 v[208:211], v[52:55], a[144:147], v[208:211]
    v_mfma_f32_16x16x32_bf16 v[212:215], v[52:55], a[148:151], v[212:215]
    v_mfma_f32_16x16x32_bf16 v[216:219], v[52:55], a[152:155], v[216:219]
    v_mfma_f32_16x16x32_bf16 v[220:223], v[52:55], a[156:159], v[220:223]
    v_mfma_f32_16x16x32_bf16 v[208:211], v[56:59], a[160:163], v[208:211]
    v_mfma_f32_16x16x32_bf16 v[212:215], v[56:59], a[164:167], v[212:215]
    v_mfma_f32_16x16x32_bf16 v[216:219], v[56:59], a[168:171], v[216:219]
    v_mfma_f32_16x16x32_bf16 v[220:223], v[56:59], a[172:175], v[220:223]
    v_mfma_f32_16x16x32_bf16 v[208:211], v[60:63], a[176:179], v[208:211]
    v_mfma_f32_16x16x32_bf16 v[212:215], v[60:63], a[180:183], v[212:215]
    v_mfma_f32_16x16x32_bf16 v[216:219], v[60:63], a[184:187], v[216:219]
    v_mfma_f32_16x16x32_bf16 v[220:223], v[60:63], a[188:191], v[220:223]
    v_mfma_f32_16x16x32_bf16 v[208:211], v[64:67], a[192:195], v[208:211]
    v_mfma_f32_16x16x32_bf16 v[212:215], v[64:67], a[196:199], v[212:215]
    v_mfma_f32_16x16x32_bf16 v[216:219], v[64:67], a[200:203], v[216:219]
    v_mfma_f32_16x16x32_bf16 v[220:223], v[64:67], a[204:207], v[220:223]
    v_mfma_f32_16x16x32_bf16 v[208:211], v[68:71], a[208:211], v[208:211]
    v_mfma_f32_16x16x32_bf16 v[212:215], v[68:71], a[212:215], v[212:215]
    v_mfma_f32_16x16x32_bf16 v[216:219], v[68:71], a[216:219], v[216:219]
    v_mfma_f32_16x16x32_bf16 v[220:223], v[68:71], a[220:223], v[220:223]
    v_mfma_f32_16x16x32_bf16 v[208:211], v[72:75], a[224:227], v[208:211]
    v_mfma_f32_16x16x32_bf16 v[212:215], v[72:75], a[228:231], v[212:215]
    v_mfma_f32_16x16x32_bf16 v[216:219], v[72:75], a[232:235], v[216:219]
    v_mfma_f32_16x16x32_bf16 v[220:223], v[72:75], a[236:239], v[220:223]
    v_mfma_f32_16x16x32_bf16 v[208:211], v[76:79], a[240:243], v[208:211]
    v_mfma_f32_16x16x32_bf16 v[212:215], v[76:79], a[244:247], v[212:215]
    v_mfma_f32_16x16x32_bf16 v[216:219], v[76:79], a[248:251], v[216:219]
    v_mfma_f32_16x16x32_bf16 v[220:223], v[76:79], a[252:255], v[220:223]
    s_nop 7
    v_cvt_pk_bf16_f32 v224, v208, v209
    v_cvt_pk_bf16_f32 v225, v210, v211
    s_mov_b32 s25, 0
    buffer_store_dwordx2 v[224:225], v11, s[48:51], s25 offen offset:96
    v_cvt_pk_bf16_f32 v226, v212, v213
    v_cvt_pk_bf16_f32 v227, v214, v215
    s_mov_b32 s25, 7168
    buffer_store_dwordx2 v[226:227], v11, s[48:51], s25 offen offset:96
    v_cvt_pk_bf16_f32 v228, v216, v217
    v_cvt_pk_bf16_f32 v229, v218, v219
    s_mov_b32 s25, 57344
    buffer_store_dwordx2 v[228:229], v11, s[48:51], s25 offen offset:96
    v_cvt_pk_bf16_f32 v230, v220, v221
    v_cvt_pk_bf16_f32 v231, v222, v223
    s_mov_b32 s25, 64512
    buffer_store_dwordx2 v[230:231], v11, s[48:51], s25 offen offset:96
    s_add_u32 s25, s58, 98304
    buffer_load_dwordx4 v[16:19], v4, s[4:7], s25 offen offset:0 sc1
    buffer_load_dwordx4 v[20:23], v4, s[4:7], s25 offen offset:1024 sc1
    buffer_load_dwordx4 v[24:27], v4, s[4:7], s25 offen offset:2048 sc1
    buffer_load_dwordx4 v[28:31], v4, s[4:7], s25 offen offset:3072 sc1
    s_add_u32 s25, s58, 102400
    buffer_load_dwordx4 v[32:35], v4, s[4:7], s25 offen offset:0 sc1
    buffer_load_dwordx4 v[36:39], v4, s[4:7], s25 offen offset:1024 sc1
    buffer_load_dwordx4 v[40:43], v4, s[4:7], s25 offen offset:2048 sc1
    buffer_load_dwordx4 v[44:47], v4, s[4:7], s25 offen offset:3072 sc1
    s_add_u32 s25, s58, 106496
    buffer_load_dwordx4 v[48:51], v4, s[4:7], s25 offen offset:0 sc1
    buffer_load_dwordx4 v[52:55], v4, s[4:7], s25 offen offset:1024 sc1
    buffer_load_dwordx4 v[56:59], v4, s[4:7], s25 offen offset:2048 sc1
    buffer_load_dwordx4 v[60:63], v4, s[4:7], s25 offen offset:3072 sc1
    s_add_u32 s25, s58, 110592
    buffer_load_dwordx4 v[64:67], v4, s[4:7], s25 offen offset:0 sc1
    buffer_load_dwordx4 v[68:71], v4, s[4:7], s25 offen offset:1024 sc1
    buffer_load_dwordx4 v[72:75], v4, s[4:7], s25 offen offset:2048 sc1
    buffer_load_dwordx4 v[76:79], v4, s[4:7], s25 offen offset:3072 sc1
    s_waitcnt vmcnt(32)
    v_mfma_f32_16x16x32_bf16 v[208:211], v[80:83], a[0:3], 0
    v_mfma_f32_16x16x32_bf16 v[212:215], v[80:83], a[4:7], 0
    v_mfma_f32_16x16x32_bf16 v[216:219], v[80:83], a[8:11], 0
    v_mfma_f32_16x16x32_bf16 v[220:223], v[80:83], a[12:15], 0
    v_mfma_f32_16x16x32_bf16 v[208:211], v[84:87], a[16:19], v[208:211]
    v_mfma_f32_16x16x32_bf16 v[212:215], v[84:87], a[20:23], v[212:215]
    v_mfma_f32_16x16x32_bf16 v[216:219], v[84:87], a[24:27], v[216:219]
    v_mfma_f32_16x16x32_bf16 v[220:223], v[84:87], a[28:31], v[220:223]
    v_mfma_f32_16x16x32_bf16 v[208:211], v[88:91], a[32:35], v[208:211]
    v_mfma_f32_16x16x32_bf16 v[212:215], v[88:91], a[36:39], v[212:215]
    v_mfma_f32_16x16x32_bf16 v[216:219], v[88:91], a[40:43], v[216:219]
    v_mfma_f32_16x16x32_bf16 v[220:223], v[88:91], a[44:47], v[220:223]
    v_mfma_f32_16x16x32_bf16 v[208:211], v[92:95], a[48:51], v[208:211]
    v_mfma_f32_16x16x32_bf16 v[212:215], v[92:95], a[52:55], v[212:215]
    v_mfma_f32_16x16x32_bf16 v[216:219], v[92:95], a[56:59], v[216:219]
    v_mfma_f32_16x16x32_bf16 v[220:223], v[92:95], a[60:63], v[220:223]
    v_mfma_f32_16x16x32_bf16 v[208:211], v[96:99], a[64:67], v[208:211]
    v_mfma_f32_16x16x32_bf16 v[212:215], v[96:99], a[68:71], v[212:215]
    v_mfma_f32_16x16x32_bf16 v[216:219], v[96:99], a[72:75], v[216:219]
    v_mfma_f32_16x16x32_bf16 v[220:223], v[96:99], a[76:79], v[220:223]
    v_mfma_f32_16x16x32_bf16 v[208:211], v[100:103], a[80:83], v[208:211]
    v_mfma_f32_16x16x32_bf16 v[212:215], v[100:103], a[84:87], v[212:215]
    v_mfma_f32_16x16x32_bf16 v[216:219], v[100:103], a[88:91], v[216:219]
    v_mfma_f32_16x16x32_bf16 v[220:223], v[100:103], a[92:95], v[220:223]
    v_mfma_f32_16x16x32_bf16 v[208:211], v[104:107], a[96:99], v[208:211]
    v_mfma_f32_16x16x32_bf16 v[212:215], v[104:107], a[100:103], v[212:215]
    v_mfma_f32_16x16x32_bf16 v[216:219], v[104:107], a[104:107], v[216:219]
    v_mfma_f32_16x16x32_bf16 v[220:223], v[104:107], a[108:111], v[220:223]
    v_mfma_f32_16x16x32_bf16 v[208:211], v[108:111], a[112:115], v[208:211]
    v_mfma_f32_16x16x32_bf16 v[212:215], v[108:111], a[116:119], v[212:215]
    v_mfma_f32_16x16x32_bf16 v[216:219], v[108:111], a[120:123], v[216:219]
    v_mfma_f32_16x16x32_bf16 v[220:223], v[108:111], a[124:127], v[220:223]
    v_mfma_f32_16x16x32_bf16 v[208:211], v[112:115], a[128:131], v[208:211]
    v_mfma_f32_16x16x32_bf16 v[212:215], v[112:115], a[132:135], v[212:215]
    v_mfma_f32_16x16x32_bf16 v[216:219], v[112:115], a[136:139], v[216:219]
    v_mfma_f32_16x16x32_bf16 v[220:223], v[112:115], a[140:143], v[220:223]
    v_mfma_f32_16x16x32_bf16 v[208:211], v[116:119], a[144:147], v[208:211]
    v_mfma_f32_16x16x32_bf16 v[212:215], v[116:119], a[148:151], v[212:215]
    v_mfma_f32_16x16x32_bf16 v[216:219], v[116:119], a[152:155], v[216:219]
    v_mfma_f32_16x16x32_bf16 v[220:223], v[116:119], a[156:159], v[220:223]
    v_mfma_f32_16x16x32_bf16 v[208:211], v[120:123], a[160:163], v[208:211]
    v_mfma_f32_16x16x32_bf16 v[212:215], v[120:123], a[164:167], v[212:215]
    v_mfma_f32_16x16x32_bf16 v[216:219], v[120:123], a[168:171], v[216:219]
    v_mfma_f32_16x16x32_bf16 v[220:223], v[120:123], a[172:175], v[220:223]
    v_mfma_f32_16x16x32_bf16 v[208:211], v[124:127], a[176:179], v[208:211]
    v_mfma_f32_16x16x32_bf16 v[212:215], v[124:127], a[180:183], v[212:215]
    v_mfma_f32_16x16x32_bf16 v[216:219], v[124:127], a[184:187], v[216:219]
    v_mfma_f32_16x16x32_bf16 v[220:223], v[124:127], a[188:191], v[220:223]
    v_mfma_f32_16x16x32_bf16 v[208:211], v[128:131], a[192:195], v[208:211]
    v_mfma_f32_16x16x32_bf16 v[212:215], v[128:131], a[196:199], v[212:215]
    v_mfma_f32_16x16x32_bf16 v[216:219], v[128:131], a[200:203], v[216:219]
    v_mfma_f32_16x16x32_bf16 v[220:223], v[128:131], a[204:207], v[220:223]
    v_mfma_f32_16x16x32_bf16 v[208:211], v[132:135], a[208:211], v[208:211]
    v_mfma_f32_16x16x32_bf16 v[212:215], v[132:135], a[212:215], v[212:215]
    v_mfma_f32_16x16x32_bf16 v[216:219], v[132:135], a[216:219], v[216:219]
    v_mfma_f32_16x16x32_bf16 v[220:223], v[132:135], a[220:223], v[220:223]
    v_mfma_f32_16x16x32_bf16 v[208:211], v[136:139], a[224:227], v[208:211]
    v_mfma_f32_16x16x32_bf16 v[212:215], v[136:139], a[228:231], v[212:215]
    v_mfma_f32_16x16x32_bf16 v[216:219], v[136:139], a[232:235], v[216:219]
    v_mfma_f32_16x16x32_bf16 v[220:223], v[136:139], a[236:239], v[220:223]
    v_mfma_f32_16x16x32_bf16 v[208:211], v[140:143], a[240:243], v[208:211]
    v_mfma_f32_16x16x32_bf16 v[212:215], v[140:143], a[244:247], v[212:215]
    v_mfma_f32_16x16x32_bf16 v[216:219], v[140:143], a[248:251], v[216:219]
    v_mfma_f32_16x16x32_bf16 v[220:223], v[140:143], a[252:255], v[220:223]
    s_nop 7
    v_cvt_pk_bf16_f32 v224, v208, v209
    v_cvt_pk_bf16_f32 v225, v210, v211
    s_mov_b32 s25, 0
    buffer_store_dwordx2 v[224:225], v11, s[48:51], s25 offen offset:128
    v_cvt_pk_bf16_f32 v226, v212, v213
    v_cvt_pk_bf16_f32 v227, v214, v215
    s_mov_b32 s25, 7168
    buffer_store_dwordx2 v[226:227], v11, s[48:51], s25 offen offset:128
    v_cvt_pk_bf16_f32 v228, v216, v217
    v_cvt_pk_bf16_f32 v229, v218, v219
    s_mov_b32 s25, 57344
    buffer_store_dwordx2 v[228:229], v11, s[48:51], s25 offen offset:128
    v_cvt_pk_bf16_f32 v230, v220, v221
    v_cvt_pk_bf16_f32 v231, v222, v223
    s_mov_b32 s25, 64512
    buffer_store_dwordx2 v[230:231], v11, s[48:51], s25 offen offset:128
    s_waitcnt vmcnt(16)
    v_mfma_f32_16x16x32_bf16 v[208:211], v[144:147], a[0:3], 0
    v_mfma_f32_16x16x32_bf16 v[212:215], v[144:147], a[4:7], 0
    v_mfma_f32_16x16x32_bf16 v[216:219], v[144:147], a[8:11], 0
    v_mfma_f32_16x16x32_bf16 v[220:223], v[144:147], a[12:15], 0
    v_mfma_f32_16x16x32_bf16 v[208:211], v[148:151], a[16:19], v[208:211]
    v_mfma_f32_16x16x32_bf16 v[212:215], v[148:151], a[20:23], v[212:215]
    v_mfma_f32_16x16x32_bf16 v[216:219], v[148:151], a[24:27], v[216:219]
    v_mfma_f32_16x16x32_bf16 v[220:223], v[148:151], a[28:31], v[220:223]
    v_mfma_f32_16x16x32_bf16 v[208:211], v[152:155], a[32:35], v[208:211]
    v_mfma_f32_16x16x32_bf16 v[212:215], v[152:155], a[36:39], v[212:215]
    v_mfma_f32_16x16x32_bf16 v[216:219], v[152:155], a[40:43], v[216:219]
    v_mfma_f32_16x16x32_bf16 v[220:223], v[152:155], a[44:47], v[220:223]
    v_mfma_f32_16x16x32_bf16 v[208:211], v[156:159], a[48:51], v[208:211]
    v_mfma_f32_16x16x32_bf16 v[212:215], v[156:159], a[52:55], v[212:215]
    v_mfma_f32_16x16x32_bf16 v[216:219], v[156:159], a[56:59], v[216:219]
    v_mfma_f32_16x16x32_bf16 v[220:223], v[156:159], a[60:63], v[220:223]
    v_mfma_f32_16x16x32_bf16 v[208:211], v[160:163], a[64:67], v[208:211]
    v_mfma_f32_16x16x32_bf16 v[212:215], v[160:163], a[68:71], v[212:215]
    v_mfma_f32_16x16x32_bf16 v[216:219], v[160:163], a[72:75], v[216:219]
    v_mfma_f32_16x16x32_bf16 v[220:223], v[160:163], a[76:79], v[220:223]
    v_mfma_f32_16x16x32_bf16 v[208:211], v[164:167], a[80:83], v[208:211]
    v_mfma_f32_16x16x32_bf16 v[212:215], v[164:167], a[84:87], v[212:215]
    v_mfma_f32_16x16x32_bf16 v[216:219], v[164:167], a[88:91], v[216:219]
    v_mfma_f32_16x16x32_bf16 v[220:223], v[164:167], a[92:95], v[220:223]
    v_mfma_f32_16x16x32_bf16 v[208:211], v[168:171], a[96:99], v[208:211]
    v_mfma_f32_16x16x32_bf16 v[212:215], v[168:171], a[100:103], v[212:215]
    v_mfma_f32_16x16x32_bf16 v[216:219], v[168:171], a[104:107], v[216:219]
    v_mfma_f32_16x16x32_bf16 v[220:223], v[168:171], a[108:111], v[220:223]
    v_mfma_f32_16x16x32_bf16 v[208:211], v[172:175], a[112:115], v[208:211]
    v_mfma_f32_16x16x32_bf16 v[212:215], v[172:175], a[116:119], v[212:215]
    v_mfma_f32_16x16x32_bf16 v[216:219], v[172:175], a[120:123], v[216:219]
    v_mfma_f32_16x16x32_bf16 v[220:223], v[172:175], a[124:127], v[220:223]
    v_mfma_f32_16x16x32_bf16 v[208:211], v[176:179], a[128:131], v[208:211]
    v_mfma_f32_16x16x32_bf16 v[212:215], v[176:179], a[132:135], v[212:215]
    v_mfma_f32_16x16x32_bf16 v[216:219], v[176:179], a[136:139], v[216:219]
    v_mfma_f32_16x16x32_bf16 v[220:223], v[176:179], a[140:143], v[220:223]
    v_mfma_f32_16x16x32_bf16 v[208:211], v[180:183], a[144:147], v[208:211]
    v_mfma_f32_16x16x32_bf16 v[212:215], v[180:183], a[148:151], v[212:215]
    v_mfma_f32_16x16x32_bf16 v[216:219], v[180:183], a[152:155], v[216:219]
    v_mfma_f32_16x16x32_bf16 v[220:223], v[180:183], a[156:159], v[220:223]
    v_mfma_f32_16x16x32_bf16 v[208:211], v[184:187], a[160:163], v[208:211]
    v_mfma_f32_16x16x32_bf16 v[212:215], v[184:187], a[164:167], v[212:215]
    v_mfma_f32_16x16x32_bf16 v[216:219], v[184:187], a[168:171], v[216:219]
    v_mfma_f32_16x16x32_bf16 v[220:223], v[184:187], a[172:175], v[220:223]
    v_mfma_f32_16x16x32_bf16 v[208:211], v[188:191], a[176:179], v[208:211]
    v_mfma_f32_16x16x32_bf16 v[212:215], v[188:191], a[180:183], v[212:215]
    v_mfma_f32_16x16x32_bf16 v[216:219], v[188:191], a[184:187], v[216:219]
    v_mfma_f32_16x16x32_bf16 v[220:223], v[188:191], a[188:191], v[220:223]
    v_mfma_f32_16x16x32_bf16 v[208:211], v[192:195], a[192:195], v[208:211]
    v_mfma_f32_16x16x32_bf16 v[212:215], v[192:195], a[196:199], v[212:215]
    v_mfma_f32_16x16x32_bf16 v[216:219], v[192:195], a[200:203], v[216:219]
    v_mfma_f32_16x16x32_bf16 v[220:223], v[192:195], a[204:207], v[220:223]
    v_mfma_f32_16x16x32_bf16 v[208:211], v[196:199], a[208:211], v[208:211]
    v_mfma_f32_16x16x32_bf16 v[212:215], v[196:199], a[212:215], v[212:215]
    v_mfma_f32_16x16x32_bf16 v[216:219], v[196:199], a[216:219], v[216:219]
    v_mfma_f32_16x16x32_bf16 v[220:223], v[196:199], a[220:223], v[220:223]
    v_mfma_f32_16x16x32_bf16 v[208:211], v[200:203], a[224:227], v[208:211]
    v_mfma_f32_16x16x32_bf16 v[212:215], v[200:203], a[228:231], v[212:215]
    v_mfma_f32_16x16x32_bf16 v[216:219], v[200:203], a[232:235], v[216:219]
    v_mfma_f32_16x16x32_bf16 v[220:223], v[200:203], a[236:239], v[220:223]
    v_mfma_f32_16x16x32_bf16 v[208:211], v[204:207], a[240:243], v[208:211]
    v_mfma_f32_16x16x32_bf16 v[212:215], v[204:207], a[244:247], v[212:215]
    v_mfma_f32_16x16x32_bf16 v[216:219], v[204:207], a[248:251], v[216:219]
    v_mfma_f32_16x16x32_bf16 v[220:223], v[204:207], a[252:255], v[220:223]
    s_nop 7
    v_cvt_pk_bf16_f32 v224, v208, v209
    v_cvt_pk_bf16_f32 v225, v210, v211
    s_mov_b32 s25, 0
    buffer_store_dwordx2 v[224:225], v11, s[48:51], s25 offen offset:160
    v_cvt_pk_bf16_f32 v226, v212, v213
    v_cvt_pk_bf16_f32 v227, v214, v215
    s_mov_b32 s25, 7168
    buffer_store_dwordx2 v[226:227], v11, s[48:51], s25 offen offset:160
    v_cvt_pk_bf16_f32 v228, v216, v217
    v_cvt_pk_bf16_f32 v229, v218, v219
    s_mov_b32 s25, 57344
    buffer_store_dwordx2 v[228:229], v11, s[48:51], s25 offen offset:160
    v_cvt_pk_bf16_f32 v230, v220, v221
    v_cvt_pk_bf16_f32 v231, v222, v223
    s_mov_b32 s25, 64512
    buffer_store_dwordx2 v[230:231], v11, s[48:51], s25 offen offset:160
    s_waitcnt vmcnt(0)
    v_mfma_f32_16x16x32_bf16 v[208:211], v[16:19], a[0:3], 0
    v_mfma_f32_16x16x32_bf16 v[212:215], v[16:19], a[4:7], 0
    v_mfma_f32_16x16x32_bf16 v[216:219], v[16:19], a[8:11], 0
    v_mfma_f32_16x16x32_bf16 v[220:223], v[16:19], a[12:15], 0
    v_mfma_f32_16x16x32_bf16 v[208:211], v[20:23], a[16:19], v[208:211]
    v_mfma_f32_16x16x32_bf16 v[212:215], v[20:23], a[20:23], v[212:215]
    v_mfma_f32_16x16x32_bf16 v[216:219], v[20:23], a[24:27], v[216:219]
    v_mfma_f32_16x16x32_bf16 v[220:223], v[20:23], a[28:31], v[220:223]
    v_mfma_f32_16x16x32_bf16 v[208:211], v[24:27], a[32:35], v[208:211]
    v_mfma_f32_16x16x32_bf16 v[212:215], v[24:27], a[36:39], v[212:215]
    v_mfma_f32_16x16x32_bf16 v[216:219], v[24:27], a[40:43], v[216:219]
    v_mfma_f32_16x16x32_bf16 v[220:223], v[24:27], a[44:47], v[220:223]
    v_mfma_f32_16x16x32_bf16 v[208:211], v[28:31], a[48:51], v[208:211]
    v_mfma_f32_16x16x32_bf16 v[212:215], v[28:31], a[52:55], v[212:215]
    v_mfma_f32_16x16x32_bf16 v[216:219], v[28:31], a[56:59], v[216:219]
    v_mfma_f32_16x16x32_bf16 v[220:223], v[28:31], a[60:63], v[220:223]
    v_mfma_f32_16x16x32_bf16 v[208:211], v[32:35], a[64:67], v[208:211]
    v_mfma_f32_16x16x32_bf16 v[212:215], v[32:35], a[68:71], v[212:215]
    v_mfma_f32_16x16x32_bf16 v[216:219], v[32:35], a[72:75], v[216:219]
    v_mfma_f32_16x16x32_bf16 v[220:223], v[32:35], a[76:79], v[220:223]
    v_mfma_f32_16x16x32_bf16 v[208:211], v[36:39], a[80:83], v[208:211]
    v_mfma_f32_16x16x32_bf16 v[212:215], v[36:39], a[84:87], v[212:215]
    v_mfma_f32_16x16x32_bf16 v[216:219], v[36:39], a[88:91], v[216:219]
    v_mfma_f32_16x16x32_bf16 v[220:223], v[36:39], a[92:95], v[220:223]
    v_mfma_f32_16x16x32_bf16 v[208:211], v[40:43], a[96:99], v[208:211]
    v_mfma_f32_16x16x32_bf16 v[212:215], v[40:43], a[100:103], v[212:215]
    v_mfma_f32_16x16x32_bf16 v[216:219], v[40:43], a[104:107], v[216:219]
    v_mfma_f32_16x16x32_bf16 v[220:223], v[40:43], a[108:111], v[220:223]
    v_mfma_f32_16x16x32_bf16 v[208:211], v[44:47], a[112:115], v[208:211]
    v_mfma_f32_16x16x32_bf16 v[212:215], v[44:47], a[116:119], v[212:215]
    v_mfma_f32_16x16x32_bf16 v[216:219], v[44:47], a[120:123], v[216:219]
    v_mfma_f32_16x16x32_bf16 v[220:223], v[44:47], a[124:127], v[220:223]
    v_mfma_f32_16x16x32_bf16 v[208:211], v[48:51], a[128:131], v[208:211]
    v_mfma_f32_16x16x32_bf16 v[212:215], v[48:51], a[132:135], v[212:215]
    v_mfma_f32_16x16x32_bf16 v[216:219], v[48:51], a[136:139], v[216:219]
    v_mfma_f32_16x16x32_bf16 v[220:223], v[48:51], a[140:143], v[220:223]
    v_mfma_f32_16x16x32_bf16 v[208:211], v[52:55], a[144:147], v[208:211]
    v_mfma_f32_16x16x32_bf16 v[212:215], v[52:55], a[148:151], v[212:215]
    v_mfma_f32_16x16x32_bf16 v[216:219], v[52:55], a[152:155], v[216:219]
    v_mfma_f32_16x16x32_bf16 v[220:223], v[52:55], a[156:159], v[220:223]
    v_mfma_f32_16x16x32_bf16 v[208:211], v[56:59], a[160:163], v[208:211]
    v_mfma_f32_16x16x32_bf16 v[212:215], v[56:59], a[164:167], v[212:215]
    v_mfma_f32_16x16x32_bf16 v[216:219], v[56:59], a[168:171], v[216:219]
    v_mfma_f32_16x16x32_bf16 v[220:223], v[56:59], a[172:175], v[220:223]
    v_mfma_f32_16x16x32_bf16 v[208:211], v[60:63], a[176:179], v[208:211]
    v_mfma_f32_16x16x32_bf16 v[212:215], v[60:63], a[180:183], v[212:215]
    v_mfma_f32_16x16x32_bf16 v[216:219], v[60:63], a[184:187], v[216:219]
    v_mfma_f32_16x16x32_bf16 v[220:223], v[60:63], a[188:191], v[220:223]
    v_mfma_f32_16x16x32_bf16 v[208:211], v[64:67], a[192:195], v[208:211]
    v_mfma_f32_16x16x32_bf16 v[212:215], v[64:67], a[196:199], v[212:215]
    v_mfma_f32_16x16x32_bf16 v[216:219], v[64:67], a[200:203], v[216:219]
    v_mfma_f32_16x16x32_bf16 v[220:223], v[64:67], a[204:207], v[220:223]
    v_mfma_f32_16x16x32_bf16 v[208:211], v[68:71], a[208:211], v[208:211]
    v_mfma_f32_16x16x32_bf16 v[212:215], v[68:71], a[212:215], v[212:215]
    v_mfma_f32_16x16x32_bf16 v[216:219], v[68:71], a[216:219], v[216:219]
    v_mfma_f32_16x16x32_bf16 v[220:223], v[68:71], a[220:223], v[220:223]
    v_mfma_f32_16x16x32_bf16 v[208:211], v[72:75], a[224:227], v[208:211]
    v_mfma_f32_16x16x32_bf16 v[212:215], v[72:75], a[228:231], v[212:215]
    v_mfma_f32_16x16x32_bf16 v[216:219], v[72:75], a[232:235], v[216:219]
    v_mfma_f32_16x16x32_bf16 v[220:223], v[72:75], a[236:239], v[220:223]
    v_mfma_f32_16x16x32_bf16 v[208:211], v[76:79], a[240:243], v[208:211]
    v_mfma_f32_16x16x32_bf16 v[212:215], v[76:79], a[244:247], v[212:215]
    v_mfma_f32_16x16x32_bf16 v[216:219], v[76:79], a[248:251], v[216:219]
    v_mfma_f32_16x16x32_bf16 v[220:223], v[76:79], a[252:255], v[220:223]
    s_nop 7
    v_cvt_pk_bf16_f32 v224, v208, v209
    v_cvt_pk_bf16_f32 v225, v210, v211
    s_mov_b32 s25, 0
    buffer_store_dwordx2 v[224:225], v11, s[48:51], s25 offen offset:192
    v_cvt_pk_bf16_f32 v226, v212, v213
    v_cvt_pk_bf16_f32 v227, v214, v215
    s_mov_b32 s25, 7168
    buffer_store_dwordx2 v[226:227], v11, s[48:51], s25 offen offset:192
    v_cvt_pk_bf16_f32 v228, v216, v217
    v_cvt_pk_bf16_f32 v229, v218, v219
    s_mov_b32 s25, 57344
    buffer_store_dwordx2 v[228:229], v11, s[48:51], s25 offen offset:192
    v_cvt_pk_bf16_f32 v230, v220, v221
    v_cvt_pk_bf16_f32 v231, v222, v223
    s_mov_b32 s25, 64512
    buffer_store_dwordx2 v[230:231], v11, s[48:51], s25 offen offset:192
    s_endpgm
Lexit2_100184:
Lcode_end:
    s_endpgm
.section .rodata,"a"
.p2align 6
.amdhsa_kernel concat_heads__linear_attn_block__memory_aug_recurrent_mem_tr__prompt_kernel
.amdhsa_next_free_vgpr 512
.amdhsa_next_free_sgpr 102
.amdhsa_accum_offset 256
.amdhsa_group_segment_fixed_size 0
.amdhsa_kernarg_size 104
.amdhsa_user_sgpr_count 2
.amdhsa_user_sgpr_kernarg_segment_ptr 1
.amdhsa_system_sgpr_workgroup_id_x 1
.end_amdhsa_kernel
.text
```
